```python
import torch

def _softmax(x, axis=-1):
    return torch.softmax(x, dim=axis)

def _gelu(x):
    return torch.nn.functional.gelu(x, approximate='tanh')

def _silu(x):
    return torch.nn.functional.silu(x)

def _sigmoid(x):
    return torch.sigmoid(x)

def _layernorm(x, axis=-1, eps=1e-05):
    m = x.mean(dim=axis, keepdim=True)
    v = x.var(dim=axis, keepdim=True, unbiased=False)
    return (x - m) / torch.sqrt(v + eps)

def _scatter_add(tgt, idx, src, axis=0):
    return tgt.clone().index_add_(axis, idx, src)

def _segment_sum(src, seg, n):
    out = torch.zeros((n,) + src.shape[1:], dtype=src.dtype)
    return out.index_add_(0, seg, src)

def _pad(x, pw):
    flat = tuple((v for pair in reversed(pw) for v in pair))
    return torch.nn.functional.pad(x, flat)
kernel_name = 'parallel_sum__sliding_local_dilated__mixer_gmlp__prompt'

def setup_inputs():

    _w = lambda a: (lambda t: t.to(torch.bfloat16) if t.is_floating_point() else t)(torch.as_tensor(a))

    def _A_setup():
        B, S, D = (1, 2048, 576)
        return {'x': _w((lambda *s: torch.randn(*s, dtype=torch.bfloat16) * 0.05)(B, S, D)), 'wqkv': _w((lambda *s: torch.randn(*s, dtype=torch.bfloat16) * 0.2)(D, 3 * D)), 'wo': _w((lambda *s: torch.randn(*s, dtype=torch.bfloat16) * 0.1)(D, D))}
    _A_in = _A_setup()

    def _B_setup():
        B, S, D, F = (1, 2048, 576, 4608)
        Fh = F // 2
        return {'x': _w((lambda *s: torch.randn(*s, dtype=torch.bfloat16) * 0.05)(B, S, D)), 'w_in': _w((lambda *s: torch.randn(*s, dtype=torch.bfloat16) * 0.8)(D, 2 * Fh)), 'w_sp': _w(0.01 * (lambda *s: torch.randn(*s, dtype=torch.bfloat16) * 0.8)(S, S)), 'b_sp': _w(1.0 + 0.01 * (lambda *s: torch.randn(*s, dtype=torch.bfloat16) * 0.05)(S)), 'w_out': _w((lambda *s: torch.randn(*s, dtype=torch.bfloat16) * 0.05)(Fh, D))}
    _B_in = _B_setup()
    return {'A_x': _A_in['x'], 'A_wqkv': _A_in['wqkv'], 'A_wo': _A_in['wo'], 'B_x': _B_in['x'], 'B_w_in': _B_in['w_in'], 'B_w_sp': _B_in['w_sp'], 'B_b_sp': _B_in['b_sp'], 'B_w_out': _B_in['w_out']}

def reference(A_x, A_wqkv, A_wo, B_x, B_w_in, B_w_sp, B_b_sp, B_w_out):

    def _A_ref(x, wqkv, wo):
        B, S, D = x.shape
        H = 32
        Dh = D // H
        W, dil = (8, 2)
        qkv = (lambda x, *d: x.permute(*d))((x @ wqkv).reshape(B, S, 3, H, Dh), 2, 0, 3, 1, 4)
        q, k, v = (qkv[0], qkv[1], qkv[2])
        scale = Dh ** (-0.5)
        pos = torch.arange(S)
        off = torch.arange(W) * dil
        idx = pos[:, None] - off[None, :]
        mask = idx >= 0
        idx_c = torch.where(mask, idx, 0).reshape(-1)
        kg = k[:, :, idx_c, :].reshape(B, H, S, W, Dh)
        vg = v[:, :, idx_c, :].reshape(B, H, S, W, Dh)
        logits = torch.einsum('bhsd,bhswd->bhsw', q, kg) * scale
        logits = torch.where(mask[None, None, :, :], logits, -1000000000.0)
        attn = _softmax(logits, axis=-1)
        o = torch.einsum('bhsw,bhswd->bhsd', attn, vg)
        return (lambda x, *d: x.permute(*d))(o, 0, 2, 1, 3).reshape(B, S, D) @ wo

    def _B_ref(x, w_in, w_sp, b_sp, w_out):
        B, S, D = x.shape
        F = w_in.shape[-1]
        Fh = F // 2
        z = _gelu(torch.einsum('bsd,df->bsf', x, w_in))
        z1 = z[..., :Fh].clone()
        z2 = _layernorm(z[..., Fh:], axis=-1)
        g = torch.einsum('ts,bsf->btf', w_sp, z2) + b_sp[None, :, None]
        return torch.einsum('bsf,fd->bsd', z1 * g, w_out)
    x = A_x
    xn = _layernorm(x, axis=-1)
    return x + _A_ref(xn, A_wqkv, A_wo) + _B_ref(xn, B_w_in, B_w_sp, B_b_sp, B_w_out)
```

```asm
; @launch grid=(256,1,1) block=(512,1,1) lds=163840
.amdgcn_target "amdgcn-amd-amdhsa--gfx950"
.text
.globl parallel_sum__sliding_local_dilated__mixer_gmlp__prompt_kernel
.p2align 8
.type parallel_sum__sliding_local_dilated__mixer_gmlp__prompt_kernel,@function
parallel_sum__sliding_local_dilated__mixer_gmlp__prompt_kernel:
    s_load_dwordx4 s[4:7], s[0:1], 0
    s_load_dwordx2 s[8:9], s[0:1], 32
    s_load_dwordx4 s[12:15], s[0:1], 72
    s_load_dwordx2 s[10:11], s[0:1], 40
    s_cmp_ge_u32 s2, 256
    s_cbranch_scc1 K1_END
    v_lshrrev_b32 v10, 6, v0
    v_and_b32 v1, 63, v0
    v_readfirstlane_b32 s50, v10
    s_and_b32 s63, s2, 7
    s_lshr_b32 s64, s2, 3
    s_and_b32 s48, s63, 1
    s_lshl_b32 s48, s48, 3
    s_and_b32 s65, s64, 7
    s_add_u32 s48, s48, s65
    s_lshr_b32 s49, s63, 1
    s_lshl_b32 s49, s49, 2
    s_lshr_b32 s64, s64, 3
    s_add_u32 s49, s49, s64
    s_lshl_b32 s64, s64, 1
    s_add_u32 s53, s64, s65
    s_sub_u32 s64, s53, 9
    s_cmp_ge_u32 s53, 9
    s_cselect_b32 s54, s64, s53
    s_and_b32 s51, s50, 3
    s_and_b32 s52, s49, 1
    s_lshl_b32 s63, s48, 7
    s_lshl_b32 s64, s51, 5
    s_add_u32 s63, s63, s64
    s_lshr_b32 s64, s50, 2
    s_mul_i32 s64, s64, 24
    s_add_u32 s63, s63, s64
    v_lshrrev_b32 v12, 3, v1
    v_and_b32 v13, 7, v1
    v_add_u32 v10, s63, v12
    v_mul_u32_u24 v10, 1152, v10
    v_lshl_add_u32 v10, v13, 4, v10
    v_add_u32 v11, 9216, v10
    v_add_u32 v14, 18432, v10
    s_add_u32 s55, s54, 1
    s_cmp_eq_u32 s55, 9
    s_cselect_b32 s55, 0, s55
    s_add_u32 s56, s55, 1
    s_cmp_eq_u32 s56, 9
    s_cselect_b32 s56, 0, s56
    s_add_u32 s57, s56, 1
    s_cmp_eq_u32 s57, 9
    s_cselect_b32 s57, 0, s57
    s_add_u32 s58, s57, 1
    s_cmp_eq_u32 s58, 9
    s_cselect_b32 s58, 0, s58
    s_add_u32 s59, s58, 1
    s_cmp_eq_u32 s59, 9
    s_cselect_b32 s59, 0, s59
    s_add_u32 s60, s59, 1
    s_cmp_eq_u32 s60, 9
    s_cselect_b32 s60, 0, s60
    s_add_u32 s61, s60, 1
    s_cmp_eq_u32 s61, 9
    s_cselect_b32 s61, 0, s61
    s_add_u32 s62, s61, 1
    s_cmp_eq_u32 s62, 9
    s_cselect_b32 s62, 0, s62
    s_lshl_b32 s69, s54, 7
    s_lshl_b32 s70, s55, 7
    s_lshl_b32 s71, s56, 7
    s_lshl_b32 s72, s57, 7
    s_lshl_b32 s73, s58, 7
    s_lshl_b32 s74, s59, 7
    s_lshl_b32 s75, s60, 7
    s_lshl_b32 s76, s61, 7
    s_lshl_b32 s77, s62, 7
    s_waitcnt lgkmcnt(0)
    s_mov_b32 s16, s4
    s_mov_b32 s17, s5
    s_mov_b32 s18, 0x240000
    s_mov_b32 s19, 0x00020000
    s_cmp_ge_u32 s50, 4
    s_cbranch_scc1 K1_HELP
    buffer_load_dwordx4 v[40:43], v10, s[16:19], s69 offen
    buffer_load_dwordx4 v[44:47], v10, s[16:19], s70 offen
    buffer_load_dwordx4 v[48:51], v10, s[16:19], s71 offen
    buffer_load_dwordx4 v[52:55], v10, s[16:19], s72 offen
    buffer_load_dwordx4 v[56:59], v10, s[16:19], s73 offen
    buffer_load_dwordx4 v[60:63], v10, s[16:19], s74 offen
    buffer_load_dwordx4 v[208:211], v10, s[16:19], s75 offen
    buffer_load_dwordx4 v[212:215], v10, s[16:19], s76 offen
    buffer_load_dwordx4 v[216:219], v10, s[16:19], s77 offen
    s_add_u32 s28, s14, 0x1200000
    s_addc_u32 s29, s15, 0
    s_mov_b32 s30, 0xb40000
    s_mov_b32 s31, 0x00020000
    s_add_u32 s36, s14, 0x900000
    s_addc_u32 s37, s15, 0
    s_mov_b32 s38, 0x900000
    s_mov_b32 s39, 0x00020000
    s_add_u32 s40, s14, 0x1d40000
    s_addc_u32 s41, s15, 0
    s_mov_b32 s42, 0xc2000
    s_mov_b32 s43, 0x00020000
    s_mov_b32 s44, s12
    s_mov_b32 s45, s13
    s_mov_b32 s46, 0x100
    s_mov_b32 s47, 0x00020000
    s_mov_b32 s79, 0x3eae1a93
    s_mov_b32 s82, 0x3f803f80
    s_mov_b32 s83, 0x3ae38e39
    v_xor_b32 v102, v12, v13
    v_and_b32 v103, 3, v1
    v_lshl_add_u32 v102, v103, 4, v102
    v_lshlrev_b32 v102, 4, v102
    v_bfe_u32 v104, v1, 2, 1
    v_lshl_add_u32 v102, v104, 10, v102
    s_mul_i32 s63, s51, 24576
    s_add_u32 s63, s63, 40960
    v_add_u32 v5, s63, v102
    v_and_b32 v101, 15, v1
    v_lshrrev_b32 v105, 4, v1
    v_xor_b32 v102, v101, v105
    v_lshl_add_u32 v102, v105, 4, v102
    v_lshlrev_b32 v6, 4, v102
    v_mul_u32_u24 v105, 2560, v105
    v_bfe_u32 v101, v1, 2, 2
    v_mul_u32_u24 v101, 320, v101
    v_lshlrev_b32 v103, 3, v103
    v_add3_u32 v4, v105, v101, v103
    s_load_dwordx2 s[20:21], s[0:1], 56
    s_load_dwordx2 s[24:25], s[0:1], 16
    s_mov_b32 s4, s10
    s_or_b32 s5, s11, 0x800000
    s_mov_b32 s6, 65536
    s_mov_b32 s7, 0x00020000
    s_mov_b32 s22, 20736
    s_mov_b32 s23, 0x00020000
    s_mov_b32 s26, 5184
    s_mov_b32 s27, 0x00020000
    s_lshl_b32 s8, s2, 15
    s_lshl_b32 s9, s51, 11
    s_add_u32 s8, s8, s9
    s_mul_i32 s9, s2, 10368
    s_mul_i32 s10, s51, 2688
    s_add_u32 s9, s9, s10
    s_min_u32 s9, s9, 2651520
    s_mul_i32 s10, s2, 2688
    s_mul_i32 s11, s51, 768
    s_add_u32 s10, s10, s11
    s_min_u32 s10, s10, 662784
    s_mov_b32 m0, 161792
    s_waitcnt lgkmcnt(0)
    s_or_b32 s21, s21, 0x800000
    s_or_b32 s25, s25, 0x800000
    s_mul_i32 s63, s51, 24576
    s_add_u32 s63, s63, 40960
    v_add_u32 v6, s63, v6
    v_xor_b32 v7, 64, v6
    s_waitcnt vmcnt(8)
    v_dot2_f32_bf16 v88, v40, s82, 0
    v_dot2_f32_bf16 v89, v40, v40, 0
    v_dot2_f32_bf16 v88, v41, s82, v88
    v_dot2_f32_bf16 v89, v41, v41, v89
    v_dot2_f32_bf16 v88, v42, s82, v88
    v_dot2_f32_bf16 v89, v42, v42, v89
    v_dot2_f32_bf16 v88, v43, s82, v88
    v_dot2_f32_bf16 v89, v43, v43, v89
    s_waitcnt vmcnt(7)
    v_dot2_f32_bf16 v88, v44, s82, v88
    v_dot2_f32_bf16 v89, v44, v44, v89
    v_dot2_f32_bf16 v88, v45, s82, v88
    v_dot2_f32_bf16 v89, v45, v45, v89
    v_dot2_f32_bf16 v88, v46, s82, v88
    v_dot2_f32_bf16 v89, v46, v46, v89
    v_dot2_f32_bf16 v88, v47, s82, v88
    v_dot2_f32_bf16 v89, v47, v47, v89
    s_waitcnt vmcnt(6)
    v_dot2_f32_bf16 v88, v48, s82, v88
    v_dot2_f32_bf16 v89, v48, v48, v89
    v_dot2_f32_bf16 v88, v49, s82, v88
    v_dot2_f32_bf16 v89, v49, v49, v89
    v_dot2_f32_bf16 v88, v50, s82, v88
    v_dot2_f32_bf16 v89, v50, v50, v89
    v_dot2_f32_bf16 v88, v51, s82, v88
    v_dot2_f32_bf16 v89, v51, v51, v89
    s_waitcnt vmcnt(5)
    v_dot2_f32_bf16 v88, v52, s82, v88
    v_dot2_f32_bf16 v89, v52, v52, v89
    v_dot2_f32_bf16 v88, v53, s82, v88
    v_dot2_f32_bf16 v89, v53, v53, v89
    v_dot2_f32_bf16 v88, v54, s82, v88
    v_dot2_f32_bf16 v89, v54, v54, v89
    v_dot2_f32_bf16 v88, v55, s82, v88
    v_dot2_f32_bf16 v89, v55, v55, v89
    s_waitcnt vmcnt(4)
    v_dot2_f32_bf16 v88, v56, s82, v88
    v_dot2_f32_bf16 v89, v56, v56, v89
    v_dot2_f32_bf16 v88, v57, s82, v88
    v_dot2_f32_bf16 v89, v57, v57, v89
    v_dot2_f32_bf16 v88, v58, s82, v88
    v_dot2_f32_bf16 v89, v58, v58, v89
    v_dot2_f32_bf16 v88, v59, s82, v88
    v_dot2_f32_bf16 v89, v59, v59, v89
    s_waitcnt vmcnt(3)
    v_dot2_f32_bf16 v88, v60, s82, v88
    v_dot2_f32_bf16 v89, v60, v60, v89
    v_dot2_f32_bf16 v88, v61, s82, v88
    v_dot2_f32_bf16 v89, v61, v61, v89
    v_dot2_f32_bf16 v88, v62, s82, v88
    v_dot2_f32_bf16 v89, v62, v62, v89
    v_dot2_f32_bf16 v88, v63, s82, v88
    v_dot2_f32_bf16 v89, v63, v63, v89
    s_waitcnt vmcnt(2)
    v_dot2_f32_bf16 v88, v208, s82, v88
    v_dot2_f32_bf16 v89, v208, v208, v89
    v_dot2_f32_bf16 v88, v209, s82, v88
    v_dot2_f32_bf16 v89, v209, v209, v89
    v_dot2_f32_bf16 v88, v210, s82, v88
    v_dot2_f32_bf16 v89, v210, v210, v89
    v_dot2_f32_bf16 v88, v211, s82, v88
    v_dot2_f32_bf16 v89, v211, v211, v89
    s_waitcnt vmcnt(1)
    v_dot2_f32_bf16 v88, v212, s82, v88
    v_dot2_f32_bf16 v89, v212, v212, v89
    v_dot2_f32_bf16 v88, v213, s82, v88
    v_dot2_f32_bf16 v89, v213, v213, v89
    v_dot2_f32_bf16 v88, v214, s82, v88
    v_dot2_f32_bf16 v89, v214, v214, v89
    v_dot2_f32_bf16 v88, v215, s82, v88
    v_dot2_f32_bf16 v89, v215, v215, v89
    s_waitcnt vmcnt(0)
    v_dot2_f32_bf16 v88, v216, s82, v88
    v_dot2_f32_bf16 v89, v216, v216, v89
    v_dot2_f32_bf16 v88, v217, s82, v88
    v_dot2_f32_bf16 v89, v217, v217, v89
    v_dot2_f32_bf16 v88, v218, s82, v88
    v_dot2_f32_bf16 v89, v218, v218, v89
    v_dot2_f32_bf16 v88, v219, s82, v88
    v_dot2_f32_bf16 v89, v219, v219, v89
    buffer_load_dwordx4 v[64:67], v11, s[16:19], s69 offen
    buffer_load_dwordx4 v[68:71], v11, s[16:19], s70 offen
    buffer_load_dwordx4 v[72:75], v11, s[16:19], s71 offen
    buffer_load_dwordx4 v[76:79], v11, s[16:19], s72 offen
    buffer_load_dwordx4 v[80:83], v11, s[16:19], s73 offen
    buffer_load_dwordx4 v[84:87], v11, s[16:19], s74 offen
    buffer_load_dwordx4 v[220:223], v11, s[16:19], s75 offen
    buffer_load_dwordx4 v[224:227], v11, s[16:19], s76 offen
    buffer_load_dwordx4 v[228:231], v11, s[16:19], s77 offen
    v_add_f32_dpp v88, v88, v88 quad_perm:[1,0,3,2] row_mask:0xf bank_mask:0xf
    v_add_f32_dpp v89, v89, v89 quad_perm:[1,0,3,2] row_mask:0xf bank_mask:0xf
    s_nop 0
    v_add_f32_dpp v88, v88, v88 quad_perm:[2,3,0,1] row_mask:0xf bank_mask:0xf
    v_add_f32_dpp v89, v89, v89 quad_perm:[2,3,0,1] row_mask:0xf bank_mask:0xf
    s_nop 0
    v_add_f32_dpp v88, v88, v88 row_half_mirror row_mask:0xf bank_mask:0xf
    v_add_f32_dpp v89, v89, v89 row_half_mirror row_mask:0xf bank_mask:0xf
    v_mul_f32 v88, s83, v88
    v_mul_f32 v94, v88, v88
    v_fma_f32 v89, v89, s83, -v94
    v_max_f32 v89, 0, v89
    v_add_f32 v89, 0x3727c5ac, v89
    v_rsq_f32 v94, v89
    s_nop 0
    v_mul_f32 v89, v88, v94
    v_sub_f32 v89, 0, v89
    v_mov_b32 v88, v94
    v_lshlrev_b32 v94, 16, v40
    v_lshlrev_b32 v96, 16, v41
    v_and_b32 v95, 0xffff0000, v40
    v_and_b32 v97, 0xffff0000, v41
    v_fma_f32 v94, v94, v88, v89
    v_fma_f32 v96, v96, v88, v89
    v_fma_f32 v95, v95, v88, v89
    v_fma_f32 v97, v97, v88, v89
    v_cvt_pk_bf16_f32 v40, v94, v95
    v_cvt_pk_bf16_f32 v41, v96, v97
    v_lshlrev_b32 v94, 16, v42
    v_lshlrev_b32 v96, 16, v43
    v_and_b32 v95, 0xffff0000, v42
    v_and_b32 v97, 0xffff0000, v43
    v_fma_f32 v94, v94, v88, v89
    v_fma_f32 v96, v96, v88, v89
    v_fma_f32 v95, v95, v88, v89
    v_fma_f32 v97, v97, v88, v89
    v_cvt_pk_bf16_f32 v42, v94, v95
    v_cvt_pk_bf16_f32 v43, v96, v97
    ds_write_b128 v5, v[40:43] offset:0
    v_lshlrev_b32 v94, 16, v44
    v_lshlrev_b32 v96, 16, v45
    v_and_b32 v95, 0xffff0000, v44
    v_and_b32 v97, 0xffff0000, v45
    v_fma_f32 v94, v94, v88, v89
    v_fma_f32 v96, v96, v88, v89
    v_fma_f32 v95, v95, v88, v89
    v_fma_f32 v97, v97, v88, v89
    v_cvt_pk_bf16_f32 v44, v94, v95
    v_cvt_pk_bf16_f32 v45, v96, v97
    v_lshlrev_b32 v94, 16, v46
    v_lshlrev_b32 v96, 16, v47
    v_and_b32 v95, 0xffff0000, v46
    v_and_b32 v97, 0xffff0000, v47
    v_fma_f32 v94, v94, v88, v89
    v_fma_f32 v96, v96, v88, v89
    v_fma_f32 v95, v95, v88, v89
    v_fma_f32 v97, v97, v88, v89
    v_cvt_pk_bf16_f32 v46, v94, v95
    v_cvt_pk_bf16_f32 v47, v96, v97
    ds_write_b128 v5, v[44:47] offset:2048
    v_lshlrev_b32 v94, 16, v48
    v_lshlrev_b32 v96, 16, v49
    v_and_b32 v95, 0xffff0000, v48
    v_and_b32 v97, 0xffff0000, v49
    v_fma_f32 v94, v94, v88, v89
    v_fma_f32 v96, v96, v88, v89
    v_fma_f32 v95, v95, v88, v89
    v_fma_f32 v97, v97, v88, v89
    v_cvt_pk_bf16_f32 v48, v94, v95
    v_cvt_pk_bf16_f32 v49, v96, v97
    v_lshlrev_b32 v94, 16, v50
    v_lshlrev_b32 v96, 16, v51
    v_and_b32 v95, 0xffff0000, v50
    v_and_b32 v97, 0xffff0000, v51
    v_fma_f32 v94, v94, v88, v89
    v_fma_f32 v96, v96, v88, v89
    v_fma_f32 v95, v95, v88, v89
    v_fma_f32 v97, v97, v88, v89
    v_cvt_pk_bf16_f32 v50, v94, v95
    v_cvt_pk_bf16_f32 v51, v96, v97
    ds_write_b128 v5, v[48:51] offset:4096
    v_lshlrev_b32 v94, 16, v52
    v_lshlrev_b32 v96, 16, v53
    v_and_b32 v95, 0xffff0000, v52
    v_and_b32 v97, 0xffff0000, v53
    v_fma_f32 v94, v94, v88, v89
    v_fma_f32 v96, v96, v88, v89
    v_fma_f32 v95, v95, v88, v89
    v_fma_f32 v97, v97, v88, v89
    v_cvt_pk_bf16_f32 v52, v94, v95
    v_cvt_pk_bf16_f32 v53, v96, v97
    v_lshlrev_b32 v94, 16, v54
    v_lshlrev_b32 v96, 16, v55
    v_and_b32 v95, 0xffff0000, v54
    v_and_b32 v97, 0xffff0000, v55
    v_fma_f32 v94, v94, v88, v89
    v_fma_f32 v96, v96, v88, v89
    v_fma_f32 v95, v95, v88, v89
    v_fma_f32 v97, v97, v88, v89
    v_cvt_pk_bf16_f32 v54, v94, v95
    v_cvt_pk_bf16_f32 v55, v96, v97
    ds_write_b128 v5, v[52:55] offset:6144
    v_lshlrev_b32 v94, 16, v56
    v_lshlrev_b32 v96, 16, v57
    v_and_b32 v95, 0xffff0000, v56
    v_and_b32 v97, 0xffff0000, v57
    v_fma_f32 v94, v94, v88, v89
    v_fma_f32 v96, v96, v88, v89
    v_fma_f32 v95, v95, v88, v89
    v_fma_f32 v97, v97, v88, v89
    v_cvt_pk_bf16_f32 v56, v94, v95
    v_cvt_pk_bf16_f32 v57, v96, v97
    v_lshlrev_b32 v94, 16, v58
    v_lshlrev_b32 v96, 16, v59
    v_and_b32 v95, 0xffff0000, v58
    v_and_b32 v97, 0xffff0000, v59
    v_fma_f32 v94, v94, v88, v89
    v_fma_f32 v96, v96, v88, v89
    v_fma_f32 v95, v95, v88, v89
    v_fma_f32 v97, v97, v88, v89
    v_cvt_pk_bf16_f32 v58, v94, v95
    v_cvt_pk_bf16_f32 v59, v96, v97
    ds_write_b128 v5, v[56:59] offset:8192
    v_lshlrev_b32 v94, 16, v60
    v_lshlrev_b32 v96, 16, v61
    v_and_b32 v95, 0xffff0000, v60
    v_and_b32 v97, 0xffff0000, v61
    v_fma_f32 v94, v94, v88, v89
    v_fma_f32 v96, v96, v88, v89
    v_fma_f32 v95, v95, v88, v89
    v_fma_f32 v97, v97, v88, v89
    v_cvt_pk_bf16_f32 v60, v94, v95
    v_cvt_pk_bf16_f32 v61, v96, v97
    v_lshlrev_b32 v94, 16, v62
    v_lshlrev_b32 v96, 16, v63
    v_and_b32 v95, 0xffff0000, v62
    v_and_b32 v97, 0xffff0000, v63
    v_fma_f32 v94, v94, v88, v89
    v_fma_f32 v96, v96, v88, v89
    v_fma_f32 v95, v95, v88, v89
    v_fma_f32 v97, v97, v88, v89
    v_cvt_pk_bf16_f32 v62, v94, v95
    v_cvt_pk_bf16_f32 v63, v96, v97
    ds_write_b128 v5, v[60:63] offset:10240
    v_lshlrev_b32 v94, 16, v208
    v_lshlrev_b32 v96, 16, v209
    v_and_b32 v95, 0xffff0000, v208
    v_and_b32 v97, 0xffff0000, v209
    v_fma_f32 v94, v94, v88, v89
    v_fma_f32 v96, v96, v88, v89
    v_fma_f32 v95, v95, v88, v89
    v_fma_f32 v97, v97, v88, v89
    v_cvt_pk_bf16_f32 v208, v94, v95
    v_cvt_pk_bf16_f32 v209, v96, v97
    v_lshlrev_b32 v94, 16, v210
    v_lshlrev_b32 v96, 16, v211
    v_and_b32 v95, 0xffff0000, v210
    v_and_b32 v97, 0xffff0000, v211
    v_fma_f32 v94, v94, v88, v89
    v_fma_f32 v96, v96, v88, v89
    v_fma_f32 v95, v95, v88, v89
    v_fma_f32 v97, v97, v88, v89
    v_cvt_pk_bf16_f32 v210, v94, v95
    v_cvt_pk_bf16_f32 v211, v96, v97
    v_lshlrev_b32 v94, 16, v212
    v_lshlrev_b32 v96, 16, v213
    v_and_b32 v95, 0xffff0000, v212
    v_and_b32 v97, 0xffff0000, v213
    v_fma_f32 v94, v94, v88, v89
    v_fma_f32 v96, v96, v88, v89
    v_fma_f32 v95, v95, v88, v89
    v_fma_f32 v97, v97, v88, v89
    v_cvt_pk_bf16_f32 v212, v94, v95
    v_cvt_pk_bf16_f32 v213, v96, v97
    v_lshlrev_b32 v94, 16, v214
    v_lshlrev_b32 v96, 16, v215
    v_and_b32 v95, 0xffff0000, v214
    v_and_b32 v97, 0xffff0000, v215
    v_fma_f32 v94, v94, v88, v89
    v_fma_f32 v96, v96, v88, v89
    v_fma_f32 v95, v95, v88, v89
    v_fma_f32 v97, v97, v88, v89
    v_cvt_pk_bf16_f32 v214, v94, v95
    v_cvt_pk_bf16_f32 v215, v96, v97
    v_lshlrev_b32 v94, 16, v216
    v_lshlrev_b32 v96, 16, v217
    v_and_b32 v95, 0xffff0000, v216
    v_and_b32 v97, 0xffff0000, v217
    v_fma_f32 v94, v94, v88, v89
    v_fma_f32 v96, v96, v88, v89
    v_fma_f32 v95, v95, v88, v89
    v_fma_f32 v97, v97, v88, v89
    v_cvt_pk_bf16_f32 v216, v94, v95
    v_cvt_pk_bf16_f32 v217, v96, v97
    v_lshlrev_b32 v94, 16, v218
    v_lshlrev_b32 v96, 16, v219
    v_and_b32 v95, 0xffff0000, v218
    v_and_b32 v97, 0xffff0000, v219
    v_fma_f32 v94, v94, v88, v89
    v_fma_f32 v96, v96, v88, v89
    v_fma_f32 v95, v95, v88, v89
    v_fma_f32 v97, v97, v88, v89
    v_cvt_pk_bf16_f32 v218, v94, v95
    v_cvt_pk_bf16_f32 v219, v96, v97
    buffer_load_dwordx4 v[16:19], v14, s[16:19], s69 offen
    buffer_load_dwordx4 v[20:23], v14, s[16:19], s70 offen
    buffer_load_dwordx4 v[24:27], v14, s[16:19], s71 offen
    buffer_load_dwordx4 v[28:31], v14, s[16:19], s72 offen
    buffer_load_dwordx4 v[32:35], v14, s[16:19], s73 offen
    buffer_load_dwordx4 v[36:39], v14, s[16:19], s74 offen
    buffer_load_dwordx4 v[232:235], v14, s[16:19], s75 offen
    buffer_load_dwordx4 v[236:239], v14, s[16:19], s76 offen
    buffer_load_dwordx4 v[240:243], v14, s[16:19], s77 offen
    s_waitcnt vmcnt(17)
    v_dot2_f32_bf16 v90, v64, s82, 0
    v_dot2_f32_bf16 v91, v64, v64, 0
    v_dot2_f32_bf16 v90, v65, s82, v90
    v_dot2_f32_bf16 v91, v65, v65, v91
    v_dot2_f32_bf16 v90, v66, s82, v90
    v_dot2_f32_bf16 v91, v66, v66, v91
    v_dot2_f32_bf16 v90, v67, s82, v90
    v_dot2_f32_bf16 v91, v67, v67, v91
    s_waitcnt vmcnt(16)
    v_dot2_f32_bf16 v90, v68, s82, v90
    v_dot2_f32_bf16 v91, v68, v68, v91
    v_dot2_f32_bf16 v90, v69, s82, v90
    v_dot2_f32_bf16 v91, v69, v69, v91
    v_dot2_f32_bf16 v90, v70, s82, v90
    v_dot2_f32_bf16 v91, v70, v70, v91
    v_dot2_f32_bf16 v90, v71, s82, v90
    v_dot2_f32_bf16 v91, v71, v71, v91
    s_waitcnt vmcnt(15)
    v_dot2_f32_bf16 v90, v72, s82, v90
    v_dot2_f32_bf16 v91, v72, v72, v91
    v_dot2_f32_bf16 v90, v73, s82, v90
    v_dot2_f32_bf16 v91, v73, v73, v91
    v_dot2_f32_bf16 v90, v74, s82, v90
    v_dot2_f32_bf16 v91, v74, v74, v91
    v_dot2_f32_bf16 v90, v75, s82, v90
    v_dot2_f32_bf16 v91, v75, v75, v91
    s_waitcnt vmcnt(14)
    v_dot2_f32_bf16 v90, v76, s82, v90
    v_dot2_f32_bf16 v91, v76, v76, v91
    v_dot2_f32_bf16 v90, v77, s82, v90
    v_dot2_f32_bf16 v91, v77, v77, v91
    v_dot2_f32_bf16 v90, v78, s82, v90
    v_dot2_f32_bf16 v91, v78, v78, v91
    v_dot2_f32_bf16 v90, v79, s82, v90
    v_dot2_f32_bf16 v91, v79, v79, v91
    s_waitcnt vmcnt(13)
    v_dot2_f32_bf16 v90, v80, s82, v90
    v_dot2_f32_bf16 v91, v80, v80, v91
    v_dot2_f32_bf16 v90, v81, s82, v90
    v_dot2_f32_bf16 v91, v81, v81, v91
    v_dot2_f32_bf16 v90, v82, s82, v90
    v_dot2_f32_bf16 v91, v82, v82, v91
    v_dot2_f32_bf16 v90, v83, s82, v90
    v_dot2_f32_bf16 v91, v83, v83, v91
    s_waitcnt vmcnt(12)
    v_dot2_f32_bf16 v90, v84, s82, v90
    v_dot2_f32_bf16 v91, v84, v84, v91
    v_dot2_f32_bf16 v90, v85, s82, v90
    v_dot2_f32_bf16 v91, v85, v85, v91
    v_dot2_f32_bf16 v90, v86, s82, v90
    v_dot2_f32_bf16 v91, v86, v86, v91
    v_dot2_f32_bf16 v90, v87, s82, v90
    v_dot2_f32_bf16 v91, v87, v87, v91
    s_waitcnt vmcnt(11)
    v_dot2_f32_bf16 v90, v220, s82, v90
    v_dot2_f32_bf16 v91, v220, v220, v91
    v_dot2_f32_bf16 v90, v221, s82, v90
    v_dot2_f32_bf16 v91, v221, v221, v91
    v_dot2_f32_bf16 v90, v222, s82, v90
    v_dot2_f32_bf16 v91, v222, v222, v91
    v_dot2_f32_bf16 v90, v223, s82, v90
    v_dot2_f32_bf16 v91, v223, v223, v91
    s_waitcnt vmcnt(10)
    v_dot2_f32_bf16 v90, v224, s82, v90
    v_dot2_f32_bf16 v91, v224, v224, v91
    v_dot2_f32_bf16 v90, v225, s82, v90
    v_dot2_f32_bf16 v91, v225, v225, v91
    v_dot2_f32_bf16 v90, v226, s82, v90
    v_dot2_f32_bf16 v91, v226, v226, v91
    v_dot2_f32_bf16 v90, v227, s82, v90
    v_dot2_f32_bf16 v91, v227, v227, v91
    s_waitcnt vmcnt(9)
    v_dot2_f32_bf16 v90, v228, s82, v90
    v_dot2_f32_bf16 v91, v228, v228, v91
    v_dot2_f32_bf16 v90, v229, s82, v90
    v_dot2_f32_bf16 v91, v229, v229, v91
    v_dot2_f32_bf16 v90, v230, s82, v90
    v_dot2_f32_bf16 v91, v230, v230, v91
    v_dot2_f32_bf16 v90, v231, s82, v90
    v_dot2_f32_bf16 v91, v231, v231, v91
    s_nop 1
    v_add_f32_dpp v90, v90, v90 quad_perm:[1,0,3,2] row_mask:0xf bank_mask:0xf
    v_add_f32_dpp v91, v91, v91 quad_perm:[1,0,3,2] row_mask:0xf bank_mask:0xf
    s_nop 0
    v_add_f32_dpp v90, v90, v90 quad_perm:[2,3,0,1] row_mask:0xf bank_mask:0xf
    v_add_f32_dpp v91, v91, v91 quad_perm:[2,3,0,1] row_mask:0xf bank_mask:0xf
    s_nop 0
    v_add_f32_dpp v90, v90, v90 row_half_mirror row_mask:0xf bank_mask:0xf
    v_add_f32_dpp v91, v91, v91 row_half_mirror row_mask:0xf bank_mask:0xf
    v_mul_f32 v90, s83, v90
    v_mul_f32 v94, v90, v90
    v_fma_f32 v91, v91, s83, -v94
    v_max_f32 v91, 0, v91
    v_add_f32 v91, 0x3727c5ac, v91
    v_rsq_f32 v94, v91
    s_nop 0
    v_mul_f32 v91, v90, v94
    v_sub_f32 v91, 0, v91
    v_mov_b32 v90, v94
    v_lshlrev_b32 v94, 16, v64
    v_lshlrev_b32 v96, 16, v65
    v_and_b32 v95, 0xffff0000, v64
    v_and_b32 v97, 0xffff0000, v65
    v_fma_f32 v94, v94, v90, v91
    v_fma_f32 v96, v96, v90, v91
    v_fma_f32 v95, v95, v90, v91
    v_fma_f32 v97, v97, v90, v91
    v_cvt_pk_bf16_f32 v64, v94, v95
    v_cvt_pk_bf16_f32 v65, v96, v97
    v_lshlrev_b32 v94, 16, v66
    v_lshlrev_b32 v96, 16, v67
    v_and_b32 v95, 0xffff0000, v66
    v_and_b32 v97, 0xffff0000, v67
    v_fma_f32 v94, v94, v90, v91
    v_fma_f32 v96, v96, v90, v91
    v_fma_f32 v95, v95, v90, v91
    v_fma_f32 v97, v97, v90, v91
    v_cvt_pk_bf16_f32 v66, v94, v95
    v_cvt_pk_bf16_f32 v67, v96, v97
    ds_write_b128 v5, v[64:67] offset:128
    v_lshlrev_b32 v94, 16, v68
    v_lshlrev_b32 v96, 16, v69
    v_and_b32 v95, 0xffff0000, v68
    v_and_b32 v97, 0xffff0000, v69
    v_fma_f32 v94, v94, v90, v91
    v_fma_f32 v96, v96, v90, v91
    v_fma_f32 v95, v95, v90, v91
    v_fma_f32 v97, v97, v90, v91
    v_cvt_pk_bf16_f32 v68, v94, v95
    v_cvt_pk_bf16_f32 v69, v96, v97
    v_lshlrev_b32 v94, 16, v70
    v_lshlrev_b32 v96, 16, v71
    v_and_b32 v95, 0xffff0000, v70
    v_and_b32 v97, 0xffff0000, v71
    v_fma_f32 v94, v94, v90, v91
    v_fma_f32 v96, v96, v90, v91
    v_fma_f32 v95, v95, v90, v91
    v_fma_f32 v97, v97, v90, v91
    v_cvt_pk_bf16_f32 v70, v94, v95
    v_cvt_pk_bf16_f32 v71, v96, v97
    ds_write_b128 v5, v[68:71] offset:2176
    v_lshlrev_b32 v94, 16, v72
    v_lshlrev_b32 v96, 16, v73
    v_and_b32 v95, 0xffff0000, v72
    v_and_b32 v97, 0xffff0000, v73
    v_fma_f32 v94, v94, v90, v91
    v_fma_f32 v96, v96, v90, v91
    v_fma_f32 v95, v95, v90, v91
    v_fma_f32 v97, v97, v90, v91
    v_cvt_pk_bf16_f32 v72, v94, v95
    v_cvt_pk_bf16_f32 v73, v96, v97
    v_lshlrev_b32 v94, 16, v74
    v_lshlrev_b32 v96, 16, v75
    v_and_b32 v95, 0xffff0000, v74
    v_and_b32 v97, 0xffff0000, v75
    v_fma_f32 v94, v94, v90, v91
    v_fma_f32 v96, v96, v90, v91
    v_fma_f32 v95, v95, v90, v91
    v_fma_f32 v97, v97, v90, v91
    v_cvt_pk_bf16_f32 v74, v94, v95
    v_cvt_pk_bf16_f32 v75, v96, v97
    ds_write_b128 v5, v[72:75] offset:4224
    v_lshlrev_b32 v94, 16, v76
    v_lshlrev_b32 v96, 16, v77
    v_and_b32 v95, 0xffff0000, v76
    v_and_b32 v97, 0xffff0000, v77
    v_fma_f32 v94, v94, v90, v91
    v_fma_f32 v96, v96, v90, v91
    v_fma_f32 v95, v95, v90, v91
    v_fma_f32 v97, v97, v90, v91
    v_cvt_pk_bf16_f32 v76, v94, v95
    v_cvt_pk_bf16_f32 v77, v96, v97
    v_lshlrev_b32 v94, 16, v78
    v_lshlrev_b32 v96, 16, v79
    v_and_b32 v95, 0xffff0000, v78
    v_and_b32 v97, 0xffff0000, v79
    v_fma_f32 v94, v94, v90, v91
    v_fma_f32 v96, v96, v90, v91
    v_fma_f32 v95, v95, v90, v91
    v_fma_f32 v97, v97, v90, v91
    v_cvt_pk_bf16_f32 v78, v94, v95
    v_cvt_pk_bf16_f32 v79, v96, v97
    ds_write_b128 v5, v[76:79] offset:6272
    v_lshlrev_b32 v94, 16, v80
    v_lshlrev_b32 v96, 16, v81
    v_and_b32 v95, 0xffff0000, v80
    v_and_b32 v97, 0xffff0000, v81
    v_fma_f32 v94, v94, v90, v91
    v_fma_f32 v96, v96, v90, v91
    v_fma_f32 v95, v95, v90, v91
    v_fma_f32 v97, v97, v90, v91
    v_cvt_pk_bf16_f32 v80, v94, v95
    v_cvt_pk_bf16_f32 v81, v96, v97
    v_lshlrev_b32 v94, 16, v82
    v_lshlrev_b32 v96, 16, v83
    v_and_b32 v95, 0xffff0000, v82
    v_and_b32 v97, 0xffff0000, v83
    v_fma_f32 v94, v94, v90, v91
    v_fma_f32 v96, v96, v90, v91
    v_fma_f32 v95, v95, v90, v91
    v_fma_f32 v97, v97, v90, v91
    v_cvt_pk_bf16_f32 v82, v94, v95
    v_cvt_pk_bf16_f32 v83, v96, v97
    ds_write_b128 v5, v[80:83] offset:8320
    v_lshlrev_b32 v94, 16, v84
    v_lshlrev_b32 v96, 16, v85
    v_and_b32 v95, 0xffff0000, v84
    v_and_b32 v97, 0xffff0000, v85
    v_fma_f32 v94, v94, v90, v91
    v_fma_f32 v96, v96, v90, v91
    v_fma_f32 v95, v95, v90, v91
    v_fma_f32 v97, v97, v90, v91
    v_cvt_pk_bf16_f32 v84, v94, v95
    v_cvt_pk_bf16_f32 v85, v96, v97
    v_lshlrev_b32 v94, 16, v86
    v_lshlrev_b32 v96, 16, v87
    v_and_b32 v95, 0xffff0000, v86
    v_and_b32 v97, 0xffff0000, v87
    v_fma_f32 v94, v94, v90, v91
    v_fma_f32 v96, v96, v90, v91
    v_fma_f32 v95, v95, v90, v91
    v_fma_f32 v97, v97, v90, v91
    v_cvt_pk_bf16_f32 v86, v94, v95
    v_cvt_pk_bf16_f32 v87, v96, v97
    ds_write_b128 v5, v[84:87] offset:10368
    v_lshlrev_b32 v94, 16, v220
    v_lshlrev_b32 v96, 16, v221
    v_and_b32 v95, 0xffff0000, v220
    v_and_b32 v97, 0xffff0000, v221
    v_fma_f32 v94, v94, v90, v91
    v_fma_f32 v96, v96, v90, v91
    v_fma_f32 v95, v95, v90, v91
    v_fma_f32 v97, v97, v90, v91
    v_cvt_pk_bf16_f32 v220, v94, v95
    v_cvt_pk_bf16_f32 v221, v96, v97
    v_lshlrev_b32 v94, 16, v222
    v_lshlrev_b32 v96, 16, v223
    v_and_b32 v95, 0xffff0000, v222
    v_and_b32 v97, 0xffff0000, v223
    v_fma_f32 v94, v94, v90, v91
    v_fma_f32 v96, v96, v90, v91
    v_fma_f32 v95, v95, v90, v91
    v_fma_f32 v97, v97, v90, v91
    v_cvt_pk_bf16_f32 v222, v94, v95
    v_cvt_pk_bf16_f32 v223, v96, v97
    v_lshlrev_b32 v94, 16, v224
    v_lshlrev_b32 v96, 16, v225
    v_and_b32 v95, 0xffff0000, v224
    v_and_b32 v97, 0xffff0000, v225
    v_fma_f32 v94, v94, v90, v91
    v_fma_f32 v96, v96, v90, v91
    v_fma_f32 v95, v95, v90, v91
    v_fma_f32 v97, v97, v90, v91
    v_cvt_pk_bf16_f32 v224, v94, v95
    v_cvt_pk_bf16_f32 v225, v96, v97
    v_lshlrev_b32 v94, 16, v226
    v_lshlrev_b32 v96, 16, v227
    v_and_b32 v95, 0xffff0000, v226
    v_and_b32 v97, 0xffff0000, v227
    v_fma_f32 v94, v94, v90, v91
    v_fma_f32 v96, v96, v90, v91
    v_fma_f32 v95, v95, v90, v91
    v_fma_f32 v97, v97, v90, v91
    v_cvt_pk_bf16_f32 v226, v94, v95
    v_cvt_pk_bf16_f32 v227, v96, v97
    v_lshlrev_b32 v94, 16, v228
    v_lshlrev_b32 v96, 16, v229
    v_and_b32 v95, 0xffff0000, v228
    v_and_b32 v97, 0xffff0000, v229
    v_fma_f32 v94, v94, v90, v91
    v_fma_f32 v96, v96, v90, v91
    v_fma_f32 v95, v95, v90, v91
    v_fma_f32 v97, v97, v90, v91
    v_cvt_pk_bf16_f32 v228, v94, v95
    v_cvt_pk_bf16_f32 v229, v96, v97
    v_lshlrev_b32 v94, 16, v230
    v_lshlrev_b32 v96, 16, v231
    v_and_b32 v95, 0xffff0000, v230
    v_and_b32 v97, 0xffff0000, v231
    v_fma_f32 v94, v94, v90, v91
    v_fma_f32 v96, v96, v90, v91
    v_fma_f32 v95, v95, v90, v91
    v_fma_f32 v97, v97, v90, v91
    v_cvt_pk_bf16_f32 v230, v94, v95
    v_cvt_pk_bf16_f32 v231, v96, v97
    s_waitcnt vmcnt(8)
    v_dot2_f32_bf16 v92, v16, s82, 0
    v_dot2_f32_bf16 v93, v16, v16, 0
    v_dot2_f32_bf16 v92, v17, s82, v92
    v_dot2_f32_bf16 v93, v17, v17, v93
    v_dot2_f32_bf16 v92, v18, s82, v92
    v_dot2_f32_bf16 v93, v18, v18, v93
    v_dot2_f32_bf16 v92, v19, s82, v92
    v_dot2_f32_bf16 v93, v19, v19, v93
    s_waitcnt vmcnt(7)
    v_dot2_f32_bf16 v92, v20, s82, v92
    v_dot2_f32_bf16 v93, v20, v20, v93
    v_dot2_f32_bf16 v92, v21, s82, v92
    v_dot2_f32_bf16 v93, v21, v21, v93
    v_dot2_f32_bf16 v92, v22, s82, v92
    v_dot2_f32_bf16 v93, v22, v22, v93
    v_dot2_f32_bf16 v92, v23, s82, v92
    v_dot2_f32_bf16 v93, v23, v23, v93
    s_waitcnt vmcnt(6)
    v_dot2_f32_bf16 v92, v24, s82, v92
    v_dot2_f32_bf16 v93, v24, v24, v93
    v_dot2_f32_bf16 v92, v25, s82, v92
    v_dot2_f32_bf16 v93, v25, v25, v93
    v_dot2_f32_bf16 v92, v26, s82, v92
    v_dot2_f32_bf16 v93, v26, v26, v93
    v_dot2_f32_bf16 v92, v27, s82, v92
    v_dot2_f32_bf16 v93, v27, v27, v93
    s_waitcnt vmcnt(5)
    v_dot2_f32_bf16 v92, v28, s82, v92
    v_dot2_f32_bf16 v93, v28, v28, v93
    v_dot2_f32_bf16 v92, v29, s82, v92
    v_dot2_f32_bf16 v93, v29, v29, v93
    v_dot2_f32_bf16 v92, v30, s82, v92
    v_dot2_f32_bf16 v93, v30, v30, v93
    v_dot2_f32_bf16 v92, v31, s82, v92
    v_dot2_f32_bf16 v93, v31, v31, v93
    s_waitcnt vmcnt(4)
    v_dot2_f32_bf16 v92, v32, s82, v92
    v_dot2_f32_bf16 v93, v32, v32, v93
    v_dot2_f32_bf16 v92, v33, s82, v92
    v_dot2_f32_bf16 v93, v33, v33, v93
    v_dot2_f32_bf16 v92, v34, s82, v92
    v_dot2_f32_bf16 v93, v34, v34, v93
    v_dot2_f32_bf16 v92, v35, s82, v92
    v_dot2_f32_bf16 v93, v35, v35, v93
    s_waitcnt vmcnt(3)
    v_dot2_f32_bf16 v92, v36, s82, v92
    v_dot2_f32_bf16 v93, v36, v36, v93
    v_dot2_f32_bf16 v92, v37, s82, v92
    v_dot2_f32_bf16 v93, v37, v37, v93
    v_dot2_f32_bf16 v92, v38, s82, v92
    v_dot2_f32_bf16 v93, v38, v38, v93
    v_dot2_f32_bf16 v92, v39, s82, v92
    v_dot2_f32_bf16 v93, v39, v39, v93
    s_waitcnt vmcnt(2)
    v_dot2_f32_bf16 v92, v232, s82, v92
    v_dot2_f32_bf16 v93, v232, v232, v93
    v_dot2_f32_bf16 v92, v233, s82, v92
    v_dot2_f32_bf16 v93, v233, v233, v93
    v_dot2_f32_bf16 v92, v234, s82, v92
    v_dot2_f32_bf16 v93, v234, v234, v93
    v_dot2_f32_bf16 v92, v235, s82, v92
    v_dot2_f32_bf16 v93, v235, v235, v93
    s_waitcnt vmcnt(1)
    v_dot2_f32_bf16 v92, v236, s82, v92
    v_dot2_f32_bf16 v93, v236, v236, v93
    v_dot2_f32_bf16 v92, v237, s82, v92
    v_dot2_f32_bf16 v93, v237, v237, v93
    v_dot2_f32_bf16 v92, v238, s82, v92
    v_dot2_f32_bf16 v93, v238, v238, v93
    v_dot2_f32_bf16 v92, v239, s82, v92
    v_dot2_f32_bf16 v93, v239, v239, v93
    s_waitcnt vmcnt(0)
    v_dot2_f32_bf16 v92, v240, s82, v92
    v_dot2_f32_bf16 v93, v240, v240, v93
    v_dot2_f32_bf16 v92, v241, s82, v92
    v_dot2_f32_bf16 v93, v241, v241, v93
    v_dot2_f32_bf16 v92, v242, s82, v92
    v_dot2_f32_bf16 v93, v242, v242, v93
    v_dot2_f32_bf16 v92, v243, s82, v92
    v_dot2_f32_bf16 v93, v243, v243, v93
    s_nop 1
    v_add_f32_dpp v92, v92, v92 quad_perm:[1,0,3,2] row_mask:0xf bank_mask:0xf
    v_add_f32_dpp v93, v93, v93 quad_perm:[1,0,3,2] row_mask:0xf bank_mask:0xf
    s_nop 0
    v_add_f32_dpp v92, v92, v92 quad_perm:[2,3,0,1] row_mask:0xf bank_mask:0xf
    v_add_f32_dpp v93, v93, v93 quad_perm:[2,3,0,1] row_mask:0xf bank_mask:0xf
    s_nop 0
    v_add_f32_dpp v92, v92, v92 row_half_mirror row_mask:0xf bank_mask:0xf
    v_add_f32_dpp v93, v93, v93 row_half_mirror row_mask:0xf bank_mask:0xf
    v_mul_f32 v92, s83, v92
    v_mul_f32 v94, v92, v92
    v_fma_f32 v93, v93, s83, -v94
    v_max_f32 v93, 0, v93
    v_add_f32 v93, 0x3727c5ac, v93
    v_rsq_f32 v94, v93
    s_nop 0
    v_mul_f32 v93, v92, v94
    v_sub_f32 v93, 0, v93
    v_mov_b32 v92, v94
    v_lshlrev_b32 v94, 16, v16
    v_lshlrev_b32 v96, 16, v17
    v_and_b32 v95, 0xffff0000, v16
    v_and_b32 v97, 0xffff0000, v17
    v_fma_f32 v94, v94, v92, v93
    v_fma_f32 v96, v96, v92, v93
    v_fma_f32 v95, v95, v92, v93
    v_fma_f32 v97, v97, v92, v93
    v_cvt_pk_bf16_f32 v16, v94, v95
    v_cvt_pk_bf16_f32 v17, v96, v97
    v_lshlrev_b32 v94, 16, v18
    v_lshlrev_b32 v96, 16, v19
    v_and_b32 v95, 0xffff0000, v18
    v_and_b32 v97, 0xffff0000, v19
    v_fma_f32 v94, v94, v92, v93
    v_fma_f32 v96, v96, v92, v93
    v_fma_f32 v95, v95, v92, v93
    v_fma_f32 v97, v97, v92, v93
    v_cvt_pk_bf16_f32 v18, v94, v95
    v_cvt_pk_bf16_f32 v19, v96, v97
    ds_write_b128 v5, v[16:19] offset:12288
    v_lshlrev_b32 v94, 16, v20
    v_lshlrev_b32 v96, 16, v21
    v_and_b32 v95, 0xffff0000, v20
    v_and_b32 v97, 0xffff0000, v21
    v_fma_f32 v94, v94, v92, v93
    v_fma_f32 v96, v96, v92, v93
    v_fma_f32 v95, v95, v92, v93
    v_fma_f32 v97, v97, v92, v93
    v_cvt_pk_bf16_f32 v20, v94, v95
    v_cvt_pk_bf16_f32 v21, v96, v97
    v_lshlrev_b32 v94, 16, v22
    v_lshlrev_b32 v96, 16, v23
    v_and_b32 v95, 0xffff0000, v22
    v_and_b32 v97, 0xffff0000, v23
    v_fma_f32 v94, v94, v92, v93
    v_fma_f32 v96, v96, v92, v93
    v_fma_f32 v95, v95, v92, v93
    v_fma_f32 v97, v97, v92, v93
    v_cvt_pk_bf16_f32 v22, v94, v95
    v_cvt_pk_bf16_f32 v23, v96, v97
    ds_write_b128 v5, v[20:23] offset:14336
    v_lshlrev_b32 v94, 16, v24
    v_lshlrev_b32 v96, 16, v25
    v_and_b32 v95, 0xffff0000, v24
    v_and_b32 v97, 0xffff0000, v25
    v_fma_f32 v94, v94, v92, v93
    v_fma_f32 v96, v96, v92, v93
    v_fma_f32 v95, v95, v92, v93
    v_fma_f32 v97, v97, v92, v93
    v_cvt_pk_bf16_f32 v24, v94, v95
    v_cvt_pk_bf16_f32 v25, v96, v97
    v_lshlrev_b32 v94, 16, v26
    v_lshlrev_b32 v96, 16, v27
    v_and_b32 v95, 0xffff0000, v26
    v_and_b32 v97, 0xffff0000, v27
    v_fma_f32 v94, v94, v92, v93
    v_fma_f32 v96, v96, v92, v93
    v_fma_f32 v95, v95, v92, v93
    v_fma_f32 v97, v97, v92, v93
    v_cvt_pk_bf16_f32 v26, v94, v95
    v_cvt_pk_bf16_f32 v27, v96, v97
    ds_write_b128 v5, v[24:27] offset:16384
    v_lshlrev_b32 v94, 16, v28
    v_lshlrev_b32 v96, 16, v29
    v_and_b32 v95, 0xffff0000, v28
    v_and_b32 v97, 0xffff0000, v29
    v_fma_f32 v94, v94, v92, v93
    v_fma_f32 v96, v96, v92, v93
    v_fma_f32 v95, v95, v92, v93
    v_fma_f32 v97, v97, v92, v93
    v_cvt_pk_bf16_f32 v28, v94, v95
    v_cvt_pk_bf16_f32 v29, v96, v97
    v_lshlrev_b32 v94, 16, v30
    v_lshlrev_b32 v96, 16, v31
    v_and_b32 v95, 0xffff0000, v30
    v_and_b32 v97, 0xffff0000, v31
    v_fma_f32 v94, v94, v92, v93
    v_fma_f32 v96, v96, v92, v93
    v_fma_f32 v95, v95, v92, v93
    v_fma_f32 v97, v97, v92, v93
    v_cvt_pk_bf16_f32 v30, v94, v95
    v_cvt_pk_bf16_f32 v31, v96, v97
    ds_write_b128 v5, v[28:31] offset:18432
    v_lshlrev_b32 v94, 16, v32
    v_lshlrev_b32 v96, 16, v33
    v_and_b32 v95, 0xffff0000, v32
    v_and_b32 v97, 0xffff0000, v33
    v_fma_f32 v94, v94, v92, v93
    v_fma_f32 v96, v96, v92, v93
    v_fma_f32 v95, v95, v92, v93
    v_fma_f32 v97, v97, v92, v93
    v_cvt_pk_bf16_f32 v32, v94, v95
    v_cvt_pk_bf16_f32 v33, v96, v97
    v_lshlrev_b32 v94, 16, v34
    v_lshlrev_b32 v96, 16, v35
    v_and_b32 v95, 0xffff0000, v34
    v_and_b32 v97, 0xffff0000, v35
    v_fma_f32 v94, v94, v92, v93
    v_fma_f32 v96, v96, v92, v93
    v_fma_f32 v95, v95, v92, v93
    v_fma_f32 v97, v97, v92, v93
    v_cvt_pk_bf16_f32 v34, v94, v95
    v_cvt_pk_bf16_f32 v35, v96, v97
    ds_write_b128 v5, v[32:35] offset:20480
    v_lshlrev_b32 v94, 16, v36
    v_lshlrev_b32 v96, 16, v37
    v_and_b32 v95, 0xffff0000, v36
    v_and_b32 v97, 0xffff0000, v37
    v_fma_f32 v94, v94, v92, v93
    v_fma_f32 v96, v96, v92, v93
    v_fma_f32 v95, v95, v92, v93
    v_fma_f32 v97, v97, v92, v93
    v_cvt_pk_bf16_f32 v36, v94, v95
    v_cvt_pk_bf16_f32 v37, v96, v97
    v_lshlrev_b32 v94, 16, v38
    v_lshlrev_b32 v96, 16, v39
    v_and_b32 v95, 0xffff0000, v38
    v_and_b32 v97, 0xffff0000, v39
    v_fma_f32 v94, v94, v92, v93
    v_fma_f32 v96, v96, v92, v93
    v_fma_f32 v95, v95, v92, v93
    v_fma_f32 v97, v97, v92, v93
    v_cvt_pk_bf16_f32 v38, v94, v95
    v_cvt_pk_bf16_f32 v39, v96, v97
    ds_write_b128 v5, v[36:39] offset:22528
    s_waitcnt lgkmcnt(0)
    s_barrier
    ds_read_b128 v[112:115], v6 offset:0
    ds_read_b128 v[116:119], v6 offset:12288
    ds_read_b128 v[120:123], v7 offset:1024
    ds_read_b128 v[124:127], v7 offset:13312
    ds_read_b128 v[128:131], v6 offset:2048
    ds_read_b128 v[132:135], v6 offset:14336
    ds_read_b128 v[136:139], v7 offset:3072
    ds_read_b128 v[140:143], v7 offset:15360
    ds_read_b128 v[144:147], v6 offset:4096
    ds_read_b128 v[148:151], v6 offset:16384
    ds_read_b128 v[152:155], v7 offset:5120
    ds_read_b128 v[156:159], v7 offset:17408
    ds_read_b128 v[160:163], v6 offset:6144
    ds_read_b128 v[164:167], v6 offset:18432
    ds_read_b128 v[168:171], v7 offset:7168
    ds_read_b128 v[172:175], v7 offset:19456
    ds_read_b128 v[176:179], v6 offset:8192
    ds_read_b128 v[180:183], v6 offset:20480
    ds_read_b128 v[184:187], v7 offset:9216
    ds_read_b128 v[188:191], v7 offset:21504
    ds_read_b128 v[192:195], v6 offset:10240
    ds_read_b128 v[196:199], v6 offset:22528
    ds_read_b128 v[200:203], v7 offset:11264
    ds_read_b128 v[204:207], v7 offset:23552
    v_lshlrev_b32 v94, 16, v232
    v_lshlrev_b32 v96, 16, v233
    v_and_b32 v95, 0xffff0000, v232
    v_and_b32 v97, 0xffff0000, v233
    v_fma_f32 v94, v94, v92, v93
    v_fma_f32 v96, v96, v92, v93
    v_fma_f32 v95, v95, v92, v93
    v_fma_f32 v97, v97, v92, v93
    v_cvt_pk_bf16_f32 v232, v94, v95
    v_cvt_pk_bf16_f32 v233, v96, v97
    v_lshlrev_b32 v94, 16, v234
    v_lshlrev_b32 v96, 16, v235
    v_and_b32 v95, 0xffff0000, v234
    v_and_b32 v97, 0xffff0000, v235
    v_fma_f32 v94, v94, v92, v93
    v_fma_f32 v96, v96, v92, v93
    v_fma_f32 v95, v95, v92, v93
    v_fma_f32 v97, v97, v92, v93
    v_cvt_pk_bf16_f32 v234, v94, v95
    v_cvt_pk_bf16_f32 v235, v96, v97
    v_lshlrev_b32 v94, 16, v236
    v_lshlrev_b32 v96, 16, v237
    v_and_b32 v95, 0xffff0000, v236
    v_and_b32 v97, 0xffff0000, v237
    v_fma_f32 v94, v94, v92, v93
    v_fma_f32 v96, v96, v92, v93
    v_fma_f32 v95, v95, v92, v93
    v_fma_f32 v97, v97, v92, v93
    v_cvt_pk_bf16_f32 v236, v94, v95
    v_cvt_pk_bf16_f32 v237, v96, v97
    v_lshlrev_b32 v94, 16, v238
    v_lshlrev_b32 v96, 16, v239
    v_and_b32 v95, 0xffff0000, v238
    v_and_b32 v97, 0xffff0000, v239
    v_fma_f32 v94, v94, v92, v93
    v_fma_f32 v96, v96, v92, v93
    v_fma_f32 v95, v95, v92, v93
    v_fma_f32 v97, v97, v92, v93
    v_cvt_pk_bf16_f32 v238, v94, v95
    v_cvt_pk_bf16_f32 v239, v96, v97
    v_lshlrev_b32 v94, 16, v240
    v_lshlrev_b32 v96, 16, v241
    v_and_b32 v95, 0xffff0000, v240
    v_and_b32 v97, 0xffff0000, v241
    v_fma_f32 v94, v94, v92, v93
    v_fma_f32 v96, v96, v92, v93
    v_fma_f32 v95, v95, v92, v93
    v_fma_f32 v97, v97, v92, v93
    v_cvt_pk_bf16_f32 v240, v94, v95
    v_cvt_pk_bf16_f32 v241, v96, v97
    v_lshlrev_b32 v94, 16, v242
    v_lshlrev_b32 v96, 16, v243
    v_and_b32 v95, 0xffff0000, v242
    v_and_b32 v97, 0xffff0000, v243
    v_fma_f32 v94, v94, v92, v93
    v_fma_f32 v96, v96, v92, v93
    v_fma_f32 v95, v95, v92, v93
    v_fma_f32 v97, v97, v92, v93
    v_cvt_pk_bf16_f32 v242, v94, v95
    v_cvt_pk_bf16_f32 v243, v96, v97
    s_mul_i32 s63, s51, -12288
    s_add_u32 s63, s63, 40960
    v_add_u32 v5, s63, v5
    s_mul_i32 s63, s51, -12288
    s_add_u32 s63, s63, 40960
    s_waitcnt lgkmcnt(0)
    s_barrier
    v_add_u32 v6, s63, v6
    v_add_u32 v7, s63, v7
    s_setprio 2
    v_bfe_u32 v15, v1, 4, 1
    v_lshlrev_b32 v15, 5, v15
    s_cmp_eq_u32 s52, 0
    s_cselect_b32 s98, 1, -1
    s_lshl_b32 s99, s52, 5
    v_mul_lo_u32 v15, v15, s98
    v_add3_u32 v2, v4, v15, s99
    v_sub_u32 v3, v4, v15
    v_add_u32 v3, s99, v3
    ds_read_b64_tr_b16 v[16:17], v2 offset:0
    ds_read_b64_tr_b16 v[18:19], v2 offset:1280
    ds_read_b64_tr_b16 v[20:21], v3 offset:32
    ds_read_b64_tr_b16 v[22:23], v3 offset:1312
    ds_read_b64_tr_b16 v[24:25], v2 offset:64
    ds_read_b64_tr_b16 v[26:27], v2 offset:1344
    ds_read_b64_tr_b16 v[28:29], v3 offset:96
    ds_read_b64_tr_b16 v[30:31], v3 offset:1376
    s_waitcnt lgkmcnt(4)
    v_mfma_f32_16x16x32_bf16 v[40:43], v[16:19], v[112:115], 0
    ds_read_b64_tr_b16 v[32:33], v2 offset:128
    v_mfma_f32_16x16x32_bf16 v[44:47], v[16:19], v[116:119], 0
    ds_read_b64_tr_b16 v[34:35], v2 offset:1408
    ds_write_b128 v5, v[208:211] offset:0
    v_mfma_f32_16x16x32_bf16 v[48:51], v[20:23], v[112:115], 0
    ds_read_b64_tr_b16 v[16:17], v3 offset:160
    v_mfma_f32_16x16x32_bf16 v[52:55], v[20:23], v[116:119], 0
    ds_read_b64_tr_b16 v[18:19], v3 offset:1440
    ds_write_b128 v5, v[220:223] offset:128
    s_waitcnt lgkmcnt(6)
    v_mfma_f32_16x16x32_bf16 v[56:59], v[24:27], v[112:115], 0
    ds_read_b64_tr_b16 v[20:21], v2 offset:192
    v_mfma_f32_16x16x32_bf16 v[60:63], v[24:27], v[116:119], 0
    ds_read_b64_tr_b16 v[22:23], v2 offset:1472
    ds_write_b128 v5, v[232:235] offset:6144
    v_mfma_f32_16x16x32_bf16 v[64:67], v[28:31], v[112:115], 0
    ds_read_b64_tr_b16 v[24:25], v3 offset:224
    v_mfma_f32_16x16x32_bf16 v[68:71], v[28:31], v[116:119], 0
    ds_read_b64_tr_b16 v[26:27], v3 offset:1504
    ds_write_b128 v5, v[212:215] offset:2048
    s_waitcnt lgkmcnt(7)
    v_mfma_f32_16x16x32_bf16 v[72:75], v[32:35], v[112:115], 0
    ds_read_b64_tr_b16 v[28:29], v2 offset:256
    v_mfma_f32_16x16x32_bf16 v[76:79], v[32:35], v[116:119], 0
    ds_read_b64_tr_b16 v[30:31], v2 offset:1536
    ds_write_b128 v5, v[224:227] offset:2176
    v_mfma_f32_16x16x32_bf16 v[80:83], v[16:19], v[112:115], 0
    ds_read_b64_tr_b16 v[32:33], v2 offset:10240
    v_mfma_f32_16x16x32_bf16 v[84:87], v[16:19], v[116:119], 0
    ds_read_b64_tr_b16 v[34:35], v2 offset:11520
    ds_write_b128 v5, v[236:239] offset:8192
    s_waitcnt lgkmcnt(7)
    v_mfma_f32_16x16x32_bf16 v[88:91], v[20:23], v[112:115], 0
    ds_read_b64_tr_b16 v[16:17], v3 offset:10272
    v_mfma_f32_16x16x32_bf16 v[92:95], v[20:23], v[116:119], 0
    ds_read_b64_tr_b16 v[18:19], v3 offset:11552
    ds_write_b128 v5, v[216:219] offset:4096
    v_mfma_f32_16x16x32_bf16 v[96:99], v[24:27], v[112:115], 0
    ds_read_b64_tr_b16 v[20:21], v2 offset:10304
    v_mfma_f32_16x16x32_bf16 v[100:103], v[24:27], v[116:119], 0
    ds_read_b64_tr_b16 v[22:23], v2 offset:11584
    ds_write_b128 v5, v[228:231] offset:4224
    s_waitcnt lgkmcnt(7)
    v_mfma_f32_16x16x32_bf16 v[104:107], v[28:31], v[112:115], 0
    ds_read_b64_tr_b16 v[24:25], v3 offset:10336
    v_mfma_f32_16x16x32_bf16 v[108:111], v[28:31], v[116:119], 0
    ds_read_b64_tr_b16 v[26:27], v3 offset:11616
    ds_write_b128 v5, v[240:243] offset:10240
    v_mfma_f32_16x16x32_bf16 v[40:43], v[32:35], v[120:123], v[40:43]
    ds_read_b64_tr_b16 v[28:29], v2 offset:10368
    v_mfma_f32_16x16x32_bf16 v[44:47], v[32:35], v[124:127], v[44:47]
    ds_read_b64_tr_b16 v[30:31], v2 offset:11648
    s_waitcnt lgkmcnt(6)
    v_mfma_f32_16x16x32_bf16 v[48:51], v[16:19], v[120:123], v[48:51]
    ds_read_b64_tr_b16 v[32:33], v3 offset:10400
    v_mfma_f32_16x16x32_bf16 v[52:55], v[16:19], v[124:127], v[52:55]
    ds_read_b64_tr_b16 v[34:35], v3 offset:11680
    v_mfma_f32_16x16x32_bf16 v[56:59], v[20:23], v[120:123], v[56:59]
    ds_read_b64_tr_b16 v[16:17], v2 offset:10432
    v_mfma_f32_16x16x32_bf16 v[60:63], v[20:23], v[124:127], v[60:63]
    ds_read_b64_tr_b16 v[18:19], v2 offset:11712
    s_waitcnt lgkmcnt(4)
    v_mfma_f32_16x16x32_bf16 v[64:67], v[24:27], v[120:123], v[64:67]
    ds_read_b64_tr_b16 v[20:21], v3 offset:10464
    v_mfma_f32_16x16x32_bf16 v[68:71], v[24:27], v[124:127], v[68:71]
    ds_read_b64_tr_b16 v[22:23], v3 offset:11744
    v_mfma_f32_16x16x32_bf16 v[72:75], v[28:31], v[120:123], v[72:75]
    ds_read_b64_tr_b16 v[24:25], v2 offset:10496
    v_mfma_f32_16x16x32_bf16 v[76:79], v[28:31], v[124:127], v[76:79]
    ds_read_b64_tr_b16 v[26:27], v2 offset:11776
    s_waitcnt lgkmcnt(4)
    v_mfma_f32_16x16x32_bf16 v[80:83], v[32:35], v[120:123], v[80:83]
    s_barrier
    ds_read_b64_tr_b16 v[28:29], v2 offset:20480
    v_mfma_f32_16x16x32_bf16 v[84:87], v[32:35], v[124:127], v[84:87]
    ds_read_b64_tr_b16 v[30:31], v2 offset:21760
    v_mfma_f32_16x16x32_bf16 v[88:91], v[16:19], v[120:123], v[88:91]
    ds_read_b64_tr_b16 v[32:33], v3 offset:20512
    v_mfma_f32_16x16x32_bf16 v[92:95], v[16:19], v[124:127], v[92:95]
    ds_read_b64_tr_b16 v[34:35], v3 offset:21792
    s_waitcnt lgkmcnt(4)
    v_mfma_f32_16x16x32_bf16 v[96:99], v[20:23], v[120:123], v[96:99]
    ds_read_b64_tr_b16 v[16:17], v2 offset:20544
    v_mfma_f32_16x16x32_bf16 v[100:103], v[20:23], v[124:127], v[100:103]
    ds_read_b64_tr_b16 v[18:19], v2 offset:21824
    v_mfma_f32_16x16x32_bf16 v[104:107], v[24:27], v[120:123], v[104:107]
    ds_read_b64_tr_b16 v[20:21], v3 offset:20576
    v_mfma_f32_16x16x32_bf16 v[108:111], v[24:27], v[124:127], v[108:111]
    ds_read_b64_tr_b16 v[22:23], v3 offset:21856
    s_waitcnt lgkmcnt(4)
    v_mfma_f32_16x16x32_bf16 v[40:43], v[28:31], v[128:131], v[40:43]
    ds_read_b64_tr_b16 v[24:25], v2 offset:20608
    v_mfma_f32_16x16x32_bf16 v[44:47], v[28:31], v[132:135], v[44:47]
    ds_read_b64_tr_b16 v[26:27], v2 offset:21888
    v_mfma_f32_16x16x32_bf16 v[48:51], v[32:35], v[128:131], v[48:51]
    ds_read_b64_tr_b16 v[28:29], v3 offset:20640
    v_mfma_f32_16x16x32_bf16 v[52:55], v[32:35], v[132:135], v[52:55]
    ds_read_b64_tr_b16 v[30:31], v3 offset:21920
    ds_read_b128 v[208:211], v6 offset:0
    s_waitcnt lgkmcnt(5)
    v_mfma_f32_16x16x32_bf16 v[56:59], v[16:19], v[128:131], v[56:59]
    ds_read_b64_tr_b16 v[32:33], v2 offset:20672
    s_cmp_lg_u32 s51, 0
    s_cbranch_scc1 K1_NOCZ
    s_lshl_b32 s64, s48, 14
    s_lshl_b32 s65, s49, 10
    s_add_u32 s64, s64, s65
    s_add_u32 s64, s64, 532480
    v_lshlrev_b32 v12, 3, v1
    v_mov_b32 v14, 0
    v_mov_b32 v15, 0
    buffer_store_dwordx2 v[14:15], v12, s[40:43], s64 offen sc1
K1_NOCZ:
    v_mfma_f32_16x16x32_bf16 v[60:63], v[16:19], v[132:135], v[60:63]
    ds_read_b64_tr_b16 v[34:35], v2 offset:21952
    ds_read_b128 v[212:215], v6 offset:6144
    v_mfma_f32_16x16x32_bf16 v[64:67], v[20:23], v[128:131], v[64:67]
    ds_read_b64_tr_b16 v[16:17], v3 offset:20704
    v_mfma_f32_16x16x32_bf16 v[68:71], v[20:23], v[132:135], v[68:71]
    ds_read_b64_tr_b16 v[18:19], v3 offset:21984
    ds_read_b128 v[216:219], v7 offset:1024
    s_waitcnt lgkmcnt(7)
    v_mfma_f32_16x16x32_bf16 v[72:75], v[24:27], v[128:131], v[72:75]
    ds_read_b64_tr_b16 v[20:21], v2 offset:20736
    v_mfma_f32_16x16x32_bf16 v[76:79], v[24:27], v[132:135], v[76:79]
    ds_read_b64_tr_b16 v[22:23], v2 offset:22016
    ds_read_b128 v[220:223], v7 offset:7168
    v_mfma_f32_16x16x32_bf16 v[80:83], v[28:31], v[128:131], v[80:83]
    ds_read_b64_tr_b16 v[24:25], v2 offset:30720
    v_mfma_f32_16x16x32_bf16 v[84:87], v[28:31], v[132:135], v[84:87]
    ds_read_b64_tr_b16 v[26:27], v2 offset:32000
    ds_read_b128 v[224:227], v6 offset:2048
    s_waitcnt lgkmcnt(7)
    v_mfma_f32_16x16x32_bf16 v[88:91], v[32:35], v[128:131], v[88:91]
    ds_read_b64_tr_b16 v[28:29], v3 offset:30752
    v_mfma_f32_16x16x32_bf16 v[92:95], v[32:35], v[132:135], v[92:95]
    ds_read_b64_tr_b16 v[30:31], v3 offset:32032
    ds_read_b128 v[228:231], v6 offset:8192
    v_mfma_f32_16x16x32_bf16 v[96:99], v[16:19], v[128:131], v[96:99]
    ds_read_b64_tr_b16 v[32:33], v2 offset:30784
    v_mfma_f32_16x16x32_bf16 v[100:103], v[16:19], v[132:135], v[100:103]
    ds_read_b64_tr_b16 v[34:35], v2 offset:32064
    ds_read_b128 v[232:235], v7 offset:3072
    s_waitcnt lgkmcnt(7)
    v_mfma_f32_16x16x32_bf16 v[104:107], v[20:23], v[128:131], v[104:107]
    ds_read_b64_tr_b16 v[16:17], v3 offset:30816
    v_mfma_f32_16x16x32_bf16 v[108:111], v[20:23], v[132:135], v[108:111]
    ds_read_b64_tr_b16 v[18:19], v3 offset:32096
    ds_read_b128 v[236:239], v7 offset:9216
    v_mfma_f32_16x16x32_bf16 v[40:43], v[24:27], v[136:139], v[40:43]
    ds_read_b64_tr_b16 v[20:21], v2 offset:30848
    v_mfma_f32_16x16x32_bf16 v[44:47], v[24:27], v[140:143], v[44:47]
    ds_read_b64_tr_b16 v[22:23], v2 offset:32128
    ds_read_b128 v[240:243], v6 offset:4096
    s_waitcnt lgkmcnt(7)
    v_mfma_f32_16x16x32_bf16 v[48:51], v[28:31], v[136:139], v[48:51]
    ds_read_b64_tr_b16 v[24:25], v3 offset:30880
    v_mfma_f32_16x16x32_bf16 v[52:55], v[28:31], v[140:143], v[52:55]
    ds_read_b64_tr_b16 v[26:27], v3 offset:32160
    ds_read_b128 v[244:247], v6 offset:10240
    v_mfma_f32_16x16x32_bf16 v[56:59], v[32:35], v[136:139], v[56:59]
    ds_read_b64_tr_b16 v[28:29], v2 offset:30912
    v_mfma_f32_16x16x32_bf16 v[60:63], v[32:35], v[140:143], v[60:63]
    ds_read_b64_tr_b16 v[30:31], v2 offset:32192
    ds_read_b128 v[248:251], v7 offset:5120
    s_waitcnt lgkmcnt(7)
    v_mfma_f32_16x16x32_bf16 v[64:67], v[16:19], v[136:139], v[64:67]
    ds_read_b64_tr_b16 v[32:33], v3 offset:30944
    v_mfma_f32_16x16x32_bf16 v[68:71], v[16:19], v[140:143], v[68:71]
    ds_read_b64_tr_b16 v[34:35], v3 offset:32224
    ds_read_b128 v[252:255], v7 offset:11264
    v_mfma_f32_16x16x32_bf16 v[72:75], v[20:23], v[136:139], v[72:75]
    ds_read_b64_tr_b16 v[16:17], v2 offset:30976
    v_mfma_f32_16x16x32_bf16 v[76:79], v[20:23], v[140:143], v[76:79]
    ds_read_b64_tr_b16 v[18:19], v2 offset:32256
    s_waitcnt lgkmcnt(6)
    v_mfma_f32_16x16x32_bf16 v[80:83], v[24:27], v[136:139], v[80:83]
    s_barrier
    v_add_u32 v2, 40960, v2
    ds_read_b64_tr_b16 v[20:21], v2 offset:0
    v_mfma_f32_16x16x32_bf16 v[84:87], v[24:27], v[140:143], v[84:87]
    ds_read_b64_tr_b16 v[22:23], v2 offset:1280
    v_mfma_f32_16x16x32_bf16 v[88:91], v[28:31], v[136:139], v[88:91]
    v_add_u32 v3, 40960, v3
    ds_read_b64_tr_b16 v[24:25], v3 offset:32
    v_mfma_f32_16x16x32_bf16 v[92:95], v[28:31], v[140:143], v[92:95]
    ds_read_b64_tr_b16 v[26:27], v3 offset:1312
    s_waitcnt lgkmcnt(4)
    v_mfma_f32_16x16x32_bf16 v[96:99], v[32:35], v[136:139], v[96:99]
    ds_read_b64_tr_b16 v[28:29], v2 offset:64
    v_mfma_f32_16x16x32_bf16 v[100:103], v[32:35], v[140:143], v[100:103]
    ds_read_b64_tr_b16 v[30:31], v2 offset:1344
    v_mfma_f32_16x16x32_bf16 v[104:107], v[16:19], v[136:139], v[104:107]
    ds_read_b64_tr_b16 v[32:33], v3 offset:96
    v_mfma_f32_16x16x32_bf16 v[108:111], v[16:19], v[140:143], v[108:111]
    ds_read_b64_tr_b16 v[34:35], v3 offset:1376
    s_waitcnt lgkmcnt(4)
    v_mfma_f32_16x16x32_bf16 v[40:43], v[20:23], v[144:147], v[40:43]
    ds_read_b64_tr_b16 v[16:17], v2 offset:128
    v_mfma_f32_16x16x32_bf16 v[44:47], v[20:23], v[148:151], v[44:47]
    ds_read_b64_tr_b16 v[18:19], v2 offset:1408
    v_mfma_f32_16x16x32_bf16 v[48:51], v[24:27], v[144:147], v[48:51]
    ds_read_b64_tr_b16 v[20:21], v3 offset:160
    v_mfma_f32_16x16x32_bf16 v[52:55], v[24:27], v[148:151], v[52:55]
    ds_read_b64_tr_b16 v[22:23], v3 offset:1440
    s_waitcnt lgkmcnt(4)
    v_mfma_f32_16x16x32_bf16 v[56:59], v[28:31], v[144:147], v[56:59]
    ds_read_b64_tr_b16 v[24:25], v2 offset:192
    v_mfma_f32_16x16x32_bf16 v[60:63], v[28:31], v[148:151], v[60:63]
    ds_read_b64_tr_b16 v[26:27], v2 offset:1472
    v_mfma_f32_16x16x32_bf16 v[64:67], v[32:35], v[144:147], v[64:67]
    ds_read_b64_tr_b16 v[28:29], v3 offset:224
    v_mfma_f32_16x16x32_bf16 v[68:71], v[32:35], v[148:151], v[68:71]
    ds_read_b64_tr_b16 v[30:31], v3 offset:1504
    s_waitcnt lgkmcnt(4)
    v_mfma_f32_16x16x32_bf16 v[72:75], v[16:19], v[144:147], v[72:75]
    ds_read_b64_tr_b16 v[32:33], v2 offset:256
    v_mfma_f32_16x16x32_bf16 v[76:79], v[16:19], v[148:151], v[76:79]
    ds_read_b64_tr_b16 v[34:35], v2 offset:1536
    v_mfma_f32_16x16x32_bf16 v[80:83], v[20:23], v[144:147], v[80:83]
    ds_read_b64_tr_b16 v[16:17], v2 offset:10240
    v_mfma_f32_16x16x32_bf16 v[84:87], v[20:23], v[148:151], v[84:87]
    ds_read_b64_tr_b16 v[18:19], v2 offset:11520
    s_waitcnt lgkmcnt(4)
    v_mfma_f32_16x16x32_bf16 v[88:91], v[24:27], v[144:147], v[88:91]
    ds_read_b64_tr_b16 v[20:21], v3 offset:10272
    v_mfma_f32_16x16x32_bf16 v[92:95], v[24:27], v[148:151], v[92:95]
    ds_read_b64_tr_b16 v[22:23], v3 offset:11552
    v_mfma_f32_16x16x32_bf16 v[96:99], v[28:31], v[144:147], v[96:99]
    ds_read_b64_tr_b16 v[24:25], v2 offset:10304
    v_mfma_f32_16x16x32_bf16 v[100:103], v[28:31], v[148:151], v[100:103]
    ds_read_b64_tr_b16 v[26:27], v2 offset:11584
    s_waitcnt lgkmcnt(4)
    v_mfma_f32_16x16x32_bf16 v[104:107], v[32:35], v[144:147], v[104:107]
    ds_read_b64_tr_b16 v[28:29], v3 offset:10336
    v_mfma_f32_16x16x32_bf16 v[108:111], v[32:35], v[148:151], v[108:111]
    ds_read_b64_tr_b16 v[30:31], v3 offset:11616
    v_mfma_f32_16x16x32_bf16 v[40:43], v[16:19], v[152:155], v[40:43]
    ds_read_b64_tr_b16 v[32:33], v2 offset:10368
    v_mfma_f32_16x16x32_bf16 v[44:47], v[16:19], v[156:159], v[44:47]
    ds_read_b64_tr_b16 v[34:35], v2 offset:11648
    s_waitcnt lgkmcnt(4)
    v_mfma_f32_16x16x32_bf16 v[48:51], v[20:23], v[152:155], v[48:51]
    ds_read_b64_tr_b16 v[16:17], v3 offset:10400
    v_mfma_f32_16x16x32_bf16 v[52:55], v[20:23], v[156:159], v[52:55]
    ds_read_b64_tr_b16 v[18:19], v3 offset:11680
    v_mfma_f32_16x16x32_bf16 v[56:59], v[24:27], v[152:155], v[56:59]
    ds_read_b64_tr_b16 v[20:21], v2 offset:10432
    v_mfma_f32_16x16x32_bf16 v[60:63], v[24:27], v[156:159], v[60:63]
    ds_read_b64_tr_b16 v[22:23], v2 offset:11712
    s_waitcnt lgkmcnt(4)
    v_mfma_f32_16x16x32_bf16 v[64:67], v[28:31], v[152:155], v[64:67]
    ds_read_b64_tr_b16 v[24:25], v3 offset:10464
    v_mfma_f32_16x16x32_bf16 v[68:71], v[28:31], v[156:159], v[68:71]
    ds_read_b64_tr_b16 v[26:27], v3 offset:11744
    v_mfma_f32_16x16x32_bf16 v[72:75], v[32:35], v[152:155], v[72:75]
    ds_read_b64_tr_b16 v[28:29], v2 offset:10496
    v_mfma_f32_16x16x32_bf16 v[76:79], v[32:35], v[156:159], v[76:79]
    ds_read_b64_tr_b16 v[30:31], v2 offset:11776
    s_waitcnt lgkmcnt(4)
    v_mfma_f32_16x16x32_bf16 v[80:83], v[16:19], v[152:155], v[80:83]
    s_barrier
    ds_read_b64_tr_b16 v[32:33], v2 offset:20480
    v_mfma_f32_16x16x32_bf16 v[84:87], v[16:19], v[156:159], v[84:87]
    ds_read_b64_tr_b16 v[34:35], v2 offset:21760
    v_mfma_f32_16x16x32_bf16 v[88:91], v[20:23], v[152:155], v[88:91]
    ds_read_b64_tr_b16 v[16:17], v3 offset:20512
    v_mfma_f32_16x16x32_bf16 v[92:95], v[20:23], v[156:159], v[92:95]
    ds_read_b64_tr_b16 v[18:19], v3 offset:21792
    s_waitcnt lgkmcnt(4)
    v_mfma_f32_16x16x32_bf16 v[96:99], v[24:27], v[152:155], v[96:99]
    ds_read_b64_tr_b16 v[20:21], v2 offset:20544
    v_mfma_f32_16x16x32_bf16 v[100:103], v[24:27], v[156:159], v[100:103]
    ds_read_b64_tr_b16 v[22:23], v2 offset:21824
    v_mfma_f32_16x16x32_bf16 v[104:107], v[28:31], v[152:155], v[104:107]
    ds_read_b64_tr_b16 v[24:25], v3 offset:20576
    v_mfma_f32_16x16x32_bf16 v[108:111], v[28:31], v[156:159], v[108:111]
    ds_read_b64_tr_b16 v[26:27], v3 offset:21856
    s_waitcnt lgkmcnt(4)
    v_mfma_f32_16x16x32_bf16 v[40:43], v[32:35], v[160:163], v[40:43]
    ds_read_b64_tr_b16 v[28:29], v2 offset:20608
    v_and_b32 v10, 15, v1
    v_mfma_f32_16x16x32_bf16 v[44:47], v[32:35], v[164:167], v[44:47]
    ds_read_b64_tr_b16 v[30:31], v2 offset:21888
    s_lshl_b32 s98, s51, 5
    v_add_u32 v10, s98, v10
    v_mfma_f32_16x16x32_bf16 v[48:51], v[16:19], v[160:163], v[48:51]
    ds_read_b64_tr_b16 v[32:33], v3 offset:20640
    v_mul_u32_u24 v11, 240, v10
    v_mfma_f32_16x16x32_bf16 v[52:55], v[16:19], v[164:167], v[52:55]
    ds_read_b64_tr_b16 v[34:35], v3 offset:21920
    v_mul_u32_u24 v10, 296, v10
    s_waitcnt lgkmcnt(4)
    v_mfma_f32_16x16x32_bf16 v[56:59], v[20:23], v[160:163], v[56:59]
    ds_read_b64_tr_b16 v[16:17], v2 offset:20672
    v_lshrrev_b32 v12, 4, v1
    v_mfma_f32_16x16x32_bf16 v[60:63], v[20:23], v[164:167], v[60:63]
    ds_read_b64_tr_b16 v[18:19], v2 offset:21952
    v_lshlrev_b32 v12, 3, v12
    v_mfma_f32_16x16x32_bf16 v[64:67], v[24:27], v[160:163], v[64:67]
    ds_read_b64_tr_b16 v[20:21], v3 offset:20704
    s_mov_b32 s98, 81920
    v_add3_u32 v10, v10, v12, s98
    v_mfma_f32_16x16x32_bf16 v[68:71], v[24:27], v[164:167], v[68:71]
    ds_read_b64_tr_b16 v[22:23], v3 offset:21984
    s_mov_b32 s98, 119808
    v_add3_u32 v11, v11, v12, s98
    s_waitcnt lgkmcnt(4)
    v_mfma_f32_16x16x32_bf16 v[72:75], v[28:31], v[160:163], v[72:75]
    ds_read_b64_tr_b16 v[24:25], v2 offset:20736
    v_bfe_u32 v15, v1, 4, 1
    v_mfma_f32_16x16x32_bf16 v[76:79], v[28:31], v[164:167], v[76:79]
    ds_read_b64_tr_b16 v[26:27], v2 offset:22016
    v_lshlrev_b32 v15, 5, v15
    v_mfma_f32_16x16x32_bf16 v[80:83], v[32:35], v[160:163], v[80:83]
    ds_read_b64_tr_b16 v[28:29], v2 offset:30720
    s_mul_i32 s98, s49, 72
    s_and_b32 s98, s98, 31
    v_add3_u32 v5, v4, v15, s98
    v_mfma_f32_16x16x32_bf16 v[84:87], v[32:35], v[164:167], v[84:87]
    ds_read_b64_tr_b16 v[30:31], v2 offset:32000
    v_and_b32 v15, 3, v1
    s_waitcnt lgkmcnt(4)
    v_mfma_f32_16x16x32_bf16 v[88:91], v[16:19], v[160:163], v[88:91]
    ds_read_b64_tr_b16 v[32:33], v3 offset:30752
    v_cmp_le_u32 vcc, 2, v15
    v_mfma_f32_16x16x32_bf16 v[92:95], v[16:19], v[164:167], v[92:95]
    ds_read_b64_tr_b16 v[34:35], v3 offset:32032
    v_cndmask_b32 v14, 0, 24, vcc
    v_mfma_f32_16x16x32_bf16 v[96:99], v[20:23], v[160:163], v[96:99]
    ds_read_b64_tr_b16 v[16:17], v2 offset:30784
    v_add_u32 v14, 152, v14
    v_mfma_f32_16x16x32_bf16 v[100:103], v[20:23], v[164:167], v[100:103]
    ds_read_b64_tr_b16 v[18:19], v2 offset:32064
    v_add_u32 v8, v5, v14
    s_waitcnt lgkmcnt(4)
    v_mfma_f32_16x16x32_bf16 v[104:107], v[24:27], v[160:163], v[104:107]
    ds_read_b64_tr_b16 v[20:21], v3 offset:30816
    v_cmp_le_u32 vcc, 1, v15
    v_mfma_f32_16x16x32_bf16 v[108:111], v[24:27], v[164:167], v[108:111]
    ds_read_b64_tr_b16 v[22:23], v3 offset:32096
    v_cndmask_b32 v14, 0, 24, vcc
    v_mfma_f32_16x16x32_bf16 v[40:43], v[28:31], v[168:171], v[40:43]
    ds_read_b64_tr_b16 v[24:25], v2 offset:30848
    v_add_u32 v14, 64, v14
    v_mfma_f32_16x16x32_bf16 v[44:47], v[28:31], v[172:175], v[44:47]
    ds_read_b64_tr_b16 v[26:27], v2 offset:32128
    v_add_u32 v6, v5, v14
    s_waitcnt lgkmcnt(4)
    v_mfma_f32_16x16x32_bf16 v[48:51], v[32:35], v[168:171], v[48:51]
    ds_read_b64_tr_b16 v[28:29], v3 offset:30880
    s_lshl_b32 s69, s51, 5
    s_cmp_eq_u32 s51, 3
    s_cselect_b32 s99, 24, 0
    s_add_u32 s99, s99, s69
    v_add_u32 v7, s99, v5
    v_mfma_f32_16x16x32_bf16 v[52:55], v[32:35], v[172:175], v[52:55]
    ds_read_b64_tr_b16 v[30:31], v3 offset:32160
    s_cmp_eq_u32 s51, 2
    s_cselect_b64 vcc, -1, 0
    v_cndmask_b32 v7, v7, v6, vcc
    v_mfma_f32_16x16x32_bf16 v[56:59], v[16:19], v[168:171], v[56:59]
    ds_read_b64_tr_b16 v[32:33], v2 offset:30912
    v_and_b32 v14, 15, v1
    v_mfma_f32_16x16x32_bf16 v[60:63], v[16:19], v[172:175], v[60:63]
    ds_read_b64_tr_b16 v[34:35], v2 offset:32192
    v_lshrrev_b32 v15, 4, v1
    s_waitcnt lgkmcnt(4)
    v_mfma_f32_16x16x32_bf16 v[64:67], v[20:23], v[168:171], v[64:67]
    ds_read_b64_tr_b16 v[16:17], v3 offset:30944
    v_xor_b32 v14, v14, v15
    v_mfma_f32_16x16x32_bf16 v[68:71], v[20:23], v[172:175], v[68:71]
    ds_read_b64_tr_b16 v[18:19], v3 offset:32224
    v_lshl_add_u32 v14, v15, 4, v14
    v_mfma_f32_16x16x32_bf16 v[72:75], v[24:27], v[168:171], v[72:75]
    ds_read_b64_tr_b16 v[20:21], v2 offset:30976
    v_lshlrev_b32 v14, 4, v14
    v_mfma_f32_16x16x32_bf16 v[76:79], v[24:27], v[172:175], v[76:79]
    ds_read_b64_tr_b16 v[22:23], v2 offset:32256
    v_add_u32 v9, 143360, v14
    s_waitcnt lgkmcnt(4)
    v_mfma_f32_16x16x32_bf16 v[80:83], v[28:31], v[168:171], v[80:83]
    s_barrier
    v_add_u32 v2, -40960, v2
    ds_read_b64_tr_b16 v[24:25], v2 offset:0
    s_mov_b32 s78, 0xc0135761
    v_mov_b32 v0, 0xbdd2d3e8
    v_mfma_f32_16x16x32_bf16 v[84:87], v[28:31], v[172:175], v[84:87]
    ds_read_b64_tr_b16 v[26:27], v2 offset:1280
    v_mfma_f32_16x16x32_bf16 v[88:91], v[32:35], v[168:171], v[88:91]
    v_add_u32 v3, -40960, v3
    ds_read_b64_tr_b16 v[28:29], v3 offset:32
    v_mfma_f32_16x16x32_bf16 v[92:95], v[32:35], v[172:175], v[92:95]
    ds_read_b64_tr_b16 v[30:31], v3 offset:1312
    s_waitcnt lgkmcnt(4)
    v_mfma_f32_16x16x32_bf16 v[96:99], v[16:19], v[168:171], v[96:99]
    ds_read_b64_tr_b16 v[32:33], v2 offset:64
    v_mfma_f32_16x16x32_bf16 v[100:103], v[16:19], v[172:175], v[100:103]
    ds_read_b64_tr_b16 v[34:35], v2 offset:1344
    v_mfma_f32_16x16x32_bf16 v[104:107], v[20:23], v[168:171], v[104:107]
    ds_read_b64_tr_b16 v[16:17], v3 offset:96
    v_mfma_f32_16x16x32_bf16 v[108:111], v[20:23], v[172:175], v[108:111]
    ds_read_b64_tr_b16 v[18:19], v3 offset:1376
    s_waitcnt lgkmcnt(4)
    v_mfma_f32_16x16x32_bf16 v[40:43], v[24:27], v[176:179], v[40:43]
    ds_read_b64_tr_b16 v[20:21], v2 offset:128
    v_mfma_f32_16x16x32_bf16 v[44:47], v[24:27], v[180:183], v[44:47]
    ds_read_b64_tr_b16 v[22:23], v2 offset:1408
    v_mfma_f32_16x16x32_bf16 v[48:51], v[28:31], v[176:179], v[48:51]
    ds_read_b64_tr_b16 v[24:25], v3 offset:160
    v_mfma_f32_16x16x32_bf16 v[52:55], v[28:31], v[180:183], v[52:55]
    ds_read_b64_tr_b16 v[26:27], v3 offset:1440
    s_waitcnt lgkmcnt(4)
    v_mfma_f32_16x16x32_bf16 v[56:59], v[32:35], v[176:179], v[56:59]
    ds_read_b64_tr_b16 v[28:29], v2 offset:192
    v_mfma_f32_16x16x32_bf16 v[60:63], v[32:35], v[180:183], v[60:63]
    ds_read_b64_tr_b16 v[30:31], v2 offset:1472
    v_mfma_f32_16x16x32_bf16 v[64:67], v[16:19], v[176:179], v[64:67]
    ds_read_b64_tr_b16 v[32:33], v3 offset:224
    v_mfma_f32_16x16x32_bf16 v[68:71], v[16:19], v[180:183], v[68:71]
    ds_read_b64_tr_b16 v[34:35], v3 offset:1504
    s_waitcnt lgkmcnt(4)
    v_mfma_f32_16x16x32_bf16 v[72:75], v[20:23], v[176:179], v[72:75]
    ds_read_b64_tr_b16 v[16:17], v2 offset:256
    v_mfma_f32_16x16x32_bf16 v[76:79], v[20:23], v[180:183], v[76:79]
    ds_read_b64_tr_b16 v[18:19], v2 offset:1536
    v_mfma_f32_16x16x32_bf16 v[80:83], v[24:27], v[176:179], v[80:83]
    ds_read_b64_tr_b16 v[20:21], v2 offset:10240
    v_mfma_f32_16x16x32_bf16 v[84:87], v[24:27], v[180:183], v[84:87]
    ds_read_b64_tr_b16 v[22:23], v2 offset:11520
    s_waitcnt lgkmcnt(4)
    v_mfma_f32_16x16x32_bf16 v[88:91], v[28:31], v[176:179], v[88:91]
    ds_read_b64_tr_b16 v[24:25], v3 offset:10272
    v_mfma_f32_16x16x32_bf16 v[92:95], v[28:31], v[180:183], v[92:95]
    ds_read_b64_tr_b16 v[26:27], v3 offset:11552
    v_mfma_f32_16x16x32_bf16 v[96:99], v[32:35], v[176:179], v[96:99]
    ds_read_b64_tr_b16 v[28:29], v2 offset:10304
    v_mfma_f32_16x16x32_bf16 v[100:103], v[32:35], v[180:183], v[100:103]
    ds_read_b64_tr_b16 v[30:31], v2 offset:11584
    s_waitcnt lgkmcnt(4)
    v_mfma_f32_16x16x32_bf16 v[104:107], v[16:19], v[176:179], v[104:107]
    ds_read_b64_tr_b16 v[32:33], v3 offset:10336
    v_mfma_f32_16x16x32_bf16 v[108:111], v[16:19], v[180:183], v[108:111]
    ds_read_b64_tr_b16 v[34:35], v3 offset:11616
    v_mfma_f32_16x16x32_bf16 v[40:43], v[20:23], v[184:187], v[40:43]
    ds_read_b64_tr_b16 v[16:17], v2 offset:10368
    v_mfma_f32_16x16x32_bf16 v[44:47], v[20:23], v[188:191], v[44:47]
    ds_read_b64_tr_b16 v[18:19], v2 offset:11648
    s_waitcnt lgkmcnt(4)
    v_mfma_f32_16x16x32_bf16 v[48:51], v[24:27], v[184:187], v[48:51]
    ds_read_b64_tr_b16 v[20:21], v3 offset:10400
    v_mfma_f32_16x16x32_bf16 v[52:55], v[24:27], v[188:191], v[52:55]
    ds_read_b64_tr_b16 v[22:23], v3 offset:11680
    v_mfma_f32_16x16x32_bf16 v[56:59], v[28:31], v[184:187], v[56:59]
    ds_read_b64_tr_b16 v[24:25], v2 offset:10432
    v_mfma_f32_16x16x32_bf16 v[60:63], v[28:31], v[188:191], v[60:63]
    ds_read_b64_tr_b16 v[26:27], v2 offset:11712
    s_waitcnt lgkmcnt(4)
    v_mfma_f32_16x16x32_bf16 v[64:67], v[32:35], v[184:187], v[64:67]
    ds_read_b64_tr_b16 v[28:29], v3 offset:10464
    v_mfma_f32_16x16x32_bf16 v[68:71], v[32:35], v[188:191], v[68:71]
    ds_read_b64_tr_b16 v[30:31], v3 offset:11744
    v_mfma_f32_16x16x32_bf16 v[72:75], v[16:19], v[184:187], v[72:75]
    ds_read_b64_tr_b16 v[32:33], v2 offset:10496
    v_mfma_f32_16x16x32_bf16 v[76:79], v[16:19], v[188:191], v[76:79]
    ds_read_b64_tr_b16 v[34:35], v2 offset:11776
    s_waitcnt lgkmcnt(4)
    v_mfma_f32_16x16x32_bf16 v[80:83], v[20:23], v[184:187], v[80:83]
    s_barrier
    ds_read_b64_tr_b16 v[16:17], v2 offset:20480
    v_mfma_f32_16x16x32_bf16 v[84:87], v[20:23], v[188:191], v[84:87]
    ds_read_b64_tr_b16 v[18:19], v2 offset:21760
    v_mfma_f32_16x16x32_bf16 v[88:91], v[24:27], v[184:187], v[88:91]
    ds_read_b64_tr_b16 v[20:21], v3 offset:20512
    v_mfma_f32_16x16x32_bf16 v[92:95], v[24:27], v[188:191], v[92:95]
    ds_read_b64_tr_b16 v[22:23], v3 offset:21792
    s_waitcnt lgkmcnt(4)
    v_mfma_f32_16x16x32_bf16 v[96:99], v[28:31], v[184:187], v[96:99]
    ds_read_b64_tr_b16 v[24:25], v2 offset:20544
    v_mfma_f32_16x16x32_bf16 v[100:103], v[28:31], v[188:191], v[100:103]
    ds_read_b64_tr_b16 v[26:27], v2 offset:21824
    v_mfma_f32_16x16x32_bf16 v[104:107], v[32:35], v[184:187], v[104:107]
    ds_read_b64_tr_b16 v[28:29], v3 offset:20576
    v_mfma_f32_16x16x32_bf16 v[108:111], v[32:35], v[188:191], v[108:111]
    ds_read_b64_tr_b16 v[30:31], v3 offset:21856
    s_waitcnt lgkmcnt(4)
    v_mfma_f32_16x16x32_bf16 v[40:43], v[16:19], v[192:195], v[40:43]
    ds_read_b64_tr_b16 v[32:33], v2 offset:20608
    v_mfma_f32_16x16x32_bf16 v[44:47], v[16:19], v[196:199], v[44:47]
    ds_read_b64_tr_b16 v[34:35], v2 offset:21888
    v_mfma_f32_16x16x32_bf16 v[48:51], v[20:23], v[192:195], v[48:51]
    ds_read_b64_tr_b16 v[16:17], v3 offset:20640
    v_mfma_f32_16x16x32_bf16 v[52:55], v[20:23], v[196:199], v[52:55]
    ds_read_b64_tr_b16 v[18:19], v3 offset:21920
    s_waitcnt lgkmcnt(4)
    v_mfma_f32_16x16x32_bf16 v[56:59], v[24:27], v[192:195], v[56:59]
    ds_read_b64_tr_b16 v[20:21], v2 offset:20672
    v_mfma_f32_16x16x32_bf16 v[60:63], v[24:27], v[196:199], v[60:63]
    ds_read_b64_tr_b16 v[22:23], v2 offset:21952
    v_mfma_f32_16x16x32_bf16 v[64:67], v[28:31], v[192:195], v[64:67]
    ds_read_b64_tr_b16 v[24:25], v3 offset:20704
    v_mfma_f32_16x16x32_bf16 v[68:71], v[28:31], v[196:199], v[68:71]
    ds_read_b64_tr_b16 v[26:27], v3 offset:21984
    s_waitcnt lgkmcnt(4)
    v_mfma_f32_16x16x32_bf16 v[72:75], v[32:35], v[192:195], v[72:75]
    ds_read_b64_tr_b16 v[28:29], v2 offset:20736
    v_mfma_f32_16x16x32_bf16 v[76:79], v[32:35], v[196:199], v[76:79]
    ds_read_b64_tr_b16 v[30:31], v2 offset:22016
    v_mfma_f32_16x16x32_bf16 v[80:83], v[16:19], v[192:195], v[80:83]
    ds_read_b64_tr_b16 v[32:33], v2 offset:30720
    v_mfma_f32_16x16x32_bf16 v[84:87], v[16:19], v[196:199], v[84:87]
    ds_read_b64_tr_b16 v[34:35], v2 offset:32000
    s_waitcnt lgkmcnt(4)
    v_mfma_f32_16x16x32_bf16 v[88:91], v[20:23], v[192:195], v[88:91]
    ds_read_b64_tr_b16 v[16:17], v3 offset:30752
    v_mfma_f32_16x16x32_bf16 v[92:95], v[20:23], v[196:199], v[92:95]
    ds_read_b64_tr_b16 v[18:19], v3 offset:32032
    v_mfma_f32_16x16x32_bf16 v[96:99], v[24:27], v[192:195], v[96:99]
    ds_read_b64_tr_b16 v[20:21], v2 offset:30784
    v_mfma_f32_16x16x32_bf16 v[100:103], v[24:27], v[196:199], v[100:103]
    ds_read_b64_tr_b16 v[22:23], v2 offset:32064
    s_waitcnt lgkmcnt(4)
    v_mfma_f32_16x16x32_bf16 v[104:107], v[28:31], v[192:195], v[104:107]
    ds_read_b64_tr_b16 v[24:25], v3 offset:30816
    v_mfma_f32_16x16x32_bf16 v[108:111], v[28:31], v[196:199], v[108:111]
    ds_read_b64_tr_b16 v[26:27], v3 offset:32096
    v_mfma_f32_16x16x32_bf16 v[40:43], v[32:35], v[200:203], v[40:43]
    ds_read_b64_tr_b16 v[28:29], v2 offset:30848
    s_mov_b64 exec, 0xffff
    buffer_load_dword v1, s[4:7], s8 idxen lds
    s_mov_b64 exec, -1
    s_add_u32 s8, s8, 8192
    v_mfma_f32_16x16x32_bf16 v[44:47], v[32:35], v[204:207], v[44:47]
    ds_read_b64_tr_b16 v[30:31], v2 offset:32128
    s_waitcnt lgkmcnt(4)
    v_mfma_f32_16x16x32_bf16 v[48:51], v[16:19], v[200:203], v[48:51]
    ds_read_b64_tr_b16 v[32:33], v3 offset:30880
    v_mfma_f32_16x16x32_bf16 v[52:55], v[16:19], v[204:207], v[52:55]
    ds_read_b64_tr_b16 v[34:35], v3 offset:32160
    v_mfma_f32_16x16x32_bf16 v[56:59], v[20:23], v[200:203], v[56:59]
    ds_read_b64_tr_b16 v[16:17], v2 offset:30912
    v_mfma_f32_16x16x32_bf16 v[60:63], v[20:23], v[204:207], v[60:63]
    ds_read_b64_tr_b16 v[18:19], v2 offset:32192
    s_waitcnt lgkmcnt(4)
    v_mfma_f32_16x16x32_bf16 v[64:67], v[24:27], v[200:203], v[64:67]
    ds_read_b64_tr_b16 v[20:21], v3 offset:30944
    v_mfma_f32_16x16x32_bf16 v[68:71], v[24:27], v[204:207], v[68:71]
    ds_read_b64_tr_b16 v[22:23], v3 offset:32224
    v_mfma_f32_16x16x32_bf16 v[72:75], v[28:31], v[200:203], v[72:75]
    ds_read_b64_tr_b16 v[24:25], v2 offset:30976
    v_mfma_f32_16x16x32_bf16 v[76:79], v[28:31], v[204:207], v[76:79]
    ds_read_b64_tr_b16 v[26:27], v2 offset:32256
    s_waitcnt lgkmcnt(4)
    v_mfma_f32_16x16x32_bf16 v[80:83], v[32:35], v[200:203], v[80:83]
    s_barrier
    v_add_u32 v2, 40960, v2
    ds_read_b64_tr_b16 v[28:29], v2 offset:0
    v_mfma_f32_16x16x32_bf16 v[84:87], v[32:35], v[204:207], v[84:87]
    ds_read_b64_tr_b16 v[30:31], v2 offset:1280
    v_mfma_f32_16x16x32_bf16 v[88:91], v[16:19], v[200:203], v[88:91]
    v_add_u32 v3, 40960, v3
    ds_read_b64_tr_b16 v[32:33], v3 offset:32
    v_mfma_f32_16x16x32_bf16 v[92:95], v[16:19], v[204:207], v[92:95]
    ds_read_b64_tr_b16 v[34:35], v3 offset:1312
    s_waitcnt lgkmcnt(4)
    v_mfma_f32_16x16x32_bf16 v[96:99], v[20:23], v[200:203], v[96:99]
    ds_read_b64_tr_b16 v[16:17], v2 offset:64
    v_mfma_f32_16x16x32_bf16 v[100:103], v[20:23], v[204:207], v[100:103]
    ds_read_b64_tr_b16 v[18:19], v2 offset:1344
    v_mfma_f32_16x16x32_bf16 v[104:107], v[24:27], v[200:203], v[104:107]
    ds_read_b64_tr_b16 v[20:21], v3 offset:96
    v_mfma_f32_16x16x32_bf16 v[108:111], v[24:27], v[204:207], v[108:111]
    ds_read_b64_tr_b16 v[22:23], v3 offset:1376
    s_waitcnt lgkmcnt(4)
    v_mfma_f32_16x16x32_bf16 v[40:43], v[28:31], v[208:211], v[40:43]
    ds_read_b64_tr_b16 v[24:25], v2 offset:128
    v_mfma_f32_16x16x32_bf16 v[44:47], v[28:31], v[212:215], v[44:47]
    ds_read_b64_tr_b16 v[26:27], v2 offset:1408
    v_mfma_f32_16x16x32_bf16 v[48:51], v[32:35], v[208:211], v[48:51]
    ds_read_b64_tr_b16 v[28:29], v3 offset:160
    v_mfma_f32_16x16x32_bf16 v[52:55], v[32:35], v[212:215], v[52:55]
    ds_read_b64_tr_b16 v[30:31], v3 offset:1440
    s_waitcnt lgkmcnt(4)
    v_mfma_f32_16x16x32_bf16 v[56:59], v[16:19], v[208:211], v[56:59]
    ds_read_b64_tr_b16 v[32:33], v2 offset:192
    v_mfma_f32_16x16x32_bf16 v[60:63], v[16:19], v[212:215], v[60:63]
    ds_read_b64_tr_b16 v[34:35], v2 offset:1472
    v_mfma_f32_16x16x32_bf16 v[64:67], v[20:23], v[208:211], v[64:67]
    ds_read_b64_tr_b16 v[16:17], v3 offset:224
    v_mfma_f32_16x16x32_bf16 v[68:71], v[20:23], v[212:215], v[68:71]
    ds_read_b64_tr_b16 v[18:19], v3 offset:1504
    s_waitcnt lgkmcnt(4)
    v_mfma_f32_16x16x32_bf16 v[72:75], v[24:27], v[208:211], v[72:75]
    ds_read_b64_tr_b16 v[20:21], v2 offset:256
    v_mfma_f32_16x16x32_bf16 v[76:79], v[24:27], v[212:215], v[76:79]
    ds_read_b64_tr_b16 v[22:23], v2 offset:1536
    v_mfma_f32_16x16x32_bf16 v[80:83], v[28:31], v[208:211], v[80:83]
    ds_read_b64_tr_b16 v[24:25], v2 offset:10240
    v_mfma_f32_16x16x32_bf16 v[84:87], v[28:31], v[212:215], v[84:87]
    ds_read_b64_tr_b16 v[26:27], v2 offset:11520
    s_waitcnt lgkmcnt(4)
    v_mfma_f32_16x16x32_bf16 v[88:91], v[32:35], v[208:211], v[88:91]
    ds_read_b64_tr_b16 v[28:29], v3 offset:10272
    v_mfma_f32_16x16x32_bf16 v[92:95], v[32:35], v[212:215], v[92:95]
    ds_read_b64_tr_b16 v[30:31], v3 offset:11552
    v_mfma_f32_16x16x32_bf16 v[96:99], v[16:19], v[208:211], v[96:99]
    ds_read_b64_tr_b16 v[32:33], v2 offset:10304
    v_mfma_f32_16x16x32_bf16 v[100:103], v[16:19], v[212:215], v[100:103]
    ds_read_b64_tr_b16 v[34:35], v2 offset:11584
    s_waitcnt lgkmcnt(4)
    v_mfma_f32_16x16x32_bf16 v[104:107], v[20:23], v[208:211], v[104:107]
    ds_read_b64_tr_b16 v[16:17], v3 offset:10336
    v_mfma_f32_16x16x32_bf16 v[108:111], v[20:23], v[212:215], v[108:111]
    ds_read_b64_tr_b16 v[18:19], v3 offset:11616
    v_mfma_f32_16x16x32_bf16 v[40:43], v[24:27], v[216:219], v[40:43]
    ds_read_b64_tr_b16 v[20:21], v2 offset:10368
    v_mfma_f32_16x16x32_bf16 v[44:47], v[24:27], v[220:223], v[44:47]
    ds_read_b64_tr_b16 v[22:23], v2 offset:11648
    s_waitcnt lgkmcnt(4)
    v_mfma_f32_16x16x32_bf16 v[48:51], v[28:31], v[216:219], v[48:51]
    ds_read_b64_tr_b16 v[24:25], v3 offset:10400
    v_mfma_f32_16x16x32_bf16 v[52:55], v[28:31], v[220:223], v[52:55]
    ds_read_b64_tr_b16 v[26:27], v3 offset:11680
    v_mfma_f32_16x16x32_bf16 v[56:59], v[32:35], v[216:219], v[56:59]
    ds_read_b64_tr_b16 v[28:29], v2 offset:10432
    v_mfma_f32_16x16x32_bf16 v[60:63], v[32:35], v[220:223], v[60:63]
    ds_read_b64_tr_b16 v[30:31], v2 offset:11712
    s_waitcnt lgkmcnt(4)
    v_mfma_f32_16x16x32_bf16 v[64:67], v[16:19], v[216:219], v[64:67]
    ds_read_b64_tr_b16 v[32:33], v3 offset:10464
    v_mfma_f32_16x16x32_bf16 v[68:71], v[16:19], v[220:223], v[68:71]
    ds_read_b64_tr_b16 v[34:35], v3 offset:11744
    v_mfma_f32_16x16x32_bf16 v[72:75], v[20:23], v[216:219], v[72:75]
    ds_read_b64_tr_b16 v[16:17], v2 offset:10496
    v_mfma_f32_16x16x32_bf16 v[76:79], v[20:23], v[220:223], v[76:79]
    ds_read_b64_tr_b16 v[18:19], v2 offset:11776
    s_waitcnt lgkmcnt(4)
    v_mfma_f32_16x16x32_bf16 v[80:83], v[24:27], v[216:219], v[80:83]
    s_barrier
    ds_read_b64_tr_b16 v[20:21], v2 offset:20480
    v_mfma_f32_16x16x32_bf16 v[84:87], v[24:27], v[220:223], v[84:87]
    ds_read_b64_tr_b16 v[22:23], v2 offset:21760
    v_mfma_f32_16x16x32_bf16 v[88:91], v[28:31], v[216:219], v[88:91]
    ds_read_b64_tr_b16 v[24:25], v3 offset:20512
    v_mfma_f32_16x16x32_bf16 v[92:95], v[28:31], v[220:223], v[92:95]
    ds_read_b64_tr_b16 v[26:27], v3 offset:21792
    s_waitcnt lgkmcnt(4)
    v_mfma_f32_16x16x32_bf16 v[96:99], v[32:35], v[216:219], v[96:99]
    ds_read_b64_tr_b16 v[28:29], v2 offset:20544
    v_mfma_f32_16x16x32_bf16 v[100:103], v[32:35], v[220:223], v[100:103]
    ds_read_b64_tr_b16 v[30:31], v2 offset:21824
    v_mfma_f32_16x16x32_bf16 v[104:107], v[16:19], v[216:219], v[104:107]
    ds_read_b64_tr_b16 v[32:33], v3 offset:20576
    v_mfma_f32_16x16x32_bf16 v[108:111], v[16:19], v[220:223], v[108:111]
    ds_read_b64_tr_b16 v[34:35], v3 offset:21856
    s_waitcnt lgkmcnt(4)
    v_mfma_f32_16x16x32_bf16 v[40:43], v[20:23], v[224:227], v[40:43]
    ds_read_b64_tr_b16 v[16:17], v2 offset:20608
    v_mfma_f32_16x16x32_bf16 v[44:47], v[20:23], v[228:231], v[44:47]
    ds_read_b64_tr_b16 v[18:19], v2 offset:21888
    v_mfma_f32_16x16x32_bf16 v[48:51], v[24:27], v[224:227], v[48:51]
    ds_read_b64_tr_b16 v[20:21], v3 offset:20640
    v_mfma_f32_16x16x32_bf16 v[52:55], v[24:27], v[228:231], v[52:55]
    ds_read_b64_tr_b16 v[22:23], v3 offset:21920
    s_waitcnt lgkmcnt(4)
    v_mfma_f32_16x16x32_bf16 v[56:59], v[28:31], v[224:227], v[56:59]
    ds_read_b64_tr_b16 v[24:25], v2 offset:20672
    v_mfma_f32_16x16x32_bf16 v[60:63], v[28:31], v[228:231], v[60:63]
    ds_read_b64_tr_b16 v[26:27], v2 offset:21952
    v_mfma_f32_16x16x32_bf16 v[64:67], v[32:35], v[224:227], v[64:67]
    ds_read_b64_tr_b16 v[28:29], v3 offset:20704
    v_mfma_f32_16x16x32_bf16 v[68:71], v[32:35], v[228:231], v[68:71]
    ds_read_b64_tr_b16 v[30:31], v3 offset:21984
    s_waitcnt lgkmcnt(4)
    v_mfma_f32_16x16x32_bf16 v[72:75], v[16:19], v[224:227], v[72:75]
    ds_read_b64_tr_b16 v[32:33], v2 offset:20736
    v_mfma_f32_16x16x32_bf16 v[76:79], v[16:19], v[228:231], v[76:79]
    ds_read_b64_tr_b16 v[34:35], v2 offset:22016
    v_mfma_f32_16x16x32_bf16 v[80:83], v[20:23], v[224:227], v[80:83]
    ds_read_b64_tr_b16 v[16:17], v2 offset:30720
    v_mfma_f32_16x16x32_bf16 v[84:87], v[20:23], v[228:231], v[84:87]
    ds_read_b64_tr_b16 v[18:19], v2 offset:32000
    s_waitcnt lgkmcnt(4)
    v_mfma_f32_16x16x32_bf16 v[88:91], v[24:27], v[224:227], v[88:91]
    ds_read_b64_tr_b16 v[20:21], v3 offset:30752
    v_mfma_f32_16x16x32_bf16 v[92:95], v[24:27], v[228:231], v[92:95]
    ds_read_b64_tr_b16 v[22:23], v3 offset:32032
    v_mfma_f32_16x16x32_bf16 v[96:99], v[28:31], v[224:227], v[96:99]
    ds_read_b64_tr_b16 v[24:25], v2 offset:30784
    v_mfma_f32_16x16x32_bf16 v[100:103], v[28:31], v[228:231], v[100:103]
    ds_read_b64_tr_b16 v[26:27], v2 offset:32064
    s_waitcnt lgkmcnt(4)
    v_mfma_f32_16x16x32_bf16 v[104:107], v[32:35], v[224:227], v[104:107]
    ds_read_b64_tr_b16 v[28:29], v3 offset:30816
    v_mfma_f32_16x16x32_bf16 v[108:111], v[32:35], v[228:231], v[108:111]
    ds_read_b64_tr_b16 v[30:31], v3 offset:32096
    v_mfma_f32_16x16x32_bf16 v[40:43], v[16:19], v[232:235], v[40:43]
    ds_read_b64_tr_b16 v[32:33], v2 offset:30848
    v_mfma_f32_16x16x32_bf16 v[44:47], v[16:19], v[236:239], v[44:47]
    ds_read_b64_tr_b16 v[34:35], v2 offset:32128
    s_waitcnt lgkmcnt(4)
    v_mfma_f32_16x16x32_bf16 v[48:51], v[20:23], v[232:235], v[48:51]
    ds_read_b64_tr_b16 v[16:17], v3 offset:30880
    v_mfma_f32_16x16x32_bf16 v[52:55], v[20:23], v[236:239], v[52:55]
    ds_read_b64_tr_b16 v[18:19], v3 offset:32160
    v_mfma_f32_16x16x32_bf16 v[56:59], v[24:27], v[232:235], v[56:59]
    ds_read_b64_tr_b16 v[20:21], v2 offset:30912
    v_mfma_f32_16x16x32_bf16 v[60:63], v[24:27], v[236:239], v[60:63]
    ds_read_b64_tr_b16 v[22:23], v2 offset:32192
    s_waitcnt lgkmcnt(4)
    v_mfma_f32_16x16x32_bf16 v[64:67], v[28:31], v[232:235], v[64:67]
    ds_read_b64_tr_b16 v[24:25], v3 offset:30944
    v_mfma_f32_16x16x32_bf16 v[68:71], v[28:31], v[236:239], v[68:71]
    ds_read_b64_tr_b16 v[26:27], v3 offset:32224
    v_mfma_f32_16x16x32_bf16 v[72:75], v[32:35], v[232:235], v[72:75]
    ds_read_b64_tr_b16 v[28:29], v2 offset:30976
    v_mfma_f32_16x16x32_bf16 v[76:79], v[32:35], v[236:239], v[76:79]
    ds_read_b64_tr_b16 v[30:31], v2 offset:32256
    s_waitcnt lgkmcnt(4)
    v_mfma_f32_16x16x32_bf16 v[80:83], v[16:19], v[232:235], v[80:83]
    s_barrier
    v_add_u32 v2, -40960, v2
    ds_read_b64_tr_b16 v[32:33], v2 offset:0
    v_mfma_f32_16x16x32_bf16 v[84:87], v[16:19], v[236:239], v[84:87]
    ds_read_b64_tr_b16 v[34:35], v2 offset:1280
    v_mfma_f32_16x16x32_bf16 v[88:91], v[20:23], v[232:235], v[88:91]
    v_add_u32 v3, -40960, v3
    ds_read_b64_tr_b16 v[16:17], v3 offset:32
    v_mfma_f32_16x16x32_bf16 v[92:95], v[20:23], v[236:239], v[92:95]
    ds_read_b64_tr_b16 v[18:19], v3 offset:1312
    s_waitcnt lgkmcnt(4)
    v_mfma_f32_16x16x32_bf16 v[96:99], v[24:27], v[232:235], v[96:99]
    ds_read_b64_tr_b16 v[20:21], v2 offset:64
    v_mfma_f32_16x16x32_bf16 v[100:103], v[24:27], v[236:239], v[100:103]
    ds_read_b64_tr_b16 v[22:23], v2 offset:1344
    v_mfma_f32_16x16x32_bf16 v[104:107], v[28:31], v[232:235], v[104:107]
    ds_read_b64_tr_b16 v[24:25], v3 offset:96
    v_mfma_f32_16x16x32_bf16 v[108:111], v[28:31], v[236:239], v[108:111]
    ds_read_b64_tr_b16 v[26:27], v3 offset:1376
    s_waitcnt lgkmcnt(4)
    v_mfma_f32_16x16x32_bf16 v[40:43], v[32:35], v[240:243], v[40:43]
    ds_read_b64_tr_b16 v[28:29], v2 offset:128
    v_mfma_f32_16x16x32_bf16 v[44:47], v[32:35], v[244:247], v[44:47]
    ds_read_b64_tr_b16 v[30:31], v2 offset:1408
    v_mfma_f32_16x16x32_bf16 v[48:51], v[16:19], v[240:243], v[48:51]
    ds_read_b64_tr_b16 v[32:33], v3 offset:160
    v_mfma_f32_16x16x32_bf16 v[52:55], v[16:19], v[244:247], v[52:55]
    ds_read_b64_tr_b16 v[34:35], v3 offset:1440
    s_waitcnt lgkmcnt(4)
    v_mfma_f32_16x16x32_bf16 v[56:59], v[20:23], v[240:243], v[56:59]
    ds_read_b64_tr_b16 v[16:17], v2 offset:192
    s_cmp_lg_u32 s51, 0
    s_cbranch_scc1 K1_NOCA
    s_lshl_b32 s64, s48, 4
    v_mov_b32 v38, 0
    v_mov_b32 v39, 1
    s_mov_b64 exec, 1
    s_waitcnt vmcnt(1)
    buffer_atomic_add v39, v38, s[44:47], s64 offen sc1
    s_mov_b64 exec, -1
K1_NOCA:
    v_mfma_f32_16x16x32_bf16 v[60:63], v[20:23], v[244:247], v[60:63]
    ds_read_b64_tr_b16 v[18:19], v2 offset:1472
    v_mfma_f32_16x16x32_bf16 v[64:67], v[24:27], v[240:243], v[64:67]
    ds_read_b64_tr_b16 v[20:21], v3 offset:224
    v_mfma_f32_16x16x32_bf16 v[68:71], v[24:27], v[244:247], v[68:71]
    ds_read_b64_tr_b16 v[22:23], v3 offset:1504
    s_waitcnt lgkmcnt(4)
    v_mfma_f32_16x16x32_bf16 v[72:75], v[28:31], v[240:243], v[72:75]
    ds_read_b64_tr_b16 v[24:25], v2 offset:256
    v_mfma_f32_16x16x32_bf16 v[76:79], v[28:31], v[244:247], v[76:79]
    ds_read_b64_tr_b16 v[26:27], v2 offset:1536
    v_mfma_f32_16x16x32_bf16 v[80:83], v[32:35], v[240:243], v[80:83]
    ds_read_b64_tr_b16 v[28:29], v2 offset:10240
    v_mfma_f32_16x16x32_bf16 v[84:87], v[32:35], v[244:247], v[84:87]
    ds_read_b64_tr_b16 v[30:31], v2 offset:11520
    s_waitcnt lgkmcnt(4)
    v_mfma_f32_16x16x32_bf16 v[88:91], v[16:19], v[240:243], v[88:91]
    ds_read_b64_tr_b16 v[32:33], v3 offset:10272
    v_mfma_f32_16x16x32_bf16 v[92:95], v[16:19], v[244:247], v[92:95]
    ds_read_b64_tr_b16 v[34:35], v3 offset:11552
    v_mfma_f32_16x16x32_bf16 v[96:99], v[20:23], v[240:243], v[96:99]
    ds_read_b64_tr_b16 v[16:17], v2 offset:10304
    v_mfma_f32_16x16x32_bf16 v[100:103], v[20:23], v[244:247], v[100:103]
    ds_read_b64_tr_b16 v[18:19], v2 offset:11584
    s_waitcnt lgkmcnt(4)
    v_mfma_f32_16x16x32_bf16 v[104:107], v[24:27], v[240:243], v[104:107]
    ds_read_b64_tr_b16 v[20:21], v3 offset:10336
    v_mfma_f32_16x16x32_bf16 v[108:111], v[24:27], v[244:247], v[108:111]
    ds_read_b64_tr_b16 v[22:23], v3 offset:11616
    v_mfma_f32_16x16x32_bf16 v[40:43], v[28:31], v[248:251], v[40:43]
    ds_read_b64_tr_b16 v[24:25], v2 offset:10368
    s_mov_b64 exec, 0xffff
    buffer_load_dword v1, s[4:7], s8 idxen lds
    s_mov_b64 exec, -1
    s_add_u32 s8, s8, 8192
    v_mfma_f32_16x16x32_bf16 v[44:47], v[28:31], v[252:255], v[44:47]
    ds_read_b64_tr_b16 v[26:27], v2 offset:11648
    s_waitcnt lgkmcnt(4)
    v_mfma_f32_16x16x32_bf16 v[48:51], v[32:35], v[248:251], v[48:51]
    ds_read_b64_tr_b16 v[28:29], v3 offset:10400
    v_mfma_f32_16x16x32_bf16 v[52:55], v[32:35], v[252:255], v[52:55]
    ds_read_b64_tr_b16 v[30:31], v3 offset:11680
    v_mfma_f32_16x16x32_bf16 v[56:59], v[16:19], v[248:251], v[56:59]
    ds_read_b64_tr_b16 v[32:33], v2 offset:10432
    v_mfma_f32_16x16x32_bf16 v[60:63], v[16:19], v[252:255], v[60:63]
    ds_read_b64_tr_b16 v[34:35], v2 offset:11712
    s_waitcnt lgkmcnt(4)
    v_mfma_f32_16x16x32_bf16 v[64:67], v[20:23], v[248:251], v[64:67]
    ds_read_b64_tr_b16 v[16:17], v3 offset:10464
    v_mfma_f32_16x16x32_bf16 v[68:71], v[20:23], v[252:255], v[68:71]
    ds_read_b64_tr_b16 v[18:19], v3 offset:11744
    v_mfma_f32_16x16x32_bf16 v[72:75], v[24:27], v[248:251], v[72:75]
    ds_read_b64_tr_b16 v[20:21], v2 offset:10496
    v_mfma_f32_16x16x32_bf16 v[76:79], v[24:27], v[252:255], v[76:79]
    ds_read_b64_tr_b16 v[22:23], v2 offset:11776
    s_waitcnt lgkmcnt(4)
    v_mfma_f32_16x16x32_bf16 v[80:83], v[28:31], v[248:251], v[80:83]
    s_barrier
    ds_read_b64_tr_b16 v[24:25], v5 offset:20480
    v_mfma_f32_16x16x32_bf16 v[84:87], v[28:31], v[252:255], v[84:87]
    ds_read_b64_tr_b16 v[26:27], v5 offset:21760
    v_mfma_f32_16x16x32_bf16 v[88:91], v[32:35], v[248:251], v[88:91]
    ds_read_b64_tr_b16 v[28:29], v5 offset:20512
    v_mfma_f32_16x16x32_bf16 v[92:95], v[32:35], v[252:255], v[92:95]
    ds_read_b64_tr_b16 v[30:31], v5 offset:21792
    s_waitcnt lgkmcnt(4)
    v_mfma_f32_16x16x32_bf16 v[96:99], v[16:19], v[248:251], v[96:99]
    ds_read_b64_tr_b16 v[32:33], v6 offset:20480
    v_mfma_f32_16x16x32_bf16 v[100:103], v[16:19], v[252:255], v[100:103]
    ds_read_b64_tr_b16 v[34:35], v6 offset:21760
    v_mfma_f32_16x16x32_bf16 v[104:107], v[20:23], v[248:251], v[104:107]
    ds_read_b64_tr_b16 v[16:17], v5 offset:20600
    v_mfma_f32_16x16x32_bf16 v[108:111], v[20:23], v[252:255], v[108:111]
    ds_read_b64_tr_b16 v[18:19], v5 offset:21880
    v_cvt_pk_bf16_f32 v12, v40, v41
    v_cvt_pk_bf16_f32 v13, v42, v43
    s_waitcnt lgkmcnt(4)
    v_mfma_f32_16x16x32_bf16 v[40:43], v[24:27], v[112:115], 0
    ds_read_b64_tr_b16 v[20:21], v8 offset:20480
    ds_write_b64 v10, v[12:13] offset:0
    v_cvt_pk_bf16_f32 v14, v44, v45
    v_cvt_pk_bf16_f32 v15, v46, v47
    v_cvt_pk_bf16_f32 v96, v96, v97
    v_cvt_pk_bf16_f32 v97, v98, v99
    v_mfma_f32_16x16x32_bf16 v[44:47], v[24:27], v[116:119], 0
    ds_read_b64_tr_b16 v[22:23], v8 offset:21760
    ds_write_b64 v10, v[14:15] offset:4736
    v_cvt_pk_bf16_f32 v2, v48, v49
    v_cvt_pk_bf16_f32 v3, v50, v51
    v_cvt_pk_bf16_f32 v100, v100, v101
    v_cvt_pk_bf16_f32 v101, v102, v103
    v_mfma_f32_16x16x32_bf16 v[48:51], v[28:31], v[112:115], 0
    ds_read_b64_tr_b16 v[24:25], v5 offset:20688
    ds_write_b64 v10, v[2:3] offset:32
    ds_write_b64 v10, v[96:97] offset:224
    v_cvt_pk_bf16_f32 v12, v52, v53
    v_cvt_pk_bf16_f32 v13, v54, v55
    v_cvt_pk_bf16_f32 v104, v104, v105
    v_cvt_pk_bf16_f32 v105, v106, v107
    v_mfma_f32_16x16x32_bf16 v[52:55], v[28:31], v[116:119], 0
    ds_read_b64_tr_b16 v[26:27], v5 offset:21968
    ds_write_b64 v10, v[12:13] offset:4768
    ds_write_b64 v10, v[100:101] offset:4960
    v_cvt_pk_bf16_f32 v14, v56, v57
    v_cvt_pk_bf16_f32 v15, v58, v59
    v_cvt_pk_bf16_f32 v108, v108, v109
    v_cvt_pk_bf16_f32 v109, v110, v111
    s_waitcnt lgkmcnt(10)
    v_mfma_f32_16x16x32_bf16 v[56:59], v[32:35], v[112:115], 0
    ds_read_b64_tr_b16 v[28:29], v5 offset:20720
    ds_write_b64 v10, v[14:15] offset:64
    ds_write_b64 v10, v[104:105] offset:256
    v_cvt_pk_bf16_f32 v2, v60, v61
    v_cvt_pk_bf16_f32 v3, v62, v63
    v_mfma_f32_16x16x32_bf16 v[60:63], v[32:35], v[116:119], 0
    ds_read_b64_tr_b16 v[30:31], v5 offset:22000
    ds_write_b64 v10, v[2:3] offset:4800
    ds_write_b64 v10, v[108:109] offset:4992
    ds_read_b128 v[104:107], v9 offset:0
    ds_read_b64_tr_b16 v[108:109], v7 offset:20480
    ds_read_b64_tr_b16 v[110:111], v7 offset:21760
    v_cvt_pk_bf16_f32 v12, v64, v65
    v_cvt_pk_bf16_f32 v13, v66, v67
    v_mfma_f32_16x16x32_bf16 v[64:67], v[16:19], v[112:115], 0
    ds_read_b64_tr_b16 v[32:33], v5 offset:30720
    ds_write_b64 v10, v[12:13] offset:96
    v_cvt_pk_bf16_f32 v14, v68, v69
    v_cvt_pk_bf16_f32 v15, v70, v71
    v_mfma_f32_16x16x32_bf16 v[68:71], v[16:19], v[116:119], 0
    ds_read_b64_tr_b16 v[34:35], v5 offset:32000
    ds_write_b64 v10, v[14:15] offset:4832
    v_cvt_pk_bf16_f32 v2, v72, v73
    v_cvt_pk_bf16_f32 v3, v74, v75
    s_waitcnt lgkmcnt(15)
    v_mfma_f32_16x16x32_bf16 v[72:75], v[20:23], v[112:115], 0
    ds_read_b64_tr_b16 v[16:17], v5 offset:30752
    ds_write_b64 v10, v[2:3] offset:128
    v_cvt_pk_bf16_f32 v12, v76, v77
    v_cvt_pk_bf16_f32 v13, v78, v79
    v_mfma_f32_16x16x32_bf16 v[76:79], v[20:23], v[116:119], 0
    ds_read_b64_tr_b16 v[18:19], v5 offset:32032
    ds_write_b64 v10, v[12:13] offset:4864
    v_cvt_pk_bf16_f32 v14, v80, v81
    v_cvt_pk_bf16_f32 v15, v82, v83
    s_waitcnt lgkmcnt(10)
    v_mfma_f32_16x16x32_bf16 v[100:103], v[20:23], v[104:107], 0
    v_mfma_f32_16x16x32_bf16 v[80:83], v[24:27], v[112:115], 0
    ds_read_b64_tr_b16 v[20:21], v6 offset:30720
    ds_write_b64 v10, v[14:15] offset:160
    v_cvt_pk_bf16_f32 v2, v84, v85
    v_cvt_pk_bf16_f32 v3, v86, v87
    v_mfma_f32_16x16x32_bf16 v[84:87], v[24:27], v[116:119], 0
    ds_read_b64_tr_b16 v[22:23], v6 offset:32000
    ds_write_b64 v10, v[2:3] offset:4896
    v_cvt_pk_bf16_f32 v12, v88, v89
    v_cvt_pk_bf16_f32 v13, v90, v91
    s_waitcnt lgkmcnt(12)
    v_mfma_f32_16x16x32_bf16 v[96:99], v[108:111], v[104:107], 0
    ds_read_b128 v[104:107], v9 offset:1024
    ds_read_b64_tr_b16 v[108:109], v7 offset:30720
    ds_read_b64_tr_b16 v[110:111], v7 offset:32000
    s_waitcnt lgkmcnt(12)
    v_mfma_f32_16x16x32_bf16 v[88:91], v[28:31], v[112:115], 0
    ds_read_b64_tr_b16 v[24:25], v5 offset:30840
    ds_write_b64 v10, v[12:13] offset:192
    v_cvt_pk_bf16_f32 v14, v92, v93
    v_cvt_pk_bf16_f32 v15, v94, v95
    v_mfma_f32_16x16x32_bf16 v[92:95], v[28:31], v[116:119], 0
    ds_read_b64_tr_b16 v[26:27], v5 offset:32120
    ds_write_b64 v10, v[14:15] offset:4928
    v_mfma_f32_16x16x32_bf16 v[40:43], v[32:35], v[120:123], v[40:43]
    ds_read_b64_tr_b16 v[28:29], v8 offset:30720
    v_mfma_f32_16x16x32_bf16 v[44:47], v[32:35], v[124:127], v[44:47]
    ds_read_b64_tr_b16 v[30:31], v8 offset:32000
    s_waitcnt lgkmcnt(10)
    v_mfma_f32_16x16x32_bf16 v[48:51], v[16:19], v[120:123], v[48:51]
    ds_read_b64_tr_b16 v[32:33], v5 offset:30928
    v_mfma_f32_16x16x32_bf16 v[52:55], v[16:19], v[124:127], v[52:55]
    ds_read_b64_tr_b16 v[34:35], v5 offset:32208
    v_mfma_f32_16x16x32_bf16 v[56:59], v[20:23], v[120:123], v[56:59]
    ds_read_b64_tr_b16 v[16:17], v5 offset:30960
    v_mfma_f32_16x16x32_bf16 v[60:63], v[20:23], v[124:127], v[60:63]
    ds_read_b64_tr_b16 v[18:19], v5 offset:32240
    s_waitcnt lgkmcnt(4)
    v_mfma_f32_16x16x32_bf16 v[64:67], v[24:27], v[120:123], v[64:67]
    s_barrier
    v_add_u32 v5, 40960, v5
    ds_read_b64_tr_b16 v[20:21], v5 offset:0
    v_mfma_f32_16x16x32_bf16 v[68:71], v[24:27], v[124:127], v[68:71]
    ds_read_b64_tr_b16 v[22:23], v5 offset:1280
    v_mfma_f32_16x16x32_bf16 v[72:75], v[28:31], v[120:123], v[72:75]
    ds_read_b64_tr_b16 v[24:25], v5 offset:32
    v_mfma_f32_16x16x32_bf16 v[76:79], v[28:31], v[124:127], v[76:79]
    ds_read_b64_tr_b16 v[26:27], v5 offset:1312
    v_mfma_f32_16x16x32_bf16 v[100:103], v[28:31], v[104:107], v[100:103]
    s_waitcnt lgkmcnt(4)
    v_mfma_f32_16x16x32_bf16 v[80:83], v[32:35], v[120:123], v[80:83]
    v_add_u32 v6, 40960, v6
    ds_read_b64_tr_b16 v[28:29], v6 offset:0
    v_mfma_f32_16x16x32_bf16 v[84:87], v[32:35], v[124:127], v[84:87]
    ds_read_b64_tr_b16 v[30:31], v6 offset:1280
    v_mfma_f32_16x16x32_bf16 v[96:99], v[108:111], v[104:107], v[96:99]
    v_mfma_f32_16x16x32_bf16 v[88:91], v[16:19], v[120:123], v[88:91]
    ds_read_b64_tr_b16 v[32:33], v5 offset:120
    v_mfma_f32_16x16x32_bf16 v[92:95], v[16:19], v[124:127], v[92:95]
    ds_read_b64_tr_b16 v[34:35], v5 offset:1400
    ds_read_b128 v[104:107], v9 offset:2048
    v_add_u32 v7, 40960, v7
    ds_read_b64_tr_b16 v[108:109], v7 offset:0
    ds_read_b64_tr_b16 v[110:111], v7 offset:1280
    s_waitcnt lgkmcnt(7)
    v_mfma_f32_16x16x32_bf16 v[40:43], v[20:23], v[128:131], v[40:43]
    v_add_u32 v8, 40960, v8
    ds_read_b64_tr_b16 v[16:17], v8 offset:0
    v_bfe_u32 v15, v1, 4, 1
    v_mfma_f32_16x16x32_bf16 v[44:47], v[20:23], v[132:135], v[44:47]
    ds_read_b64_tr_b16 v[18:19], v8 offset:1280
    v_lshlrev_b32 v15, 5, v15
    v_mfma_f32_16x16x32_bf16 v[48:51], v[24:27], v[128:131], v[48:51]
    ds_read_b64_tr_b16 v[20:21], v5 offset:208
    s_lshl_b32 s99, s52, 6
    v_add3_u32 v2, v4, v15, s99
    v_mfma_f32_16x16x32_bf16 v[52:55], v[24:27], v[132:135], v[52:55]
    ds_read_b64_tr_b16 v[22:23], v5 offset:1488
    v_sub_u32 v3, v4, v15
    s_waitcnt lgkmcnt(7)
    v_mfma_f32_16x16x32_bf16 v[56:59], v[28:31], v[128:131], v[56:59]
    ds_read_b64_tr_b16 v[24:25], v5 offset:240
    v_add_u32 v4, 256, v2
    v_mfma_f32_16x16x32_bf16 v[60:63], v[28:31], v[132:135], v[60:63]
    ds_read_b64_tr_b16 v[26:27], v5 offset:1520
    v_add_u32 v15, 32, v3
    v_mfma_f32_16x16x32_bf16 v[64:67], v[32:35], v[128:131], v[64:67]
    ds_read_b64_tr_b16 v[28:29], v5 offset:10240
    s_cmp_eq_u32 s52, 0
    s_cselect_b64 vcc, -1, 0
    v_cndmask_b32 v4, v15, v4, vcc
    v_mfma_f32_16x16x32_bf16 v[68:71], v[32:35], v[132:135], v[68:71]
    ds_read_b64_tr_b16 v[30:31], v5 offset:11520
    v_add_u32 v3, s99, v3
    s_waitcnt lgkmcnt(4)
    v_mfma_f32_16x16x32_bf16 v[72:75], v[16:19], v[128:131], v[72:75]
    ds_read_b64_tr_b16 v[32:33], v5 offset:10272
    v_add_u32 v2, 40960, v2
    v_mfma_f32_16x16x32_bf16 v[76:79], v[16:19], v[132:135], v[76:79]
    ds_read_b64_tr_b16 v[34:35], v5 offset:11552
    v_add_u32 v3, 40960, v3
    v_mfma_f32_16x16x32_bf16 v[100:103], v[16:19], v[104:107], v[100:103]
    v_mfma_f32_16x16x32_bf16 v[80:83], v[20:23], v[128:131], v[80:83]
    ds_read_b64_tr_b16 v[16:17], v6 offset:10240
    v_add_u32 v4, 40960, v4
    v_mfma_f32_16x16x32_bf16 v[84:87], v[20:23], v[132:135], v[84:87]
    ds_read_b64_tr_b16 v[18:19], v6 offset:11520
    ds_read_b64 v[12:13], v10 offset:4896
    v_mfma_f32_16x16x32_bf16 v[96:99], v[108:111], v[104:107], v[96:99]
    ds_read_b128 v[104:107], v9 offset:3072
    ds_read_b64_tr_b16 v[108:109], v7 offset:10240
    ds_read_b64_tr_b16 v[110:111], v7 offset:11520
    s_waitcnt lgkmcnt(8)
    v_mfma_f32_16x16x32_bf16 v[88:91], v[24:27], v[128:131], v[88:91]
    ds_read_b64_tr_b16 v[20:21], v5 offset:10360
    v_mfma_f32_16x16x32_bf16 v[92:95], v[24:27], v[132:135], v[92:95]
    ds_read_b64_tr_b16 v[22:23], v5 offset:11640
    v_mfma_f32_16x16x32_bf16 v[40:43], v[28:31], v[136:139], v[40:43]
    ds_read_b64_tr_b16 v[24:25], v8 offset:10240
    v_mfma_f32_16x16x32_bf16 v[44:47], v[28:31], v[140:143], v[44:47]
    ds_read_b64_tr_b16 v[26:27], v8 offset:11520
    s_waitcnt lgkmcnt(8)
    v_mfma_f32_16x16x32_bf16 v[48:51], v[32:35], v[136:139], v[48:51]
    ds_read_b64_tr_b16 v[28:29], v5 offset:10448
    v_mfma_f32_16x16x32_bf16 v[52:55], v[32:35], v[140:143], v[52:55]
    ds_read_b64_tr_b16 v[30:31], v5 offset:11728
    v_mfma_f32_16x16x32_bf16 v[56:59], v[16:19], v[136:139], v[56:59]
    ds_read_b64_tr_b16 v[32:33], v5 offset:10480
    s_waitcnt lgkmcnt(10)
    v_and_b32 v15, 0xffff0000, v13
    v_mfma_f32_16x16x32_bf16 v[60:63], v[16:19], v[140:143], v[60:63]
    ds_read_b64_tr_b16 v[34:35], v5 offset:11760
    v_lshlrev_b32 v14, 16, v13
    s_waitcnt lgkmcnt(4)
    v_mfma_f32_16x16x32_bf16 v[64:67], v[20:23], v[136:139], v[64:67]
    s_barrier
    ds_read_b64_tr_b16 v[16:17], v5 offset:20480
    v_and_b32 v13, 0xffff0000, v12
    v_mfma_f32_16x16x32_bf16 v[68:71], v[20:23], v[140:143], v[68:71]
    ds_read_b64_tr_b16 v[18:19], v5 offset:21760
    v_lshlrev_b32 v12, 16, v12
    v_mfma_f32_16x16x32_bf16 v[72:75], v[24:27], v[136:139], v[72:75]
    ds_read_b64_tr_b16 v[20:21], v5 offset:20512
    v_mul_f32 v36, v12, v12
    v_mfma_f32_16x16x32_bf16 v[76:79], v[24:27], v[140:143], v[76:79]
    ds_read_b64_tr_b16 v[22:23], v5 offset:21792
    v_mul_f32 v37, v13, v13
    v_mfma_f32_16x16x32_bf16 v[100:103], v[24:27], v[104:107], v[100:103]
    s_waitcnt lgkmcnt(4)
    v_mfma_f32_16x16x32_bf16 v[80:83], v[28:31], v[136:139], v[80:83]
    ds_read_b64_tr_b16 v[24:25], v6 offset:20480
    v_mul_f32 v38, v14, v14
    v_mfma_f32_16x16x32_bf16 v[84:87], v[28:31], v[140:143], v[84:87]
    ds_read_b64_tr_b16 v[26:27], v6 offset:21760
    v_mul_f32 v39, v15, v15
    v_mfma_f32_16x16x32_bf16 v[96:99], v[108:111], v[104:107], v[96:99]
    v_mfma_f32_16x16x32_bf16 v[88:91], v[32:35], v[136:139], v[88:91]
    ds_read_b64_tr_b16 v[28:29], v5 offset:20600
    v_fma_f32 v36, v36, v0, s78
    v_mfma_f32_16x16x32_bf16 v[92:95], v[32:35], v[140:143], v[92:95]
    ds_read_b64_tr_b16 v[30:31], v5 offset:21880
    v_fma_f32 v37, v37, v0, s78
    ds_read_b128 v[104:107], v9 offset:4096
    ds_read_b64_tr_b16 v[108:109], v7 offset:20480
    ds_read_b64_tr_b16 v[110:111], v7 offset:21760
    s_waitcnt lgkmcnt(7)
    v_mfma_f32_16x16x32_bf16 v[40:43], v[16:19], v[144:147], v[40:43]
    ds_read_b64_tr_b16 v[32:33], v8 offset:20480
    v_fma_f32 v38, v38, v0, s78
    v_mfma_f32_16x16x32_bf16 v[44:47], v[16:19], v[148:151], v[44:47]
    ds_read_b64_tr_b16 v[34:35], v8 offset:21760
    v_fma_f32 v39, v39, v0, s78
    v_mfma_f32_16x16x32_bf16 v[48:51], v[20:23], v[144:147], v[48:51]
    ds_read_b64_tr_b16 v[16:17], v5 offset:20688
    v_mul_f32 v36, v36, v12
    v_mfma_f32_16x16x32_bf16 v[52:55], v[20:23], v[148:151], v[52:55]
    ds_read_b64_tr_b16 v[18:19], v5 offset:21968
    v_mul_f32 v37, v37, v13
    s_waitcnt lgkmcnt(7)
    v_mfma_f32_16x16x32_bf16 v[56:59], v[24:27], v[144:147], v[56:59]
    ds_read_b64_tr_b16 v[20:21], v5 offset:20720
    v_mul_f32 v38, v38, v14
    v_mfma_f32_16x16x32_bf16 v[60:63], v[24:27], v[148:151], v[60:63]
    ds_read_b64_tr_b16 v[22:23], v5 offset:22000
    v_mul_f32 v39, v39, v15
    v_mfma_f32_16x16x32_bf16 v[64:67], v[28:31], v[144:147], v[64:67]
    ds_read_b64_tr_b16 v[24:25], v5 offset:30720
    v_exp_f32 v36, v36
    v_mfma_f32_16x16x32_bf16 v[68:71], v[28:31], v[148:151], v[68:71]
    ds_read_b64_tr_b16 v[26:27], v5 offset:32000
    v_exp_f32 v37, v37
    s_waitcnt lgkmcnt(4)
    v_mfma_f32_16x16x32_bf16 v[72:75], v[32:35], v[144:147], v[72:75]
    ds_read_b64_tr_b16 v[28:29], v5 offset:30752
    v_exp_f32 v38, v38
    v_mfma_f32_16x16x32_bf16 v[76:79], v[32:35], v[148:151], v[76:79]
    ds_read_b64_tr_b16 v[30:31], v5 offset:32032
    v_exp_f32 v39, v39
    v_mfma_f32_16x16x32_bf16 v[100:103], v[32:35], v[104:107], v[100:103]
    v_mfma_f32_16x16x32_bf16 v[80:83], v[16:19], v[144:147], v[80:83]
    ds_read_b64_tr_b16 v[32:33], v6 offset:30720
    v_add_f32 v36, 1.0, v36
    v_mfma_f32_16x16x32_bf16 v[84:87], v[16:19], v[148:151], v[84:87]
    ds_read_b64_tr_b16 v[34:35], v6 offset:32000
    v_add_f32 v37, 1.0, v37
    v_mfma_f32_16x16x32_bf16 v[96:99], v[108:111], v[104:107], v[96:99]
    ds_read_b128 v[104:107], v9 offset:5120
    ds_read_b64_tr_b16 v[108:109], v7 offset:30720
    ds_read_b64_tr_b16 v[110:111], v7 offset:32000
    s_waitcnt lgkmcnt(7)
    v_mfma_f32_16x16x32_bf16 v[88:91], v[20:23], v[144:147], v[88:91]
    ds_read_b64_tr_b16 v[16:17], v5 offset:30840
    v_add_f32 v38, 1.0, v38
    v_mfma_f32_16x16x32_bf16 v[92:95], v[20:23], v[148:151], v[92:95]
    ds_read_b64_tr_b16 v[18:19], v5 offset:32120
    v_add_f32 v39, 1.0, v39
    v_mfma_f32_16x16x32_bf16 v[40:43], v[24:27], v[152:155], v[40:43]
    ds_read_b64_tr_b16 v[20:21], v8 offset:30720
    s_mov_b64 exec, 0xffff
    buffer_load_dword v1, s[4:7], s8 idxen lds
    s_mov_b64 exec, -1
    s_add_u32 s8, s8, 8192
    v_rcp_f32 v36, v36
    v_mfma_f32_16x16x32_bf16 v[44:47], v[24:27], v[156:159], v[44:47]
    ds_read_b64_tr_b16 v[22:23], v8 offset:32000
    v_rcp_f32 v37, v37
    s_waitcnt lgkmcnt(7)
    v_mfma_f32_16x16x32_bf16 v[48:51], v[28:31], v[152:155], v[48:51]
    ds_read_b64_tr_b16 v[24:25], v5 offset:30928
    v_rcp_f32 v38, v38
    v_mfma_f32_16x16x32_bf16 v[52:55], v[28:31], v[156:159], v[52:55]
    ds_read_b64_tr_b16 v[26:27], v5 offset:32208
    v_rcp_f32 v39, v39
    v_mfma_f32_16x16x32_bf16 v[56:59], v[32:35], v[152:155], v[56:59]
    ds_read_b64_tr_b16 v[28:29], v5 offset:30960
    v_mul_f32 v12, v12, v36
    v_mfma_f32_16x16x32_bf16 v[60:63], v[32:35], v[156:159], v[60:63]
    ds_read_b64_tr_b16 v[30:31], v5 offset:32240
    v_mul_f32 v13, v13, v37
    s_waitcnt lgkmcnt(4)
    v_mfma_f32_16x16x32_bf16 v[64:67], v[16:19], v[152:155], v[64:67]
    s_barrier
    v_add_u32 v5, -40960, v5
    ds_read_b64_tr_b16 v[32:33], v5 offset:0
    v_mul_f32 v14, v14, v38
    v_mfma_f32_16x16x32_bf16 v[68:71], v[16:19], v[156:159], v[68:71]
    ds_read_b64_tr_b16 v[34:35], v5 offset:1280
    v_mul_f32 v15, v15, v39
    v_mfma_f32_16x16x32_bf16 v[72:75], v[20:23], v[152:155], v[72:75]
    ds_read_b64_tr_b16 v[16:17], v5 offset:32
    v_cvt_pk_bf16_f32 v36, v12, v13
    v_mfma_f32_16x16x32_bf16 v[76:79], v[20:23], v[156:159], v[76:79]
    ds_read_b64_tr_b16 v[18:19], v5 offset:1312
    v_cvt_pk_bf16_f32 v37, v14, v15
    v_mfma_f32_16x16x32_bf16 v[100:103], v[20:23], v[104:107], v[100:103]
    s_waitcnt lgkmcnt(4)
    v_mfma_f32_16x16x32_bf16 v[80:83], v[24:27], v[152:155], v[80:83]
    v_add_u32 v6, -40960, v6
    ds_read_b64_tr_b16 v[20:21], v6 offset:0
    ds_write_b64 v10, v[36:37] offset:4896
    v_mfma_f32_16x16x32_bf16 v[84:87], v[24:27], v[156:159], v[84:87]
    ds_read_b64_tr_b16 v[22:23], v6 offset:1280
    ds_read_b64 v[12:13], v10 offset:4928
    v_mfma_f32_16x16x32_bf16 v[96:99], v[108:111], v[104:107], v[96:99]
    v_mfma_f32_16x16x32_bf16 v[88:91], v[28:31], v[152:155], v[88:91]
    ds_read_b64_tr_b16 v[24:25], v5 offset:120
    v_mfma_f32_16x16x32_bf16 v[92:95], v[28:31], v[156:159], v[92:95]
    ds_read_b64_tr_b16 v[26:27], v5 offset:1400
    ds_read_b128 v[104:107], v9 offset:6144
    v_add_u32 v7, -40960, v7
    ds_read_b64_tr_b16 v[108:109], v7 offset:0
    ds_read_b64_tr_b16 v[110:111], v7 offset:1280
    s_waitcnt lgkmcnt(9)
    v_mfma_f32_16x16x32_bf16 v[40:43], v[32:35], v[160:163], v[40:43]
    v_add_u32 v8, -40960, v8
    ds_read_b64_tr_b16 v[28:29], v8 offset:0
    v_mfma_f32_16x16x32_bf16 v[44:47], v[32:35], v[164:167], v[44:47]
    ds_read_b64_tr_b16 v[30:31], v8 offset:1280
    v_mfma_f32_16x16x32_bf16 v[48:51], v[16:19], v[160:163], v[48:51]
    ds_read_b64_tr_b16 v[32:33], v5 offset:208
    v_mfma_f32_16x16x32_bf16 v[52:55], v[16:19], v[164:167], v[52:55]
    ds_read_b64_tr_b16 v[34:35], v5 offset:1488
    s_waitcnt lgkmcnt(7)
    v_mfma_f32_16x16x32_bf16 v[56:59], v[20:23], v[160:163], v[56:59]
    ds_read_b64_tr_b16 v[16:17], v5 offset:240
    v_and_b32 v15, 0xffff0000, v13
    v_mfma_f32_16x16x32_bf16 v[60:63], v[20:23], v[164:167], v[60:63]
    ds_read_b64_tr_b16 v[18:19], v5 offset:1520
    v_lshlrev_b32 v14, 16, v13
    v_mfma_f32_16x16x32_bf16 v[64:67], v[24:27], v[160:163], v[64:67]
    ds_read_b64_tr_b16 v[20:21], v5 offset:10240
    v_and_b32 v13, 0xffff0000, v12
    v_mfma_f32_16x16x32_bf16 v[68:71], v[24:27], v[164:167], v[68:71]
    ds_read_b64_tr_b16 v[22:23], v5 offset:11520
    v_lshlrev_b32 v12, 16, v12
    s_waitcnt lgkmcnt(4)
    v_mfma_f32_16x16x32_bf16 v[72:75], v[28:31], v[160:163], v[72:75]
    ds_read_b64_tr_b16 v[24:25], v5 offset:10272
    v_mul_f32 v36, v12, v12
    v_mfma_f32_16x16x32_bf16 v[76:79], v[28:31], v[164:167], v[76:79]
    ds_read_b64_tr_b16 v[26:27], v5 offset:11552
    v_mul_f32 v37, v13, v13
    v_mfma_f32_16x16x32_bf16 v[100:103], v[28:31], v[104:107], v[100:103]
    v_mfma_f32_16x16x32_bf16 v[80:83], v[32:35], v[160:163], v[80:83]
    ds_read_b64_tr_b16 v[28:29], v6 offset:10240
    v_mul_f32 v38, v14, v14
    v_mfma_f32_16x16x32_bf16 v[84:87], v[32:35], v[164:167], v[84:87]
    ds_read_b64_tr_b16 v[30:31], v6 offset:11520
    v_mul_f32 v39, v15, v15
    v_mfma_f32_16x16x32_bf16 v[96:99], v[108:111], v[104:107], v[96:99]
    ds_read_b128 v[104:107], v9 offset:7168
    ds_read_b64_tr_b16 v[108:109], v7 offset:10240
    ds_read_b64_tr_b16 v[110:111], v7 offset:11520
    s_waitcnt lgkmcnt(7)
    v_mfma_f32_16x16x32_bf16 v[88:91], v[16:19], v[160:163], v[88:91]
    ds_read_b64_tr_b16 v[32:33], v5 offset:10360
    v_fma_f32 v36, v36, v0, s78
    v_mfma_f32_16x16x32_bf16 v[92:95], v[16:19], v[164:167], v[92:95]
    ds_read_b64_tr_b16 v[34:35], v5 offset:11640
    v_fma_f32 v37, v37, v0, s78
    v_mfma_f32_16x16x32_bf16 v[40:43], v[20:23], v[168:171], v[40:43]
    ds_read_b64_tr_b16 v[16:17], v8 offset:10240
    v_fma_f32 v38, v38, v0, s78
    v_mfma_f32_16x16x32_bf16 v[44:47], v[20:23], v[172:175], v[44:47]
    ds_read_b64_tr_b16 v[18:19], v8 offset:11520
    v_fma_f32 v39, v39, v0, s78
    s_waitcnt lgkmcnt(7)
    v_mfma_f32_16x16x32_bf16 v[48:51], v[24:27], v[168:171], v[48:51]
    ds_read_b64_tr_b16 v[20:21], v5 offset:10448
    v_mul_f32 v36, v36, v12
    v_mfma_f32_16x16x32_bf16 v[52:55], v[24:27], v[172:175], v[52:55]
    ds_read_b64_tr_b16 v[22:23], v5 offset:11728
    v_mul_f32 v37, v37, v13
    v_mfma_f32_16x16x32_bf16 v[56:59], v[28:31], v[168:171], v[56:59]
    ds_read_b64_tr_b16 v[24:25], v5 offset:10480
    v_mul_f32 v38, v38, v14
    v_mfma_f32_16x16x32_bf16 v[60:63], v[28:31], v[172:175], v[60:63]
    ds_read_b64_tr_b16 v[26:27], v5 offset:11760
    v_mul_f32 v39, v39, v15
    s_waitcnt lgkmcnt(4)
    v_mfma_f32_16x16x32_bf16 v[64:67], v[32:35], v[168:171], v[64:67]
    s_barrier
    ds_read_b64_tr_b16 v[28:29], v5 offset:20480
    v_exp_f32 v36, v36
    v_mfma_f32_16x16x32_bf16 v[68:71], v[32:35], v[172:175], v[68:71]
    ds_read_b64_tr_b16 v[30:31], v5 offset:21760
    v_exp_f32 v37, v37
    v_mfma_f32_16x16x32_bf16 v[72:75], v[16:19], v[168:171], v[72:75]
    ds_read_b64_tr_b16 v[32:33], v5 offset:20512
    v_exp_f32 v38, v38
    v_mfma_f32_16x16x32_bf16 v[76:79], v[16:19], v[172:175], v[76:79]
    ds_read_b64_tr_b16 v[34:35], v5 offset:21792
    v_exp_f32 v39, v39
    v_mfma_f32_16x16x32_bf16 v[100:103], v[16:19], v[104:107], v[100:103]
    s_waitcnt lgkmcnt(4)
    v_mfma_f32_16x16x32_bf16 v[80:83], v[20:23], v[168:171], v[80:83]
    ds_read_b64_tr_b16 v[16:17], v6 offset:20480
    v_add_f32 v36, 1.0, v36
    v_mfma_f32_16x16x32_bf16 v[84:87], v[20:23], v[172:175], v[84:87]
    ds_read_b64_tr_b16 v[18:19], v6 offset:21760
    v_add_f32 v37, 1.0, v37
    v_mfma_f32_16x16x32_bf16 v[96:99], v[108:111], v[104:107], v[96:99]
    v_mfma_f32_16x16x32_bf16 v[88:91], v[24:27], v[168:171], v[88:91]
    ds_read_b64_tr_b16 v[20:21], v5 offset:20600
    v_add_f32 v38, 1.0, v38
    v_mfma_f32_16x16x32_bf16 v[92:95], v[24:27], v[172:175], v[92:95]
    ds_read_b64_tr_b16 v[22:23], v5 offset:21880
    v_add_f32 v39, 1.0, v39
    ds_read_b128 v[104:107], v9 offset:8192
    ds_read_b64_tr_b16 v[108:109], v7 offset:20480
    ds_read_b64_tr_b16 v[110:111], v7 offset:21760
    s_waitcnt lgkmcnt(7)
    v_mfma_f32_16x16x32_bf16 v[40:43], v[28:31], v[176:179], v[40:43]
    ds_read_b64_tr_b16 v[24:25], v8 offset:20480
    v_rcp_f32 v36, v36
    v_mfma_f32_16x16x32_bf16 v[44:47], v[28:31], v[180:183], v[44:47]
    ds_read_b64_tr_b16 v[26:27], v8 offset:21760
    v_rcp_f32 v37, v37
    v_mfma_f32_16x16x32_bf16 v[48:51], v[32:35], v[176:179], v[48:51]
    ds_read_b64_tr_b16 v[28:29], v5 offset:20688
    v_rcp_f32 v38, v38
    v_mfma_f32_16x16x32_bf16 v[52:55], v[32:35], v[180:183], v[52:55]
    ds_read_b64_tr_b16 v[30:31], v5 offset:21968
    v_rcp_f32 v39, v39
    s_waitcnt lgkmcnt(7)
    v_mfma_f32_16x16x32_bf16 v[56:59], v[16:19], v[176:179], v[56:59]
    ds_read_b64_tr_b16 v[32:33], v5 offset:20720
    v_mul_f32 v12, v12, v36
    v_mfma_f32_16x16x32_bf16 v[60:63], v[16:19], v[180:183], v[60:63]
    ds_read_b64_tr_b16 v[34:35], v5 offset:22000
    v_mul_f32 v13, v13, v37
    v_mfma_f32_16x16x32_bf16 v[64:67], v[20:23], v[176:179], v[64:67]
    ds_read_b64_tr_b16 v[16:17], v5 offset:30720
    v_mul_f32 v14, v14, v38
    v_mfma_f32_16x16x32_bf16 v[68:71], v[20:23], v[180:183], v[68:71]
    ds_read_b64_tr_b16 v[18:19], v5 offset:32000
    v_mul_f32 v15, v15, v39
    s_waitcnt lgkmcnt(4)
    v_mfma_f32_16x16x32_bf16 v[72:75], v[24:27], v[176:179], v[72:75]
    ds_read_b64_tr_b16 v[20:21], v5 offset:30752
    v_cvt_pk_bf16_f32 v36, v12, v13
    v_mfma_f32_16x16x32_bf16 v[76:79], v[24:27], v[180:183], v[76:79]
    ds_read_b64_tr_b16 v[22:23], v5 offset:32032
    v_cvt_pk_bf16_f32 v37, v14, v15
    v_mfma_f32_16x16x32_bf16 v[100:103], v[24:27], v[104:107], v[100:103]
    v_mfma_f32_16x16x32_bf16 v[80:83], v[28:31], v[176:179], v[80:83]
    ds_read_b64_tr_b16 v[24:25], v6 offset:30720
    ds_write_b64 v10, v[36:37] offset:4928
    v_mfma_f32_16x16x32_bf16 v[84:87], v[28:31], v[180:183], v[84:87]
    ds_read_b64_tr_b16 v[26:27], v6 offset:32000
    ds_read_b64 v[12:13], v10 offset:4960
    v_mfma_f32_16x16x32_bf16 v[96:99], v[108:111], v[104:107], v[96:99]
    ds_read_b128 v[104:107], v9 offset:9216
    ds_read_b64_tr_b16 v[108:109], v7 offset:30720
    ds_read_b64_tr_b16 v[110:111], v7 offset:32000
    s_waitcnt lgkmcnt(9)
    v_mfma_f32_16x16x32_bf16 v[88:91], v[32:35], v[176:179], v[88:91]
    ds_read_b64_tr_b16 v[28:29], v5 offset:30840
    v_mfma_f32_16x16x32_bf16 v[92:95], v[32:35], v[180:183], v[92:95]
    ds_read_b64_tr_b16 v[30:31], v5 offset:32120
    v_mfma_f32_16x16x32_bf16 v[40:43], v[16:19], v[184:187], v[40:43]
    ds_read_b64_tr_b16 v[32:33], v8 offset:30720
    v_mfma_f32_16x16x32_bf16 v[44:47], v[16:19], v[188:191], v[44:47]
    ds_read_b64_tr_b16 v[34:35], v8 offset:32000
    s_waitcnt lgkmcnt(8)
    v_mfma_f32_16x16x32_bf16 v[48:51], v[20:23], v[184:187], v[48:51]
    ds_read_b64_tr_b16 v[16:17], v5 offset:30928
    v_mfma_f32_16x16x32_bf16 v[52:55], v[20:23], v[188:191], v[52:55]
    ds_read_b64_tr_b16 v[18:19], v5 offset:32208
    v_mfma_f32_16x16x32_bf16 v[56:59], v[24:27], v[184:187], v[56:59]
    ds_read_b64_tr_b16 v[20:21], v5 offset:30960
    s_waitcnt lgkmcnt(10)
    v_and_b32 v15, 0xffff0000, v13
    v_mfma_f32_16x16x32_bf16 v[60:63], v[24:27], v[188:191], v[60:63]
    ds_read_b64_tr_b16 v[22:23], v5 offset:32240
    v_lshlrev_b32 v14, 16, v13
    s_waitcnt lgkmcnt(4)
    v_mfma_f32_16x16x32_bf16 v[64:67], v[28:31], v[184:187], v[64:67]
    s_barrier
    v_add_u32 v5, 40960, v5
    ds_read_b64_tr_b16 v[24:25], v5 offset:0
    v_and_b32 v13, 0xffff0000, v12
    v_mfma_f32_16x16x32_bf16 v[68:71], v[28:31], v[188:191], v[68:71]
    ds_read_b64_tr_b16 v[26:27], v5 offset:1280
    v_lshlrev_b32 v12, 16, v12
    v_mfma_f32_16x16x32_bf16 v[72:75], v[32:35], v[184:187], v[72:75]
    ds_read_b64_tr_b16 v[28:29], v5 offset:32
    v_mul_f32 v36, v12, v12
    v_mfma_f32_16x16x32_bf16 v[76:79], v[32:35], v[188:191], v[76:79]
    ds_read_b64_tr_b16 v[30:31], v5 offset:1312
    v_mul_f32 v37, v13, v13
    v_mfma_f32_16x16x32_bf16 v[100:103], v[32:35], v[104:107], v[100:103]
    s_waitcnt lgkmcnt(4)
    v_mfma_f32_16x16x32_bf16 v[80:83], v[16:19], v[184:187], v[80:83]
    v_add_u32 v6, 40960, v6
    ds_read_b64_tr_b16 v[32:33], v6 offset:0
    v_mul_f32 v38, v14, v14
    v_mfma_f32_16x16x32_bf16 v[84:87], v[16:19], v[188:191], v[84:87]
    ds_read_b64_tr_b16 v[34:35], v6 offset:1280
    v_mul_f32 v39, v15, v15
    v_mfma_f32_16x16x32_bf16 v[96:99], v[108:111], v[104:107], v[96:99]
    v_mfma_f32_16x16x32_bf16 v[88:91], v[20:23], v[184:187], v[88:91]
    ds_read_b64_tr_b16 v[16:17], v5 offset:120
    v_fma_f32 v36, v36, v0, s78
    v_mfma_f32_16x16x32_bf16 v[92:95], v[20:23], v[188:191], v[92:95]
    ds_read_b64_tr_b16 v[18:19], v5 offset:1400
    v_fma_f32 v37, v37, v0, s78
    ds_read_b128 v[104:107], v9 offset:10240
    v_add_u32 v7, 40960, v7
    ds_read_b64_tr_b16 v[108:109], v7 offset:0
    ds_read_b64_tr_b16 v[110:111], v7 offset:1280
    s_waitcnt lgkmcnt(7)
    v_mfma_f32_16x16x32_bf16 v[40:43], v[24:27], v[192:195], v[40:43]
    v_add_u32 v8, 40960, v8
    ds_read_b64_tr_b16 v[20:21], v8 offset:0
    v_fma_f32 v38, v38, v0, s78
    v_mfma_f32_16x16x32_bf16 v[44:47], v[24:27], v[196:199], v[44:47]
    ds_read_b64_tr_b16 v[22:23], v8 offset:1280
    v_fma_f32 v39, v39, v0, s78
    v_mfma_f32_16x16x32_bf16 v[48:51], v[28:31], v[192:195], v[48:51]
    ds_read_b64_tr_b16 v[24:25], v5 offset:208
    v_mul_f32 v36, v36, v12
    v_mfma_f32_16x16x32_bf16 v[52:55], v[28:31], v[196:199], v[52:55]
    ds_read_b64_tr_b16 v[26:27], v5 offset:1488
    v_mul_f32 v37, v37, v13
    s_waitcnt lgkmcnt(7)
    v_mfma_f32_16x16x32_bf16 v[56:59], v[32:35], v[192:195], v[56:59]
    ds_read_b64_tr_b16 v[28:29], v5 offset:240
    v_mul_f32 v38, v38, v14
    v_mfma_f32_16x16x32_bf16 v[60:63], v[32:35], v[196:199], v[60:63]
    ds_read_b64_tr_b16 v[30:31], v5 offset:1520
    v_mul_f32 v39, v39, v15
    v_mfma_f32_16x16x32_bf16 v[64:67], v[16:19], v[192:195], v[64:67]
    ds_read_b64_tr_b16 v[32:33], v5 offset:10240
    v_exp_f32 v36, v36
    v_mfma_f32_16x16x32_bf16 v[68:71], v[16:19], v[196:199], v[68:71]
    ds_read_b64_tr_b16 v[34:35], v5 offset:11520
    v_exp_f32 v37, v37
    s_waitcnt lgkmcnt(4)
    v_mfma_f32_16x16x32_bf16 v[72:75], v[20:23], v[192:195], v[72:75]
    ds_read_b64_tr_b16 v[16:17], v5 offset:10272
    v_exp_f32 v38, v38
    v_mfma_f32_16x16x32_bf16 v[76:79], v[20:23], v[196:199], v[76:79]
    ds_read_b64_tr_b16 v[18:19], v5 offset:11552
    v_exp_f32 v39, v39
    v_mfma_f32_16x16x32_bf16 v[100:103], v[20:23], v[104:107], v[100:103]
    v_mfma_f32_16x16x32_bf16 v[80:83], v[24:27], v[192:195], v[80:83]
    ds_read_b64_tr_b16 v[20:21], v6 offset:10240
    v_add_f32 v36, 1.0, v36
    v_mfma_f32_16x16x32_bf16 v[84:87], v[24:27], v[196:199], v[84:87]
    ds_read_b64_tr_b16 v[22:23], v6 offset:11520
    v_add_f32 v37, 1.0, v37
    v_mfma_f32_16x16x32_bf16 v[96:99], v[108:111], v[104:107], v[96:99]
    ds_read_b128 v[104:107], v9 offset:11264
    ds_read_b64_tr_b16 v[108:109], v7 offset:10240
    ds_read_b64_tr_b16 v[110:111], v7 offset:11520
    s_waitcnt lgkmcnt(7)
    v_mfma_f32_16x16x32_bf16 v[88:91], v[28:31], v[192:195], v[88:91]
    ds_read_b64_tr_b16 v[24:25], v5 offset:10360
    v_add_f32 v38, 1.0, v38
    v_mfma_f32_16x16x32_bf16 v[92:95], v[28:31], v[196:199], v[92:95]
    ds_read_b64_tr_b16 v[26:27], v5 offset:11640
    v_add_f32 v39, 1.0, v39
    v_mfma_f32_16x16x32_bf16 v[40:43], v[32:35], v[200:203], v[40:43]
    ds_read_b64_tr_b16 v[28:29], v8 offset:10240
    s_mov_b64 exec, 0xffff
    buffer_load_dword v1, s[4:7], s8 idxen lds
    s_mov_b64 exec, -1
    s_add_u32 s8, s8, 8192
    v_rcp_f32 v36, v36
    v_mfma_f32_16x16x32_bf16 v[44:47], v[32:35], v[204:207], v[44:47]
    ds_read_b64_tr_b16 v[30:31], v8 offset:11520
    v_rcp_f32 v37, v37
    s_waitcnt lgkmcnt(7)
    v_mfma_f32_16x16x32_bf16 v[48:51], v[16:19], v[200:203], v[48:51]
    ds_read_b64_tr_b16 v[32:33], v5 offset:10448
    v_rcp_f32 v38, v38
    v_mfma_f32_16x16x32_bf16 v[52:55], v[16:19], v[204:207], v[52:55]
    ds_read_b64_tr_b16 v[34:35], v5 offset:11728
    v_rcp_f32 v39, v39
    v_mfma_f32_16x16x32_bf16 v[56:59], v[20:23], v[200:203], v[56:59]
    ds_read_b64_tr_b16 v[16:17], v5 offset:10480
    v_mul_f32 v12, v12, v36
    v_mfma_f32_16x16x32_bf16 v[60:63], v[20:23], v[204:207], v[60:63]
    ds_read_b64_tr_b16 v[18:19], v5 offset:11760
    v_mul_f32 v13, v13, v37
    s_waitcnt lgkmcnt(4)
    v_mfma_f32_16x16x32_bf16 v[64:67], v[24:27], v[200:203], v[64:67]
    s_barrier
    ds_read_b64_tr_b16 v[20:21], v5 offset:20480
    v_mul_f32 v14, v14, v38
    v_mfma_f32_16x16x32_bf16 v[68:71], v[24:27], v[204:207], v[68:71]
    ds_read_b64_tr_b16 v[22:23], v5 offset:21760
    v_mul_f32 v15, v15, v39
    v_mfma_f32_16x16x32_bf16 v[72:75], v[28:31], v[200:203], v[72:75]
    ds_read_b64_tr_b16 v[24:25], v5 offset:20512
    v_cvt_pk_bf16_f32 v36, v12, v13
    v_mfma_f32_16x16x32_bf16 v[76:79], v[28:31], v[204:207], v[76:79]
    ds_read_b64_tr_b16 v[26:27], v5 offset:21792
    v_cvt_pk_bf16_f32 v37, v14, v15
    v_mfma_f32_16x16x32_bf16 v[100:103], v[28:31], v[104:107], v[100:103]
    s_waitcnt lgkmcnt(4)
    v_mfma_f32_16x16x32_bf16 v[80:83], v[32:35], v[200:203], v[80:83]
    ds_read_b64_tr_b16 v[28:29], v6 offset:20480
    ds_write_b64 v10, v[36:37] offset:4960
    v_mfma_f32_16x16x32_bf16 v[84:87], v[32:35], v[204:207], v[84:87]
    ds_read_b64_tr_b16 v[30:31], v6 offset:21760
    ds_read_b64 v[12:13], v10 offset:4992
    v_mfma_f32_16x16x32_bf16 v[96:99], v[108:111], v[104:107], v[96:99]
    v_mfma_f32_16x16x32_bf16 v[88:91], v[16:19], v[200:203], v[88:91]
    ds_read_b64_tr_b16 v[32:33], v5 offset:20600
    v_mfma_f32_16x16x32_bf16 v[92:95], v[16:19], v[204:207], v[92:95]
    ds_read_b64_tr_b16 v[34:35], v5 offset:21880
    ds_read_b128 v[104:107], v9 offset:12288
    ds_read_b64_tr_b16 v[108:109], v7 offset:20480
    ds_read_b64_tr_b16 v[110:111], v7 offset:21760
    s_waitcnt lgkmcnt(9)
    v_mfma_f32_16x16x32_bf16 v[40:43], v[20:23], v[208:211], v[40:43]
    ds_read_b64_tr_b16 v[16:17], v8 offset:20480
    v_mfma_f32_16x16x32_bf16 v[44:47], v[20:23], v[212:215], v[44:47]
    ds_read_b64_tr_b16 v[18:19], v8 offset:21760
    v_mfma_f32_16x16x32_bf16 v[48:51], v[24:27], v[208:211], v[48:51]
    ds_read_b64_tr_b16 v[20:21], v5 offset:20688
    v_mfma_f32_16x16x32_bf16 v[52:55], v[24:27], v[212:215], v[52:55]
    ds_read_b64_tr_b16 v[22:23], v5 offset:21968
    s_waitcnt lgkmcnt(7)
    v_mfma_f32_16x16x32_bf16 v[56:59], v[28:31], v[208:211], v[56:59]
    ds_read_b64_tr_b16 v[24:25], v5 offset:20720
    v_and_b32 v15, 0xffff0000, v13
    v_mfma_f32_16x16x32_bf16 v[60:63], v[28:31], v[212:215], v[60:63]
    ds_read_b64_tr_b16 v[26:27], v5 offset:22000
    v_lshlrev_b32 v14, 16, v13
    v_mfma_f32_16x16x32_bf16 v[64:67], v[32:35], v[208:211], v[64:67]
    ds_read_b64_tr_b16 v[28:29], v5 offset:30720
    v_and_b32 v13, 0xffff0000, v12
    v_mfma_f32_16x16x32_bf16 v[68:71], v[32:35], v[212:215], v[68:71]
    ds_read_b64_tr_b16 v[30:31], v5 offset:32000
    v_lshlrev_b32 v12, 16, v12
    s_waitcnt lgkmcnt(4)
    v_mfma_f32_16x16x32_bf16 v[72:75], v[16:19], v[208:211], v[72:75]
    ds_read_b64_tr_b16 v[32:33], v5 offset:30752
    v_mul_f32 v36, v12, v12
    v_mfma_f32_16x16x32_bf16 v[76:79], v[16:19], v[212:215], v[76:79]
    ds_read_b64_tr_b16 v[34:35], v5 offset:32032
    v_mul_f32 v37, v13, v13
    v_mfma_f32_16x16x32_bf16 v[100:103], v[16:19], v[104:107], v[100:103]
    v_mfma_f32_16x16x32_bf16 v[80:83], v[20:23], v[208:211], v[80:83]
    ds_read_b64_tr_b16 v[16:17], v6 offset:30720
    v_mul_f32 v38, v14, v14
    v_mfma_f32_16x16x32_bf16 v[84:87], v[20:23], v[212:215], v[84:87]
    ds_read_b64_tr_b16 v[18:19], v6 offset:32000
    v_mul_f32 v39, v15, v15
    v_mfma_f32_16x16x32_bf16 v[96:99], v[108:111], v[104:107], v[96:99]
    ds_read_b128 v[104:107], v9 offset:13312
    ds_read_b64_tr_b16 v[108:109], v7 offset:30720
    ds_read_b64_tr_b16 v[110:111], v7 offset:32000
    s_waitcnt lgkmcnt(7)
    v_mfma_f32_16x16x32_bf16 v[88:91], v[24:27], v[208:211], v[88:91]
    ds_read_b64_tr_b16 v[20:21], v5 offset:30840
    v_fma_f32 v36, v36, v0, s78
    v_mfma_f32_16x16x32_bf16 v[92:95], v[24:27], v[212:215], v[92:95]
    ds_read_b64_tr_b16 v[22:23], v5 offset:32120
    v_fma_f32 v37, v37, v0, s78
    v_mfma_f32_16x16x32_bf16 v[40:43], v[28:31], v[216:219], v[40:43]
    ds_read_b64_tr_b16 v[24:25], v8 offset:30720
    v_fma_f32 v38, v38, v0, s78
    v_mfma_f32_16x16x32_bf16 v[44:47], v[28:31], v[220:223], v[44:47]
    ds_read_b64_tr_b16 v[26:27], v8 offset:32000
    v_fma_f32 v39, v39, v0, s78
    s_waitcnt lgkmcnt(7)
    v_mfma_f32_16x16x32_bf16 v[48:51], v[32:35], v[216:219], v[48:51]
    ds_read_b64_tr_b16 v[28:29], v5 offset:30928
    v_mul_f32 v36, v36, v12
    v_mfma_f32_16x16x32_bf16 v[52:55], v[32:35], v[220:223], v[52:55]
    ds_read_b64_tr_b16 v[30:31], v5 offset:32208
    v_mul_f32 v37, v37, v13
    v_mfma_f32_16x16x32_bf16 v[56:59], v[16:19], v[216:219], v[56:59]
    ds_read_b64_tr_b16 v[32:33], v5 offset:30960
    v_mul_f32 v38, v38, v14
    v_mfma_f32_16x16x32_bf16 v[60:63], v[16:19], v[220:223], v[60:63]
    ds_read_b64_tr_b16 v[34:35], v5 offset:32240
    v_mul_f32 v39, v39, v15
    s_waitcnt lgkmcnt(4)
    v_mfma_f32_16x16x32_bf16 v[64:67], v[20:23], v[216:219], v[64:67]
    s_barrier
    v_add_u32 v5, -40960, v5
    ds_read_b64_tr_b16 v[16:17], v5 offset:0
    v_exp_f32 v36, v36
    v_mfma_f32_16x16x32_bf16 v[68:71], v[20:23], v[220:223], v[68:71]
    ds_read_b64_tr_b16 v[18:19], v5 offset:1280
    v_exp_f32 v37, v37
    v_mfma_f32_16x16x32_bf16 v[72:75], v[24:27], v[216:219], v[72:75]
    ds_read_b64_tr_b16 v[20:21], v5 offset:32
    v_exp_f32 v38, v38
    v_mfma_f32_16x16x32_bf16 v[76:79], v[24:27], v[220:223], v[76:79]
    ds_read_b64_tr_b16 v[22:23], v5 offset:1312
    v_exp_f32 v39, v39
    v_mfma_f32_16x16x32_bf16 v[100:103], v[24:27], v[104:107], v[100:103]
    s_waitcnt lgkmcnt(4)
    v_mfma_f32_16x16x32_bf16 v[80:83], v[28:31], v[216:219], v[80:83]
    v_add_u32 v6, -40960, v6
    ds_read_b64_tr_b16 v[24:25], v6 offset:0
    v_add_f32 v36, 1.0, v36
    v_mfma_f32_16x16x32_bf16 v[84:87], v[28:31], v[220:223], v[84:87]
    ds_read_b64_tr_b16 v[26:27], v6 offset:1280
    v_add_f32 v37, 1.0, v37
    v_mfma_f32_16x16x32_bf16 v[96:99], v[108:111], v[104:107], v[96:99]
    v_mfma_f32_16x16x32_bf16 v[88:91], v[32:35], v[216:219], v[88:91]
    ds_read_b64_tr_b16 v[28:29], v5 offset:120
    v_add_f32 v38, 1.0, v38
    v_mfma_f32_16x16x32_bf16 v[92:95], v[32:35], v[220:223], v[92:95]
    ds_read_b64_tr_b16 v[30:31], v5 offset:1400
    v_add_f32 v39, 1.0, v39
    ds_read_b128 v[104:107], v9 offset:14336
    v_add_u32 v7, -40960, v7
    ds_read_b64_tr_b16 v[108:109], v7 offset:0
    ds_read_b64_tr_b16 v[110:111], v7 offset:1280
    s_waitcnt lgkmcnt(7)
    v_mfma_f32_16x16x32_bf16 v[40:43], v[16:19], v[224:227], v[40:43]
    v_add_u32 v8, -40960, v8
    ds_read_b64_tr_b16 v[32:33], v8 offset:0
    v_rcp_f32 v36, v36
    v_mfma_f32_16x16x32_bf16 v[44:47], v[16:19], v[228:231], v[44:47]
    ds_read_b64_tr_b16 v[34:35], v8 offset:1280
    v_rcp_f32 v37, v37
    v_mfma_f32_16x16x32_bf16 v[48:51], v[20:23], v[224:227], v[48:51]
    ds_read_b64_tr_b16 v[16:17], v5 offset:208
    v_rcp_f32 v38, v38
    v_mfma_f32_16x16x32_bf16 v[52:55], v[20:23], v[228:231], v[52:55]
    ds_read_b64_tr_b16 v[18:19], v5 offset:1488
    v_rcp_f32 v39, v39
    s_waitcnt lgkmcnt(7)
    v_mfma_f32_16x16x32_bf16 v[56:59], v[24:27], v[224:227], v[56:59]
    ds_read_b64_tr_b16 v[20:21], v5 offset:240
    v_mul_f32 v12, v12, v36
    v_mfma_f32_16x16x32_bf16 v[60:63], v[24:27], v[228:231], v[60:63]
    ds_read_b64_tr_b16 v[22:23], v5 offset:1520
    v_mul_f32 v13, v13, v37
    v_mfma_f32_16x16x32_bf16 v[64:67], v[28:31], v[224:227], v[64:67]
    ds_read_b64_tr_b16 v[24:25], v5 offset:10240
    v_mul_f32 v14, v14, v38
    v_mfma_f32_16x16x32_bf16 v[68:71], v[28:31], v[228:231], v[68:71]
    ds_read_b64_tr_b16 v[26:27], v5 offset:11520
    v_mul_f32 v15, v15, v39
    s_waitcnt lgkmcnt(4)
    v_mfma_f32_16x16x32_bf16 v[72:75], v[32:35], v[224:227], v[72:75]
    ds_read_b64_tr_b16 v[28:29], v5 offset:10272
    v_cvt_pk_bf16_f32 v36, v12, v13
    v_mfma_f32_16x16x32_bf16 v[76:79], v[32:35], v[228:231], v[76:79]
    ds_read_b64_tr_b16 v[30:31], v5 offset:11552
    v_cvt_pk_bf16_f32 v37, v14, v15
    v_mfma_f32_16x16x32_bf16 v[100:103], v[32:35], v[104:107], v[100:103]
    v_mfma_f32_16x16x32_bf16 v[80:83], v[16:19], v[224:227], v[80:83]
    ds_read_b64_tr_b16 v[32:33], v6 offset:10240
    ds_write_b64 v10, v[36:37] offset:4992
    v_mfma_f32_16x16x32_bf16 v[84:87], v[16:19], v[228:231], v[84:87]
    ds_read_b64_tr_b16 v[34:35], v6 offset:11520
    v_mfma_f32_16x16x32_bf16 v[96:99], v[108:111], v[104:107], v[96:99]
    ds_read_b128 v[104:107], v9 offset:15360
    ds_read_b64_tr_b16 v[108:109], v7 offset:10240
    ds_read_b64_tr_b16 v[110:111], v7 offset:11520
    s_waitcnt lgkmcnt(8)
    v_mfma_f32_16x16x32_bf16 v[88:91], v[20:23], v[224:227], v[88:91]
    ds_read_b64_tr_b16 v[16:17], v5 offset:10360
    v_mfma_f32_16x16x32_bf16 v[92:95], v[20:23], v[228:231], v[92:95]
    ds_read_b64_tr_b16 v[18:19], v5 offset:11640
    v_mfma_f32_16x16x32_bf16 v[40:43], v[24:27], v[232:235], v[40:43]
    ds_read_b64_tr_b16 v[20:21], v8 offset:10240
    v_mfma_f32_16x16x32_bf16 v[44:47], v[24:27], v[236:239], v[44:47]
    ds_read_b64_tr_b16 v[22:23], v8 offset:11520
    s_waitcnt lgkmcnt(7)
    v_mfma_f32_16x16x32_bf16 v[48:51], v[28:31], v[232:235], v[48:51]
    ds_read_b64_tr_b16 v[24:25], v5 offset:10448
    v_mfma_f32_16x16x32_bf16 v[52:55], v[28:31], v[236:239], v[52:55]
    ds_read_b64_tr_b16 v[26:27], v5 offset:11728
    v_mfma_f32_16x16x32_bf16 v[56:59], v[32:35], v[232:235], v[56:59]
    ds_read_b64_tr_b16 v[28:29], v5 offset:10480
    v_mfma_f32_16x16x32_bf16 v[60:63], v[32:35], v[236:239], v[60:63]
    ds_read_b64_tr_b16 v[30:31], v5 offset:11760
    s_waitcnt lgkmcnt(4)
    v_mfma_f32_16x16x32_bf16 v[64:67], v[16:19], v[232:235], v[64:67]
    s_barrier
    ds_read_b64_tr_b16 v[32:33], v5 offset:20480
    v_mfma_f32_16x16x32_bf16 v[68:71], v[16:19], v[236:239], v[68:71]
    ds_read_b64_tr_b16 v[34:35], v5 offset:21760
    v_mfma_f32_16x16x32_bf16 v[72:75], v[20:23], v[232:235], v[72:75]
    ds_read_b64_tr_b16 v[16:17], v5 offset:20512
    v_mfma_f32_16x16x32_bf16 v[76:79], v[20:23], v[236:239], v[76:79]
    ds_read_b64_tr_b16 v[18:19], v5 offset:21792
    v_mfma_f32_16x16x32_bf16 v[100:103], v[20:23], v[104:107], v[100:103]
    s_waitcnt lgkmcnt(4)
    v_mfma_f32_16x16x32_bf16 v[80:83], v[24:27], v[232:235], v[80:83]
    ds_read_b64_tr_b16 v[20:21], v6 offset:20480
    v_mfma_f32_16x16x32_bf16 v[84:87], v[24:27], v[236:239], v[84:87]
    ds_read_b64_tr_b16 v[22:23], v6 offset:21760
    v_mfma_f32_16x16x32_bf16 v[96:99], v[108:111], v[104:107], v[96:99]
    v_mfma_f32_16x16x32_bf16 v[88:91], v[28:31], v[232:235], v[88:91]
    ds_read_b64_tr_b16 v[24:25], v5 offset:20600
    v_mfma_f32_16x16x32_bf16 v[92:95], v[28:31], v[236:239], v[92:95]
    ds_read_b64_tr_b16 v[26:27], v5 offset:21880
    ds_read_b128 v[104:107], v9 offset:16384
    ds_read_b64_tr_b16 v[108:109], v7 offset:20480
    ds_read_b64_tr_b16 v[110:111], v7 offset:21760
    s_waitcnt lgkmcnt(7)
    v_mfma_f32_16x16x32_bf16 v[40:43], v[32:35], v[240:243], v[40:43]
    ds_read_b64_tr_b16 v[28:29], v8 offset:20480
    v_mfma_f32_16x16x32_bf16 v[44:47], v[32:35], v[244:247], v[44:47]
    ds_read_b64_tr_b16 v[30:31], v8 offset:21760
    v_mfma_f32_16x16x32_bf16 v[48:51], v[16:19], v[240:243], v[48:51]
    ds_read_b64_tr_b16 v[32:33], v5 offset:20688
    v_mfma_f32_16x16x32_bf16 v[52:55], v[16:19], v[244:247], v[52:55]
    ds_read_b64_tr_b16 v[34:35], v5 offset:21968
    s_waitcnt lgkmcnt(7)
    v_mfma_f32_16x16x32_bf16 v[56:59], v[20:23], v[240:243], v[56:59]
    ds_read_b64_tr_b16 v[16:17], v5 offset:20720
    v_mfma_f32_16x16x32_bf16 v[60:63], v[20:23], v[244:247], v[60:63]
    ds_read_b64_tr_b16 v[18:19], v5 offset:22000
    v_mfma_f32_16x16x32_bf16 v[64:67], v[24:27], v[240:243], v[64:67]
    ds_read_b64_tr_b16 v[20:21], v5 offset:30720
    v_mfma_f32_16x16x32_bf16 v[68:71], v[24:27], v[244:247], v[68:71]
    ds_read_b64_tr_b16 v[22:23], v5 offset:32000
    s_waitcnt lgkmcnt(4)
    v_mfma_f32_16x16x32_bf16 v[72:75], v[28:31], v[240:243], v[72:75]
    ds_read_b64_tr_b16 v[24:25], v5 offset:30752
    v_mfma_f32_16x16x32_bf16 v[76:79], v[28:31], v[244:247], v[76:79]
    ds_read_b64_tr_b16 v[26:27], v5 offset:32032
    v_mfma_f32_16x16x32_bf16 v[100:103], v[28:31], v[104:107], v[100:103]
    v_mfma_f32_16x16x32_bf16 v[80:83], v[32:35], v[240:243], v[80:83]
    ds_read_b64_tr_b16 v[28:29], v6 offset:30720
    v_mfma_f32_16x16x32_bf16 v[84:87], v[32:35], v[244:247], v[84:87]
    ds_read_b64_tr_b16 v[30:31], v6 offset:32000
    v_mfma_f32_16x16x32_bf16 v[96:99], v[108:111], v[104:107], v[96:99]
    ds_read_b128 v[104:107], v9 offset:17408
    ds_read_b64_tr_b16 v[108:109], v7 offset:30720
    ds_read_b64_tr_b16 v[110:111], v7 offset:32000
    s_waitcnt lgkmcnt(7)
    v_mfma_f32_16x16x32_bf16 v[88:91], v[16:19], v[240:243], v[88:91]
    ds_read_b64_tr_b16 v[32:33], v5 offset:30840
    v_mfma_f32_16x16x32_bf16 v[92:95], v[16:19], v[244:247], v[92:95]
    ds_read_b64_tr_b16 v[34:35], v5 offset:32120
    v_mfma_f32_16x16x32_bf16 v[40:43], v[20:23], v[248:251], v[40:43]
    ds_read_b64_tr_b16 v[16:17], v8 offset:30720
    s_mov_b64 exec, 0x1fffff
    buffer_load_dword v1, s[20:23], s9 idxen lds
    s_mov_b64 exec, -1
    v_mfma_f32_16x16x32_bf16 v[44:47], v[20:23], v[252:255], v[44:47]
    ds_read_b64_tr_b16 v[18:19], v8 offset:32000
    s_waitcnt lgkmcnt(7)
    v_mfma_f32_16x16x32_bf16 v[48:51], v[24:27], v[248:251], v[48:51]
    ds_read_b64_tr_b16 v[20:21], v5 offset:30928
    v_mfma_f32_16x16x32_bf16 v[52:55], v[24:27], v[252:255], v[52:55]
    ds_read_b64_tr_b16 v[22:23], v5 offset:32208
    v_mfma_f32_16x16x32_bf16 v[56:59], v[28:31], v[248:251], v[56:59]
    ds_read_b64_tr_b16 v[24:25], v5 offset:30960
    v_mfma_f32_16x16x32_bf16 v[60:63], v[28:31], v[252:255], v[60:63]
    ds_read_b64_tr_b16 v[26:27], v5 offset:32240
    s_waitcnt lgkmcnt(4)
    v_mfma_f32_16x16x32_bf16 v[64:67], v[32:35], v[248:251], v[64:67]
    s_barrier
    ds_read_b64_tr_b16 v[28:29], v2 offset:0
    v_mfma_f32_16x16x32_bf16 v[68:71], v[32:35], v[252:255], v[68:71]
    ds_read_b64_tr_b16 v[30:31], v2 offset:1280
    v_mfma_f32_16x16x32_bf16 v[72:75], v[16:19], v[248:251], v[72:75]
    ds_read_b64_tr_b16 v[32:33], v3 offset:32
    v_mfma_f32_16x16x32_bf16 v[76:79], v[16:19], v[252:255], v[76:79]
    ds_read_b64_tr_b16 v[34:35], v3 offset:1312
    v_mfma_f32_16x16x32_bf16 v[100:103], v[16:19], v[104:107], v[100:103]
    s_waitcnt lgkmcnt(4)
    v_mfma_f32_16x16x32_bf16 v[80:83], v[20:23], v[248:251], v[80:83]
    ds_read_b64_tr_b16 v[16:17], v2 offset:64
    v_mfma_f32_16x16x32_bf16 v[84:87], v[20:23], v[252:255], v[84:87]
    ds_read_b64_tr_b16 v[18:19], v2 offset:1344
    v_mfma_f32_16x16x32_bf16 v[96:99], v[108:111], v[104:107], v[96:99]
    v_mfma_f32_16x16x32_bf16 v[88:91], v[24:27], v[248:251], v[88:91]
    ds_read_b64_tr_b16 v[20:21], v3 offset:96
    v_mfma_f32_16x16x32_bf16 v[92:95], v[24:27], v[252:255], v[92:95]
    ds_read_b64_tr_b16 v[22:23], v3 offset:1376
    s_mul_i32 s98, s51, 7680
    v_subrev_u32 v5, s98, v11
    v_add_u32 v38, s69, v5
    v_cvt_pk_bf16_f32 v12, v40, v41
    v_cvt_pk_bf16_f32 v13, v42, v43
    s_waitcnt lgkmcnt(4)
    v_mfma_f32_16x16x32_bf16 v[40:43], v[28:31], v[112:115], 0
    ds_read_b64_tr_b16 v[24:25], v2 offset:128
    ds_write_b64 v11, v[12:13] offset:3840
    v_cvt_pk_bf16_f32 v14, v44, v45
    v_cvt_pk_bf16_f32 v15, v46, v47
    v_cvt_pk_bf16_f32 v96, v96, v97
    v_cvt_pk_bf16_f32 v97, v98, v99
    v_mfma_f32_16x16x32_bf16 v[44:47], v[28:31], v[116:119], 0
    ds_read_b64_tr_b16 v[26:27], v2 offset:1408
    ds_write_b64 v11, v[14:15] offset:7680
    v_cvt_pk_bf16_f32 v6, v48, v49
    v_cvt_pk_bf16_f32 v7, v50, v51
    v_cvt_pk_bf16_f32 v100, v100, v101
    v_cvt_pk_bf16_f32 v101, v102, v103
    v_mfma_f32_16x16x32_bf16 v[48:51], v[32:35], v[112:115], 0
    ds_read_b64_tr_b16 v[28:29], v3 offset:160
    ds_write_b64 v11, v[6:7] offset:3872
    ds_write_b64 v38, v[96:97] offset:0
    v_cvt_pk_bf16_f32 v8, v52, v53
    v_cvt_pk_bf16_f32 v9, v54, v55
    v_mfma_f32_16x16x32_bf16 v[52:55], v[32:35], v[116:119], 0
    ds_read_b64_tr_b16 v[30:31], v3 offset:1440
    ds_write_b64 v11, v[8:9] offset:7712
    ds_write_b64 v5, v[100:101] offset:128
    v_cvt_pk_bf16_f32 v12, v56, v57
    v_cvt_pk_bf16_f32 v13, v58, v59
    s_waitcnt lgkmcnt(10)
    v_mfma_f32_16x16x32_bf16 v[56:59], v[16:19], v[112:115], 0
    ds_read_b64_tr_b16 v[32:33], v2 offset:192
    ds_write_b64 v11, v[12:13] offset:3904
    v_cvt_pk_bf16_f32 v14, v60, v61
    v_cvt_pk_bf16_f32 v15, v62, v63
    v_mfma_f32_16x16x32_bf16 v[60:63], v[16:19], v[116:119], 0
    ds_read_b64_tr_b16 v[34:35], v2 offset:1472
    ds_write_b64 v11, v[14:15] offset:7744
    v_cvt_pk_bf16_f32 v6, v64, v65
    v_cvt_pk_bf16_f32 v7, v66, v67
    v_mfma_f32_16x16x32_bf16 v[64:67], v[20:23], v[112:115], 0
    ds_read_b64_tr_b16 v[16:17], v3 offset:224
    ds_write_b64 v11, v[6:7] offset:3936
    v_cvt_pk_bf16_f32 v8, v68, v69
    v_cvt_pk_bf16_f32 v9, v70, v71
    v_mfma_f32_16x16x32_bf16 v[68:71], v[20:23], v[116:119], 0
    ds_read_b64_tr_b16 v[18:19], v3 offset:1504
    ds_write_b64 v11, v[8:9] offset:7776
    v_cvt_pk_bf16_f32 v12, v72, v73
    v_cvt_pk_bf16_f32 v13, v74, v75
    s_waitcnt lgkmcnt(10)
    v_mfma_f32_16x16x32_bf16 v[72:75], v[24:27], v[112:115], 0
    ds_read_b64_tr_b16 v[20:21], v4 offset:0
    ds_write_b64 v11, v[12:13] offset:3968
    v_cvt_pk_bf16_f32 v14, v76, v77
    v_cvt_pk_bf16_f32 v15, v78, v79
    v_mfma_f32_16x16x32_bf16 v[76:79], v[24:27], v[116:119], 0
    ds_read_b64_tr_b16 v[22:23], v4 offset:1280
    ds_write_b64 v11, v[14:15] offset:7808
    v_cvt_pk_bf16_f32 v6, v80, v81
    v_cvt_pk_bf16_f32 v7, v82, v83
    v_mfma_f32_16x16x32_bf16 v[80:83], v[28:31], v[112:115], 0
    ds_read_b64_tr_b16 v[24:25], v2 offset:10240
    ds_write_b64 v11, v[6:7] offset:4000
    v_cvt_pk_bf16_f32 v8, v84, v85
    v_cvt_pk_bf16_f32 v9, v86, v87
    v_mfma_f32_16x16x32_bf16 v[84:87], v[28:31], v[116:119], 0
    ds_read_b64_tr_b16 v[26:27], v2 offset:11520
    ds_write_b64 v11, v[8:9] offset:7840
    v_cvt_pk_bf16_f32 v12, v88, v89
    v_cvt_pk_bf16_f32 v13, v90, v91
    s_waitcnt lgkmcnt(9)
    v_mfma_f32_16x16x32_bf16 v[88:91], v[32:35], v[112:115], 0
    ds_read_b64_tr_b16 v[28:29], v3 offset:10272
    ds_write_b64 v11, v[12:13] offset:4032
    v_cvt_pk_bf16_f32 v14, v92, v93
    v_cvt_pk_bf16_f32 v15, v94, v95
    v_mfma_f32_16x16x32_bf16 v[92:95], v[32:35], v[116:119], 0
    ds_read_b64_tr_b16 v[30:31], v3 offset:11552
    ds_write_b64 v11, v[14:15] offset:7872
    v_mfma_f32_16x16x32_bf16 v[96:99], v[16:19], v[112:115], 0
    ds_read_b64_tr_b16 v[32:33], v2 offset:10304
    v_mfma_f32_16x16x32_bf16 v[100:103], v[16:19], v[116:119], 0
    ds_read_b64_tr_b16 v[34:35], v2 offset:11584
    s_waitcnt lgkmcnt(7)
    v_mfma_f32_16x16x32_bf16 v[104:107], v[20:23], v[112:115], 0
    ds_read_b64_tr_b16 v[16:17], v3 offset:10336
    v_mfma_f32_16x16x32_bf16 v[108:111], v[20:23], v[116:119], 0
    ds_read_b64_tr_b16 v[18:19], v3 offset:11616
    v_mfma_f32_16x16x32_bf16 v[40:43], v[24:27], v[120:123], v[40:43]
    ds_read_b64_tr_b16 v[20:21], v2 offset:10368
    v_mfma_f32_16x16x32_bf16 v[44:47], v[24:27], v[124:127], v[44:47]
    ds_read_b64_tr_b16 v[22:23], v2 offset:11648
    s_waitcnt lgkmcnt(4)
    v_mfma_f32_16x16x32_bf16 v[48:51], v[28:31], v[120:123], v[48:51]
    ds_read_b64_tr_b16 v[24:25], v3 offset:10400
    v_mfma_f32_16x16x32_bf16 v[52:55], v[28:31], v[124:127], v[52:55]
    ds_read_b64_tr_b16 v[26:27], v3 offset:11680
    v_mfma_f32_16x16x32_bf16 v[56:59], v[32:35], v[120:123], v[56:59]
    ds_read_b64_tr_b16 v[28:29], v2 offset:10432
    v_mfma_f32_16x16x32_bf16 v[60:63], v[32:35], v[124:127], v[60:63]
    ds_read_b64_tr_b16 v[30:31], v2 offset:11712
    s_waitcnt lgkmcnt(4)
    v_mfma_f32_16x16x32_bf16 v[64:67], v[16:19], v[120:123], v[64:67]
    ds_read_b64_tr_b16 v[32:33], v3 offset:10464
    v_mfma_f32_16x16x32_bf16 v[68:71], v[16:19], v[124:127], v[68:71]
    ds_read_b64_tr_b16 v[34:35], v3 offset:11744
    v_mfma_f32_16x16x32_bf16 v[72:75], v[20:23], v[120:123], v[72:75]
    ds_read_b64_tr_b16 v[16:17], v4 offset:10240
    v_mfma_f32_16x16x32_bf16 v[76:79], v[20:23], v[124:127], v[76:79]
    ds_read_b64_tr_b16 v[18:19], v4 offset:11520
    s_waitcnt lgkmcnt(4)
    v_mfma_f32_16x16x32_bf16 v[80:83], v[24:27], v[120:123], v[80:83]
    s_barrier
    ds_read_b64_tr_b16 v[20:21], v2 offset:20480
    v_mfma_f32_16x16x32_bf16 v[84:87], v[24:27], v[124:127], v[84:87]
    ds_read_b64_tr_b16 v[22:23], v2 offset:21760
    v_mfma_f32_16x16x32_bf16 v[88:91], v[28:31], v[120:123], v[88:91]
    ds_read_b64_tr_b16 v[24:25], v3 offset:20512
    v_mfma_f32_16x16x32_bf16 v[92:95], v[28:31], v[124:127], v[92:95]
    ds_read_b64_tr_b16 v[26:27], v3 offset:21792
    s_waitcnt lgkmcnt(4)
    v_mfma_f32_16x16x32_bf16 v[96:99], v[32:35], v[120:123], v[96:99]
    ds_read_b64_tr_b16 v[28:29], v2 offset:20544
    v_mfma_f32_16x16x32_bf16 v[100:103], v[32:35], v[124:127], v[100:103]
    ds_read_b64_tr_b16 v[30:31], v2 offset:21824
    v_mfma_f32_16x16x32_bf16 v[104:107], v[16:19], v[120:123], v[104:107]
    ds_read_b64_tr_b16 v[32:33], v3 offset:20576
    v_mfma_f32_16x16x32_bf16 v[108:111], v[16:19], v[124:127], v[108:111]
    ds_read_b64_tr_b16 v[34:35], v3 offset:21856
    s_waitcnt lgkmcnt(4)
    v_mfma_f32_16x16x32_bf16 v[40:43], v[20:23], v[128:131], v[40:43]
    ds_read_b64_tr_b16 v[16:17], v2 offset:20608
    v_mfma_f32_16x16x32_bf16 v[44:47], v[20:23], v[132:135], v[44:47]
    ds_read_b64_tr_b16 v[18:19], v2 offset:21888
    v_mfma_f32_16x16x32_bf16 v[48:51], v[24:27], v[128:131], v[48:51]
    ds_read_b64_tr_b16 v[20:21], v3 offset:20640
    v_mfma_f32_16x16x32_bf16 v[52:55], v[24:27], v[132:135], v[52:55]
    ds_read_b64_tr_b16 v[22:23], v3 offset:21920
    s_waitcnt lgkmcnt(4)
    v_mfma_f32_16x16x32_bf16 v[56:59], v[28:31], v[128:131], v[56:59]
    ds_read_b64_tr_b16 v[24:25], v2 offset:20672
    v_mfma_f32_16x16x32_bf16 v[60:63], v[28:31], v[132:135], v[60:63]
    ds_read_b64_tr_b16 v[26:27], v2 offset:21952
    v_mfma_f32_16x16x32_bf16 v[64:67], v[32:35], v[128:131], v[64:67]
    ds_read_b64_tr_b16 v[28:29], v3 offset:20704
    v_mfma_f32_16x16x32_bf16 v[68:71], v[32:35], v[132:135], v[68:71]
    ds_read_b64_tr_b16 v[30:31], v3 offset:21984
    s_waitcnt lgkmcnt(4)
    v_mfma_f32_16x16x32_bf16 v[72:75], v[16:19], v[128:131], v[72:75]
    ds_read_b64_tr_b16 v[32:33], v4 offset:20480
    v_mfma_f32_16x16x32_bf16 v[76:79], v[16:19], v[132:135], v[76:79]
    ds_read_b64_tr_b16 v[34:35], v4 offset:21760
    v_mfma_f32_16x16x32_bf16 v[80:83], v[20:23], v[128:131], v[80:83]
    ds_read_b64_tr_b16 v[16:17], v2 offset:30720
    v_mfma_f32_16x16x32_bf16 v[84:87], v[20:23], v[132:135], v[84:87]
    ds_read_b64_tr_b16 v[18:19], v2 offset:32000
    s_waitcnt lgkmcnt(4)
    v_mfma_f32_16x16x32_bf16 v[88:91], v[24:27], v[128:131], v[88:91]
    ds_read_b64_tr_b16 v[20:21], v3 offset:30752
    v_mfma_f32_16x16x32_bf16 v[92:95], v[24:27], v[132:135], v[92:95]
    ds_read_b64_tr_b16 v[22:23], v3 offset:32032
    v_mfma_f32_16x16x32_bf16 v[96:99], v[28:31], v[128:131], v[96:99]
    ds_read_b64_tr_b16 v[24:25], v2 offset:30784
    v_mfma_f32_16x16x32_bf16 v[100:103], v[28:31], v[132:135], v[100:103]
    ds_read_b64_tr_b16 v[26:27], v2 offset:32064
    s_waitcnt lgkmcnt(4)
    v_mfma_f32_16x16x32_bf16 v[104:107], v[32:35], v[128:131], v[104:107]
    ds_read_b64_tr_b16 v[28:29], v3 offset:30816
    v_mfma_f32_16x16x32_bf16 v[108:111], v[32:35], v[132:135], v[108:111]
    ds_read_b64_tr_b16 v[30:31], v3 offset:32096
    v_mfma_f32_16x16x32_bf16 v[40:43], v[16:19], v[136:139], v[40:43]
    ds_read_b64_tr_b16 v[32:33], v2 offset:30848
    v_mfma_f32_16x16x32_bf16 v[44:47], v[16:19], v[140:143], v[44:47]
    ds_read_b64_tr_b16 v[34:35], v2 offset:32128
    s_waitcnt lgkmcnt(4)
    v_mfma_f32_16x16x32_bf16 v[48:51], v[20:23], v[136:139], v[48:51]
    ds_read_b64_tr_b16 v[16:17], v3 offset:30880
    v_mfma_f32_16x16x32_bf16 v[52:55], v[20:23], v[140:143], v[52:55]
    ds_read_b64_tr_b16 v[18:19], v3 offset:32160
    v_mfma_f32_16x16x32_bf16 v[56:59], v[24:27], v[136:139], v[56:59]
    ds_read_b64_tr_b16 v[20:21], v2 offset:30912
    v_mfma_f32_16x16x32_bf16 v[60:63], v[24:27], v[140:143], v[60:63]
    ds_read_b64_tr_b16 v[22:23], v2 offset:32192
    s_waitcnt lgkmcnt(4)
    v_mfma_f32_16x16x32_bf16 v[64:67], v[28:31], v[136:139], v[64:67]
    ds_read_b64_tr_b16 v[24:25], v3 offset:30944
    v_mfma_f32_16x16x32_bf16 v[68:71], v[28:31], v[140:143], v[68:71]
    ds_read_b64_tr_b16 v[26:27], v3 offset:32224
    v_mfma_f32_16x16x32_bf16 v[72:75], v[32:35], v[136:139], v[72:75]
    ds_read_b64_tr_b16 v[28:29], v4 offset:30720
    v_mfma_f32_16x16x32_bf16 v[76:79], v[32:35], v[140:143], v[76:79]
    ds_read_b64_tr_b16 v[30:31], v4 offset:32000
    s_waitcnt lgkmcnt(4)
    v_mfma_f32_16x16x32_bf16 v[80:83], v[16:19], v[136:139], v[80:83]
    s_barrier
    v_add_u32 v2, -40960, v2
    ds_read_b64_tr_b16 v[32:33], v2 offset:0
    v_mfma_f32_16x16x32_bf16 v[84:87], v[16:19], v[140:143], v[84:87]
    ds_read_b64_tr_b16 v[34:35], v2 offset:1280
    v_mfma_f32_16x16x32_bf16 v[88:91], v[20:23], v[136:139], v[88:91]
    v_add_u32 v3, -40960, v3
    ds_read_b64_tr_b16 v[16:17], v3 offset:32
    v_mfma_f32_16x16x32_bf16 v[92:95], v[20:23], v[140:143], v[92:95]
    ds_read_b64_tr_b16 v[18:19], v3 offset:1312
    s_waitcnt lgkmcnt(4)
    v_mfma_f32_16x16x32_bf16 v[96:99], v[24:27], v[136:139], v[96:99]
    ds_read_b64_tr_b16 v[20:21], v2 offset:64
    v_mfma_f32_16x16x32_bf16 v[100:103], v[24:27], v[140:143], v[100:103]
    ds_read_b64_tr_b16 v[22:23], v2 offset:1344
    v_mfma_f32_16x16x32_bf16 v[104:107], v[28:31], v[136:139], v[104:107]
    ds_read_b64_tr_b16 v[24:25], v3 offset:96
    v_mfma_f32_16x16x32_bf16 v[108:111], v[28:31], v[140:143], v[108:111]
    ds_read_b64_tr_b16 v[26:27], v3 offset:1376
    s_waitcnt lgkmcnt(4)
    v_mfma_f32_16x16x32_bf16 v[40:43], v[32:35], v[144:147], v[40:43]
    ds_read_b64_tr_b16 v[28:29], v2 offset:128
    v_mfma_f32_16x16x32_bf16 v[44:47], v[32:35], v[148:151], v[44:47]
    ds_read_b64_tr_b16 v[30:31], v2 offset:1408
    v_mfma_f32_16x16x32_bf16 v[48:51], v[16:19], v[144:147], v[48:51]
    ds_read_b64_tr_b16 v[32:33], v3 offset:160
    v_mfma_f32_16x16x32_bf16 v[52:55], v[16:19], v[148:151], v[52:55]
    ds_read_b64_tr_b16 v[34:35], v3 offset:1440
    s_waitcnt lgkmcnt(4)
    v_mfma_f32_16x16x32_bf16 v[56:59], v[20:23], v[144:147], v[56:59]
    ds_read_b64_tr_b16 v[16:17], v2 offset:192
    v_mfma_f32_16x16x32_bf16 v[60:63], v[20:23], v[148:151], v[60:63]
    ds_read_b64_tr_b16 v[18:19], v2 offset:1472
    v_mfma_f32_16x16x32_bf16 v[64:67], v[24:27], v[144:147], v[64:67]
    ds_read_b64_tr_b16 v[20:21], v3 offset:224
    v_mfma_f32_16x16x32_bf16 v[68:71], v[24:27], v[148:151], v[68:71]
    ds_read_b64_tr_b16 v[22:23], v3 offset:1504
    s_waitcnt lgkmcnt(4)
    v_mfma_f32_16x16x32_bf16 v[72:75], v[28:31], v[144:147], v[72:75]
    v_add_u32 v4, -40960, v4
    ds_read_b64_tr_b16 v[24:25], v4 offset:0
    v_mfma_f32_16x16x32_bf16 v[76:79], v[28:31], v[148:151], v[76:79]
    ds_read_b64_tr_b16 v[26:27], v4 offset:1280
    v_mfma_f32_16x16x32_bf16 v[80:83], v[32:35], v[144:147], v[80:83]
    ds_read_b64_tr_b16 v[28:29], v2 offset:10240
    v_mfma_f32_16x16x32_bf16 v[84:87], v[32:35], v[148:151], v[84:87]
    ds_read_b64_tr_b16 v[30:31], v2 offset:11520
    s_waitcnt lgkmcnt(4)
    v_mfma_f32_16x16x32_bf16 v[88:91], v[16:19], v[144:147], v[88:91]
    ds_read_b64_tr_b16 v[32:33], v3 offset:10272
    v_mfma_f32_16x16x32_bf16 v[92:95], v[16:19], v[148:151], v[92:95]
    ds_read_b64_tr_b16 v[34:35], v3 offset:11552
    v_mfma_f32_16x16x32_bf16 v[96:99], v[20:23], v[144:147], v[96:99]
    ds_read_b64_tr_b16 v[16:17], v2 offset:10304
    v_mfma_f32_16x16x32_bf16 v[100:103], v[20:23], v[148:151], v[100:103]
    ds_read_b64_tr_b16 v[18:19], v2 offset:11584
    s_waitcnt lgkmcnt(4)
    v_mfma_f32_16x16x32_bf16 v[104:107], v[24:27], v[144:147], v[104:107]
    ds_read_b64_tr_b16 v[20:21], v3 offset:10336
    v_mfma_f32_16x16x32_bf16 v[108:111], v[24:27], v[148:151], v[108:111]
    ds_read_b64_tr_b16 v[22:23], v3 offset:11616
    v_mfma_f32_16x16x32_bf16 v[40:43], v[28:31], v[152:155], v[40:43]
    ds_read_b64_tr_b16 v[24:25], v2 offset:10368
    s_mov_b64 exec, 0x3f
    buffer_load_dword v1, s[24:27], s10 idxen lds
    s_mov_b64 exec, -1
    v_mfma_f32_16x16x32_bf16 v[44:47], v[28:31], v[156:159], v[44:47]
    ds_read_b64_tr_b16 v[26:27], v2 offset:11648
    s_waitcnt lgkmcnt(4)
    v_mfma_f32_16x16x32_bf16 v[48:51], v[32:35], v[152:155], v[48:51]
    ds_read_b64_tr_b16 v[28:29], v3 offset:10400
    v_mfma_f32_16x16x32_bf16 v[52:55], v[32:35], v[156:159], v[52:55]
    ds_read_b64_tr_b16 v[30:31], v3 offset:11680
    v_mfma_f32_16x16x32_bf16 v[56:59], v[16:19], v[152:155], v[56:59]
    ds_read_b64_tr_b16 v[32:33], v2 offset:10432
    v_mfma_f32_16x16x32_bf16 v[60:63], v[16:19], v[156:159], v[60:63]
    ds_read_b64_tr_b16 v[34:35], v2 offset:11712
    s_waitcnt lgkmcnt(4)
    v_mfma_f32_16x16x32_bf16 v[64:67], v[20:23], v[152:155], v[64:67]
    ds_read_b64_tr_b16 v[16:17], v3 offset:10464
    v_mfma_f32_16x16x32_bf16 v[68:71], v[20:23], v[156:159], v[68:71]
    ds_read_b64_tr_b16 v[18:19], v3 offset:11744
    v_mfma_f32_16x16x32_bf16 v[72:75], v[24:27], v[152:155], v[72:75]
    ds_read_b64_tr_b16 v[20:21], v4 offset:10240
    v_mfma_f32_16x16x32_bf16 v[76:79], v[24:27], v[156:159], v[76:79]
    ds_read_b64_tr_b16 v[22:23], v4 offset:11520
    s_waitcnt lgkmcnt(4)
    v_mfma_f32_16x16x32_bf16 v[80:83], v[28:31], v[152:155], v[80:83]
    s_barrier
    ds_read_b64_tr_b16 v[24:25], v2 offset:20480
    v_mfma_f32_16x16x32_bf16 v[84:87], v[28:31], v[156:159], v[84:87]
    ds_read_b64_tr_b16 v[26:27], v2 offset:21760
    v_mfma_f32_16x16x32_bf16 v[88:91], v[32:35], v[152:155], v[88:91]
    ds_read_b64_tr_b16 v[28:29], v3 offset:20512
    v_mfma_f32_16x16x32_bf16 v[92:95], v[32:35], v[156:159], v[92:95]
    ds_read_b64_tr_b16 v[30:31], v3 offset:21792
    s_waitcnt lgkmcnt(4)
    v_mfma_f32_16x16x32_bf16 v[96:99], v[16:19], v[152:155], v[96:99]
    ds_read_b64_tr_b16 v[32:33], v2 offset:20544
    v_mfma_f32_16x16x32_bf16 v[100:103], v[16:19], v[156:159], v[100:103]
    ds_read_b64_tr_b16 v[34:35], v2 offset:21824
    v_mfma_f32_16x16x32_bf16 v[104:107], v[20:23], v[152:155], v[104:107]
    ds_read_b64_tr_b16 v[16:17], v3 offset:20576
    v_mfma_f32_16x16x32_bf16 v[108:111], v[20:23], v[156:159], v[108:111]
    ds_read_b64_tr_b16 v[18:19], v3 offset:21856
    s_waitcnt lgkmcnt(4)
    v_mfma_f32_16x16x32_bf16 v[40:43], v[24:27], v[160:163], v[40:43]
    ds_read_b64_tr_b16 v[20:21], v2 offset:20608
    v_and_b32 v12, 15, v1
    v_mfma_f32_16x16x32_bf16 v[44:47], v[24:27], v[164:167], v[44:47]
    ds_read_b64_tr_b16 v[22:23], v2 offset:21888
    s_lshl_b32 s99, s51, 5
    v_add_u32 v13, s99, v12
    v_mfma_f32_16x16x32_bf16 v[48:51], v[28:31], v[160:163], v[48:51]
    ds_read_b64_tr_b16 v[24:25], v3 offset:20640
    v_mul_u32_u24 v10, 240, v13
    v_mfma_f32_16x16x32_bf16 v[52:55], v[28:31], v[164:167], v[52:55]
    ds_read_b64_tr_b16 v[26:27], v3 offset:21920
    v_lshrrev_b32 v14, 4, v1
    s_waitcnt lgkmcnt(4)
    v_mfma_f32_16x16x32_bf16 v[56:59], v[32:35], v[160:163], v[56:59]
    ds_read_b64_tr_b16 v[28:29], v2 offset:20672
    v_lshl_add_u32 v10, v14, 4, v10
    v_mfma_f32_16x16x32_bf16 v[60:63], v[32:35], v[164:167], v[60:63]
    ds_read_b64_tr_b16 v[30:31], v2 offset:21952
    v_add_u32 v10, 119808, v10
    v_mfma_f32_16x16x32_bf16 v[64:67], v[16:19], v[160:163], v[64:67]
    ds_read_b64_tr_b16 v[32:33], v3 offset:20704
    v_mfma_f32_16x16x32_bf16 v[68:71], v[16:19], v[164:167], v[68:71]
    ds_read_b64_tr_b16 v[34:35], v3 offset:21984
    ds_read_b128 v[112:115], v10 offset:3984
    s_waitcnt lgkmcnt(5)
    v_mfma_f32_16x16x32_bf16 v[72:75], v[20:23], v[160:163], v[72:75]
    ds_read_b64_tr_b16 v[16:17], v4 offset:20480
    ds_read_b128 v[116:119], v10 offset:7824
    v_mfma_f32_16x16x32_bf16 v[76:79], v[20:23], v[164:167], v[76:79]
    ds_read_b64_tr_b16 v[18:19], v4 offset:21760
    ds_read_b128 v[120:123], v10 offset:0
    v_mfma_f32_16x16x32_bf16 v[80:83], v[24:27], v[160:163], v[80:83]
    ds_read_b64_tr_b16 v[20:21], v2 offset:30720
    ds_read_b128 v[124:127], v10 offset:3840
    v_mfma_f32_16x16x32_bf16 v[84:87], v[24:27], v[164:167], v[84:87]
    ds_read_b64_tr_b16 v[22:23], v2 offset:32000
    ds_read_b128 v[128:131], v10 offset:7680
    s_waitcnt lgkmcnt(9)
    v_mfma_f32_16x16x32_bf16 v[88:91], v[28:31], v[160:163], v[88:91]
    ds_read_b64_tr_b16 v[24:25], v3 offset:30752
    v_lshrrev_b32 v11, 2, v1
    v_mfma_f32_16x16x32_bf16 v[92:95], v[28:31], v[164:167], v[92:95]
    ds_read_b64_tr_b16 v[26:27], v3 offset:32032
    v_add_u32 v11, s99, v11
    v_mfma_f32_16x16x32_bf16 v[96:99], v[32:35], v[160:163], v[96:99]
    ds_read_b64_tr_b16 v[28:29], v2 offset:30784
    v_mul_u32_u24 v11, 240, v11
    v_mfma_f32_16x16x32_bf16 v[100:103], v[32:35], v[164:167], v[100:103]
    ds_read_b64_tr_b16 v[30:31], v2 offset:32064
    v_and_b32 v15, 3, v1
    s_waitcnt lgkmcnt(5)
    v_mfma_f32_16x16x32_bf16 v[104:107], v[16:19], v[160:163], v[104:107]
    ds_read_b64_tr_b16 v[32:33], v3 offset:30816
    v_lshl_add_u32 v11, v15, 3, v11
    v_mfma_f32_16x16x32_bf16 v[108:111], v[16:19], v[164:167], v[108:111]
    ds_read_b64_tr_b16 v[34:35], v3 offset:32096
    v_add_u32 v11, 119880, v11
    v_mfma_f32_16x16x32_bf16 v[40:43], v[20:23], v[168:171], v[40:43]
    ds_read_b64_tr_b16 v[16:17], v2 offset:30848
    s_mul_i32 s98, s49, 36
    s_add_u32 s98, s98, 0
    v_lshl_add_u32 v14, v14, 2, s98
    v_mfma_f32_16x16x32_bf16 v[44:47], v[20:23], v[172:175], v[44:47]
    ds_read_b64_tr_b16 v[18:19], v2 offset:32128
    v_lshlrev_b32 v12, 4, v12
    s_waitcnt lgkmcnt(4)
    v_mfma_f32_16x16x32_bf16 v[48:51], v[24:27], v[168:171], v[48:51]
    ds_read_b64_tr_b16 v[20:21], v3 offset:30880
    v_lshrrev_b32 v15, 3, v14
    v_mfma_f32_16x16x32_bf16 v[52:55], v[24:27], v[172:175], v[52:55]
    ds_read_b64_tr_b16 v[22:23], v3 offset:32160
    v_lshl_add_u32 v148, v15, 8, v12
    v_mfma_f32_16x16x32_bf16 v[56:59], v[28:31], v[168:171], v[56:59]
    ds_read_b64_tr_b16 v[24:25], v2 offset:30912
    v_and_b32 v15, 7, v14
    v_mfma_f32_16x16x32_bf16 v[60:63], v[28:31], v[172:175], v[60:63]
    ds_read_b64_tr_b16 v[26:27], v2 offset:32192
    v_lshl_add_u32 v148, v15, 1, v148
    s_waitcnt lgkmcnt(4)
    v_mfma_f32_16x16x32_bf16 v[64:67], v[32:35], v[168:171], v[64:67]
    ds_read_b64_tr_b16 v[28:29], v3 offset:30944
    v_add_u32 v14, 2, v14
    v_mfma_f32_16x16x32_bf16 v[68:71], v[32:35], v[172:175], v[68:71]
    ds_read_b64_tr_b16 v[30:31], v3 offset:32224
    v_lshrrev_b32 v15, 3, v14
    v_mfma_f32_16x16x32_bf16 v[72:75], v[16:19], v[168:171], v[72:75]
    ds_read_b64_tr_b16 v[32:33], v4 offset:30720
    v_lshl_add_u32 v13, v15, 8, v12
    v_mfma_f32_16x16x32_bf16 v[76:79], v[16:19], v[172:175], v[76:79]
    ds_read_b64_tr_b16 v[34:35], v4 offset:32000
    v_and_b32 v15, 7, v14
    s_waitcnt lgkmcnt(4)
    v_mfma_f32_16x16x32_bf16 v[80:83], v[20:23], v[168:171], v[80:83]
    s_barrier
    v_add_u32 v2, 40960, v2
    ds_read_b64_tr_b16 v[16:17], v2 offset:0
    v_lshl_add_u32 v13, v15, 1, v13
    v_mfma_f32_16x16x32_bf16 v[84:87], v[20:23], v[172:175], v[84:87]
    ds_read_b64_tr_b16 v[18:19], v2 offset:1280
    v_mov_b32 v151, v12
    v_mfma_f32_16x16x32_bf16 v[88:91], v[24:27], v[168:171], v[88:91]
    v_add_u32 v3, 40960, v3
    ds_read_b64_tr_b16 v[20:21], v3 offset:32
    v_mov_b32 v12, v148
    v_mfma_f32_16x16x32_bf16 v[92:95], v[24:27], v[172:175], v[92:95]
    ds_read_b64_tr_b16 v[22:23], v3 offset:1312
    s_lshl_b32 s69, s48, 3
    s_lshl_b32 s70, s51, 1
    s_add_u32 s69, s69, s70
    s_mul_i32 s69, s69, 92160
    s_add_u32 s70, s69, 92160
    s_add_u32 s98, s98, 16
    s_lshr_b32 s71, s98, 3
    s_lshl_b32 s71, s71, 8
    s_and_b32 s99, s98, 7
    s_lshl_b32 s99, s99, 1
    s_add_u32 s71, s71, s99
    s_add_u32 s98, s98, 2
    s_lshr_b32 s73, s98, 3
    s_lshl_b32 s73, s73, 8
    s_and_b32 s99, s98, 7
    s_lshl_b32 s99, s99, 1
    s_add_u32 s73, s73, s99
    s_add_u32 s72, s71, s70
    s_add_u32 s71, s71, s69
    s_add_u32 s74, s73, s70
    s_add_u32 s73, s73, s69
    s_or_b32 s98, s48, s51
    s_cmp_eq_u32 s98, 0
    s_cselect_b32 s75, 0, -1
    s_mov_b32 s76, 0x55555555
    s_mov_b32 s77, 0x55555555
    v_mov_b32 v14, 0xce6e6b28
    s_waitcnt lgkmcnt(4)
    v_mfma_f32_16x16x32_bf16 v[96:99], v[28:31], v[168:171], v[96:99]
    ds_read_b64_tr_b16 v[24:25], v2 offset:64
    v_and_b32 v15, 1, v1
    v_mfma_f32_16x16x32_bf16 v[100:103], v[28:31], v[172:175], v[100:103]
    ds_read_b64_tr_b16 v[26:27], v2 offset:1344
    v_lshlrev_b32 v15, 4, v15
    v_mfma_f32_16x16x32_bf16 v[104:107], v[32:35], v[168:171], v[104:107]
    ds_read_b64_tr_b16 v[28:29], v3 offset:96
    s_mov_b32 exec_lo, 0
    v_mov_b32 v113, 0
    v_mov_b32 v114, 0
    v_mov_b32 v115, 0
    s_mov_b32 exec_hi, 0xffff0000
    v_mov_b32 v112, 0
    s_mov_b64 exec, -1
    v_mfma_f32_16x16x32_bf16 v[108:111], v[32:35], v[172:175], v[108:111]
    ds_read_b64_tr_b16 v[30:31], v3 offset:1376
    s_mov_b32 exec_lo, 0
    v_mov_b32 v117, 0
    v_mov_b32 v118, 0
    v_mov_b32 v119, 0
    s_mov_b32 exec_hi, 0xffff0000
    v_mov_b32 v116, 0
    s_mov_b64 exec, -1
    s_waitcnt lgkmcnt(4)
    v_mfma_f32_16x16x32_bf16 v[40:43], v[16:19], v[176:179], v[40:43]
    ds_read_b64_tr_b16 v[32:33], v2 offset:128
    v_mfma_f32_16x16x32_bf16 v[132:135], v[120:123], v[112:115], 0
    v_mfma_f32_16x16x32_bf16 v[44:47], v[16:19], v[180:183], v[44:47]
    ds_read_b64_tr_b16 v[34:35], v2 offset:1408
    v_mfma_f32_16x16x32_bf16 v[136:139], v[124:127], v[112:115], 0
    v_mfma_f32_16x16x32_bf16 v[48:51], v[20:23], v[176:179], v[48:51]
    ds_read_b64_tr_b16 v[16:17], v3 offset:160
    v_mfma_f32_16x16x32_bf16 v[140:143], v[124:127], v[116:119], 0
    v_mfma_f32_16x16x32_bf16 v[52:55], v[20:23], v[180:183], v[52:55]
    ds_read_b64_tr_b16 v[18:19], v3 offset:1440
    v_mfma_f32_16x16x32_bf16 v[144:147], v[128:131], v[116:119], 0
    s_waitcnt lgkmcnt(4)
    v_mfma_f32_16x16x32_bf16 v[56:59], v[24:27], v[176:179], v[56:59]
    ds_read_b64_tr_b16 v[20:21], v2 offset:192
    ds_read_b64_tr_b16 v[120:121], v11 offset:0
    v_mfma_f32_16x16x32_bf16 v[60:63], v[24:27], v[180:183], v[60:63]
    ds_read_b64_tr_b16 v[22:23], v2 offset:1472
    ds_read_b64_tr_b16 v[126:127], v11 offset:32
    v_mfma_f32_16x16x32_bf16 v[64:67], v[28:31], v[176:179], v[64:67]
    ds_read_b64_tr_b16 v[24:25], v3 offset:224
    ds_read_b64_tr_b16 v[122:123], v11 offset:3840
    v_mfma_f32_16x16x32_bf16 v[68:71], v[28:31], v[180:183], v[68:71]
    ds_read_b64_tr_b16 v[26:27], v3 offset:1504
    ds_read_b64_tr_b16 v[128:129], v11 offset:3872
    s_waitcnt lgkmcnt(8)
    v_mfma_f32_16x16x32_bf16 v[72:75], v[32:35], v[176:179], v[72:75]
    v_add_u32 v4, 40960, v4
    ds_read_b64_tr_b16 v[28:29], v4 offset:0
    ds_read_b64_tr_b16 v[124:125], v11 offset:7680
    v_mfma_f32_16x16x32_bf16 v[76:79], v[32:35], v[180:183], v[76:79]
    ds_read_b64_tr_b16 v[30:31], v4 offset:1280
    ds_read_b64_tr_b16 v[130:131], v11 offset:7712
    v_mfma_f32_16x16x32_bf16 v[80:83], v[16:19], v[176:179], v[80:83]
    ds_read_b64_tr_b16 v[32:33], v2 offset:10240
    v_cndmask_b32 v132, v133, v132, s[76:77]
    v_mfma_f32_16x16x32_bf16 v[84:87], v[16:19], v[180:183], v[84:87]
    ds_read_b64_tr_b16 v[34:35], v2 offset:11520
    v_cndmask_b32 v133, v135, v134, s[76:77]
    s_waitcnt lgkmcnt(7)
    v_mfma_f32_16x16x32_bf16 v[88:91], v[20:23], v[176:179], v[88:91]
    ds_read_b64_tr_b16 v[16:17], v3 offset:10272
    v_cndmask_b32 v136, v137, v136, s[76:77]
    v_mfma_f32_16x16x32_bf16 v[92:95], v[20:23], v[180:183], v[92:95]
    ds_read_b64_tr_b16 v[18:19], v3 offset:11552
    v_cndmask_b32 v137, v139, v138, s[76:77]
    v_mfma_f32_16x16x32_bf16 v[96:99], v[24:27], v[176:179], v[96:99]
    ds_read_b64_tr_b16 v[20:21], v2 offset:10304
    v_cndmask_b32 v140, v141, v140, s[76:77]
    v_mfma_f32_16x16x32_bf16 v[100:103], v[24:27], v[180:183], v[100:103]
    ds_read_b64_tr_b16 v[22:23], v2 offset:11584
    v_cndmask_b32 v141, v143, v142, s[76:77]
    s_waitcnt lgkmcnt(4)
    v_mfma_f32_16x16x32_bf16 v[104:107], v[28:31], v[176:179], v[104:107]
    ds_read_b64_tr_b16 v[24:25], v3 offset:10336
    v_cndmask_b32 v144, v145, v144, s[76:77]
    v_mfma_f32_16x16x32_bf16 v[108:111], v[28:31], v[180:183], v[108:111]
    ds_read_b64_tr_b16 v[26:27], v3 offset:11616
    v_cndmask_b32 v145, v147, v146, s[76:77]
    v_mfma_f32_16x16x32_bf16 v[40:43], v[32:35], v[184:187], v[40:43]
    ds_read_b64_tr_b16 v[28:29], v2 offset:10368
    s_mov_b32 vcc_lo, 0xf0000
    s_mov_b32 vcc_hi, 0xfff00ff
    v_cndmask_b32 v140, v14, v140, vcc
    s_and_b32 vcc_lo, vcc_lo, s75
    s_and_b32 vcc_hi, vcc_hi, s75
    v_cndmask_b32 v132, v14, v132, vcc
    v_mfma_f32_16x16x32_bf16 v[44:47], v[32:35], v[188:191], v[44:47]
    ds_read_b64_tr_b16 v[30:31], v2 offset:11648
    s_mov_b32 vcc_lo, 0x3f0003
    s_mov_b32 vcc_hi, 0x3fff03ff
    v_cndmask_b32 v141, v14, v141, vcc
    s_and_b32 vcc_lo, vcc_lo, s75
    s_and_b32 vcc_hi, vcc_hi, s75
    v_cndmask_b32 v133, v14, v133, vcc
    s_waitcnt lgkmcnt(4)
    v_mfma_f32_16x16x32_bf16 v[48:51], v[16:19], v[184:187], v[48:51]
    ds_read_b64_tr_b16 v[32:33], v3 offset:10400
    s_mov_b32 vcc_lo, 0xfff0ffff
    s_mov_b32 vcc_hi, 0xf000ff00
    v_cndmask_b32 v144, v14, v144, vcc
    v_cndmask_b32 v136, v14, v136, vcc
    v_mfma_f32_16x16x32_bf16 v[52:55], v[16:19], v[188:191], v[52:55]
    ds_read_b64_tr_b16 v[34:35], v3 offset:11680
    s_mov_b32 vcc_lo, 0xffc0fffc
    s_mov_b32 vcc_hi, 0xc000fc00
    v_cndmask_b32 v145, v14, v145, vcc
    v_cndmask_b32 v137, v14, v137, vcc
    v_mfma_f32_16x16x32_bf16 v[56:59], v[20:23], v[184:187], v[56:59]
    ds_read_b64_tr_b16 v[16:17], v2 offset:10432
    v_max3_f32 v148, v132, v133, v136
    v_mfma_f32_16x16x32_bf16 v[60:63], v[20:23], v[188:191], v[60:63]
    ds_read_b64_tr_b16 v[18:19], v2 offset:11712
    v_max_f32 v148, v148, v137
    s_waitcnt lgkmcnt(4)
    v_mfma_f32_16x16x32_bf16 v[64:67], v[24:27], v[184:187], v[64:67]
    ds_read_b64_tr_b16 v[20:21], v3 offset:10464
    v_max3_f32 v149, v140, v141, v144
    v_mfma_f32_16x16x32_bf16 v[68:71], v[24:27], v[188:191], v[68:71]
    ds_read_b64_tr_b16 v[22:23], v3 offset:11744
    v_max_f32 v149, v149, v145
    v_mfma_f32_16x16x32_bf16 v[72:75], v[28:31], v[184:187], v[72:75]
    ds_read_b64_tr_b16 v[24:25], v4 offset:10240
    v_mfma_f32_16x16x32_bf16 v[76:79], v[28:31], v[188:191], v[76:79]
    ds_read_b64_tr_b16 v[26:27], v4 offset:11520
    v_permlane16_swap_b32 v148, v149
    s_waitcnt lgkmcnt(4)
    v_mfma_f32_16x16x32_bf16 v[80:83], v[32:35], v[184:187], v[80:83]
    s_barrier
    ds_read_b64_tr_b16 v[28:29], v2 offset:20480
    v_max_f32 v148, v148, v149
    v_mfma_f32_16x16x32_bf16 v[84:87], v[32:35], v[188:191], v[84:87]
    ds_read_b64_tr_b16 v[30:31], v2 offset:21760
    v_mov_b32 v149, v148
    v_mfma_f32_16x16x32_bf16 v[88:91], v[16:19], v[184:187], v[88:91]
    ds_read_b64_tr_b16 v[32:33], v3 offset:20512
    v_mfma_f32_16x16x32_bf16 v[92:95], v[16:19], v[188:191], v[92:95]
    ds_read_b64_tr_b16 v[34:35], v3 offset:21792
    v_permlane32_swap_b32 v148, v149
    s_waitcnt lgkmcnt(4)
    v_mfma_f32_16x16x32_bf16 v[96:99], v[20:23], v[184:187], v[96:99]
    ds_read_b64_tr_b16 v[16:17], v2 offset:20544
    v_max_f32 v148, v148, v149
    v_mfma_f32_16x16x32_bf16 v[100:103], v[20:23], v[188:191], v[100:103]
    ds_read_b64_tr_b16 v[18:19], v2 offset:21824
    v_mov_b32 v149, v148
    v_mfma_f32_16x16x32_bf16 v[104:107], v[24:27], v[184:187], v[104:107]
    ds_read_b64_tr_b16 v[20:21], v3 offset:20576
    v_mfma_f32_16x16x32_bf16 v[108:111], v[24:27], v[188:191], v[108:111]
    ds_read_b64_tr_b16 v[22:23], v3 offset:21856
    v_permlane16_swap_b32 v148, v149
    s_waitcnt lgkmcnt(4)
    v_mfma_f32_16x16x32_bf16 v[40:43], v[28:31], v[192:195], v[40:43]
    ds_read_b64_tr_b16 v[24:25], v2 offset:20608
    v_mul_f32 v148, s79, v148
    v_mfma_f32_16x16x32_bf16 v[44:47], v[28:31], v[196:199], v[44:47]
    ds_read_b64_tr_b16 v[26:27], v2 offset:21888
    v_mul_f32 v149, s79, v149
    v_mfma_f32_16x16x32_bf16 v[48:51], v[32:35], v[192:195], v[48:51]
    ds_read_b64_tr_b16 v[28:29], v3 offset:20640
    v_fma_f32 v132, v132, s79, -v148
    v_mfma_f32_16x16x32_bf16 v[52:55], v[32:35], v[196:199], v[52:55]
    ds_read_b64_tr_b16 v[30:31], v3 offset:21920
    v_fma_f32 v133, v133, s79, -v148
    s_waitcnt lgkmcnt(4)
    v_mfma_f32_16x16x32_bf16 v[56:59], v[16:19], v[192:195], v[56:59]
    ds_read_b64_tr_b16 v[32:33], v2 offset:20672
    v_fma_f32 v136, v136, s79, -v148
    v_mfma_f32_16x16x32_bf16 v[60:63], v[16:19], v[196:199], v[60:63]
    ds_read_b64_tr_b16 v[34:35], v2 offset:21952
    v_fma_f32 v137, v137, s79, -v148
    v_mfma_f32_16x16x32_bf16 v[64:67], v[20:23], v[192:195], v[64:67]
    ds_read_b64_tr_b16 v[16:17], v3 offset:20704
    v_fma_f32 v140, v140, s79, -v149
    v_mfma_f32_16x16x32_bf16 v[68:71], v[20:23], v[196:199], v[68:71]
    ds_read_b64_tr_b16 v[18:19], v3 offset:21984
    v_fma_f32 v141, v141, s79, -v149
    s_waitcnt lgkmcnt(4)
    v_mfma_f32_16x16x32_bf16 v[72:75], v[24:27], v[192:195], v[72:75]
    ds_read_b64_tr_b16 v[20:21], v4 offset:20480
    v_fma_f32 v144, v144, s79, -v149
    v_mfma_f32_16x16x32_bf16 v[76:79], v[24:27], v[196:199], v[76:79]
    ds_read_b64_tr_b16 v[22:23], v4 offset:21760
    v_fma_f32 v145, v145, s79, -v149
    v_mfma_f32_16x16x32_bf16 v[80:83], v[28:31], v[192:195], v[80:83]
    ds_read_b64_tr_b16 v[24:25], v2 offset:30720
    v_exp_f32 v132, v132
    v_mfma_f32_16x16x32_bf16 v[84:87], v[28:31], v[196:199], v[84:87]
    ds_read_b64_tr_b16 v[26:27], v2 offset:32000
    v_exp_f32 v133, v133
    s_waitcnt lgkmcnt(4)
    v_mfma_f32_16x16x32_bf16 v[88:91], v[32:35], v[192:195], v[88:91]
    ds_read_b64_tr_b16 v[28:29], v3 offset:30752
    v_exp_f32 v136, v136
    v_mfma_f32_16x16x32_bf16 v[92:95], v[32:35], v[196:199], v[92:95]
    ds_read_b64_tr_b16 v[30:31], v3 offset:32032
    v_exp_f32 v137, v137
    v_mfma_f32_16x16x32_bf16 v[96:99], v[16:19], v[192:195], v[96:99]
    ds_read_b64_tr_b16 v[32:33], v2 offset:30784
    v_exp_f32 v140, v140
    v_mfma_f32_16x16x32_bf16 v[100:103], v[16:19], v[196:199], v[100:103]
    ds_read_b64_tr_b16 v[34:35], v2 offset:32064
    v_exp_f32 v141, v141
    s_waitcnt lgkmcnt(4)
    v_mfma_f32_16x16x32_bf16 v[104:107], v[20:23], v[192:195], v[104:107]
    ds_read_b64_tr_b16 v[16:17], v3 offset:30816
    v_exp_f32 v144, v144
    v_mfma_f32_16x16x32_bf16 v[108:111], v[20:23], v[196:199], v[108:111]
    ds_read_b64_tr_b16 v[18:19], v3 offset:32096
    v_exp_f32 v145, v145
    v_mfma_f32_16x16x32_bf16 v[40:43], v[24:27], v[200:203], v[40:43]
    ds_read_b64_tr_b16 v[20:21], v2 offset:30848
    v_add_f32 v148, v132, v133
    v_mfma_f32_16x16x32_bf16 v[44:47], v[24:27], v[204:207], v[44:47]
    ds_read_b64_tr_b16 v[22:23], v2 offset:32128
    v_add_f32 v134, v136, v137
    s_waitcnt lgkmcnt(4)
    v_mfma_f32_16x16x32_bf16 v[48:51], v[28:31], v[200:203], v[48:51]
    ds_read_b64_tr_b16 v[24:25], v3 offset:30880
    v_add_f32 v149, v140, v141
    v_mfma_f32_16x16x32_bf16 v[52:55], v[28:31], v[204:207], v[52:55]
    ds_read_b64_tr_b16 v[26:27], v3 offset:32160
    v_add_f32 v142, v144, v145
    v_mfma_f32_16x16x32_bf16 v[56:59], v[32:35], v[200:203], v[56:59]
    ds_read_b64_tr_b16 v[28:29], v2 offset:30912
    v_add_f32 v148, v148, v134
    v_mfma_f32_16x16x32_bf16 v[60:63], v[32:35], v[204:207], v[60:63]
    ds_read_b64_tr_b16 v[30:31], v2 offset:32192
    v_add_f32 v149, v149, v142
    s_waitcnt lgkmcnt(4)
    v_mfma_f32_16x16x32_bf16 v[64:67], v[16:19], v[200:203], v[64:67]
    ds_read_b64_tr_b16 v[32:33], v3 offset:30944
    v_mfma_f32_16x16x32_bf16 v[68:71], v[16:19], v[204:207], v[68:71]
    ds_read_b64_tr_b16 v[34:35], v3 offset:32224
    v_permlane16_swap_b32 v148, v149
    v_mfma_f32_16x16x32_bf16 v[72:75], v[20:23], v[200:203], v[72:75]
    ds_read_b64_tr_b16 v[16:17], v4 offset:30720
    v_add_f32 v148, v148, v149
    v_mfma_f32_16x16x32_bf16 v[76:79], v[20:23], v[204:207], v[76:79]
    ds_read_b64_tr_b16 v[18:19], v4 offset:32000
    v_mov_b32 v149, v148
    s_waitcnt lgkmcnt(4)
    v_mfma_f32_16x16x32_bf16 v[80:83], v[24:27], v[200:203], v[80:83]
    s_barrier
    v_add_u32 v2, -40960, v2
    ds_read_b64_tr_b16 v[20:21], v2 offset:0
    v_mfma_f32_16x16x32_bf16 v[84:87], v[24:27], v[204:207], v[84:87]
    ds_read_b64_tr_b16 v[22:23], v2 offset:1280
    v_permlane32_swap_b32 v148, v149
    v_mfma_f32_16x16x32_bf16 v[88:91], v[28:31], v[200:203], v[88:91]
    v_add_u32 v3, -40960, v3
    ds_read_b64_tr_b16 v[24:25], v3 offset:32
    v_add_f32 v148, v148, v149
    v_mfma_f32_16x16x32_bf16 v[92:95], v[28:31], v[204:207], v[92:95]
    ds_read_b64_tr_b16 v[26:27], v3 offset:1312
    v_mov_b32 v149, v148
    s_waitcnt lgkmcnt(4)
    v_mfma_f32_16x16x32_bf16 v[96:99], v[32:35], v[200:203], v[96:99]
    ds_read_b64_tr_b16 v[28:29], v2 offset:64
    v_mfma_f32_16x16x32_bf16 v[100:103], v[32:35], v[204:207], v[100:103]
    ds_read_b64_tr_b16 v[30:31], v2 offset:1344
    v_permlane16_swap_b32 v148, v149
    v_mfma_f32_16x16x32_bf16 v[104:107], v[16:19], v[200:203], v[104:107]
    ds_read_b64_tr_b16 v[32:33], v3 offset:96
    v_rcp_f32 v148, v148
    v_mfma_f32_16x16x32_bf16 v[108:111], v[16:19], v[204:207], v[108:111]
    ds_read_b64_tr_b16 v[34:35], v3 offset:1376
    v_rcp_f32 v149, v149
    s_waitcnt lgkmcnt(4)
    v_mfma_f32_16x16x32_bf16 v[40:43], v[20:23], v[208:211], v[40:43]
    ds_read_b64_tr_b16 v[16:17], v2 offset:128
    v_mul_f32 v132, v132, v148
    v_mfma_f32_16x16x32_bf16 v[44:47], v[20:23], v[212:215], v[44:47]
    ds_read_b64_tr_b16 v[18:19], v2 offset:1408
    v_mul_f32 v133, v133, v148
    v_mfma_f32_16x16x32_bf16 v[48:51], v[24:27], v[208:211], v[48:51]
    ds_read_b64_tr_b16 v[20:21], v3 offset:160
    v_mul_f32 v136, v136, v148
    v_mfma_f32_16x16x32_bf16 v[52:55], v[24:27], v[212:215], v[52:55]
    ds_read_b64_tr_b16 v[22:23], v3 offset:1440
    v_mul_f32 v137, v137, v148
    s_waitcnt lgkmcnt(4)
    v_mfma_f32_16x16x32_bf16 v[56:59], v[28:31], v[208:211], v[56:59]
    ds_read_b64_tr_b16 v[24:25], v2 offset:192
    v_mul_f32 v140, v140, v149
    v_mfma_f32_16x16x32_bf16 v[60:63], v[28:31], v[212:215], v[60:63]
    ds_read_b64_tr_b16 v[26:27], v2 offset:1472
    v_mul_f32 v141, v141, v149
    v_mfma_f32_16x16x32_bf16 v[64:67], v[32:35], v[208:211], v[64:67]
    ds_read_b64_tr_b16 v[28:29], v3 offset:224
    v_mul_f32 v144, v144, v149
    v_mfma_f32_16x16x32_bf16 v[68:71], v[32:35], v[212:215], v[68:71]
    ds_read_b64_tr_b16 v[30:31], v3 offset:1504
    v_mul_f32 v145, v145, v149
    s_waitcnt lgkmcnt(4)
    v_mfma_f32_16x16x32_bf16 v[72:75], v[16:19], v[208:211], v[72:75]
    v_add_u32 v4, -40960, v4
    ds_read_b64_tr_b16 v[32:33], v4 offset:0
    v_cvt_pk_bf16_f32 v112, v132, 0
    v_mfma_f32_16x16x32_bf16 v[76:79], v[16:19], v[212:215], v[76:79]
    ds_read_b64_tr_b16 v[34:35], v4 offset:1280
    v_cvt_pk_bf16_f32 v113, v133, 0
    v_mfma_f32_16x16x32_bf16 v[80:83], v[20:23], v[208:211], v[80:83]
    ds_read_b64_tr_b16 v[16:17], v2 offset:10240
    v_cvt_pk_bf16_f32 v114, v136, 0
    v_mfma_f32_16x16x32_bf16 v[84:87], v[20:23], v[212:215], v[84:87]
    ds_read_b64_tr_b16 v[18:19], v2 offset:11520
    v_cvt_pk_bf16_f32 v115, v137, 0
    s_waitcnt lgkmcnt(4)
    v_mfma_f32_16x16x32_bf16 v[88:91], v[24:27], v[208:211], v[88:91]
    ds_read_b64_tr_b16 v[20:21], v3 offset:10272
    v_cvt_pk_bf16_f32 v116, v140, 0
    v_mfma_f32_16x16x32_bf16 v[92:95], v[24:27], v[212:215], v[92:95]
    ds_read_b64_tr_b16 v[22:23], v3 offset:11552
    v_cvt_pk_bf16_f32 v117, v141, 0
    v_mfma_f32_16x16x32_bf16 v[96:99], v[28:31], v[208:211], v[96:99]
    ds_read_b64_tr_b16 v[24:25], v2 offset:10304
    v_cvt_pk_bf16_f32 v118, v144, 0
    v_mfma_f32_16x16x32_bf16 v[100:103], v[28:31], v[212:215], v[100:103]
    ds_read_b64_tr_b16 v[26:27], v2 offset:11584
    v_cvt_pk_bf16_f32 v119, v145, 0
    s_waitcnt lgkmcnt(4)
    v_mfma_f32_16x16x32_bf16 v[104:107], v[32:35], v[208:211], v[104:107]
    ds_read_b64_tr_b16 v[28:29], v3 offset:10336
    v_lshlrev_b32 v112, v15, v112
    v_mfma_f32_16x16x32_bf16 v[108:111], v[32:35], v[212:215], v[108:111]
    ds_read_b64_tr_b16 v[30:31], v3 offset:11616
    v_lshlrev_b32 v113, v15, v113
    v_mfma_f32_16x16x32_bf16 v[40:43], v[16:19], v[216:219], v[40:43]
    ds_read_b64_tr_b16 v[32:33], v2 offset:10368
    v_lshlrev_b32 v114, v15, v114
    v_mfma_f32_16x16x32_bf16 v[44:47], v[16:19], v[220:223], v[44:47]
    ds_read_b64_tr_b16 v[34:35], v2 offset:11648
    v_lshlrev_b32 v115, v15, v115
    s_waitcnt lgkmcnt(4)
    v_mfma_f32_16x16x32_bf16 v[48:51], v[20:23], v[216:219], v[48:51]
    ds_read_b64_tr_b16 v[16:17], v3 offset:10400
    v_lshlrev_b32 v116, v15, v116
    v_mfma_f32_16x16x32_bf16 v[52:55], v[20:23], v[220:223], v[52:55]
    ds_read_b64_tr_b16 v[18:19], v3 offset:11680
    v_lshlrev_b32 v117, v15, v117
    v_mfma_f32_16x16x32_bf16 v[56:59], v[24:27], v[216:219], v[56:59]
    ds_read_b64_tr_b16 v[20:21], v2 offset:10432
    v_lshlrev_b32 v118, v15, v118
    v_mfma_f32_16x16x32_bf16 v[60:63], v[24:27], v[220:223], v[60:63]
    ds_read_b64_tr_b16 v[22:23], v2 offset:11712
    v_lshlrev_b32 v119, v15, v119
    s_waitcnt lgkmcnt(4)
    v_mfma_f32_16x16x32_bf16 v[64:67], v[28:31], v[216:219], v[64:67]
    ds_read_b64_tr_b16 v[24:25], v3 offset:10464
    v_mfma_f32_16x16x32_bf16 v[132:135], v[120:123], v[112:115], 0
    v_mfma_f32_16x16x32_bf16 v[68:71], v[28:31], v[220:223], v[68:71]
    ds_read_b64_tr_b16 v[26:27], v3 offset:11744
    v_mfma_f32_16x16x32_bf16 v[136:139], v[126:129], v[112:115], 0
    v_mfma_f32_16x16x32_bf16 v[72:75], v[32:35], v[216:219], v[72:75]
    ds_read_b64_tr_b16 v[28:29], v4 offset:10240
    v_mfma_f32_16x16x32_bf16 v[140:143], v[122:125], v[116:119], 0
    v_mfma_f32_16x16x32_bf16 v[76:79], v[32:35], v[220:223], v[76:79]
    ds_read_b64_tr_b16 v[30:31], v4 offset:11520
    v_mfma_f32_16x16x32_bf16 v[144:147], v[128:131], v[116:119], 0
    s_waitcnt lgkmcnt(4)
    v_mfma_f32_16x16x32_bf16 v[80:83], v[16:19], v[216:219], v[80:83]
    s_barrier
    ds_read_b64_tr_b16 v[32:33], v2 offset:20480
    v_mfma_f32_16x16x32_bf16 v[84:87], v[16:19], v[220:223], v[84:87]
    ds_read_b64_tr_b16 v[34:35], v2 offset:21760
    v_cvt_pk_bf16_f32 v132, v132, v133
    v_mfma_f32_16x16x32_bf16 v[88:91], v[20:23], v[216:219], v[88:91]
    ds_read_b64_tr_b16 v[16:17], v3 offset:20512
    v_cvt_pk_bf16_f32 v133, v134, v135
    v_mfma_f32_16x16x32_bf16 v[92:95], v[20:23], v[220:223], v[92:95]
    ds_read_b64_tr_b16 v[18:19], v3 offset:21792
    v_cvt_pk_bf16_f32 v136, v136, v137
    s_waitcnt lgkmcnt(4)
    v_mfma_f32_16x16x32_bf16 v[96:99], v[24:27], v[216:219], v[96:99]
    ds_read_b64_tr_b16 v[20:21], v2 offset:20544
    v_mfma_f32_16x16x32_bf16 v[100:103], v[24:27], v[220:223], v[100:103]
    ds_read_b64_tr_b16 v[22:23], v2 offset:21824
    buffer_store_dwordx2 v[132:133], v12, s[28:31], s69 offen sc1
    s_mov_b64 exec, 0xffff
    buffer_store_dword v136, v151, s[28:31], s71 offen sc1
    s_mov_b64 exec, -1
    v_mfma_f32_16x16x32_bf16 v[104:107], v[28:31], v[216:219], v[104:107]
    ds_read_b64_tr_b16 v[24:25], v3 offset:20576
    v_cvt_pk_bf16_f32 v140, v140, v141
    v_mfma_f32_16x16x32_bf16 v[108:111], v[28:31], v[220:223], v[108:111]
    ds_read_b64_tr_b16 v[26:27], v3 offset:21856
    v_cvt_pk_bf16_f32 v141, v142, v143
    s_waitcnt lgkmcnt(4)
    v_mfma_f32_16x16x32_bf16 v[40:43], v[32:35], v[224:227], v[40:43]
    ds_read_b64_tr_b16 v[28:29], v2 offset:20608
    v_cvt_pk_bf16_f32 v144, v144, v145
    v_mfma_f32_16x16x32_bf16 v[44:47], v[32:35], v[228:231], v[44:47]
    ds_read_b64_tr_b16 v[30:31], v2 offset:21888
    v_mfma_f32_16x16x32_bf16 v[48:51], v[16:19], v[224:227], v[48:51]
    ds_read_b64_tr_b16 v[32:33], v3 offset:20640
    buffer_store_dwordx2 v[140:141], v12, s[28:31], s70 offen sc1
    s_mov_b64 exec, 0xffff
    buffer_store_dword v144, v151, s[28:31], s72 offen sc1
    s_mov_b64 exec, -1
    v_mfma_f32_16x16x32_bf16 v[52:55], v[16:19], v[228:231], v[52:55]
    ds_read_b64_tr_b16 v[34:35], v3 offset:21920
    s_waitcnt lgkmcnt(4)
    v_mfma_f32_16x16x32_bf16 v[56:59], v[20:23], v[224:227], v[56:59]
    ds_read_b64_tr_b16 v[16:17], v2 offset:20672
    v_mfma_f32_16x16x32_bf16 v[60:63], v[20:23], v[228:231], v[60:63]
    ds_read_b64_tr_b16 v[18:19], v2 offset:21952
    v_mfma_f32_16x16x32_bf16 v[64:67], v[24:27], v[224:227], v[64:67]
    ds_read_b64_tr_b16 v[20:21], v3 offset:20704
    v_mfma_f32_16x16x32_bf16 v[68:71], v[24:27], v[228:231], v[68:71]
    ds_read_b64_tr_b16 v[22:23], v3 offset:21984
    s_waitcnt lgkmcnt(4)
    v_mfma_f32_16x16x32_bf16 v[72:75], v[28:31], v[224:227], v[72:75]
    ds_read_b64_tr_b16 v[24:25], v4 offset:20480
    v_mfma_f32_16x16x32_bf16 v[76:79], v[28:31], v[228:231], v[76:79]
    ds_read_b64_tr_b16 v[26:27], v4 offset:21760
    v_mfma_f32_16x16x32_bf16 v[80:83], v[32:35], v[224:227], v[80:83]
    ds_read_b64_tr_b16 v[28:29], v2 offset:30720
    v_mfma_f32_16x16x32_bf16 v[84:87], v[32:35], v[228:231], v[84:87]
    ds_read_b64_tr_b16 v[30:31], v2 offset:32000
    s_waitcnt lgkmcnt(4)
    v_mfma_f32_16x16x32_bf16 v[88:91], v[16:19], v[224:227], v[88:91]
    ds_read_b64_tr_b16 v[32:33], v3 offset:30752
    v_mfma_f32_16x16x32_bf16 v[92:95], v[16:19], v[228:231], v[92:95]
    ds_read_b64_tr_b16 v[34:35], v3 offset:32032
    v_mfma_f32_16x16x32_bf16 v[96:99], v[20:23], v[224:227], v[96:99]
    ds_read_b64_tr_b16 v[16:17], v2 offset:30784
    v_mfma_f32_16x16x32_bf16 v[100:103], v[20:23], v[228:231], v[100:103]
    ds_read_b64_tr_b16 v[18:19], v2 offset:32064
    s_waitcnt lgkmcnt(4)
    v_mfma_f32_16x16x32_bf16 v[104:107], v[24:27], v[224:227], v[104:107]
    ds_read_b64_tr_b16 v[20:21], v3 offset:30816
    v_mfma_f32_16x16x32_bf16 v[108:111], v[24:27], v[228:231], v[108:111]
    ds_read_b64_tr_b16 v[22:23], v3 offset:32096
    v_mfma_f32_16x16x32_bf16 v[40:43], v[28:31], v[232:235], v[40:43]
    ds_read_b64_tr_b16 v[24:25], v2 offset:30848
    v_mfma_f32_16x16x32_bf16 v[44:47], v[28:31], v[236:239], v[44:47]
    ds_read_b64_tr_b16 v[26:27], v2 offset:32128
    s_waitcnt lgkmcnt(4)
    v_mfma_f32_16x16x32_bf16 v[48:51], v[32:35], v[232:235], v[48:51]
    ds_read_b64_tr_b16 v[28:29], v3 offset:30880
    v_mfma_f32_16x16x32_bf16 v[52:55], v[32:35], v[236:239], v[52:55]
    ds_read_b64_tr_b16 v[30:31], v3 offset:32160
    v_mfma_f32_16x16x32_bf16 v[56:59], v[16:19], v[232:235], v[56:59]
    ds_read_b64_tr_b16 v[32:33], v2 offset:30912
    v_mfma_f32_16x16x32_bf16 v[60:63], v[16:19], v[236:239], v[60:63]
    ds_read_b64_tr_b16 v[34:35], v2 offset:32192
    s_waitcnt lgkmcnt(4)
    v_mfma_f32_16x16x32_bf16 v[64:67], v[20:23], v[232:235], v[64:67]
    ds_read_b64_tr_b16 v[16:17], v3 offset:30944
    v_mfma_f32_16x16x32_bf16 v[68:71], v[20:23], v[236:239], v[68:71]
    ds_read_b64_tr_b16 v[18:19], v3 offset:32224
    v_mfma_f32_16x16x32_bf16 v[72:75], v[24:27], v[232:235], v[72:75]
    ds_read_b64_tr_b16 v[20:21], v4 offset:30720
    v_mfma_f32_16x16x32_bf16 v[76:79], v[24:27], v[236:239], v[76:79]
    ds_read_b64_tr_b16 v[22:23], v4 offset:32000
    s_waitcnt lgkmcnt(4)
    v_mfma_f32_16x16x32_bf16 v[80:83], v[28:31], v[232:235], v[80:83]
    s_barrier
    v_add_u32 v2, 40960, v2
    ds_read_b64_tr_b16 v[24:25], v2 offset:0
    v_mfma_f32_16x16x32_bf16 v[84:87], v[28:31], v[236:239], v[84:87]
    ds_read_b64_tr_b16 v[26:27], v2 offset:1280
    v_mfma_f32_16x16x32_bf16 v[88:91], v[32:35], v[232:235], v[88:91]
    v_add_u32 v3, 40960, v3
    ds_read_b64_tr_b16 v[28:29], v3 offset:32
    v_mfma_f32_16x16x32_bf16 v[92:95], v[32:35], v[236:239], v[92:95]
    ds_read_b64_tr_b16 v[30:31], v3 offset:1312
    s_waitcnt lgkmcnt(4)
    v_mfma_f32_16x16x32_bf16 v[96:99], v[16:19], v[232:235], v[96:99]
    ds_read_b64_tr_b16 v[32:33], v2 offset:64
    v_mfma_f32_16x16x32_bf16 v[100:103], v[16:19], v[236:239], v[100:103]
    ds_read_b64_tr_b16 v[34:35], v2 offset:1344
    v_mfma_f32_16x16x32_bf16 v[104:107], v[20:23], v[232:235], v[104:107]
    ds_read_b64_tr_b16 v[16:17], v3 offset:96
    v_mfma_f32_16x16x32_bf16 v[108:111], v[20:23], v[236:239], v[108:111]
    ds_read_b64_tr_b16 v[18:19], v3 offset:1376
    s_waitcnt lgkmcnt(4)
    v_mfma_f32_16x16x32_bf16 v[40:43], v[24:27], v[240:243], v[40:43]
    ds_read_b64_tr_b16 v[20:21], v2 offset:128
    v_mfma_f32_16x16x32_bf16 v[44:47], v[24:27], v[244:247], v[44:47]
    ds_read_b64_tr_b16 v[22:23], v2 offset:1408
    v_mfma_f32_16x16x32_bf16 v[48:51], v[28:31], v[240:243], v[48:51]
    ds_read_b64_tr_b16 v[24:25], v3 offset:160
    v_lshrrev_b32 v204, 4, v1
    v_lshlrev_b32 v204, 12, v204
    v_and_b32 v205, 15, v1
    v_lshl_add_u32 v204, v205, 4, v204
    s_lshl_b32 s9, s48, 14
    s_lshl_b32 s10, s51, 8
    s_add_u32 s9, s9, s10
    buffer_load_dwordx4 v[112:115], v204, s[40:43], s9 offen offset:0 sc1
    buffer_load_dwordx4 v[116:119], v204, s[40:43], s9 offen offset:1024 sc1
    buffer_load_dwordx4 v[120:123], v204, s[40:43], s9 offen offset:2048 sc1
    buffer_load_dwordx4 v[124:127], v204, s[40:43], s9 offen offset:3072 sc1
    v_mfma_f32_16x16x32_bf16 v[52:55], v[28:31], v[244:247], v[52:55]
    ds_read_b64_tr_b16 v[26:27], v3 offset:1440
    s_waitcnt lgkmcnt(4)
    v_mfma_f32_16x16x32_bf16 v[56:59], v[32:35], v[240:243], v[56:59]
    ds_read_b64_tr_b16 v[28:29], v2 offset:192
    v_mfma_f32_16x16x32_bf16 v[60:63], v[32:35], v[244:247], v[60:63]
    ds_read_b64_tr_b16 v[30:31], v2 offset:1472
    v_mfma_f32_16x16x32_bf16 v[64:67], v[16:19], v[240:243], v[64:67]
    ds_read_b64_tr_b16 v[32:33], v3 offset:224
    v_mfma_f32_16x16x32_bf16 v[68:71], v[16:19], v[244:247], v[68:71]
    ds_read_b64_tr_b16 v[34:35], v3 offset:1504
    s_waitcnt lgkmcnt(4)
    v_mfma_f32_16x16x32_bf16 v[72:75], v[20:23], v[240:243], v[72:75]
    v_add_u32 v4, 40960, v4
    ds_read_b64_tr_b16 v[16:17], v4 offset:0
    v_mfma_f32_16x16x32_bf16 v[76:79], v[20:23], v[244:247], v[76:79]
    ds_read_b64_tr_b16 v[18:19], v4 offset:1280
    v_mfma_f32_16x16x32_bf16 v[80:83], v[24:27], v[240:243], v[80:83]
    ds_read_b64_tr_b16 v[20:21], v2 offset:10240
    v_mfma_f32_16x16x32_bf16 v[84:87], v[24:27], v[244:247], v[84:87]
    ds_read_b64_tr_b16 v[22:23], v2 offset:11520
    s_waitcnt lgkmcnt(4)
    v_mfma_f32_16x16x32_bf16 v[88:91], v[28:31], v[240:243], v[88:91]
    ds_read_b64_tr_b16 v[24:25], v3 offset:10272
    v_mfma_f32_16x16x32_bf16 v[92:95], v[28:31], v[244:247], v[92:95]
    ds_read_b64_tr_b16 v[26:27], v3 offset:11552
    v_mfma_f32_16x16x32_bf16 v[96:99], v[32:35], v[240:243], v[96:99]
    ds_read_b64_tr_b16 v[28:29], v2 offset:10304
    v_mfma_f32_16x16x32_bf16 v[100:103], v[32:35], v[244:247], v[100:103]
    ds_read_b64_tr_b16 v[30:31], v2 offset:11584
    s_waitcnt lgkmcnt(4)
    v_mfma_f32_16x16x32_bf16 v[104:107], v[16:19], v[240:243], v[104:107]
    ds_read_b64_tr_b16 v[32:33], v3 offset:10336
    v_mfma_f32_16x16x32_bf16 v[108:111], v[16:19], v[244:247], v[108:111]
    ds_read_b64_tr_b16 v[34:35], v3 offset:11616
    v_mfma_f32_16x16x32_bf16 v[40:43], v[20:23], v[248:251], v[40:43]
    ds_read_b64_tr_b16 v[16:17], v2 offset:10368
    v_mfma_f32_16x16x32_bf16 v[44:47], v[20:23], v[252:255], v[44:47]
    ds_read_b64_tr_b16 v[18:19], v2 offset:11648
    s_waitcnt lgkmcnt(4)
    v_mfma_f32_16x16x32_bf16 v[48:51], v[24:27], v[248:251], v[48:51]
    ds_read_b64_tr_b16 v[20:21], v3 offset:10400
    v_mfma_f32_16x16x32_bf16 v[52:55], v[24:27], v[252:255], v[52:55]
    ds_read_b64_tr_b16 v[22:23], v3 offset:11680
    v_mfma_f32_16x16x32_bf16 v[56:59], v[28:31], v[248:251], v[56:59]
    ds_read_b64_tr_b16 v[24:25], v2 offset:10432
    v_mfma_f32_16x16x32_bf16 v[60:63], v[28:31], v[252:255], v[60:63]
    ds_read_b64_tr_b16 v[26:27], v2 offset:11712
    s_waitcnt lgkmcnt(4)
    v_mfma_f32_16x16x32_bf16 v[64:67], v[32:35], v[248:251], v[64:67]
    ds_read_b64_tr_b16 v[28:29], v3 offset:10464
    v_mfma_f32_16x16x32_bf16 v[68:71], v[32:35], v[252:255], v[68:71]
    ds_read_b64_tr_b16 v[30:31], v3 offset:11744
    v_mfma_f32_16x16x32_bf16 v[72:75], v[16:19], v[248:251], v[72:75]
    ds_read_b64_tr_b16 v[32:33], v4 offset:10240
    v_mfma_f32_16x16x32_bf16 v[76:79], v[16:19], v[252:255], v[76:79]
    ds_read_b64_tr_b16 v[34:35], v4 offset:11520
    s_waitcnt lgkmcnt(4)
    v_mfma_f32_16x16x32_bf16 v[80:83], v[20:23], v[248:251], v[80:83]
    v_mfma_f32_16x16x32_bf16 v[84:87], v[20:23], v[252:255], v[84:87]
    v_mfma_f32_16x16x32_bf16 v[88:91], v[24:27], v[248:251], v[88:91]
    v_mfma_f32_16x16x32_bf16 v[92:95], v[24:27], v[252:255], v[92:95]
    s_waitcnt lgkmcnt(0)
    v_mfma_f32_16x16x32_bf16 v[96:99], v[28:31], v[248:251], v[96:99]
    v_mfma_f32_16x16x32_bf16 v[100:103], v[28:31], v[252:255], v[100:103]
    v_mfma_f32_16x16x32_bf16 v[104:107], v[32:35], v[248:251], v[104:107]
    v_mfma_f32_16x16x32_bf16 v[108:111], v[32:35], v[252:255], v[108:111]
    s_load_dwordx2 s[32:33], s[0:1], 48
    s_lshl_b32 s63, s48, 8
    s_lshl_b32 s99, s51, 6
    s_add_u32 s63, s63, s99
    v_and_b32 v218, 15, v1
    v_lshlrev_b32 v218, 1, v218
    s_mov_b32 s34, 4096
    s_mov_b32 s35, 0x00020000
    s_waitcnt lgkmcnt(0)
    buffer_load_ushort v216, v218, s[32:35], s63 offen
    buffer_load_ushort v217, v218, s[32:35], s63 offen offset:32
    s_barrier
    v_lshrrev_b32 v206, 4, v1
    v_lshlrev_b32 v207, 6, v206
    v_lshlrev_b32 v206, 3, v206
    v_bfe_u32 v212, v1, 2, 2
    v_add_u32 v206, v206, v212
    s_lshl_b32 s9, s51, 5
    v_add_u32 v206, s9, v206
    v_mul_u32_u24 v206, 296, v206
    v_and_b32 v212, 3, v1
    v_lshl_add_u32 v206, v212, 3, v206
    v_add_u32 v206, 81920, v206
    ds_read_b64_tr_b16 v[144:145], v206 offset:0
    ds_read_b64_tr_b16 v[146:147], v206 offset:1184
    ds_read_b64_tr_b16 v[148:149], v206 offset:32
    ds_read_b64_tr_b16 v[150:151], v206 offset:1216
    ds_read_b64_tr_b16 v[152:153], v206 offset:64
    ds_read_b64_tr_b16 v[154:155], v206 offset:1248
    ds_read_b64_tr_b16 v[156:157], v206 offset:96
    ds_read_b64_tr_b16 v[158:159], v206 offset:1280
    ds_read_b64_tr_b16 v[160:161], v206 offset:128
    ds_read_b64_tr_b16 v[162:163], v206 offset:1312
    s_lshl_b32 s9, s50, 8
    s_add_u32 s9, s9, 161792
    v_lshlrev_b32 v205, 4, v205
    v_add_u32 v205, s9, v205
    v_add_u32 v207, s9, v207
    v_lshlrev_b32 v208, 4, v1
    v_xor_b32 v209, 64, v208
    s_lshl_b32 s12, s49, 6
    s_lshl_b32 s13, s48, 2
    s_add_u32 s12, s12, s13
    s_add_u32 s12, s12, s51
    s_mul_i32 s12, s12, 9216
    s_add_u32 s13, s12, 4096
    s_add_u32 s10, s12, 8192
    s_mov_b32 s11, 0x39e38e39
    s_lshr_b32 s9, s51, 1
    s_mul_i32 s9, s9, 34816
    s_and_b32 s53, s51, 1
    s_mul_i32 s53, s53, 9216
    s_add_u32 s9, s9, s53
    s_add_u32 s9, s9, 16384
    v_add_u32 v210, s9, v208
    v_add_u32 v211, s9, v209
    s_lshl_b32 s63, s48, 3
    s_lshl_b32 s98, s51, 1
    s_add_u32 s63, s63, s98
    s_mul_i32 s63, s63, 72
    s_mul_i32 s98, s49, 9
    s_add_u32 s98, s98, s52
    s_lshr_b32 s98, s98, 1
    s_add_u32 s63, s63, s98
    s_lshl_b32 s69, s63, 10
    s_add_u32 s70, s69, 73728
    s_cmp_eq_u32 s52, 0
    s_cselect_b32 s63, 4608, 0
    s_sub_u32 s63, s63, 512
    s_add_u32 s71, s69, s63
    s_add_u32 s72, s70, s63
    v_lshlrev_b32 v10, 4, v1
    v_lshrrev_b32 v12, 5, v1
    v_lshlrev_b32 v12, 8, v12
    v_and_b32 v13, 15, v1
    v_lshl_add_u32 v12, v13, 4, v12
    v_bfe_u32 v13, v1, 4, 1
    v_lshl_add_u32 v12, v13, 3, v12
    v_cvt_pk_bf16_f32 v168, v40, v41
    v_cvt_pk_bf16_f32 v169, v42, v43
    v_cvt_pk_bf16_f32 v170, v48, v49
    v_cvt_pk_bf16_f32 v171, v50, v51
    s_nop 0
    v_permlane32_swap_b32 v168, v170
    v_permlane32_swap_b32 v169, v171
    s_nop 0
    v_permlane16_swap_b32 v168, v170
    v_permlane16_swap_b32 v169, v171
    v_cvt_pk_bf16_f32 v184, v44, v45
    v_cvt_pk_bf16_f32 v185, v46, v47
    v_cvt_pk_bf16_f32 v186, v52, v53
    v_cvt_pk_bf16_f32 v187, v54, v55
    s_nop 0
    v_permlane32_swap_b32 v184, v186
    v_permlane32_swap_b32 v185, v187
    s_nop 0
    v_permlane16_swap_b32 v184, v186
    v_permlane16_swap_b32 v185, v187
    v_cvt_pk_bf16_f32 v172, v56, v57
    v_cvt_pk_bf16_f32 v173, v58, v59
    v_cvt_pk_bf16_f32 v174, v64, v65
    v_cvt_pk_bf16_f32 v175, v66, v67
    s_nop 0
    v_permlane32_swap_b32 v172, v174
    v_permlane32_swap_b32 v173, v175
    s_nop 0
    v_permlane16_swap_b32 v172, v174
    v_permlane16_swap_b32 v173, v175
    v_cvt_pk_bf16_f32 v188, v60, v61
    v_cvt_pk_bf16_f32 v189, v62, v63
    v_cvt_pk_bf16_f32 v190, v68, v69
    v_cvt_pk_bf16_f32 v191, v70, v71
    s_nop 0
    v_permlane32_swap_b32 v188, v190
    v_permlane32_swap_b32 v189, v191
    s_nop 0
    v_permlane16_swap_b32 v188, v190
    v_permlane16_swap_b32 v189, v191
    v_cvt_pk_bf16_f32 v176, v72, v73
    v_cvt_pk_bf16_f32 v177, v74, v75
    v_cvt_pk_bf16_f32 v178, v80, v81
    v_cvt_pk_bf16_f32 v179, v82, v83
    s_nop 0
    v_permlane32_swap_b32 v176, v178
    v_permlane32_swap_b32 v177, v179
    s_nop 0
    v_permlane16_swap_b32 v176, v178
    v_permlane16_swap_b32 v177, v179
    v_cvt_pk_bf16_f32 v192, v76, v77
    v_cvt_pk_bf16_f32 v193, v78, v79
    v_cvt_pk_bf16_f32 v194, v84, v85
    v_cvt_pk_bf16_f32 v195, v86, v87
    s_nop 0
    v_permlane32_swap_b32 v192, v194
    v_permlane32_swap_b32 v193, v195
    s_nop 0
    v_permlane16_swap_b32 v192, v194
    v_permlane16_swap_b32 v193, v195
    v_cvt_pk_bf16_f32 v180, v88, v89
    v_cvt_pk_bf16_f32 v181, v90, v91
    v_cvt_pk_bf16_f32 v182, v96, v97
    v_cvt_pk_bf16_f32 v183, v98, v99
    s_nop 0
    v_permlane32_swap_b32 v180, v182
    v_permlane32_swap_b32 v181, v183
    s_nop 0
    v_permlane16_swap_b32 v180, v182
    v_permlane16_swap_b32 v181, v183
    v_cvt_pk_bf16_f32 v196, v92, v93
    v_cvt_pk_bf16_f32 v197, v94, v95
    v_cvt_pk_bf16_f32 v198, v100, v101
    v_cvt_pk_bf16_f32 v199, v102, v103
    s_nop 0
    v_permlane32_swap_b32 v196, v198
    v_permlane32_swap_b32 v197, v199
    s_nop 0
    v_permlane16_swap_b32 v196, v198
    v_permlane16_swap_b32 v197, v199
    v_cvt_pk_bf16_f32 v200, v104, v105
    v_cvt_pk_bf16_f32 v201, v106, v107
    v_cvt_pk_bf16_f32 v202, v108, v109
    v_cvt_pk_bf16_f32 v203, v110, v111
    s_waitcnt vmcnt(3)
    v_add_f32 v112, v112, v120
    v_add_f32 v113, v113, v121
    v_add_f32 v114, v114, v122
    v_add_f32 v115, v115, v123
    s_waitcnt vmcnt(2)
    v_add_f32 v116, v116, v124
    v_add_f32 v117, v117, v125
    v_add_f32 v118, v118, v126
    v_add_f32 v119, v119, v127
    v_add_f32 v112, v112, v116
    v_add_f32 v113, v113, v117
    v_add_f32 v114, v114, v118
    v_add_f32 v115, v115, v119
    v_mov_b32 v116, v112
    v_mov_b32 v117, v113
    v_mov_b32 v118, v114
    v_mov_b32 v119, v115
    v_permlane16_swap_b32 v112, v116
    v_permlane16_swap_b32 v113, v117
    v_permlane16_swap_b32 v114, v118
    v_permlane16_swap_b32 v115, v119
    v_add_f32 v112, v112, v116
    v_add_f32 v113, v113, v117
    v_add_f32 v114, v114, v118
    v_add_f32 v115, v115, v119
    v_mov_b32 v116, v112
    v_mov_b32 v117, v113
    v_mov_b32 v118, v114
    v_mov_b32 v119, v115
    v_permlane32_swap_b32 v112, v116
    v_permlane32_swap_b32 v113, v117
    v_permlane32_swap_b32 v114, v118
    v_permlane32_swap_b32 v115, v119
    v_add_f32 v112, v112, v116
    v_add_f32 v113, v113, v117
    v_add_f32 v114, v114, v118
    v_add_f32 v115, v115, v119
    v_mul_f32 v112, s11, v112
    v_mul_f32 v212, v112, v112
    v_fma_f32 v113, v113, s11, -v212
    v_max_f32 v113, 0, v113
    v_add_f32 v113, 0x3727c5ac, v113
    v_rsq_f32 v212, v113
    s_nop 0
    v_mul_f32 v113, v112, v212
    v_sub_f32 v113, 0, v113
    v_mov_b32 v112, v212
    v_mul_f32 v114, s11, v114
    v_mul_f32 v212, v114, v114
    v_fma_f32 v115, v115, s11, -v212
    v_max_f32 v115, 0, v115
    v_add_f32 v115, 0x3727c5ac, v115
    v_rsq_f32 v212, v115
    s_nop 0
    v_mul_f32 v115, v114, v212
    v_sub_f32 v115, 0, v115
    v_mov_b32 v114, v212
    ds_write_b128 v205, v[112:115]
    s_waitcnt lgkmcnt(0)
    ds_read_b128 v[128:131], v207 offset:0
    ds_read_b128 v[132:135], v207 offset:16
    ds_read_b128 v[136:139], v207 offset:32
    ds_read_b128 v[140:143], v207 offset:48
    v_lshlrev_b32 v212, 16, v144
    v_and_b32 v213, 0xffff0000, v144
    s_waitcnt lgkmcnt(3)
    v_fma_f32 v212, v212, v128, v129
    v_fma_f32 v213, v213, v130, v131
    v_cvt_pk_bf16_f32 v144, v212, v213
    v_lshlrev_b32 v214, 16, v145
    v_and_b32 v215, 0xffff0000, v145
    s_waitcnt lgkmcnt(2)
    v_fma_f32 v214, v214, v132, v133
    v_fma_f32 v215, v215, v134, v135
    v_cvt_pk_bf16_f32 v145, v214, v215
    v_lshlrev_b32 v212, 16, v146
    v_and_b32 v213, 0xffff0000, v146
    s_waitcnt lgkmcnt(1)
    v_fma_f32 v212, v212, v136, v137
    v_fma_f32 v213, v213, v138, v139
    v_cvt_pk_bf16_f32 v146, v212, v213
    v_lshlrev_b32 v214, 16, v147
    v_and_b32 v215, 0xffff0000, v147
    s_waitcnt lgkmcnt(0)
    v_fma_f32 v214, v214, v140, v141
    v_fma_f32 v215, v215, v142, v143
    v_cvt_pk_bf16_f32 v147, v214, v215
    buffer_store_dwordx4 v[144:147], v208, s[36:39], s12 offen offset:0 sc1
    ds_write_b128 v210, v[144:147] offset:0
    v_lshlrev_b32 v212, 16, v148
    v_and_b32 v213, 0xffff0000, v148
    v_fma_f32 v212, v212, v128, v129
    v_fma_f32 v213, v213, v130, v131
    v_cvt_pk_bf16_f32 v148, v212, v213
    v_lshlrev_b32 v214, 16, v149
    v_and_b32 v215, 0xffff0000, v149
    v_fma_f32 v214, v214, v132, v133
    v_fma_f32 v215, v215, v134, v135
    v_cvt_pk_bf16_f32 v149, v214, v215
    v_lshlrev_b32 v212, 16, v150
    v_and_b32 v213, 0xffff0000, v150
    v_fma_f32 v212, v212, v136, v137
    v_fma_f32 v213, v213, v138, v139
    v_cvt_pk_bf16_f32 v150, v212, v213
    v_lshlrev_b32 v214, 16, v151
    v_and_b32 v215, 0xffff0000, v151
    v_fma_f32 v214, v214, v140, v141
    v_fma_f32 v215, v215, v142, v143
    v_cvt_pk_bf16_f32 v151, v214, v215
    buffer_store_dwordx4 v[148:151], v209, s[36:39], s12 offen offset:1024 sc1
    ds_write_b128 v211, v[148:151] offset:1024
    v_lshlrev_b32 v212, 16, v152
    v_and_b32 v213, 0xffff0000, v152
    v_fma_f32 v212, v212, v128, v129
    v_fma_f32 v213, v213, v130, v131
    v_cvt_pk_bf16_f32 v152, v212, v213
    v_lshlrev_b32 v214, 16, v153
    v_and_b32 v215, 0xffff0000, v153
    v_fma_f32 v214, v214, v132, v133
    v_fma_f32 v215, v215, v134, v135
    v_cvt_pk_bf16_f32 v153, v214, v215
    v_lshlrev_b32 v212, 16, v154
    v_and_b32 v213, 0xffff0000, v154
    v_fma_f32 v212, v212, v136, v137
    v_fma_f32 v213, v213, v138, v139
    v_cvt_pk_bf16_f32 v154, v212, v213
    v_lshlrev_b32 v214, 16, v155
    v_and_b32 v215, 0xffff0000, v155
    v_fma_f32 v214, v214, v140, v141
    v_fma_f32 v215, v215, v142, v143
    v_cvt_pk_bf16_f32 v155, v214, v215
    buffer_store_dwordx4 v[152:155], v208, s[36:39], s12 offen offset:2048 sc1
    ds_write_b128 v210, v[152:155] offset:2048
    v_lshlrev_b32 v212, 16, v156
    v_and_b32 v213, 0xffff0000, v156
    v_fma_f32 v212, v212, v128, v129
    v_fma_f32 v213, v213, v130, v131
    v_cvt_pk_bf16_f32 v156, v212, v213
    v_lshlrev_b32 v214, 16, v157
    v_and_b32 v215, 0xffff0000, v157
    v_fma_f32 v214, v214, v132, v133
    v_fma_f32 v215, v215, v134, v135
    v_cvt_pk_bf16_f32 v157, v214, v215
    v_lshlrev_b32 v212, 16, v158
    v_and_b32 v213, 0xffff0000, v158
    v_fma_f32 v212, v212, v136, v137
    v_fma_f32 v213, v213, v138, v139
    v_cvt_pk_bf16_f32 v158, v212, v213
    v_lshlrev_b32 v214, 16, v159
    v_and_b32 v215, 0xffff0000, v159
    v_fma_f32 v214, v214, v140, v141
    v_fma_f32 v215, v215, v142, v143
    v_cvt_pk_bf16_f32 v159, v214, v215
    buffer_store_dwordx4 v[156:159], v209, s[36:39], s12 offen offset:3072 sc1
    ds_write_b128 v211, v[156:159] offset:3072
    v_lshlrev_b32 v212, 16, v160
    v_and_b32 v213, 0xffff0000, v160
    v_fma_f32 v212, v212, v128, v129
    v_fma_f32 v213, v213, v130, v131
    v_cvt_pk_bf16_f32 v160, v212, v213
    v_lshlrev_b32 v214, 16, v161
    v_and_b32 v215, 0xffff0000, v161
    v_fma_f32 v214, v214, v132, v133
    v_fma_f32 v215, v215, v134, v135
    v_cvt_pk_bf16_f32 v161, v214, v215
    v_lshlrev_b32 v212, 16, v162
    v_and_b32 v213, 0xffff0000, v162
    v_fma_f32 v212, v212, v136, v137
    v_fma_f32 v213, v213, v138, v139
    v_cvt_pk_bf16_f32 v162, v212, v213
    v_lshlrev_b32 v214, 16, v163
    v_and_b32 v215, 0xffff0000, v163
    v_fma_f32 v214, v214, v140, v141
    v_fma_f32 v215, v215, v142, v143
    v_cvt_pk_bf16_f32 v163, v214, v215
    buffer_store_dwordx4 v[160:163], v208, s[36:39], s13 offen offset:0 sc1
    ds_write_b128 v210, v[160:163] offset:4096
    s_branch K2_CONS
K1_HELP:
    s_getpc_b64 s[64:65]
CPF1:
    s_add_u32 s64, s64, parallel_sum__sliding_local_dilated__mixer_gmlp__prompt_kernel-CPF1
    s_addc_u32 s65, s65, -1
    s_lshr_b32 s66, s2, 3
    s_mul_i32 s66, s66, 1536
    v_lshlrev_b32 v40, 7, v1
    v_add_u32 v40, s66, v40
    v_mov_b32 v34, (K2_TEXT-parallel_sum__sliding_local_dilated__mixer_gmlp__prompt_kernel)-4
    v_min_u32 v40, v40, v34
    v_mov_b32 v41, s65
    v_add_co_u32 v40, vcc, s64, v40
    s_nop 1
    v_addc_co_u32 v41, vcc, 0, v41, vcc
    s_mov_b64 exec, 0xfff
    global_load_dword v34, v[40:41], off
    s_mov_b64 exec, -1
    s_getpc_b64 s[64:65]
    s_add_u32 s64, s64, K1_TAB@rel32@lo+4
    s_addc_u32 s65, s65, K1_TAB@rel32@hi+12
    s_lshl_b32 s66, s51, 12
    v_lshlrev_b32 v32, 4, v1
    v_add_u32 v32, s66, v32
    v_mov_b32 v33, s65
    v_add_co_u32 v32, vcc, s64, v32
    s_nop 1
    v_addc_co_u32 v33, vcc, 0, v33, vcc
    global_load_dwordx4 v[16:19], v[32:33], off
    global_load_dwordx4 v[20:23], v[32:33], off offset:1024
    global_load_dwordx4 v[24:27], v[32:33], off offset:2048
    global_load_dwordx4 v[64:67], v[32:33], off offset:3072
    buffer_load_dwordx4 v[40:43], v10, s[16:19], s69 offen
    buffer_load_dwordx4 v[44:47], v10, s[16:19], s70 offen
    buffer_load_dwordx4 v[48:51], v10, s[16:19], s71 offen
    buffer_load_dwordx4 v[52:55], v10, s[16:19], s72 offen
    buffer_load_dwordx4 v[56:59], v10, s[16:19], s73 offen
    buffer_load_dwordx4 v[60:63], v10, s[16:19], s74 offen
    buffer_load_dwordx4 v[208:211], v10, s[16:19], s75 offen
    buffer_load_dwordx4 v[212:215], v10, s[16:19], s76 offen
    buffer_load_dwordx4 v[216:219], v10, s[16:19], s77 offen
    s_add_u32 s28, s14, 0x1200000
    s_addc_u32 s29, s15, 0
    s_mov_b32 s30, 0xb40000
    s_mov_b32 s31, 0x00020000
    s_add_u32 s36, s14, 0x900000
    s_addc_u32 s37, s15, 0
    s_mov_b32 s38, 0x900000
    s_mov_b32 s39, 0x00020000
    s_add_u32 s40, s14, 0x1d40000
    s_addc_u32 s41, s15, 0
    s_mov_b32 s42, 0xc2000
    s_mov_b32 s43, 0x00020000
    s_mov_b32 s44, s12
    s_mov_b32 s45, s13
    s_mov_b32 s46, 0x100
    s_mov_b32 s47, 0x00020000
    s_mov_b32 s79, 0x3eae1a93
    s_mov_b32 s82, 0x3f803f80
    s_mov_b32 s83, 0x3ae38e39
    v_xor_b32 v102, v12, v13
    v_and_b32 v103, 3, v1
    v_lshl_add_u32 v102, v103, 4, v102
    v_lshlrev_b32 v102, 4, v102
    v_bfe_u32 v104, v1, 2, 1
    v_lshl_add_u32 v102, v104, 10, v102
    s_mul_i32 s63, s51, 24576
    s_add_u32 s63, s63, 40960
    v_add_u32 v5, s63, v102
    v_and_b32 v101, 15, v1
    v_lshrrev_b32 v105, 4, v1
    v_xor_b32 v102, v101, v105
    v_lshl_add_u32 v102, v105, 4, v102
    v_lshlrev_b32 v6, 4, v102
    v_mul_u32_u24 v105, 2560, v105
    v_bfe_u32 v101, v1, 2, 2
    v_mul_u32_u24 v101, 320, v101
    v_lshlrev_b32 v103, 3, v103
    v_add3_u32 v4, v105, v101, v103
    s_mov_b32 s20, s6
    s_mov_b32 s21, s7
    s_mov_b32 s22, 0x1e6000
    s_mov_b32 s23, 0x00020000
    s_mov_b32 s24, s8
    s_mov_b32 s25, s9
    s_mov_b32 s26, 0x510000
    s_mov_b32 s27, 0x00020000
    s_lshl_b32 s68, s51, 10
    s_mul_i32 s64, s49, 288
    s_and_b32 s64, s64, -64
    s_mul_i32 s65, s49, 72
    s_and_b32 s65, s65, -32
    v_mov_b32 v106, 0x7f000000
    s_mov_b32 s4, s10
    s_mov_b32 s5, s11
    s_mov_b32 s6, 0x800000
    s_mov_b32 s7, 0x00020000
    s_waitcnt vmcnt(8)
    v_dot2_f32_bf16 v88, v40, s82, 0
    v_dot2_f32_bf16 v89, v40, v40, 0
    v_dot2_f32_bf16 v88, v41, s82, v88
    v_dot2_f32_bf16 v89, v41, v41, v89
    v_dot2_f32_bf16 v88, v42, s82, v88
    v_dot2_f32_bf16 v89, v42, v42, v89
    v_dot2_f32_bf16 v88, v43, s82, v88
    v_dot2_f32_bf16 v89, v43, v43, v89
    s_waitcnt vmcnt(7)
    v_dot2_f32_bf16 v88, v44, s82, v88
    v_dot2_f32_bf16 v89, v44, v44, v89
    v_dot2_f32_bf16 v88, v45, s82, v88
    v_dot2_f32_bf16 v89, v45, v45, v89
    v_dot2_f32_bf16 v88, v46, s82, v88
    v_dot2_f32_bf16 v89, v46, v46, v89
    v_dot2_f32_bf16 v88, v47, s82, v88
    v_dot2_f32_bf16 v89, v47, v47, v89
    s_waitcnt vmcnt(6)
    v_dot2_f32_bf16 v88, v48, s82, v88
    v_dot2_f32_bf16 v89, v48, v48, v89
    v_dot2_f32_bf16 v88, v49, s82, v88
    v_dot2_f32_bf16 v89, v49, v49, v89
    v_dot2_f32_bf16 v88, v50, s82, v88
    v_dot2_f32_bf16 v89, v50, v50, v89
    v_dot2_f32_bf16 v88, v51, s82, v88
    v_dot2_f32_bf16 v89, v51, v51, v89
    s_waitcnt vmcnt(5)
    v_dot2_f32_bf16 v88, v52, s82, v88
    v_dot2_f32_bf16 v89, v52, v52, v89
    v_dot2_f32_bf16 v88, v53, s82, v88
    v_dot2_f32_bf16 v89, v53, v53, v89
    v_dot2_f32_bf16 v88, v54, s82, v88
    v_dot2_f32_bf16 v89, v54, v54, v89
    v_dot2_f32_bf16 v88, v55, s82, v88
    v_dot2_f32_bf16 v89, v55, v55, v89
    s_waitcnt vmcnt(4)
    v_dot2_f32_bf16 v88, v56, s82, v88
    v_dot2_f32_bf16 v89, v56, v56, v89
    v_dot2_f32_bf16 v88, v57, s82, v88
    v_dot2_f32_bf16 v89, v57, v57, v89
    v_dot2_f32_bf16 v88, v58, s82, v88
    v_dot2_f32_bf16 v89, v58, v58, v89
    v_dot2_f32_bf16 v88, v59, s82, v88
    v_dot2_f32_bf16 v89, v59, v59, v89
    s_waitcnt vmcnt(3)
    v_dot2_f32_bf16 v88, v60, s82, v88
    v_dot2_f32_bf16 v89, v60, v60, v89
    v_dot2_f32_bf16 v88, v61, s82, v88
    v_dot2_f32_bf16 v89, v61, v61, v89
    v_dot2_f32_bf16 v88, v62, s82, v88
    v_dot2_f32_bf16 v89, v62, v62, v89
    v_dot2_f32_bf16 v88, v63, s82, v88
    v_dot2_f32_bf16 v89, v63, v63, v89
    s_waitcnt vmcnt(2)
    v_dot2_f32_bf16 v88, v208, s82, v88
    v_dot2_f32_bf16 v89, v208, v208, v89
    v_dot2_f32_bf16 v88, v209, s82, v88
    v_dot2_f32_bf16 v89, v209, v209, v89
    v_dot2_f32_bf16 v88, v210, s82, v88
    v_dot2_f32_bf16 v89, v210, v210, v89
    v_dot2_f32_bf16 v88, v211, s82, v88
    v_dot2_f32_bf16 v89, v211, v211, v89
    s_waitcnt vmcnt(1)
    v_dot2_f32_bf16 v88, v212, s82, v88
    v_dot2_f32_bf16 v89, v212, v212, v89
    v_dot2_f32_bf16 v88, v213, s82, v88
    v_dot2_f32_bf16 v89, v213, v213, v89
    v_dot2_f32_bf16 v88, v214, s82, v88
    v_dot2_f32_bf16 v89, v214, v214, v89
    v_dot2_f32_bf16 v88, v215, s82, v88
    v_dot2_f32_bf16 v89, v215, v215, v89
    s_waitcnt vmcnt(0)
    v_dot2_f32_bf16 v88, v216, s82, v88
    v_dot2_f32_bf16 v89, v216, v216, v89
    v_dot2_f32_bf16 v88, v217, s82, v88
    v_dot2_f32_bf16 v89, v217, v217, v89
    v_dot2_f32_bf16 v88, v218, s82, v88
    v_dot2_f32_bf16 v89, v218, v218, v89
    v_dot2_f32_bf16 v88, v219, s82, v88
    v_dot2_f32_bf16 v89, v219, v219, v89
    s_nop 1
    v_add_f32_dpp v88, v88, v88 quad_perm:[1,0,3,2] row_mask:0xf bank_mask:0xf
    v_add_f32_dpp v89, v89, v89 quad_perm:[1,0,3,2] row_mask:0xf bank_mask:0xf
    s_nop 0
    v_add_f32_dpp v88, v88, v88 quad_perm:[2,3,0,1] row_mask:0xf bank_mask:0xf
    v_add_f32_dpp v89, v89, v89 quad_perm:[2,3,0,1] row_mask:0xf bank_mask:0xf
    s_nop 0
    v_add_f32_dpp v88, v88, v88 row_half_mirror row_mask:0xf bank_mask:0xf
    v_add_f32_dpp v89, v89, v89 row_half_mirror row_mask:0xf bank_mask:0xf
    v_mul_f32 v88, s83, v88
    v_mul_f32 v94, v88, v88
    v_fma_f32 v89, v89, s83, -v94
    v_max_f32 v89, 0, v89
    v_add_f32 v89, 0x3727c5ac, v89
    v_rsq_f32 v94, v89
    s_nop 0
    v_mul_f32 v89, v88, v94
    v_sub_f32 v89, 0, v89
    v_mov_b32 v88, v94
    s_mul_i32 s63, s54, 589824
    s_add_u32 s63, s63, 4608
    s_add_u32 s63, s63, s64
    s_add_u32 m0, s68, 0
    s_nop 0
    buffer_load_dwordx4 v16, s[24:27], s63 offen lds
    s_add_u32 m0, s68, 4096
    s_nop 0
    buffer_load_dwordx4 v17, s[24:27], s63 offen lds
    s_add_u32 m0, s68, 8192
    s_nop 0
    buffer_load_dwordx4 v18, s[24:27], s63 offen lds
    s_add_u32 m0, s68, 12288
    s_nop 0
    buffer_load_dwordx4 v19, s[24:27], s63 offen lds
    s_add_u32 m0, s68, 16384
    s_nop 0
    buffer_load_dwordx4 v20, s[24:27], s63 offen lds
    v_lshlrev_b32 v94, 16, v40
    v_lshlrev_b32 v96, 16, v41
    v_and_b32 v95, 0xffff0000, v40
    v_and_b32 v97, 0xffff0000, v41
    v_fma_f32 v94, v94, v88, v89
    v_fma_f32 v96, v96, v88, v89
    v_fma_f32 v95, v95, v88, v89
    v_fma_f32 v97, v97, v88, v89
    v_cvt_pk_bf16_f32 v40, v94, v95
    v_cvt_pk_bf16_f32 v41, v96, v97
    v_lshlrev_b32 v94, 16, v42
    v_lshlrev_b32 v96, 16, v43
    v_and_b32 v95, 0xffff0000, v42
    v_and_b32 v97, 0xffff0000, v43
    v_fma_f32 v94, v94, v88, v89
    v_fma_f32 v96, v96, v88, v89
    v_fma_f32 v95, v95, v88, v89
    v_fma_f32 v97, v97, v88, v89
    v_cvt_pk_bf16_f32 v42, v94, v95
    v_cvt_pk_bf16_f32 v43, v96, v97
    ds_write_b128 v5, v[40:43] offset:12416
    v_lshlrev_b32 v94, 16, v44
    v_lshlrev_b32 v96, 16, v45
    v_and_b32 v95, 0xffff0000, v44
    v_and_b32 v97, 0xffff0000, v45
    v_fma_f32 v94, v94, v88, v89
    v_fma_f32 v96, v96, v88, v89
    v_fma_f32 v95, v95, v88, v89
    v_fma_f32 v97, v97, v88, v89
    v_cvt_pk_bf16_f32 v44, v94, v95
    v_cvt_pk_bf16_f32 v45, v96, v97
    v_lshlrev_b32 v94, 16, v46
    v_lshlrev_b32 v96, 16, v47
    v_and_b32 v95, 0xffff0000, v46
    v_and_b32 v97, 0xffff0000, v47
    v_fma_f32 v94, v94, v88, v89
    v_fma_f32 v96, v96, v88, v89
    v_fma_f32 v95, v95, v88, v89
    v_fma_f32 v97, v97, v88, v89
    v_cvt_pk_bf16_f32 v46, v94, v95
    v_cvt_pk_bf16_f32 v47, v96, v97
    ds_write_b128 v5, v[44:47] offset:14464
    v_lshlrev_b32 v94, 16, v48
    v_lshlrev_b32 v96, 16, v49
    v_and_b32 v95, 0xffff0000, v48
    v_and_b32 v97, 0xffff0000, v49
    v_fma_f32 v94, v94, v88, v89
    v_fma_f32 v96, v96, v88, v89
    v_fma_f32 v95, v95, v88, v89
    v_fma_f32 v97, v97, v88, v89
    v_cvt_pk_bf16_f32 v48, v94, v95
    v_cvt_pk_bf16_f32 v49, v96, v97
    v_lshlrev_b32 v94, 16, v50
    v_lshlrev_b32 v96, 16, v51
    v_and_b32 v95, 0xffff0000, v50
    v_and_b32 v97, 0xffff0000, v51
    v_fma_f32 v94, v94, v88, v89
    v_fma_f32 v96, v96, v88, v89
    v_fma_f32 v95, v95, v88, v89
    v_fma_f32 v97, v97, v88, v89
    v_cvt_pk_bf16_f32 v50, v94, v95
    v_cvt_pk_bf16_f32 v51, v96, v97
    ds_write_b128 v5, v[48:51] offset:16512
    v_lshlrev_b32 v94, 16, v52
    v_lshlrev_b32 v96, 16, v53
    v_and_b32 v95, 0xffff0000, v52
    v_and_b32 v97, 0xffff0000, v53
    v_fma_f32 v94, v94, v88, v89
    v_fma_f32 v96, v96, v88, v89
    v_fma_f32 v95, v95, v88, v89
    v_fma_f32 v97, v97, v88, v89
    v_cvt_pk_bf16_f32 v52, v94, v95
    v_cvt_pk_bf16_f32 v53, v96, v97
    v_lshlrev_b32 v94, 16, v54
    v_lshlrev_b32 v96, 16, v55
    v_and_b32 v95, 0xffff0000, v54
    v_and_b32 v97, 0xffff0000, v55
    v_fma_f32 v94, v94, v88, v89
    v_fma_f32 v96, v96, v88, v89
    v_fma_f32 v95, v95, v88, v89
    v_fma_f32 v97, v97, v88, v89
    v_cvt_pk_bf16_f32 v54, v94, v95
    v_cvt_pk_bf16_f32 v55, v96, v97
    ds_write_b128 v5, v[52:55] offset:18560
    v_lshlrev_b32 v94, 16, v56
    v_lshlrev_b32 v96, 16, v57
    v_and_b32 v95, 0xffff0000, v56
    v_and_b32 v97, 0xffff0000, v57
    v_fma_f32 v94, v94, v88, v89
    v_fma_f32 v96, v96, v88, v89
    v_fma_f32 v95, v95, v88, v89
    v_fma_f32 v97, v97, v88, v89
    v_cvt_pk_bf16_f32 v56, v94, v95
    v_cvt_pk_bf16_f32 v57, v96, v97
    v_lshlrev_b32 v94, 16, v58
    v_lshlrev_b32 v96, 16, v59
    v_and_b32 v95, 0xffff0000, v58
    v_and_b32 v97, 0xffff0000, v59
    v_fma_f32 v94, v94, v88, v89
    v_fma_f32 v96, v96, v88, v89
    v_fma_f32 v95, v95, v88, v89
    v_fma_f32 v97, v97, v88, v89
    v_cvt_pk_bf16_f32 v58, v94, v95
    v_cvt_pk_bf16_f32 v59, v96, v97
    ds_write_b128 v5, v[56:59] offset:20608
    v_lshlrev_b32 v94, 16, v60
    v_lshlrev_b32 v96, 16, v61
    v_and_b32 v95, 0xffff0000, v60
    v_and_b32 v97, 0xffff0000, v61
    v_fma_f32 v94, v94, v88, v89
    v_fma_f32 v96, v96, v88, v89
    v_fma_f32 v95, v95, v88, v89
    v_fma_f32 v97, v97, v88, v89
    v_cvt_pk_bf16_f32 v60, v94, v95
    v_cvt_pk_bf16_f32 v61, v96, v97
    v_lshlrev_b32 v94, 16, v62
    v_lshlrev_b32 v96, 16, v63
    v_and_b32 v95, 0xffff0000, v62
    v_and_b32 v97, 0xffff0000, v63
    v_fma_f32 v94, v94, v88, v89
    v_fma_f32 v96, v96, v88, v89
    v_fma_f32 v95, v95, v88, v89
    v_fma_f32 v97, v97, v88, v89
    v_cvt_pk_bf16_f32 v62, v94, v95
    v_cvt_pk_bf16_f32 v63, v96, v97
    ds_write_b128 v5, v[60:63] offset:22656
    s_mul_i32 s63, s55, 589824
    s_add_u32 s63, s63, 4608
    s_add_u32 s63, s63, s64
    s_add_u32 m0, s68, 20480
    s_nop 0
    buffer_load_dwordx4 v16, s[24:27], s63 offen lds
    s_add_u32 m0, s68, 24576
    s_nop 0
    buffer_load_dwordx4 v17, s[24:27], s63 offen lds
    s_add_u32 m0, s68, 28672
    s_nop 0
    buffer_load_dwordx4 v18, s[24:27], s63 offen lds
    s_add_u32 m0, s68, 32768
    s_nop 0
    buffer_load_dwordx4 v19, s[24:27], s63 offen lds
    s_add_u32 m0, s68, 36864
    s_nop 0
    buffer_load_dwordx4 v20, s[24:27], s63 offen lds
    s_waitcnt lgkmcnt(0)
    s_barrier
    v_lshlrev_b32 v94, 16, v208
    v_lshlrev_b32 v96, 16, v209
    v_and_b32 v95, 0xffff0000, v208
    v_and_b32 v97, 0xffff0000, v209
    v_fma_f32 v94, v94, v88, v89
    v_fma_f32 v96, v96, v88, v89
    v_fma_f32 v95, v95, v88, v89
    v_fma_f32 v97, v97, v88, v89
    v_cvt_pk_bf16_f32 v208, v94, v95
    v_cvt_pk_bf16_f32 v209, v96, v97
    v_lshlrev_b32 v94, 16, v210
    v_lshlrev_b32 v96, 16, v211
    v_and_b32 v95, 0xffff0000, v210
    v_and_b32 v97, 0xffff0000, v211
    v_fma_f32 v94, v94, v88, v89
    v_fma_f32 v96, v96, v88, v89
    v_fma_f32 v95, v95, v88, v89
    v_fma_f32 v97, v97, v88, v89
    v_cvt_pk_bf16_f32 v210, v94, v95
    v_cvt_pk_bf16_f32 v211, v96, v97
    v_lshlrev_b32 v94, 16, v212
    v_lshlrev_b32 v96, 16, v213
    v_and_b32 v95, 0xffff0000, v212
    v_and_b32 v97, 0xffff0000, v213
    v_fma_f32 v94, v94, v88, v89
    v_fma_f32 v96, v96, v88, v89
    v_fma_f32 v95, v95, v88, v89
    v_fma_f32 v97, v97, v88, v89
    v_cvt_pk_bf16_f32 v212, v94, v95
    v_cvt_pk_bf16_f32 v213, v96, v97
    v_lshlrev_b32 v94, 16, v214
    v_lshlrev_b32 v96, 16, v215
    v_and_b32 v95, 0xffff0000, v214
    v_and_b32 v97, 0xffff0000, v215
    v_fma_f32 v94, v94, v88, v89
    v_fma_f32 v96, v96, v88, v89
    v_fma_f32 v95, v95, v88, v89
    v_fma_f32 v97, v97, v88, v89
    v_cvt_pk_bf16_f32 v214, v94, v95
    v_cvt_pk_bf16_f32 v215, v96, v97
    v_lshlrev_b32 v94, 16, v216
    v_lshlrev_b32 v96, 16, v217
    v_and_b32 v95, 0xffff0000, v216
    v_and_b32 v97, 0xffff0000, v217
    v_fma_f32 v94, v94, v88, v89
    v_fma_f32 v96, v96, v88, v89
    v_fma_f32 v95, v95, v88, v89
    v_fma_f32 v97, v97, v88, v89
    v_cvt_pk_bf16_f32 v216, v94, v95
    v_cvt_pk_bf16_f32 v217, v96, v97
    v_lshlrev_b32 v94, 16, v218
    v_lshlrev_b32 v96, 16, v219
    v_and_b32 v95, 0xffff0000, v218
    v_and_b32 v97, 0xffff0000, v219
    v_fma_f32 v94, v94, v88, v89
    v_fma_f32 v96, v96, v88, v89
    v_fma_f32 v95, v95, v88, v89
    v_fma_f32 v97, v97, v88, v89
    v_cvt_pk_bf16_f32 v218, v94, v95
    v_cvt_pk_bf16_f32 v219, v96, v97
    s_mul_i32 s63, s51, -12288
    s_add_u32 s63, s63, 40960
    v_add_u32 v5, s63, v5
    s_waitcnt vmcnt(5)
    s_barrier
    s_mul_i32 s63, s56, 589824
    s_add_u32 s63, s63, 4608
    s_add_u32 s63, s63, s64
    s_add_u32 m0, s68, 40960
    s_nop 0
    buffer_load_dwordx4 v16, s[24:27], s63 offen lds
    ds_write_b128 v5, v[208:211] offset:6272
    ds_write_b128 v5, v[212:215] offset:8320
    ds_write_b128 v5, v[216:219] offset:10368
    s_mov_b32 s78, 0xc0135761
    v_mov_b32 v9, 0xbdd2d3e8
    s_lshl_b32 s8, s2, 15
    s_lshl_b32 s9, s51, 11
    s_add_u32 s8, s8, s9
    v_lshlrev_b32 v8, 7, v1
    s_add_u32 m0, s68, 45056
    s_nop 0
    buffer_load_dwordx4 v17, s[24:27], s63 offen lds
    s_mul_i32 s98, s48, 147456
    s_sub_u32 s98, s98, 18432
    v_add_u32 v100, s98, v27
    v_bfe_u32 v101, v1, 3, 1
    v_add_u32 v101, s54, v101
    v_add_u32 v102, 0, v101
    v_subrev_u32 v103, 9, v102
    s_add_u32 m0, s68, 49152
    s_nop 0
    buffer_load_dwordx4 v18, s[24:27], s63 offen lds
    v_min_u32 v102, v102, v103
    v_lshl_add_u32 v28, v102, 7, v100
    v_add_u32 v102, 2, v101
    v_subrev_u32 v103, 9, v102
    v_min_u32 v102, v102, v103
    v_lshl_add_u32 v29, v102, 7, v100
    s_add_u32 m0, s68, 53248
    s_nop 0
    buffer_load_dwordx4 v19, s[24:27], s63 offen lds
    v_add_u32 v102, 4, v101
    v_subrev_u32 v103, 9, v102
    v_min_u32 v102, v102, v103
    v_lshl_add_u32 v30, v102, 7, v100
    v_add_u32 v102, 6, v101
    v_subrev_u32 v103, 9, v102
    s_add_u32 m0, s68, 57344
    s_nop 0
    buffer_load_dwordx4 v20, s[24:27], s63 offen lds
    v_min_u32 v102, v102, v103
    v_lshl_add_u32 v31, v102, 7, v100
    v_add_u32 v102, 8, v101
    v_subrev_u32 v103, 9, v102
    v_min_u32 v102, v102, v103
    v_lshl_add_u32 v32, v102, 7, v100
    v_and_b32 v103, 15, v1
    v_cmp_gt_u32 vcc, 8, v103
    s_nop 1
    v_cndmask_b32 v32, v106, v32, vcc
    buffer_load_dwordx4 v[232:235], v28, s[16:19], 0 offen
    buffer_load_dwordx4 v[236:239], v29, s[16:19], 0 offen
    buffer_load_dwordx4 v[240:243], v30, s[16:19], 0 offen
    s_waitcnt vmcnt(8) lgkmcnt(0)
    s_barrier
    s_mul_i32 s63, s57, 589824
    s_add_u32 s63, s63, 4608
    s_add_u32 s63, s63, s64
    s_add_u32 m0, s68, 61440
    s_nop 0
    buffer_load_dwordx4 v16, s[24:27], s63 offen lds
    s_lshl_b32 s67, s48, 14
    s_add_u32 s67, s67, 532480
    v_and_b32 v37, 15, v1
    v_lshlrev_b32 v37, 10, v37
    v_mov_b32 v6, 0
    v_mov_b32 v36, 1
    buffer_load_dwordx4 v[244:247], v31, s[16:19], 0 offen
    buffer_load_dwordx4 v[248:251], v32, s[16:19], 0 offen
    s_waitcnt vmcnt(5)
    v_lshlrev_b32 v94, 16, v232
    v_and_b32 v95, 0xffff0000, v232
    v_add_f32 v92, v94, v95
    s_add_u32 m0, s68, 65536
    s_nop 0
    buffer_load_dwordx4 v17, s[24:27], s63 offen lds
    v_mul_f32 v93, v94, v94
    v_fmac_f32 v93, v95, v95
    v_lshlrev_b32 v96, 16, v233
    v_and_b32 v97, 0xffff0000, v233
    v_add_f32 v92, v92, v96
    v_fmac_f32 v93, v96, v96
    s_add_u32 m0, s68, 69632
    s_nop 0
    buffer_load_dwordx4 v18, s[24:27], s63 offen lds
    v_add_f32 v92, v92, v97
    v_fmac_f32 v93, v97, v97
    v_lshlrev_b32 v94, 16, v234
    v_and_b32 v95, 0xffff0000, v234
    v_add_f32 v92, v92, v94
    v_fmac_f32 v93, v94, v94
    s_add_u32 m0, s68, 73728
    s_nop 0
    buffer_load_dwordx4 v19, s[24:27], s63 offen lds
    v_add_f32 v92, v92, v95
    v_fmac_f32 v93, v95, v95
    v_lshlrev_b32 v96, 16, v235
    v_and_b32 v97, 0xffff0000, v235
    v_add_f32 v92, v92, v96
    v_fmac_f32 v93, v96, v96
    s_add_u32 m0, s68, 77824
    s_nop 0
    buffer_load_dwordx4 v20, s[24:27], s63 offen lds
    v_add_f32 v92, v92, v97
    v_fmac_f32 v93, v97, v97
    s_waitcnt vmcnt(8)
    v_lshlrev_b32 v94, 16, v236
    v_and_b32 v95, 0xffff0000, v236
    v_add_f32 v92, v92, v94
    v_fmac_f32 v93, v94, v94
    v_add_f32 v92, v92, v95
    v_fmac_f32 v93, v95, v95
    v_lshlrev_b32 v96, 16, v237
    v_and_b32 v97, 0xffff0000, v237
    v_add_f32 v92, v92, v96
    s_barrier
    s_mul_i32 s63, s58, 589824
    s_add_u32 s63, s63, 4608
    s_add_u32 s63, s63, s64
    s_add_u32 m0, s68, 0
    s_nop 0
    buffer_load_dwordx4 v16, s[24:27], s63 offen lds
    v_fmac_f32 v93, v96, v96
    v_add_f32 v92, v92, v97
    v_fmac_f32 v93, v97, v97
    v_lshlrev_b32 v94, 16, v238
    v_and_b32 v95, 0xffff0000, v238
    v_add_f32 v92, v92, v94
    s_add_u32 m0, s68, 4096
    s_nop 0
    buffer_load_dwordx4 v17, s[24:27], s63 offen lds
    v_fmac_f32 v93, v94, v94
    v_add_f32 v92, v92, v95
    v_fmac_f32 v93, v95, v95
    v_lshlrev_b32 v96, 16, v239
    v_and_b32 v97, 0xffff0000, v239
    v_add_f32 v92, v92, v96
    s_add_u32 m0, s68, 8192
    s_nop 0
    buffer_load_dwordx4 v18, s[24:27], s63 offen lds
    v_fmac_f32 v93, v96, v96
    v_add_f32 v92, v92, v97
    v_fmac_f32 v93, v97, v97
    s_waitcnt vmcnt(10)
    v_lshlrev_b32 v94, 16, v240
    v_and_b32 v95, 0xffff0000, v240
    s_add_u32 m0, s68, 12288
    s_nop 0
    buffer_load_dwordx4 v19, s[24:27], s63 offen lds
    v_add_f32 v92, v92, v94
    v_fmac_f32 v93, v94, v94
    v_add_f32 v92, v92, v95
    v_fmac_f32 v93, v95, v95
    v_lshlrev_b32 v96, 16, v241
    v_and_b32 v97, 0xffff0000, v241
    s_add_u32 m0, s68, 16384
    s_nop 0
    buffer_load_dwordx4 v20, s[24:27], s63 offen lds
    v_add_f32 v92, v92, v96
    v_fmac_f32 v93, v96, v96
    v_add_f32 v92, v92, v97
    v_fmac_f32 v93, v97, v97
    v_lshlrev_b32 v94, 16, v242
    v_and_b32 v95, 0xffff0000, v242
    v_add_f32 v92, v92, v94
    v_fmac_f32 v93, v94, v94
    v_add_f32 v92, v92, v95
    v_fmac_f32 v93, v95, v95
    v_lshlrev_b32 v96, 16, v243
    s_waitcnt vmcnt(5)
    s_barrier
    s_mul_i32 s63, s59, 589824
    s_add_u32 s63, s63, 4608
    s_add_u32 s63, s63, s64
    s_add_u32 m0, s68, 20480
    s_nop 0
    buffer_load_dwordx4 v16, s[24:27], s63 offen lds
    v_and_b32 v97, 0xffff0000, v243
    v_add_f32 v92, v92, v96
    v_fmac_f32 v93, v96, v96
    v_add_f32 v92, v92, v97
    v_fmac_f32 v93, v97, v97
    v_lshlrev_b32 v94, 16, v244
    s_add_u32 m0, s68, 24576
    s_nop 0
    buffer_load_dwordx4 v17, s[24:27], s63 offen lds
    v_and_b32 v95, 0xffff0000, v244
    v_add_f32 v92, v92, v94
    v_fmac_f32 v93, v94, v94
    v_add_f32 v92, v92, v95
    v_fmac_f32 v93, v95, v95
    v_lshlrev_b32 v96, 16, v245
    s_add_u32 m0, s68, 28672
    s_nop 0
    buffer_load_dwordx4 v18, s[24:27], s63 offen lds
    v_and_b32 v97, 0xffff0000, v245
    v_add_f32 v92, v92, v96
    v_fmac_f32 v93, v96, v96
    v_add_f32 v92, v92, v97
    v_fmac_f32 v93, v97, v97
    s_add_u32 m0, s68, 32768
    s_nop 0
    buffer_load_dwordx4 v19, s[24:27], s63 offen lds
    v_lshlrev_b32 v94, 16, v246
    v_and_b32 v95, 0xffff0000, v246
    v_add_f32 v92, v92, v94
    v_fmac_f32 v93, v94, v94
    v_add_f32 v92, v92, v95
    v_fmac_f32 v93, v95, v95
    s_add_u32 m0, s68, 36864
    s_nop 0
    buffer_load_dwordx4 v20, s[24:27], s63 offen lds
    v_lshlrev_b32 v96, 16, v247
    v_and_b32 v97, 0xffff0000, v247
    v_add_f32 v92, v92, v96
    v_fmac_f32 v93, v96, v96
    v_add_f32 v92, v92, v97
    v_fmac_f32 v93, v97, v97
    v_lshlrev_b32 v94, 16, v248
    v_and_b32 v95, 0xffff0000, v248
    v_add_f32 v92, v92, v94
    v_fmac_f32 v93, v94, v94
    v_add_f32 v92, v92, v95
    s_waitcnt vmcnt(5)
    s_barrier
    s_mul_i32 s63, s60, 589824
    s_add_u32 s63, s63, 4608
    s_add_u32 s63, s63, s64
    s_add_u32 m0, s68, 40960
    s_nop 0
    buffer_load_dwordx4 v16, s[24:27], s63 offen lds
    v_fmac_f32 v93, v95, v95
    v_lshlrev_b32 v96, 16, v249
    v_and_b32 v97, 0xffff0000, v249
    v_add_f32 v92, v92, v96
    v_fmac_f32 v93, v96, v96
    s_add_u32 m0, s68, 45056
    s_nop 0
    buffer_load_dwordx4 v17, s[24:27], s63 offen lds
    v_add_f32 v92, v92, v97
    v_fmac_f32 v93, v97, v97
    v_lshlrev_b32 v94, 16, v250
    v_and_b32 v95, 0xffff0000, v250
    v_add_f32 v92, v92, v94
    v_fmac_f32 v93, v94, v94
    s_add_u32 m0, s68, 49152
    s_nop 0
    buffer_load_dwordx4 v18, s[24:27], s63 offen lds
    v_add_f32 v92, v92, v95
    v_fmac_f32 v93, v95, v95
    v_lshlrev_b32 v96, 16, v251
    v_and_b32 v97, 0xffff0000, v251
    v_add_f32 v92, v92, v96
    v_fmac_f32 v93, v96, v96
    s_add_u32 m0, s68, 53248
    s_nop 0
    buffer_load_dwordx4 v19, s[24:27], s63 offen lds
    v_add_f32 v92, v92, v97
    v_fmac_f32 v93, v97, v97
    s_nop 0
    v_add_f32_dpp v92, v92, v92 quad_perm:[1,0,3,2] row_mask:0xf bank_mask:0xf
    v_add_f32_dpp v93, v93, v93 quad_perm:[1,0,3,2] row_mask:0xf bank_mask:0xf
    s_nop 0
    v_add_f32_dpp v92, v92, v92 quad_perm:[2,3,0,1] row_mask:0xf bank_mask:0xf
    v_add_f32_dpp v93, v93, v93 quad_perm:[2,3,0,1] row_mask:0xf bank_mask:0xf
    s_add_u32 m0, s68, 57344
    s_nop 0
    buffer_load_dwordx4 v20, s[24:27], s63 offen lds
    v_add_f32_dpp v92, v92, v92 row_half_mirror row_mask:0xf bank_mask:0xf
    v_add_f32_dpp v93, v93, v93 row_half_mirror row_mask:0xf bank_mask:0xf
    s_nop 0
    v_add_f32_dpp v92, v92, v92 row_mirror row_mask:0xf bank_mask:0xf
    v_add_f32_dpp v93, v93, v93 row_mirror row_mask:0xf bank_mask:0xf
    v_mul_f32 v92, s83, v92
    v_mul_f32 v94, v92, v92
    v_fma_f32 v93, v93, s83, -v94
    v_max_f32 v93, 0, v93
    v_add_f32 v93, 0x3727c5ac, v93
    v_rsq_f32 v94, v93
    s_waitcnt vmcnt(5)
    s_barrier
    s_mul_i32 s63, s61, 589824
    s_add_u32 s63, s63, 4608
    s_add_u32 s63, s63, s64
    s_add_u32 m0, s68, 61440
    s_nop 0
    buffer_load_dwordx4 v16, s[24:27], s63 offen lds
    v_mul_f32 v93, v92, v94
    v_sub_f32 v93, 0, v93
    v_mov_b32 v92, v94
    v_lshlrev_b32 v94, 16, v232
    v_lshlrev_b32 v96, 16, v233
    v_and_b32 v95, 0xffff0000, v232
    s_add_u32 m0, s68, 65536
    s_nop 0
    buffer_load_dwordx4 v17, s[24:27], s63 offen lds
    v_and_b32 v97, 0xffff0000, v233
    v_fma_f32 v94, v94, v92, v93
    v_fma_f32 v96, v96, v92, v93
    v_fma_f32 v95, v95, v92, v93
    v_fma_f32 v97, v97, v92, v93
    v_cvt_pk_bf16_f32 v232, v94, v95
    s_add_u32 m0, s68, 69632
    s_nop 0
    buffer_load_dwordx4 v18, s[24:27], s63 offen lds
    v_cvt_pk_bf16_f32 v233, v96, v97
    v_lshlrev_b32 v94, 16, v234
    v_lshlrev_b32 v96, 16, v235
    v_and_b32 v95, 0xffff0000, v234
    v_and_b32 v97, 0xffff0000, v235
    s_add_u32 m0, s68, 73728
    s_nop 0
    buffer_load_dwordx4 v19, s[24:27], s63 offen lds
    v_fma_f32 v94, v94, v92, v93
    v_fma_f32 v96, v96, v92, v93
    v_fma_f32 v95, v95, v92, v93
    v_fma_f32 v97, v97, v92, v93
    v_cvt_pk_bf16_f32 v234, v94, v95
    v_cvt_pk_bf16_f32 v235, v96, v97
    s_add_u32 m0, s68, 77824
    s_nop 0
    buffer_load_dwordx4 v20, s[24:27], s63 offen lds
    ds_write_b128 v26, v[232:235] offset:0
    v_lshlrev_b32 v94, 16, v236
    v_lshlrev_b32 v96, 16, v237
    v_and_b32 v95, 0xffff0000, v236
    v_and_b32 v97, 0xffff0000, v237
    v_fma_f32 v94, v94, v92, v93
    v_fma_f32 v96, v96, v92, v93
    v_fma_f32 v95, v95, v92, v93
    v_fma_f32 v97, v97, v92, v93
    v_cvt_pk_bf16_f32 v236, v94, v95
    v_cvt_pk_bf16_f32 v237, v96, v97
    s_waitcnt vmcnt(5)
    s_barrier
    s_mul_i32 s63, s62, 589824
    s_add_u32 s63, s63, 4608
    s_add_u32 s63, s63, s64
    s_add_u32 m0, s68, 0
    s_nop 0
    buffer_load_dwordx4 v16, s[24:27], s63 offen lds
    v_lshlrev_b32 v94, 16, v238
    v_lshlrev_b32 v96, 16, v239
    v_and_b32 v95, 0xffff0000, v238
    v_and_b32 v97, 0xffff0000, v239
    v_fma_f32 v94, v94, v92, v93
    v_fma_f32 v96, v96, v92, v93
    s_add_u32 m0, s68, 4096
    s_nop 0
    buffer_load_dwordx4 v17, s[24:27], s63 offen lds
    v_fma_f32 v95, v95, v92, v93
    v_fma_f32 v97, v97, v92, v93
    v_cvt_pk_bf16_f32 v238, v94, v95
    v_cvt_pk_bf16_f32 v239, v96, v97
    ds_write_b128 v26, v[236:239] offset:4096
    v_lshlrev_b32 v94, 16, v240
    s_add_u32 m0, s68, 8192
    s_nop 0
    buffer_load_dwordx4 v18, s[24:27], s63 offen lds
    v_lshlrev_b32 v96, 16, v241
    v_and_b32 v95, 0xffff0000, v240
    v_and_b32 v97, 0xffff0000, v241
    v_fma_f32 v94, v94, v92, v93
    v_fma_f32 v96, v96, v92, v93
    s_add_u32 m0, s68, 12288
    s_nop 0
    buffer_load_dwordx4 v19, s[24:27], s63 offen lds
    v_fma_f32 v95, v95, v92, v93
    v_fma_f32 v97, v97, v92, v93
    v_cvt_pk_bf16_f32 v240, v94, v95
    v_cvt_pk_bf16_f32 v241, v96, v97
    v_lshlrev_b32 v94, 16, v242
    v_lshlrev_b32 v96, 16, v243
    s_add_u32 m0, s68, 16384
    s_nop 0
    buffer_load_dwordx4 v20, s[24:27], s63 offen lds
    v_and_b32 v95, 0xffff0000, v242
    v_and_b32 v97, 0xffff0000, v243
    v_fma_f32 v94, v94, v92, v93
    v_fma_f32 v96, v96, v92, v93
    v_fma_f32 v95, v95, v92, v93
    v_fma_f32 v97, v97, v92, v93
    v_cvt_pk_bf16_f32 v242, v94, v95
    v_cvt_pk_bf16_f32 v243, v96, v97
    ds_write_b128 v26, v[240:243] offset:8192
    v_lshlrev_b32 v94, 16, v244
    v_lshlrev_b32 v96, 16, v245
    s_waitcnt vmcnt(5)
    s_barrier
    s_mul_i32 s63, s54, 221184
    s_add_u32 s63, s63, s65
    s_add_u32 m0, s68, 20480
    s_nop 0
    buffer_load_dwordx4 v21, s[20:23], s63 offen lds
    v_and_b32 v95, 0xffff0000, v244
    v_and_b32 v97, 0xffff0000, v245
    v_fma_f32 v94, v94, v92, v93
    v_fma_f32 v96, v96, v92, v93
    v_fma_f32 v95, v95, v92, v93
    v_fma_f32 v97, v97, v92, v93
    s_add_u32 m0, s68, 24576
    s_nop 0
    buffer_load_dwordx4 v22, s[20:23], s63 offen lds
    v_cvt_pk_bf16_f32 v244, v94, v95
    v_cvt_pk_bf16_f32 v245, v96, v97
    v_lshlrev_b32 v94, 16, v246
    v_lshlrev_b32 v96, 16, v247
    v_and_b32 v95, 0xffff0000, v246
    v_and_b32 v97, 0xffff0000, v247
    s_add_u32 m0, s68, 28672
    s_nop 0
    buffer_load_dwordx4 v23, s[20:23], s63 offen lds
    v_fma_f32 v94, v94, v92, v93
    v_fma_f32 v96, v96, v92, v93
    v_fma_f32 v95, v95, v92, v93
    v_fma_f32 v97, v97, v92, v93
    v_cvt_pk_bf16_f32 v246, v94, v95
    s_add_u32 m0, s68, 32768
    s_nop 0
    buffer_load_dwordx4 v24, s[20:23], s63 offen lds
    v_cvt_pk_bf16_f32 v247, v96, v97
    ds_write_b128 v26, v[244:247] offset:12288
    v_lshlrev_b32 v94, 16, v248
    v_lshlrev_b32 v96, 16, v249
    v_and_b32 v95, 0xffff0000, v248
    v_and_b32 v97, 0xffff0000, v249
    s_add_u32 m0, s68, 36864
    s_nop 0
    buffer_load_dwordx4 v25, s[20:23], s63 offen lds
    v_fma_f32 v94, v94, v92, v93
    v_fma_f32 v96, v96, v92, v93
    v_fma_f32 v95, v95, v92, v93
    v_fma_f32 v97, v97, v92, v93
    v_cvt_pk_bf16_f32 v248, v94, v95
    v_cvt_pk_bf16_f32 v249, v96, v97
    v_lshlrev_b32 v94, 16, v250
    v_lshlrev_b32 v96, 16, v251
    v_and_b32 v95, 0xffff0000, v250
    v_and_b32 v97, 0xffff0000, v251
    v_fma_f32 v94, v94, v92, v93
    s_waitcnt vmcnt(5)
    s_barrier
    s_mul_i32 s63, s55, 221184
    s_add_u32 s63, s63, s65
    s_add_u32 m0, s68, 40960
    s_nop 0
    buffer_load_dwordx4 v21, s[20:23], s63 offen lds
    v_fma_f32 v96, v96, v92, v93
    v_fma_f32 v95, v95, v92, v93
    s_add_u32 m0, s68, 45056
    s_nop 0
    buffer_load_dwordx4 v22, s[20:23], s63 offen lds
    v_fma_f32 v97, v97, v92, v93
    s_add_u32 m0, s68, 49152
    s_nop 0
    buffer_load_dwordx4 v23, s[20:23], s63 offen lds
    v_cvt_pk_bf16_f32 v250, v94, v95
    s_add_u32 m0, s68, 53248
    s_nop 0
    buffer_load_dwordx4 v24, s[20:23], s63 offen lds
    v_cvt_pk_bf16_f32 v251, v96, v97
    s_add_u32 m0, s68, 57344
    s_nop 0
    buffer_load_dwordx4 v25, s[20:23], s63 offen lds
    s_mov_b32 exec_lo, 0x00ff00ff
    s_mov_b32 exec_hi, 0x00ff00ff
    ds_write_b128 v26, v[248:251] offset:16384
    s_mov_b64 exec, -1
    s_waitcnt vmcnt(5) lgkmcnt(0)
    s_barrier
    s_mul_i32 s63, s56, 221184
    s_add_u32 s63, s63, s65
    s_add_u32 m0, s68, 61440
    s_nop 0
    buffer_load_dwordx4 v21, s[20:23], s63 offen lds
    s_add_u32 m0, s68, 65536
    s_nop 0
    buffer_load_dwordx4 v22, s[20:23], s63 offen lds
    s_add_u32 m0, s68, 69632
    s_nop 0
    buffer_load_dwordx4 v23, s[20:23], s63 offen lds
    s_add_u32 m0, s68, 73728
    s_nop 0
    buffer_load_dwordx4 v24, s[20:23], s63 offen lds
    s_add_u32 m0, s68, 77824
    s_nop 0
    buffer_load_dwordx4 v25, s[20:23], s63 offen lds
    s_waitcnt vmcnt(5)
    s_barrier
    s_mul_i32 s63, s57, 221184
    s_add_u32 s63, s63, s65
    s_add_u32 m0, s68, 0
    s_nop 0
    buffer_load_dwordx4 v21, s[20:23], s63 offen lds
    v_and_b32 v10, 15, v1
    v_lshlrev_b32 v11, 3, v10
    s_lshl_b32 s98, s51, 5
    v_add_u32 v10, s98, v10
    v_mul_u32_u24 v10, 296, v10
    v_lshrrev_b32 v12, 4, v1
    v_lshlrev_b32 v12, 3, v12
    s_mov_b32 s98, 81920
    v_add3_u32 v10, v10, v12, s98
    ds_read_b64 v[60:61], v10 offset:0
    ds_read_b64 v[62:63], v10 offset:32
    ds_read_b64 v[64:65], v10 offset:64
    s_add_u32 m0, s68, 4096
    s_nop 0
    buffer_load_dwordx4 v22, s[20:23], s63 offen lds
    ds_read_b64 v[66:67], v10 offset:96
    ds_read_b64 v[68:69], v10 offset:128
    ds_read_b64 v[70:71], v10 offset:160
    ds_read_b64 v[72:73], v10 offset:192
    ds_read_b64 v[74:75], v10 offset:224
    ds_read_b64 v[76:77], v10 offset:256
    ds_read_b64 v[80:81], v10 offset:4736
    ds_read_b64 v[82:83], v10 offset:4768
    ds_read_b64 v[84:85], v10 offset:4800
    ds_read_b64 v[86:87], v10 offset:4832
    ds_read_b64 v[88:89], v10 offset:4864
    s_add_u32 m0, s68, 8192
    s_nop 0
    buffer_load_dwordx4 v23, s[20:23], s63 offen lds
    v_mov_b32 v78, 0
    v_mov_b32 v79, 0
    v_mov_b32 v98, 0
    v_mov_b32 v99, 0
    v_mov_b32 v132, s82
    v_mov_b32 v133, s82
    v_mov_b32 v134, s82
    v_mov_b32 v135, s82
    s_waitcnt lgkmcnt(13)
    v_lshlrev_b32 v100, 16, v60
    v_and_b32 v101, 0xffff0000, v60
    v_lshlrev_b32 v102, 16, v61
    s_add_u32 m0, s68, 12288
    s_nop 0
    buffer_load_dwordx4 v24, s[20:23], s63 offen lds
    v_and_b32 v103, 0xffff0000, v61
    v_mul_f32 v104, v100, v100
    v_mul_f32 v105, v101, v101
    v_mul_f32 v106, v102, v102
    v_mul_f32 v107, v103, v103
    v_fma_f32 v104, v104, v9, s78
    v_fma_f32 v105, v105, v9, s78
    v_fma_f32 v106, v106, v9, s78
    v_fma_f32 v107, v107, v9, s78
    v_mul_f32 v104, v104, v100
    v_mul_f32 v105, v105, v101
    s_add_u32 m0, s68, 16384
    s_nop 0
    buffer_load_dwordx4 v25, s[20:23], s63 offen lds
    v_mul_f32 v106, v106, v102
    v_mul_f32 v107, v107, v103
    v_exp_f32 v104, v104
    v_exp_f32 v105, v105
    v_exp_f32 v106, v106
    v_exp_f32 v107, v107
    v_add_f32 v104, 1.0, v104
    v_add_f32 v105, 1.0, v105
    v_add_f32 v106, 1.0, v106
    v_add_f32 v107, 1.0, v107
    v_rcp_f32 v104, v104
    v_rcp_f32 v105, v105
    v_rcp_f32 v106, v106
    v_rcp_f32 v107, v107
    s_waitcnt vmcnt(5)
    s_barrier
    s_mul_i32 s63, s58, 221184
    s_add_u32 s63, s63, s65
    s_add_u32 m0, s68, 20480
    s_nop 0
    buffer_load_dwordx4 v21, s[20:23], s63 offen lds
    v_mul_f32 v100, v100, v104
    v_mul_f32 v101, v101, v105
    v_mul_f32 v102, v102, v106
    v_mul_f32 v103, v103, v107
    v_cvt_pk_bf16_f32 v60, v100, v101
    v_cvt_pk_bf16_f32 v61, v102, v103
    ds_write_b64 v10, v[60:61] offset:0
    s_waitcnt lgkmcnt(13)
    v_lshlrev_b32 v108, 16, v62
    v_and_b32 v109, 0xffff0000, v62
    v_lshlrev_b32 v110, 16, v63
    v_and_b32 v111, 0xffff0000, v63
    s_add_u32 m0, s68, 24576
    s_nop 0
    buffer_load_dwordx4 v22, s[20:23], s63 offen lds
    v_mul_f32 v112, v108, v108
    v_mul_f32 v113, v109, v109
    v_mul_f32 v114, v110, v110
    v_mul_f32 v115, v111, v111
    v_fma_f32 v112, v112, v9, s78
    v_fma_f32 v113, v113, v9, s78
    v_fma_f32 v114, v114, v9, s78
    v_fma_f32 v115, v115, v9, s78
    v_mul_f32 v112, v112, v108
    v_mul_f32 v113, v113, v109
    v_mul_f32 v114, v114, v110
    s_add_u32 m0, s68, 28672
    s_nop 0
    buffer_load_dwordx4 v23, s[20:23], s63 offen lds
    v_mul_f32 v115, v115, v111
    v_exp_f32 v112, v112
    v_exp_f32 v113, v113
    v_exp_f32 v114, v114
    v_exp_f32 v115, v115
    v_add_f32 v112, 1.0, v112
    v_add_f32 v113, 1.0, v113
    s_add_u32 m0, s68, 32768
    s_nop 0
    buffer_load_dwordx4 v24, s[20:23], s63 offen lds
    v_add_f32 v114, 1.0, v114
    v_add_f32 v115, 1.0, v115
    v_rcp_f32 v112, v112
    v_rcp_f32 v113, v113
    v_rcp_f32 v114, v114
    v_rcp_f32 v115, v115
    v_mul_f32 v108, v108, v112
    s_add_u32 m0, s68, 36864
    s_nop 0
    buffer_load_dwordx4 v25, s[20:23], s63 offen lds
    v_mul_f32 v109, v109, v113
    v_mul_f32 v110, v110, v114
    v_mul_f32 v111, v111, v115
    v_cvt_pk_bf16_f32 v62, v108, v109
    v_cvt_pk_bf16_f32 v63, v110, v111
    ds_write_b64 v10, v[62:63] offset:32
    s_waitcnt lgkmcnt(13)
    v_lshlrev_b32 v100, 16, v64
    v_and_b32 v101, 0xffff0000, v64
    v_lshlrev_b32 v102, 16, v65
    v_and_b32 v103, 0xffff0000, v65
    v_mul_f32 v104, v100, v100
    v_mul_f32 v105, v101, v101
    v_mul_f32 v106, v102, v102
    v_mul_f32 v107, v103, v103
    v_fma_f32 v104, v104, v9, s78
    v_fma_f32 v105, v105, v9, s78
    v_fma_f32 v106, v106, v9, s78
    v_fma_f32 v107, v107, v9, s78
    v_mul_f32 v104, v104, v100
    v_mul_f32 v105, v105, v101
    v_mul_f32 v106, v106, v102
    v_mul_f32 v107, v107, v103
    s_waitcnt vmcnt(5)
    s_barrier
    s_mul_i32 s63, s59, 221184
    s_add_u32 s63, s63, s65
    s_add_u32 m0, s68, 40960
    s_nop 0
    buffer_load_dwordx4 v21, s[20:23], s63 offen lds
    v_exp_f32 v104, v104
    v_exp_f32 v105, v105
    v_exp_f32 v106, v106
    v_exp_f32 v107, v107
    v_add_f32 v104, 1.0, v104
    v_add_f32 v105, 1.0, v105
    v_add_f32 v106, 1.0, v106
    s_add_u32 m0, s68, 45056
    s_nop 0
    buffer_load_dwordx4 v22, s[20:23], s63 offen lds
    v_add_f32 v107, 1.0, v107
    v_rcp_f32 v104, v104
    v_rcp_f32 v105, v105
    v_rcp_f32 v106, v106
    v_rcp_f32 v107, v107
    v_mul_f32 v100, v100, v104
    v_mul_f32 v101, v101, v105
    s_add_u32 m0, s68, 49152
    s_nop 0
    buffer_load_dwordx4 v23, s[20:23], s63 offen lds
    v_mul_f32 v102, v102, v106
    v_mul_f32 v103, v103, v107
    v_cvt_pk_bf16_f32 v64, v100, v101
    v_cvt_pk_bf16_f32 v65, v102, v103
    ds_write_b64 v10, v[64:65] offset:64
    s_waitcnt lgkmcnt(13)
    v_lshlrev_b32 v108, 16, v66
    v_and_b32 v109, 0xffff0000, v66
    v_lshlrev_b32 v110, 16, v67
    v_and_b32 v111, 0xffff0000, v67
    v_mul_f32 v112, v108, v108
    v_mul_f32 v113, v109, v109
    s_add_u32 m0, s68, 53248
    s_nop 0
    buffer_load_dwordx4 v24, s[20:23], s63 offen lds
    v_mul_f32 v114, v110, v110
    v_mul_f32 v115, v111, v111
    v_fma_f32 v112, v112, v9, s78
    v_fma_f32 v113, v113, v9, s78
    v_fma_f32 v114, v114, v9, s78
    v_fma_f32 v115, v115, v9, s78
    v_mul_f32 v112, v112, v108
    v_mul_f32 v113, v113, v109
    v_mul_f32 v114, v114, v110
    v_mul_f32 v115, v115, v111
    v_exp_f32 v112, v112
    s_add_u32 m0, s68, 57344
    s_nop 0
    buffer_load_dwordx4 v25, s[20:23], s63 offen lds
    v_exp_f32 v113, v113
    v_exp_f32 v114, v114
    v_exp_f32 v115, v115
    v_add_f32 v112, 1.0, v112
    v_add_f32 v113, 1.0, v113
    v_add_f32 v114, 1.0, v114
    v_add_f32 v115, 1.0, v115
    v_rcp_f32 v112, v112
    v_rcp_f32 v113, v113
    v_rcp_f32 v114, v114
    v_rcp_f32 v115, v115
    v_mul_f32 v108, v108, v112
    v_mul_f32 v109, v109, v113
    v_mul_f32 v110, v110, v114
    s_waitcnt vmcnt(5)
    s_barrier
    s_mul_i32 s63, s60, 221184
    s_add_u32 s63, s63, s65
    s_add_u32 m0, s68, 61440
    s_nop 0
    buffer_load_dwordx4 v21, s[20:23], s63 offen lds
    v_and_b32 v39, 15, v1
    v_lshlrev_b32 v39, 4, v39
    buffer_load_dword v38, v39, s[44:47], 0 offen sc1
    v_mul_f32 v111, v111, v115
    v_cvt_pk_bf16_f32 v66, v108, v109
    v_cvt_pk_bf16_f32 v67, v110, v111
    ds_write_b64 v10, v[66:67] offset:96
    s_waitcnt lgkmcnt(13)
    v_lshlrev_b32 v100, 16, v68
    v_and_b32 v101, 0xffff0000, v68
    v_lshlrev_b32 v102, 16, v69
    v_and_b32 v103, 0xffff0000, v69
    v_mul_f32 v104, v100, v100
    v_mul_f32 v105, v101, v101
    v_mul_f32 v106, v102, v102
    s_add_u32 m0, s68, 65536
    s_nop 0
    buffer_load_dwordx4 v22, s[20:23], s63 offen lds
    v_mul_f32 v107, v103, v103
    v_fma_f32 v104, v104, v9, s78
    v_fma_f32 v105, v105, v9, s78
    v_fma_f32 v106, v106, v9, s78
    v_fma_f32 v107, v107, v9, s78
    v_mul_f32 v104, v104, v100
    v_mul_f32 v105, v105, v101
    v_mul_f32 v106, v106, v102
    v_mul_f32 v107, v107, v103
    v_exp_f32 v104, v104
    s_add_u32 m0, s68, 69632
    s_nop 0
    buffer_load_dwordx4 v23, s[20:23], s63 offen lds
    v_exp_f32 v105, v105
    v_exp_f32 v106, v106
    v_exp_f32 v107, v107
    v_add_f32 v104, 1.0, v104
    v_add_f32 v105, 1.0, v105
    v_add_f32 v106, 1.0, v106
    v_add_f32 v107, 1.0, v107
    v_rcp_f32 v104, v104
    s_add_u32 m0, s68, 73728
    s_nop 0
    buffer_load_dwordx4 v24, s[20:23], s63 offen lds
    v_rcp_f32 v105, v105
    v_rcp_f32 v106, v106
    v_rcp_f32 v107, v107
    v_mul_f32 v100, v100, v104
    v_mul_f32 v101, v101, v105
    v_mul_f32 v102, v102, v106
    v_mul_f32 v103, v103, v107
    v_cvt_pk_bf16_f32 v68, v100, v101
    s_add_u32 m0, s68, 77824
    s_nop 0
    buffer_load_dwordx4 v25, s[20:23], s63 offen lds
    v_cvt_pk_bf16_f32 v69, v102, v103
    ds_write_b64 v10, v[68:69] offset:128
    s_waitcnt lgkmcnt(13)
    v_lshlrev_b32 v108, 16, v70
    v_and_b32 v109, 0xffff0000, v70
    v_lshlrev_b32 v110, 16, v71
    v_and_b32 v111, 0xffff0000, v71
    v_mul_f32 v112, v108, v108
    v_mul_f32 v113, v109, v109
    v_mul_f32 v114, v110, v110
    v_mul_f32 v115, v111, v111
    v_fma_f32 v112, v112, v9, s78
    v_fma_f32 v113, v113, v9, s78
    v_fma_f32 v114, v114, v9, s78
    v_fma_f32 v115, v115, v9, s78
    v_mul_f32 v112, v112, v108
    v_mul_f32 v113, v113, v109
    v_mul_f32 v114, v114, v110
    v_mul_f32 v115, v115, v111
    v_exp_f32 v112, v112
    v_exp_f32 v113, v113
    s_waitcnt vmcnt(6)
    s_barrier
    s_mul_i32 s63, s61, 221184
    s_add_u32 s63, s63, s65
    s_add_u32 m0, s68, 0
    s_nop 0
    buffer_load_dwordx4 v21, s[20:23], s63 offen lds
    v_exp_f32 v114, v114
    v_exp_f32 v115, v115
    v_add_f32 v112, 1.0, v112
    v_add_f32 v113, 1.0, v113
    v_add_f32 v114, 1.0, v114
    v_add_f32 v115, 1.0, v115
    v_rcp_f32 v112, v112
    v_rcp_f32 v113, v113
    s_add_u32 m0, s68, 4096
    s_nop 0
    buffer_load_dwordx4 v22, s[20:23], s63 offen lds
    v_rcp_f32 v114, v114
    v_rcp_f32 v115, v115
    v_mul_f32 v108, v108, v112
    v_mul_f32 v109, v109, v113
    v_mul_f32 v110, v110, v114
    v_mul_f32 v111, v111, v115
    v_cvt_pk_bf16_f32 v70, v108, v109
    v_cvt_pk_bf16_f32 v71, v110, v111
    s_add_u32 m0, s68, 8192
    s_nop 0
    buffer_load_dwordx4 v23, s[20:23], s63 offen lds
    ds_write_b64 v10, v[70:71] offset:160
    s_waitcnt lgkmcnt(13)
    v_lshlrev_b32 v100, 16, v72
    v_and_b32 v101, 0xffff0000, v72
    v_lshlrev_b32 v102, 16, v73
    v_and_b32 v103, 0xffff0000, v73
    v_mul_f32 v104, v100, v100
    v_mul_f32 v105, v101, v101
    v_mul_f32 v106, v102, v102
    v_mul_f32 v107, v103, v103
    v_fma_f32 v104, v104, v9, s78
    v_fma_f32 v105, v105, v9, s78
    s_add_u32 m0, s68, 12288
    s_nop 0
    buffer_load_dwordx4 v24, s[20:23], s63 offen lds
    v_fma_f32 v106, v106, v9, s78
    v_fma_f32 v107, v107, v9, s78
    v_mul_f32 v104, v104, v100
    v_mul_f32 v105, v105, v101
    v_mul_f32 v106, v106, v102
    v_mul_f32 v107, v107, v103
    v_exp_f32 v104, v104
    v_exp_f32 v105, v105
    v_exp_f32 v106, v106
    s_add_u32 m0, s68, 16384
    s_nop 0
    buffer_load_dwordx4 v25, s[20:23], s63 offen lds
    v_exp_f32 v107, v107
    v_add_f32 v104, 1.0, v104
    v_add_f32 v105, 1.0, v105
    v_add_f32 v106, 1.0, v106
    v_add_f32 v107, 1.0, v107
    v_rcp_f32 v104, v104
    v_rcp_f32 v105, v105
    v_rcp_f32 v106, v106
    v_rcp_f32 v107, v107
    v_mul_f32 v100, v100, v104
    v_mul_f32 v101, v101, v105
    v_mul_f32 v102, v102, v106
    v_mul_f32 v103, v103, v107
    v_cvt_pk_bf16_f32 v72, v100, v101
    v_cvt_pk_bf16_f32 v73, v102, v103
    ds_write_b64 v10, v[72:73] offset:192
    s_waitcnt vmcnt(5)
    s_barrier
    s_mul_i32 s63, s62, 221184
    s_add_u32 s63, s63, s65
    s_add_u32 m0, s68, 20480
    s_nop 0
    buffer_load_dwordx4 v21, s[20:23], s63 offen lds
    s_waitcnt lgkmcnt(13)
    v_lshlrev_b32 v108, 16, v74
    v_and_b32 v109, 0xffff0000, v74
    v_lshlrev_b32 v110, 16, v75
    v_and_b32 v111, 0xffff0000, v75
    v_mul_f32 v112, v108, v108
    v_mul_f32 v113, v109, v109
    v_mul_f32 v114, v110, v110
    v_mul_f32 v115, v111, v111
    v_fma_f32 v112, v112, v9, s78
    v_fma_f32 v113, v113, v9, s78
    v_fma_f32 v114, v114, v9, s78
    v_fma_f32 v115, v115, v9, s78
    s_add_u32 m0, s68, 24576
    s_nop 0
    buffer_load_dwordx4 v22, s[20:23], s63 offen lds
    v_mul_f32 v112, v112, v108
    v_mul_f32 v113, v113, v109
    v_mul_f32 v114, v114, v110
    v_mul_f32 v115, v115, v111
    v_exp_f32 v112, v112
    v_exp_f32 v113, v113
    v_exp_f32 v114, v114
    v_exp_f32 v115, v115
    s_add_u32 m0, s68, 28672
    s_nop 0
    buffer_load_dwordx4 v23, s[20:23], s63 offen lds
    v_add_f32 v112, 1.0, v112
    v_add_f32 v113, 1.0, v113
    v_add_f32 v114, 1.0, v114
    v_add_f32 v115, 1.0, v115
    v_rcp_f32 v112, v112
    v_rcp_f32 v113, v113
    v_rcp_f32 v114, v114
    s_add_u32 m0, s68, 32768
    s_nop 0
    buffer_load_dwordx4 v24, s[20:23], s63 offen lds
    v_rcp_f32 v115, v115
    v_mul_f32 v108, v108, v112
    v_mul_f32 v109, v109, v113
    v_mul_f32 v110, v110, v114
    v_mul_f32 v111, v111, v115
    v_cvt_pk_bf16_f32 v74, v108, v109
    v_cvt_pk_bf16_f32 v75, v110, v111
    ds_write_b64 v10, v[74:75] offset:224
    s_waitcnt lgkmcnt(13)
    v_lshlrev_b32 v100, 16, v76
    v_and_b32 v101, 0xffff0000, v76
    s_add_u32 m0, s68, 36864
    s_nop 0
    buffer_load_dwordx4 v25, s[20:23], s63 offen lds
    v_lshlrev_b32 v102, 16, v77
    v_and_b32 v103, 0xffff0000, v77
    v_mul_f32 v104, v100, v100
    v_mul_f32 v105, v101, v101
    v_mul_f32 v106, v102, v102
    v_mul_f32 v107, v103, v103
    v_fma_f32 v104, v104, v9, s78
    v_fma_f32 v105, v105, v9, s78
    v_fma_f32 v106, v106, v9, s78
    v_fma_f32 v107, v107, v9, s78
    v_mul_f32 v104, v104, v100
    v_mul_f32 v105, v105, v101
    v_mul_f32 v106, v106, v102
    v_mul_f32 v107, v107, v103
    v_exp_f32 v104, v104
    v_exp_f32 v105, v105
    v_exp_f32 v106, v106
    v_exp_f32 v107, v107
    s_waitcnt vmcnt(5)
    s_barrier
    s_mul_i32 s63, s54, 589824
    s_add_u32 s63, s63, s64
    s_add_u32 m0, s68, 40960
    s_nop 0
    buffer_load_dwordx4 v16, s[24:27], s63 offen lds
    v_cmp_gt_u32 vcc, 16, v38
    s_cmp_lg_u32 s51, 0
    s_cbranch_scc1 K1_GOK
    s_mov_b32 s10, 0
K1_GPOLL:
    s_cmp_eq_u32 vcc_lo, 0
    s_cbranch_scc1 K1_GOK
    s_sleep 16
    buffer_load_dword v38, v39, s[44:47], 0 offen sc1
    s_add_u32 s10, s10, 1
    s_waitcnt vmcnt(0)
    v_cmp_gt_u32 vcc, 16, v38
    s_cmp_lt_u32 s10, 0x10000
    s_cbranch_scc1 K1_GPOLL
K1_GOK:
    v_add_f32 v104, 1.0, v104
    v_add_f32 v105, 1.0, v105
    v_add_f32 v106, 1.0, v106
    v_add_f32 v107, 1.0, v107
    v_rcp_f32 v104, v104
    v_rcp_f32 v105, v105
    v_rcp_f32 v106, v106
    v_rcp_f32 v107, v107
    s_add_u32 m0, s68, 45056
    s_nop 0
    buffer_load_dwordx4 v17, s[24:27], s63 offen lds
    v_mul_f32 v100, v100, v104
    v_mul_f32 v101, v101, v105
    v_mul_f32 v102, v102, v106
    v_mul_f32 v103, v103, v107
    v_cvt_pk_bf16_f32 v76, v100, v101
    v_cvt_pk_bf16_f32 v77, v102, v103
    ds_write_b64 v10, v[76:77] offset:256
    s_waitcnt lgkmcnt(13)
    v_lshlrev_b32 v108, 16, v80
    v_and_b32 v109, 0xffff0000, v80
    v_lshlrev_b32 v110, 16, v81
    s_add_u32 m0, s68, 49152
    s_nop 0
    buffer_load_dwordx4 v18, s[24:27], s63 offen lds
    v_and_b32 v111, 0xffff0000, v81
    v_mul_f32 v112, v108, v108
    v_mul_f32 v113, v109, v109
    v_mul_f32 v114, v110, v110
    v_mul_f32 v115, v111, v111
    v_fma_f32 v112, v112, v9, s78
    v_fma_f32 v113, v113, v9, s78
    v_fma_f32 v114, v114, v9, s78
    v_fma_f32 v115, v115, v9, s78
    v_mul_f32 v112, v112, v108
    v_mul_f32 v113, v113, v109
    s_add_u32 m0, s68, 53248
    s_nop 0
    buffer_load_dwordx4 v19, s[24:27], s63 offen lds
    v_mul_f32 v114, v114, v110
    v_mul_f32 v115, v115, v111
    v_exp_f32 v112, v112
    v_exp_f32 v113, v113
    v_exp_f32 v114, v114
    v_exp_f32 v115, v115
    v_add_f32 v112, 1.0, v112
    s_add_u32 m0, s68, 57344
    s_nop 0
    buffer_load_dwordx4 v20, s[24:27], s63 offen lds
    v_add_f32 v113, 1.0, v113
    v_add_f32 v114, 1.0, v114
    v_add_f32 v115, 1.0, v115
    v_rcp_f32 v112, v112
    v_rcp_f32 v113, v113
    v_rcp_f32 v114, v114
    v_rcp_f32 v115, v115
    v_mul_f32 v108, v108, v112
    v_mul_f32 v109, v109, v113
    v_mul_f32 v110, v110, v114
    v_mul_f32 v111, v111, v115
    v_cvt_pk_bf16_f32 v80, v108, v109
    v_cvt_pk_bf16_f32 v81, v110, v111
    ds_write_b64 v10, v[80:81] offset:4736
    s_waitcnt lgkmcnt(13)
    v_lshlrev_b32 v100, 16, v82
    v_and_b32 v101, 0xffff0000, v82
    v_lshlrev_b32 v102, 16, v83
    v_and_b32 v103, 0xffff0000, v83
    s_waitcnt vmcnt(5)
    s_barrier
    s_mul_i32 s63, s55, 589824
    s_add_u32 s63, s63, s64
    s_add_u32 m0, s68, 61440
    s_nop 0
    buffer_load_dwordx4 v16, s[24:27], s63 offen lds
    v_mul_f32 v104, v100, v100
    v_mul_f32 v105, v101, v101
    v_mul_f32 v106, v102, v102
    v_mul_f32 v107, v103, v103
    v_fma_f32 v104, v104, v9, s78
    v_fma_f32 v105, v105, v9, s78
    v_fma_f32 v106, v106, v9, s78
    v_fma_f32 v107, v107, v9, s78
    v_mul_f32 v104, v104, v100
    v_mul_f32 v105, v105, v101
    v_mul_f32 v106, v106, v102
    s_add_u32 m0, s68, 65536
    s_nop 0
    buffer_load_dwordx4 v17, s[24:27], s63 offen lds
    v_mul_f32 v107, v107, v103
    v_exp_f32 v104, v104
    v_exp_f32 v105, v105
    v_exp_f32 v106, v106
    v_exp_f32 v107, v107
    v_add_f32 v104, 1.0, v104
    v_add_f32 v105, 1.0, v105
    s_add_u32 m0, s68, 69632
    s_nop 0
    buffer_load_dwordx4 v18, s[24:27], s63 offen lds
    v_add_f32 v106, 1.0, v106
    v_add_f32 v107, 1.0, v107
    v_rcp_f32 v104, v104
    v_rcp_f32 v105, v105
    v_rcp_f32 v106, v106
    v_rcp_f32 v107, v107
    v_mul_f32 v100, v100, v104
    s_add_u32 m0, s68, 73728
    s_nop 0
    buffer_load_dwordx4 v19, s[24:27], s63 offen lds
    v_mul_f32 v101, v101, v105
    v_mul_f32 v102, v102, v106
    v_mul_f32 v103, v103, v107
    v_cvt_pk_bf16_f32 v82, v100, v101
    v_cvt_pk_bf16_f32 v83, v102, v103
    ds_write_b64 v10, v[82:83] offset:4768
    s_waitcnt lgkmcnt(13)
    v_lshlrev_b32 v108, 16, v84
    v_and_b32 v109, 0xffff0000, v84
    v_lshlrev_b32 v110, 16, v85
    v_and_b32 v111, 0xffff0000, v85
    v_mul_f32 v112, v108, v108
    s_add_u32 m0, s68, 77824
    s_nop 0
    buffer_load_dwordx4 v20, s[24:27], s63 offen lds
    v_mul_f32 v113, v109, v109
    v_mul_f32 v114, v110, v110
    v_mul_f32 v115, v111, v111
    v_fma_f32 v112, v112, v9, s78
    v_fma_f32 v113, v113, v9, s78
    v_fma_f32 v114, v114, v9, s78
    v_fma_f32 v115, v115, v9, s78
    v_mul_f32 v112, v112, v108
    v_mul_f32 v113, v113, v109
    v_mul_f32 v114, v114, v110
    v_mul_f32 v115, v115, v111
    v_exp_f32 v112, v112
    v_exp_f32 v113, v113
    v_exp_f32 v114, v114
    v_exp_f32 v115, v115
    v_add_f32 v112, 1.0, v112
    v_add_f32 v113, 1.0, v113
    v_add_f32 v114, 1.0, v114
    s_waitcnt vmcnt(5)
    s_barrier
    s_mul_i32 s63, s56, 589824
    s_add_u32 s63, s63, s64
    s_add_u32 m0, s68, 0
    s_nop 0
    buffer_load_dwordx4 v16, s[24:27], s63 offen lds
    v_add_f32 v115, 1.0, v115
    v_rcp_f32 v112, v112
    v_rcp_f32 v113, v113
    v_rcp_f32 v114, v114
    v_rcp_f32 v115, v115
    v_mul_f32 v108, v108, v112
    v_mul_f32 v109, v109, v113
    s_add_u32 m0, s68, 4096
    s_nop 0
    buffer_load_dwordx4 v17, s[24:27], s63 offen lds
    v_mul_f32 v110, v110, v114
    v_mul_f32 v111, v111, v115
    v_cvt_pk_bf16_f32 v84, v108, v109
    v_cvt_pk_bf16_f32 v85, v110, v111
    ds_write_b64 v10, v[84:85] offset:4800
    s_waitcnt lgkmcnt(13)
    v_lshlrev_b32 v100, 16, v86
    v_and_b32 v101, 0xffff0000, v86
    v_lshlrev_b32 v102, 16, v87
    v_and_b32 v103, 0xffff0000, v87
    v_mul_f32 v104, v100, v100
    v_mul_f32 v105, v101, v101
    s_add_u32 m0, s68, 8192
    s_nop 0
    buffer_load_dwordx4 v18, s[24:27], s63 offen lds
    v_mul_f32 v106, v102, v102
    v_mul_f32 v107, v103, v103
    v_fma_f32 v104, v104, v9, s78
    v_fma_f32 v105, v105, v9, s78
    v_fma_f32 v106, v106, v9, s78
    v_fma_f32 v107, v107, v9, s78
    v_mul_f32 v104, v104, v100
    v_mul_f32 v105, v105, v101
    v_mul_f32 v106, v106, v102
    v_mul_f32 v107, v107, v103
    v_exp_f32 v104, v104
    s_add_u32 m0, s68, 12288
    s_nop 0
    buffer_load_dwordx4 v19, s[24:27], s63 offen lds
    v_exp_f32 v105, v105
    v_exp_f32 v106, v106
    v_exp_f32 v107, v107
    v_add_f32 v104, 1.0, v104
    v_add_f32 v105, 1.0, v105
    v_add_f32 v106, 1.0, v106
    v_add_f32 v107, 1.0, v107
    s_add_u32 m0, s68, 16384
    s_nop 0
    buffer_load_dwordx4 v20, s[24:27], s63 offen lds
    v_rcp_f32 v104, v104
    v_rcp_f32 v105, v105
    v_rcp_f32 v106, v106
    v_rcp_f32 v107, v107
    v_mul_f32 v100, v100, v104
    v_mul_f32 v101, v101, v105
    v_mul_f32 v102, v102, v106
    v_mul_f32 v103, v103, v107
    v_cvt_pk_bf16_f32 v86, v100, v101
    v_cvt_pk_bf16_f32 v87, v102, v103
    ds_write_b64 v10, v[86:87] offset:4832
    s_waitcnt lgkmcnt(13)
    v_lshlrev_b32 v108, 16, v88
    v_and_b32 v109, 0xffff0000, v88
    v_lshlrev_b32 v110, 16, v89
    v_and_b32 v111, 0xffff0000, v89
    v_mul_f32 v112, v108, v108
    v_mul_f32 v113, v109, v109
    v_mul_f32 v114, v110, v110
    s_waitcnt vmcnt(5)
    s_barrier
    s_mul_i32 s63, s57, 589824
    s_add_u32 s63, s63, s64
    s_add_u32 m0, s68, 20480
    s_nop 0
    buffer_load_dwordx4 v16, s[24:27], s63 offen lds
    v_mov_b32 v40, 159744
    v_mov_b32 v42, 0
    v_mov_b32 v43, 0
    v_mov_b32 v44, 0
    v_mov_b32 v45, 0
    ds_write_b128 v40, v[42:45]
    ds_write_b128 v40, v[42:45] offset:16
    v_mul_f32 v115, v111, v111
    v_fma_f32 v112, v112, v9, s78
    v_fma_f32 v113, v113, v9, s78
    v_fma_f32 v114, v114, v9, s78
    v_fma_f32 v115, v115, v9, s78
    v_mul_f32 v112, v112, v108
    s_add_u32 m0, s68, 24576
    s_nop 0
    buffer_load_dwordx4 v17, s[24:27], s63 offen lds
    v_mul_f32 v113, v113, v109
    v_mul_f32 v114, v114, v110
    v_mul_f32 v115, v115, v111
    v_exp_f32 v112, v112
    v_exp_f32 v113, v113
    v_exp_f32 v114, v114
    v_exp_f32 v115, v115
    v_add_f32 v112, 1.0, v112
    s_add_u32 m0, s68, 28672
    s_nop 0
    buffer_load_dwordx4 v18, s[24:27], s63 offen lds
    v_add_f32 v113, 1.0, v113
    v_add_f32 v114, 1.0, v114
    v_add_f32 v115, 1.0, v115
    v_rcp_f32 v112, v112
    v_rcp_f32 v113, v113
    v_rcp_f32 v114, v114
    v_rcp_f32 v115, v115
    v_mul_f32 v108, v108, v112
    s_add_u32 m0, s68, 32768
    s_nop 0
    buffer_load_dwordx4 v19, s[24:27], s63 offen lds
    v_mul_f32 v109, v109, v113
    v_mul_f32 v110, v110, v114
    v_mul_f32 v111, v111, v115
    v_cvt_pk_bf16_f32 v88, v108, v109
    v_cvt_pk_bf16_f32 v89, v110, v111
    ds_write_b64 v10, v[88:89] offset:4864
    ds_read_b64 v[90:91], v10 offset:4896
    ds_read_b64 v[92:93], v10 offset:4928
    ds_read_b64 v[94:95], v10 offset:4960
    ds_read_b64 v[96:97], v10 offset:4992
    v_mfma_f32_16x16x32_bf16 v[116:119], v[132:135], v[60:63], 0
    s_add_u32 m0, s68, 36864
    s_nop 0
    buffer_load_dwordx4 v20, s[24:27], s63 offen lds
    v_mfma_f32_16x16x32_bf16 v[124:127], v[60:63], v[60:63], 0
    v_mfma_f32_16x16x32_bf16 v[120:123], v[132:135], v[80:83], 0
    v_mfma_f32_16x16x32_bf16 v[128:131], v[80:83], v[80:83], 0
    v_mfma_f32_16x16x32_bf16 v[116:119], v[132:135], v[64:67], v[116:119]
    v_mfma_f32_16x16x32_bf16 v[124:127], v[64:67], v[64:67], v[124:127]
    v_mfma_f32_16x16x32_bf16 v[120:123], v[132:135], v[84:87], v[120:123]
    v_mfma_f32_16x16x32_bf16 v[128:131], v[84:87], v[84:87], v[128:131]
    v_mfma_f32_16x16x32_bf16 v[116:119], v[132:135], v[68:71], v[116:119]
    v_mfma_f32_16x16x32_bf16 v[124:127], v[68:71], v[68:71], v[124:127]
    s_waitcnt lgkmcnt(3)
    v_mfma_f32_16x16x32_bf16 v[120:123], v[132:135], v[88:91], v[120:123]
    v_mfma_f32_16x16x32_bf16 v[128:131], v[88:91], v[88:91], v[128:131]
    v_mfma_f32_16x16x32_bf16 v[116:119], v[132:135], v[72:75], v[116:119]
    s_waitcnt vmcnt(5)
    s_barrier
    s_mul_i32 s63, s58, 589824
    s_add_u32 s63, s63, s64
    s_add_u32 m0, s68, 40960
    s_nop 0
    buffer_load_dwordx4 v16, s[24:27], s63 offen lds
    v_mfma_f32_16x16x32_bf16 v[124:127], v[72:75], v[72:75], v[124:127]
    s_waitcnt lgkmcnt(1)
    v_mfma_f32_16x16x32_bf16 v[120:123], v[132:135], v[92:95], v[120:123]
    v_mfma_f32_16x16x32_bf16 v[128:131], v[92:95], v[92:95], v[128:131]
    s_add_u32 m0, s68, 45056
    s_nop 0
    buffer_load_dwordx4 v17, s[24:27], s63 offen lds
    v_mfma_f32_16x16x32_bf16 v[116:119], v[132:135], v[76:79], v[116:119]
    v_mfma_f32_16x16x32_bf16 v[124:127], v[76:79], v[76:79], v[124:127]
    s_add_u32 m0, s68, 49152
    s_nop 0
    buffer_load_dwordx4 v18, s[24:27], s63 offen lds
    s_waitcnt lgkmcnt(0)
    v_mfma_f32_16x16x32_bf16 v[120:123], v[132:135], v[96:99], v[120:123]
    v_mfma_f32_16x16x32_bf16 v[128:131], v[96:99], v[96:99], v[128:131]
    s_add_u32 m0, s68, 53248
    s_nop 0
    buffer_load_dwordx4 v19, s[24:27], s63 offen lds
    s_mov_b32 vcc_lo, 0xaaaaaaaa
    s_mov_b32 vcc_hi, 0xaaaaaaaa
    v_cndmask_b32 v124, v124, v125, vcc
    v_cndmask_b32 v126, v126, v127, vcc
    s_nop 0
    v_cndmask_b32 v128, v128, v129, vcc
    v_cndmask_b32 v130, v130, v131, vcc
    s_mov_b32 vcc_lo, 0xcccccccc
    s_mov_b32 vcc_hi, 0xcccccccc
    v_cndmask_b32 v117, v124, v126, vcc
    v_cndmask_b32 v121, v128, v130, vcc
    s_lshl_b32 s99, s48, 4
    s_add_u32 s99, s99, s49
    s_lshl_b32 s99, s99, 10
    s_lshl_b32 s98, s51, 8
    s_add_u32 s99, s99, s98
    s_mov_b32 exec_lo, 0xf0000f
    s_mov_b32 exec_hi, 0xf0000f00
    buffer_store_dwordx2 v[116:117], v11, s[40:43], s99 offen offset:0 sc1
    buffer_store_dwordx2 v[120:121], v11, s[40:43], s99 offen offset:128 sc1
    s_mov_b64 exec, -1
    s_add_u32 m0, s68, 57344
    s_nop 0
    buffer_load_dwordx4 v20, s[24:27], s63 offen lds
    s_waitcnt vmcnt(7)
    s_barrier
    s_mul_i32 s63, s59, 589824
    s_add_u32 s63, s63, s64
    s_add_u32 m0, s68, 61440
    s_nop 0
    buffer_load_dwordx4 v16, s[24:27], s63 offen lds
    v_and_b32 v12, 15, v1
    s_lshl_b32 s99, s51, 5
    v_add_u32 v13, s99, v12
    v_mul_u32_u24 v10, 240, v13
    v_lshrrev_b32 v14, 4, v1
    v_lshl_add_u32 v10, v14, 4, v10
    v_add_u32 v10, 119808, v10
    ds_read_b128 v[136:139], v10 offset:4016
    ds_read_b128 v[140:143], v10 offset:7856
    s_add_u32 m0, s68, 65536
    s_nop 0
    buffer_load_dwordx4 v17, s[24:27], s63 offen lds
    ds_read_b128 v[144:147], v10 offset:32
    ds_read_b128 v[148:151], v10 offset:3872
    ds_read_b128 v[152:155], v10 offset:7712
    v_lshrrev_b32 v11, 2, v1
    v_add_u32 v11, s99, v11
    v_mul_u32_u24 v11, 240, v11
    v_and_b32 v15, 3, v1
    v_lshl_add_u32 v11, v15, 3, v11
    v_add_u32 v11, 119912, v11
    s_add_u32 m0, s68, 69632
    s_nop 0
    buffer_load_dwordx4 v18, s[24:27], s63 offen lds
    s_mul_i32 s98, s49, 36
    s_add_u32 s98, s98, 16
    v_lshl_add_u32 v14, v14, 2, s98
    v_lshlrev_b32 v12, 4, v12
    v_lshrrev_b32 v15, 3, v14
    v_lshl_add_u32 v172, v15, 8, v12
    v_and_b32 v15, 7, v14
    v_lshl_add_u32 v172, v15, 1, v172
    v_add_u32 v14, 2, v14
    v_lshrrev_b32 v15, 3, v14
    v_lshl_add_u32 v13, v15, 8, v12
    v_and_b32 v15, 7, v14
    v_lshl_add_u32 v13, v15, 1, v13
    v_mov_b32 v175, v12
    v_mov_b32 v12, v172
    s_lshl_b32 s69, s48, 3
    s_lshl_b32 s70, s51, 1
    s_add_u32 s69, s69, s70
    s_mul_i32 s69, s69, 92160
    s_add_u32 s70, s69, 92160
    s_add_u32 s98, s98, 16
    s_lshr_b32 s71, s98, 3
    s_lshl_b32 s71, s71, 8
    s_and_b32 s99, s98, 7
    s_lshl_b32 s99, s99, 1
    s_add_u32 s71, s71, s99
    s_add_u32 s98, s98, 2
    s_lshr_b32 s73, s98, 3
    s_lshl_b32 s73, s73, 8
    s_and_b32 s99, s98, 7
    s_lshl_b32 s99, s99, 1
    s_add_u32 s73, s73, s99
    s_add_u32 s72, s71, s70
    s_add_u32 s71, s71, s69
    s_add_u32 s74, s73, s70
    s_add_u32 s73, s73, s69
    s_or_b32 s98, s48, s51
    s_cmp_eq_u32 s98, 0
    s_cselect_b32 s75, 0, -1
    s_mov_b32 s76, 0x55555555
    s_mov_b32 s77, 0x55555555
    v_mov_b32 v14, 0xce6e6b28
    v_and_b32 v15, 1, v1
    v_lshlrev_b32 v15, 4, v15
    s_add_u32 m0, s68, 73728
    s_nop 0
    buffer_load_dwordx4 v19, s[24:27], s63 offen lds
    s_add_u32 m0, s68, 77824
    s_nop 0
    buffer_load_dwordx4 v20, s[24:27], s63 offen lds
    s_waitcnt vmcnt(5)
    s_barrier
    s_cmp_lg_u32 s51, 0
    s_cbranch_scc1 K1_NOAT
    s_lshl_b32 s10, s49, 10
    s_add_u32 s10, s10, s67
    v_lshlrev_b32 v39, 2, v1
    s_mov_b32 exec_hi, 0
    buffer_store_dword v36, v39, s[40:43], s10 offen sc1
    s_mov_b64 exec, -1
K1_NOAT:
    s_mul_i32 s63, s60, 589824
    s_add_u32 s63, s63, s64
    s_add_u32 m0, s68, 0
    s_nop 0
    buffer_load_dwordx4 v16, s[24:27], s63 offen lds
    s_getpc_b64 s[10:11]
CPF2:
    s_add_u32 s10, s10, K2_TEXT-CPF2
    s_addc_u32 s11, s11, 0
    s_lshr_b32 s12, s2, 3
    s_mul_i32 s12, s12, 1536
    v_lshlrev_b32 v32, 7, v1
    v_add_u32 v32, s12, v32
    v_mov_b32 v35, (TEXT_END-K2_TEXT)-4
    v_min_u32 v32, v32, v35
    v_mov_b32 v33, s11
    v_add_co_u32 v32, vcc, s10, v32
    s_nop 1
    v_addc_co_u32 v33, vcc, 0, v33, vcc
    s_mov_b64 exec, 0xfff
    global_load_dword v35, v[32:33], off
    s_mov_b64 exec, -1
    s_add_u32 m0, s68, 4096
    s_nop 0
    buffer_load_dwordx4 v17, s[24:27], s63 offen lds
    s_mov_b32 exec_lo, 0
    s_waitcnt lgkmcnt(4)
    v_mov_b32 v138, 0
    v_mov_b32 v139, 0
    s_mov_b32 exec_hi, 0xffff0000
    v_mov_b32 v137, 0
    s_mov_b32 exec_lo, 0xffff
    v_mov_b32 v136, 0
    s_mov_b64 exec, -1
    s_add_u32 m0, s68, 8192
    s_nop 0
    buffer_load_dwordx4 v18, s[24:27], s63 offen lds
    s_mov_b32 exec_lo, 0
    s_waitcnt lgkmcnt(3)
    v_mov_b32 v142, 0
    v_mov_b32 v143, 0
    s_mov_b32 exec_hi, 0xffff0000
    v_mov_b32 v141, 0
    s_mov_b32 exec_lo, 0xffff
    v_mov_b32 v140, 0
    s_mov_b64 exec, -1
    s_waitcnt lgkmcnt(2)
    v_mfma_f32_16x16x32_bf16 v[156:159], v[144:147], v[136:139], 0
    s_add_u32 m0, s68, 12288
    s_nop 0
    buffer_load_dwordx4 v19, s[24:27], s63 offen lds
    s_waitcnt lgkmcnt(1)
    v_mfma_f32_16x16x32_bf16 v[160:163], v[148:151], v[136:139], 0
    v_mfma_f32_16x16x32_bf16 v[164:167], v[148:151], v[140:143], 0
    s_waitcnt lgkmcnt(0)
    v_mfma_f32_16x16x32_bf16 v[168:171], v[152:155], v[140:143], 0
    ds_read_b64_tr_b16 v[144:145], v11 offset:0
    ds_read_b64_tr_b16 v[150:151], v11 offset:32
    s_add_u32 m0, s68, 16384
    s_nop 0
    buffer_load_dwordx4 v20, s[24:27], s63 offen lds
    ds_read_b64_tr_b16 v[146:147], v11 offset:3840
    ds_read_b64_tr_b16 v[152:153], v11 offset:3872
    ds_read_b64_tr_b16 v[148:149], v11 offset:7680
    ds_read_b64_tr_b16 v[154:155], v11 offset:7712
    v_cndmask_b32 v156, v157, v156, s[76:77]
    v_cndmask_b32 v157, v159, v158, s[76:77]
    v_cndmask_b32 v160, v161, v160, s[76:77]
    v_cndmask_b32 v161, v163, v162, s[76:77]
    v_cndmask_b32 v164, v165, v164, s[76:77]
    v_cndmask_b32 v165, v167, v166, s[76:77]
    v_cndmask_b32 v168, v169, v168, s[76:77]
    v_cndmask_b32 v169, v171, v170, s[76:77]
    s_mov_b32 vcc_lo, 0xf0000
    s_mov_b32 vcc_hi, 0xfff00ff
    v_cndmask_b32 v164, v14, v164, vcc
    s_and_b32 vcc_lo, vcc_lo, s75
    s_and_b32 vcc_hi, vcc_hi, s75
    v_cndmask_b32 v156, v14, v156, vcc
    s_waitcnt vmcnt(6)
    s_barrier
    s_mul_i32 s63, s61, 589824
    s_add_u32 s63, s63, s64
    s_add_u32 m0, s68, 20480
    s_nop 0
    buffer_load_dwordx4 v16, s[24:27], s63 offen lds
    s_mov_b32 vcc_lo, 0x3f0003
    s_mov_b32 vcc_hi, 0x3fff03ff
    v_cndmask_b32 v165, v14, v165, vcc
    s_and_b32 vcc_lo, vcc_lo, s75
    s_and_b32 vcc_hi, vcc_hi, s75
    v_cndmask_b32 v157, v14, v157, vcc
    s_mov_b32 vcc_lo, 0xfff0ffff
    s_mov_b32 vcc_hi, 0xf000ff00
    v_cndmask_b32 v168, v14, v168, vcc
    v_cndmask_b32 v160, v14, v160, vcc
    s_add_u32 m0, s68, 24576
    s_nop 0
    buffer_load_dwordx4 v17, s[24:27], s63 offen lds
    s_mov_b32 vcc_lo, 0xffc0fffc
    s_mov_b32 vcc_hi, 0xc000fc00
    v_cndmask_b32 v169, v14, v169, vcc
    v_cndmask_b32 v161, v14, v161, vcc
    v_max3_f32 v172, v156, v157, v160
    v_max_f32 v172, v172, v161
    v_max3_f32 v173, v164, v165, v168
    s_add_u32 m0, s68, 28672
    s_nop 0
    buffer_load_dwordx4 v18, s[24:27], s63 offen lds
    v_max_f32 v173, v173, v169
    s_nop 1
    v_permlane16_swap_b32 v172, v173
    v_max_f32 v172, v172, v173
    v_mov_b32 v173, v172
    s_nop 1
    v_permlane32_swap_b32 v172, v173
    v_max_f32 v172, v172, v173
    s_add_u32 m0, s68, 32768
    s_nop 0
    buffer_load_dwordx4 v19, s[24:27], s63 offen lds
    v_mov_b32 v173, v172
    s_nop 1
    v_permlane16_swap_b32 v172, v173
    v_mul_f32 v172, s79, v172
    v_mul_f32 v173, s79, v173
    v_fma_f32 v156, v156, s79, -v172
    v_fma_f32 v157, v157, s79, -v172
    s_add_u32 m0, s68, 36864
    s_nop 0
    buffer_load_dwordx4 v20, s[24:27], s63 offen lds
    v_fma_f32 v160, v160, s79, -v172
    v_fma_f32 v161, v161, s79, -v172
    v_fma_f32 v164, v164, s79, -v173
    v_fma_f32 v165, v165, s79, -v173
    v_fma_f32 v168, v168, s79, -v173
    v_fma_f32 v169, v169, s79, -v173
    v_exp_f32 v156, v156
    v_exp_f32 v157, v157
    v_exp_f32 v160, v160
    s_waitcnt vmcnt(5)
    s_barrier
    s_mul_i32 s63, s62, 589824
    s_add_u32 s63, s63, s64
    s_add_u32 m0, s68, 40960
    s_nop 0
    buffer_load_dwordx4 v16, s[24:27], s63 offen lds
    v_exp_f32 v161, v161
    v_exp_f32 v164, v164
    v_exp_f32 v165, v165
    s_add_u32 m0, s68, 45056
    s_nop 0
    buffer_load_dwordx4 v17, s[24:27], s63 offen lds
    v_exp_f32 v168, v168
    v_exp_f32 v169, v169
    v_add_f32 v172, v156, v157
    v_add_f32 v158, v160, v161
    s_add_u32 m0, s68, 49152
    s_nop 0
    buffer_load_dwordx4 v18, s[24:27], s63 offen lds
    v_add_f32 v173, v164, v165
    v_add_f32 v166, v168, v169
    v_add_f32 v172, v172, v158
    v_add_f32 v173, v173, v166
    s_nop 1
    v_permlane16_swap_b32 v172, v173
    v_add_f32 v172, v172, v173
    s_add_u32 m0, s68, 53248
    s_nop 0
    buffer_load_dwordx4 v19, s[24:27], s63 offen lds
    v_mov_b32 v173, v172
    s_nop 1
    v_permlane32_swap_b32 v172, v173
    v_add_f32 v172, v172, v173
    v_mov_b32 v173, v172
    s_nop 1
    v_permlane16_swap_b32 v172, v173
    v_rcp_f32 v172, v172
    s_add_u32 m0, s68, 57344
    s_nop 0
    buffer_load_dwordx4 v20, s[24:27], s63 offen lds
    v_rcp_f32 v173, v173
    v_mul_f32 v156, v156, v172
    v_mul_f32 v157, v157, v172
    v_mul_f32 v160, v160, v172
    v_mul_f32 v161, v161, v172
    v_mul_f32 v164, v164, v173
    v_mul_f32 v165, v165, v173
    v_mul_f32 v168, v168, v173
    v_mul_f32 v169, v169, v173
    v_cvt_pk_bf16_f32 v136, v156, 0
    s_waitcnt vmcnt(5)
    s_barrier
    buffer_load_dword v3, v37, s[40:43], s67 offen sc1
    v_cvt_pk_bf16_f32 v137, v157, 0
    v_cvt_pk_bf16_f32 v138, v160, 0
    v_cvt_pk_bf16_f32 v139, v161, 0
    v_cvt_pk_bf16_f32 v140, v164, 0
    v_cvt_pk_bf16_f32 v141, v165, 0
    v_cvt_pk_bf16_f32 v142, v168, 0
    v_cvt_pk_bf16_f32 v143, v169, 0
    v_lshlrev_b32 v136, v15, v136
    v_lshlrev_b32 v137, v15, v137
    v_lshlrev_b32 v138, v15, v138
    v_lshlrev_b32 v139, v15, v139
    v_lshlrev_b32 v140, v15, v140
    v_lshlrev_b32 v141, v15, v141
    v_lshlrev_b32 v142, v15, v142
    v_lshlrev_b32 v143, v15, v143
    s_waitcnt lgkmcnt(3)
    v_mfma_f32_16x16x32_bf16 v[156:159], v[144:147], v[136:139], 0
    s_waitcnt lgkmcnt(2)
    v_mfma_f32_16x16x32_bf16 v[160:163], v[150:153], v[136:139], 0
    s_waitcnt lgkmcnt(1)
    v_mfma_f32_16x16x32_bf16 v[164:167], v[146:149], v[140:143], 0
    s_waitcnt lgkmcnt(0)
    v_mfma_f32_16x16x32_bf16 v[168:171], v[152:155], v[140:143], 0
    s_nop 1
    v_cvt_pk_bf16_f32 v156, v156, v157
    v_cvt_pk_bf16_f32 v157, v158, v159
    v_cvt_pk_bf16_f32 v160, v160, v161
    v_cvt_pk_bf16_f32 v161, v162, v163
    s_mov_b32 exec_lo, 0xffff0000
    buffer_store_dwordx2 v[156:157], v12, s[28:31], s69 offen sc1
    s_mov_b64 exec, 0xffff
    buffer_store_dword v157, v13, s[28:31], s69 offen sc1
    buffer_store_dwordx2 v[160:161], v175, s[28:31], s71 offen sc1
    s_mov_b64 exec, -1
    v_cvt_pk_bf16_f32 v164, v164, v165
    v_cvt_pk_bf16_f32 v165, v166, v167
    v_cvt_pk_bf16_f32 v168, v168, v169
    v_cvt_pk_bf16_f32 v169, v170, v171
    s_mov_b32 exec_lo, 0xffff0000
    buffer_store_dwordx2 v[164:165], v12, s[28:31], s70 offen sc1
    s_mov_b64 exec, 0xffff
    buffer_store_dword v165, v13, s[28:31], s70 offen sc1
    buffer_store_dwordx2 v[168:169], v175, s[28:31], s72 offen sc1
    s_mov_b64 exec, -1
    s_waitcnt vmcnt(6)
    v_mov_b32 v39, v3
    s_cmp_lg_u32 s51, 0
    s_cbranch_scc1 K1_FOK
    s_mov_b32 s10, 0
K1_FPOLL:
    v_cmp_ne_u32 vcc, v3, v36
    s_nop 0
    s_and_b32 s11, vcc_lo, 0xffff
    s_cbranch_scc0 K1_FOK
    s_sleep 4
    buffer_load_dword v3, v37, s[40:43], s67 offen sc1
    s_add_u32 s10, s10, 1
    s_cmp_lt_u32 s10, 0x20000
    s_waitcnt vmcnt(0)
    s_cbranch_scc1 K1_FPOLL
K1_FOK:
    s_barrier
    v_lshrrev_b32 v248, 4, v1
    v_lshlrev_b32 v248, 12, v248
    v_and_b32 v249, 15, v1
    v_lshl_add_u32 v248, v249, 4, v248
    s_lshl_b32 s9, s48, 14
    s_lshl_b32 s10, s51, 8
    s_add_u32 s9, s9, s10
    buffer_load_dwordx4 v[176:179], v248, s[40:43], s9 offen offset:0 sc1
    buffer_load_dwordx4 v[180:183], v248, s[40:43], s9 offen offset:1024 sc1
    buffer_load_dwordx4 v[184:187], v248, s[40:43], s9 offen offset:2048 sc1
    buffer_load_dwordx4 v[188:191], v248, s[40:43], s9 offen offset:3072 sc1
    s_barrier
    v_lshrrev_b32 v250, 4, v1
    v_lshlrev_b32 v251, 6, v250
    v_lshlrev_b32 v250, 3, v250
    v_bfe_u32 v244, v1, 2, 2
    v_add_u32 v250, v250, v244
    s_lshl_b32 s9, s51, 5
    v_add_u32 v250, s9, v250
    v_mul_u32_u24 v250, 296, v250
    v_and_b32 v244, 3, v1
    v_lshl_add_u32 v250, v244, 3, v250
    v_add_u32 v250, 81920, v250
    ds_read_b64_tr_b16 v[228:229], v250 offset:160
    ds_read_b64_tr_b16 v[230:231], v250 offset:1344
    ds_read_b64_tr_b16 v[232:233], v250 offset:192
    ds_read_b64_tr_b16 v[234:235], v250 offset:1376
    ds_read_b64_tr_b16 v[236:237], v250 offset:224
    ds_read_b64_tr_b16 v[238:239], v250 offset:1408
    ds_read_b64_tr_b16 v[240:241], v250 offset:256
    ds_read_b64_tr_b16 v[242:243], v250 offset:1440
    s_lshl_b32 s9, s50, 8
    s_add_u32 s9, s9, 161792
    v_lshlrev_b32 v249, 4, v249
    v_add_u32 v249, s9, v249
    v_add_u32 v251, s9, v251
    v_lshlrev_b32 v252, 4, v1
    v_xor_b32 v253, 64, v252
    s_lshl_b32 s12, s49, 6
    s_lshl_b32 s13, s48, 2
    s_add_u32 s12, s12, s13
    s_add_u32 s12, s12, s51
    s_mul_i32 s12, s12, 9216
    s_add_u32 s13, s12, 4096
    s_add_u32 s10, s12, 8192
    s_mov_b32 s11, 0x39e38e39
    s_lshr_b32 s9, s51, 1
    s_mul_i32 s9, s9, 34816
    s_and_b32 s53, s51, 1
    s_mul_i32 s53, s53, 9216
    s_add_u32 s9, s9, s53
    s_add_u32 s9, s9, 16384
    v_add_u32 v254, s9, v252
    v_add_u32 v255, s9, v253
    s_lshl_b32 s63, s48, 7
    s_lshl_b32 s66, s51, 5
    s_add_u32 s63, s63, s66
    v_lshrrev_b32 v45, 3, v1
    v_add_u32 v45, s63, v45
    v_lshlrev_b32 v45, 12, v45
    v_and_b32 v46, 7, v1
    v_lshrrev_b32 v47, 4, v1
    v_xor_b32 v46, v46, v47
    v_lshlrev_b32 v46, 4, v46
    v_add_u32 v40, v45, v46
    v_xor_b32 v47, 64, v40
    v_add_u32 v41, 0x7c00, v47
    v_add_u32 v42, 0xf800, v40
    v_add_u32 v43, 0x17400, v47
    s_lshl_b32 s66, s51, 12
    s_lshr_b32 s62, s48, 3
    s_lshl_b32 s60, s62, 11
    s_mul_i32 s61, s62, 294912
    s_lshl_b32 s62, s62, 3
    s_and_b32 s58, s48, 7
    s_mov_b32 s63, s58
    s_lshl_b32 s63, s63, 8
    s_xor_b32 s63, s63, s60
    s_add_u32 m0, s66, 0
    s_nop 0
    buffer_load_dwordx4 v40, s[4:7], s63 offen offset:0 lds
    buffer_load_dwordx4 v41, s[4:7], s63 offen offset:1024 lds
    buffer_load_dwordx4 v42, s[4:7], s63 offen offset:2048 lds
    buffer_load_dwordx4 v43, s[4:7], s63 offen offset:3072 lds
    s_mov_b32 s63, s58
    s_lshl_b32 s63, s63, 8
    s_add_u32 s63, s63, 128
    s_xor_b32 s63, s63, s60
    s_add_u32 m0, s66, 34816
    s_nop 0
    buffer_load_dwordx4 v40, s[4:7], s63 offen offset:0 lds
    buffer_load_dwordx4 v41, s[4:7], s63 offen offset:1024 lds
    buffer_load_dwordx4 v42, s[4:7], s63 offen offset:2048 lds
    buffer_load_dwordx4 v43, s[4:7], s63 offen offset:3072 lds
    s_waitcnt vmcnt(9)
    v_add_f32 v176, v176, v184
    v_add_f32 v177, v177, v185
    v_add_f32 v178, v178, v186
    v_add_f32 v179, v179, v187
    s_waitcnt vmcnt(8)
    v_add_f32 v180, v180, v188
    v_add_f32 v181, v181, v189
    v_add_f32 v182, v182, v190
    v_add_f32 v183, v183, v191
    v_add_f32 v176, v176, v180
    v_add_f32 v177, v177, v181
    v_add_f32 v178, v178, v182
    v_add_f32 v179, v179, v183
    v_mov_b32 v180, v176
    v_mov_b32 v181, v177
    v_mov_b32 v182, v178
    v_mov_b32 v183, v179
    v_permlane16_swap_b32 v176, v180
    v_permlane16_swap_b32 v177, v181
    v_permlane16_swap_b32 v178, v182
    v_permlane16_swap_b32 v179, v183
    v_add_f32 v176, v176, v180
    v_add_f32 v177, v177, v181
    v_add_f32 v178, v178, v182
    v_add_f32 v179, v179, v183
    v_mov_b32 v180, v176
    v_mov_b32 v181, v177
    v_mov_b32 v182, v178
    v_mov_b32 v183, v179
    v_permlane32_swap_b32 v176, v180
    v_permlane32_swap_b32 v177, v181
    v_permlane32_swap_b32 v178, v182
    v_permlane32_swap_b32 v179, v183
    v_add_f32 v176, v176, v180
    v_add_f32 v177, v177, v181
    v_add_f32 v178, v178, v182
    v_add_f32 v179, v179, v183
    v_mul_f32 v176, s11, v176
    v_mul_f32 v244, v176, v176
    v_fma_f32 v177, v177, s11, -v244
    v_max_f32 v177, 0, v177
    v_add_f32 v177, 0x3727c5ac, v177
    v_rsq_f32 v244, v177
    s_nop 0
    v_mul_f32 v177, v176, v244
    v_sub_f32 v177, 0, v177
    v_mov_b32 v176, v244
    v_mul_f32 v178, s11, v178
    v_mul_f32 v244, v178, v178
    v_fma_f32 v179, v179, s11, -v244
    v_max_f32 v179, 0, v179
    v_add_f32 v179, 0x3727c5ac, v179
    v_rsq_f32 v244, v179
    s_nop 0
    v_mul_f32 v179, v178, v244
    v_sub_f32 v179, 0, v179
    v_mov_b32 v178, v244
    ds_write_b128 v249, v[176:179]
    s_waitcnt lgkmcnt(0)
    ds_read_b128 v[192:195], v251 offset:0
    ds_read_b128 v[196:199], v251 offset:16
    ds_read_b128 v[200:203], v251 offset:32
    ds_read_b128 v[204:207], v251 offset:48
    v_lshlrev_b32 v244, 16, v228
    v_and_b32 v245, 0xffff0000, v228
    s_waitcnt lgkmcnt(3)
    v_fma_f32 v244, v244, v192, v193
    v_fma_f32 v245, v245, v194, v195
    v_cvt_pk_bf16_f32 v228, v244, v245
    v_lshlrev_b32 v246, 16, v229
    v_and_b32 v247, 0xffff0000, v229
    s_waitcnt lgkmcnt(2)
    v_fma_f32 v246, v246, v196, v197
    v_fma_f32 v247, v247, v198, v199
    v_cvt_pk_bf16_f32 v229, v246, v247
    v_lshlrev_b32 v244, 16, v230
    v_and_b32 v245, 0xffff0000, v230
    s_waitcnt lgkmcnt(1)
    v_fma_f32 v244, v244, v200, v201
    v_fma_f32 v245, v245, v202, v203
    v_cvt_pk_bf16_f32 v230, v244, v245
    v_lshlrev_b32 v246, 16, v231
    v_and_b32 v247, 0xffff0000, v231
    s_waitcnt lgkmcnt(0)
    v_fma_f32 v246, v246, v204, v205
    v_fma_f32 v247, v247, v206, v207
    v_cvt_pk_bf16_f32 v231, v246, v247
    buffer_store_dwordx4 v[228:231], v253, s[36:39], s13 offen offset:1024 sc1
    ds_write_b128 v255, v[228:231] offset:5120
    v_lshlrev_b32 v244, 16, v232
    v_and_b32 v245, 0xffff0000, v232
    v_fma_f32 v244, v244, v192, v193
    v_fma_f32 v245, v245, v194, v195
    v_cvt_pk_bf16_f32 v232, v244, v245
    v_lshlrev_b32 v246, 16, v233
    v_and_b32 v247, 0xffff0000, v233
    v_fma_f32 v246, v246, v196, v197
    v_fma_f32 v247, v247, v198, v199
    v_cvt_pk_bf16_f32 v233, v246, v247
    v_lshlrev_b32 v244, 16, v234
    v_and_b32 v245, 0xffff0000, v234
    v_fma_f32 v244, v244, v200, v201
    v_fma_f32 v245, v245, v202, v203
    v_cvt_pk_bf16_f32 v234, v244, v245
    v_lshlrev_b32 v246, 16, v235
    v_and_b32 v247, 0xffff0000, v235
    v_fma_f32 v246, v246, v204, v205
    v_fma_f32 v247, v247, v206, v207
    v_cvt_pk_bf16_f32 v235, v246, v247
    buffer_store_dwordx4 v[232:235], v252, s[36:39], s13 offen offset:2048 sc1
    ds_write_b128 v254, v[232:235] offset:6144
    v_lshlrev_b32 v244, 16, v236
    v_and_b32 v245, 0xffff0000, v236
    v_fma_f32 v244, v244, v192, v193
    v_fma_f32 v245, v245, v194, v195
    v_cvt_pk_bf16_f32 v236, v244, v245
    v_lshlrev_b32 v246, 16, v237
    v_and_b32 v247, 0xffff0000, v237
    v_fma_f32 v246, v246, v196, v197
    v_fma_f32 v247, v247, v198, v199
    v_cvt_pk_bf16_f32 v237, v246, v247
    v_lshlrev_b32 v244, 16, v238
    v_and_b32 v245, 0xffff0000, v238
    v_fma_f32 v244, v244, v200, v201
    v_fma_f32 v245, v245, v202, v203
    v_cvt_pk_bf16_f32 v238, v244, v245
    v_lshlrev_b32 v246, 16, v239
    v_and_b32 v247, 0xffff0000, v239
    v_fma_f32 v246, v246, v204, v205
    v_fma_f32 v247, v247, v206, v207
    v_cvt_pk_bf16_f32 v239, v246, v247
    buffer_store_dwordx4 v[236:239], v253, s[36:39], s13 offen offset:3072 sc1
    ds_write_b128 v255, v[236:239] offset:7168
    v_lshlrev_b32 v244, 16, v240
    v_and_b32 v245, 0xffff0000, v240
    v_fma_f32 v244, v244, v192, v193
    v_fma_f32 v245, v245, v194, v195
    v_cvt_pk_bf16_f32 v240, v244, v245
    v_lshlrev_b32 v246, 16, v241
    v_and_b32 v247, 0xffff0000, v241
    v_fma_f32 v246, v246, v196, v197
    v_fma_f32 v247, v247, v198, v199
    v_cvt_pk_bf16_f32 v241, v246, v247
    v_lshlrev_b32 v244, 16, v242
    v_and_b32 v245, 0xffff0000, v242
    v_fma_f32 v244, v244, v200, v201
    v_fma_f32 v245, v245, v202, v203
    v_cvt_pk_bf16_f32 v242, v244, v245
    v_lshlrev_b32 v246, 16, v243
    v_and_b32 v247, 0xffff0000, v243
    v_fma_f32 v246, v246, v204, v205
    v_fma_f32 v247, v247, v206, v207
    v_cvt_pk_bf16_f32 v243, v246, v247
    buffer_store_dwordx4 v[240:243], v252, s[36:39], s10 offen offset:0 sc1
    ds_write_b128 v254, v[240:243] offset:8192
K2_TEXT:
    s_mov_b32 s32, s48
    s_mov_b32 s33, s49
    s_mov_b32 s34, s51
    s_mov_b32 s48, s52
    s_lshl_b32 s49, s34, 12
    s_mov_b32 s8, s14
    s_mov_b32 s9, s15
    v_mov_b32 v2, v1
    v_and_b32 v3, 15, v2
    v_lshrrev_b32 v4, 4, v2
    v_lshlrev_b32 v214, 4, v2
    s_add_u32 s72, s8, 0x1dc2000
    s_addc_u32 s73, s9, 0
    s_mov_b32 s74, 0x40000
    s_mov_b32 s75, 0x00020000
    s_mul_i32 s46, s33, 589824
    s_mul_i32 s47, s34, 4608
    s_add_u32 s46, s46, s47
    v_add_u32 v44, s46, v214
    s_add_u32 s50, s47, 16384
    s_mov_b32 s44, -1
    s_mov_b32 s45, 0
    v_lshlrev_b32 v46, 14, v3
    s_lshl_b32 s59, s33, 10
    s_add_u32 s59, s59, 128
    v_mov_b32 v47, 159744
    s_add_u32 s16, s8, 0x900000
    s_addc_u32 s17, s9, 0
    s_mov_b32 s18, 0x900000
    s_mov_b32 s19, 0x00020000
    s_waitcnt vmcnt(4) lgkmcnt(0)
    s_barrier
    s_cmp_le_u32 s58, 0
    s_addc_u32 s37, 0, 0
    s_lshl_b32 s37, s37, 8
    s_xor_b32 s37, s37, s60
    s_add_u32 m0, s66, 69632
    s_nop 0
    buffer_load_dwordx4 v40, s[4:7], s37 offen offset:0 lds
    buffer_load_dwordx4 v41, s[4:7], s37 offen offset:1024 lds
    buffer_load_dwordx4 v42, s[4:7], s37 offen offset:2048 lds
    buffer_load_dwordx4 v43, s[4:7], s37 offen offset:3072 lds
    s_cmp_le_u32 s58, 0
    s_addc_u32 s37, 0, 0
    s_lshl_b32 s37, s37, 8
    s_add_u32 s37, s37, 128
    s_xor_b32 s37, s37, s60
    s_add_u32 m0, s66, 104448
    s_nop 0
    buffer_load_dwordx4 v40, s[4:7], s37 offen offset:0 lds
    buffer_load_dwordx4 v41, s[4:7], s37 offen offset:1024 lds
    buffer_load_dwordx4 v42, s[4:7], s37 offen offset:2048 lds
    buffer_load_dwordx4 v43, s[4:7], s37 offen offset:3072 lds
    v_mov_b32 v5, 159744
    v_mov_b32 v6, 1
    s_waitcnt vmcnt(8) lgkmcnt(0)
    s_mov_b64 exec, 1
    ds_add_rtn_u32 v7, v5, v6 offset:8
    s_waitcnt lgkmcnt(0)
    v_readfirstlane_b32 s47, v7
    s_nop 0
    s_cmp_lg_u32 s47, 7
    s_cbranch_scc1 K1_SIGH
    s_mov_b64 exec, -1
    v_mov_b32 v6, 1
    v_lshlrev_b32 v5, 2, v2
    s_lshl_b32 s46, s32, 14
    s_lshl_b32 s47, s33, 10
    s_add_u32 s46, s46, s47
    s_mov_b32 exec_hi, 0
    buffer_store_dword v6, v5, s[72:75], s46 offen offset:128 sc1
K1_SIGH:
    s_mov_b64 exec, -1
    s_barrier
    s_cmp_le_u32 s58, 0
    s_addc_u32 s57, 0, 0
    s_lshl_b32 s57, 1, s57
    s_mov_b32 s41, 0
    s_cmp_lg_u32 s34, 0
    s_cbranch_scc1 KZ_WAITL
KZ_POLL:
    buffer_load_dword v45, v46, s[72:75], s59 offen sc1
    s_waitcnt vmcnt(0)
    v_cmp_ne_u32 vcc, 1, v45
    s_add_u32 s41, s41, 1
    s_lshr_b32 s65, vcc_lo, s62
    s_and_b32 s42, s65, s57
    s_cbranch_scc0 KZ_SET
    s_sleep 3
    s_cmp_lt_u32 s41, 0x20000
    s_cbranch_scc1 KZ_POLL
KZ_SET:
    v_mov_b32 v45, 1
    ds_write_b32 v47, v45 offset:12
    s_branch KZ_GO
KZ_WAITL:
    ds_read_b32 v45, v47 offset:12
    s_waitcnt lgkmcnt(0)
    s_add_u32 s41, s41, 1
    v_readfirstlane_b32 s42, v45
    s_nop 0
    s_cmp_lg_u32 s42, 0
    s_cbranch_scc1 KZ_GO
    s_sleep 1
    s_cmp_lt_u32 s41, 0x400000
    s_cbranch_scc1 KZ_WAITL
KZ_GO:
    s_cmp_le_u32 s58, 0
    s_addc_u32 s38, 0, 0
    s_xor_b32 s38, s38, s62
    s_mul_i32 s38, s38, 36864
    s_add_u32 m0, s50, 69632
    s_mov_b64 exec, s[44:45]
    buffer_load_dwordx4 v44, s[16:19], s38 offen sc1 lds
    s_mov_b64 exec, -1
    buffer_load_dwordx4 v44, s[16:19], s38 offen offset:512 sc1 lds
    buffer_load_dwordx4 v44, s[16:19], s38 offen offset:1536 sc1 lds
    buffer_load_dwordx4 v44, s[16:19], s38 offen offset:2560 sc1 lds
    buffer_load_dwordx4 v44, s[16:19], s38 offen offset:3584 sc1 lds
    s_cmp_le_u32 s58, 0
    s_addc_u32 s38, 0, 0
    s_xor_b32 s38, s38, s62
    s_mul_i32 s38, s38, 36864
    s_add_u32 s38, s38, 18432
    s_add_u32 m0, s50, 104448
    s_mov_b64 exec, s[44:45]
    buffer_load_dwordx4 v44, s[16:19], s38 offen sc1 lds
    s_mov_b64 exec, -1
    buffer_load_dwordx4 v44, s[16:19], s38 offen offset:512 sc1 lds
    buffer_load_dwordx4 v44, s[16:19], s38 offen offset:1536 sc1 lds
    buffer_load_dwordx4 v44, s[16:19], s38 offen offset:2560 sc1 lds
    buffer_load_dwordx4 v44, s[16:19], s38 offen offset:3584 sc1 lds
    s_cmp_le_u32 s58, 1
    s_addc_u32 s37, 1, 0
    s_lshl_b32 s37, s37, 8
    s_xor_b32 s37, s37, s60
    s_add_u32 m0, s66, 0
    s_nop 0
    buffer_load_dwordx4 v40, s[4:7], s37 offen offset:0 lds
    buffer_load_dwordx4 v41, s[4:7], s37 offen offset:1024 lds
    buffer_load_dwordx4 v42, s[4:7], s37 offen offset:2048 lds
    buffer_load_dwordx4 v43, s[4:7], s37 offen offset:3072 lds
    s_cmp_le_u32 s58, 1
    s_addc_u32 s57, 1, 0
    s_cmp_lg_u32 s34, 0
    s_cbranch_scc1 KL_OK2
    s_mov_b32 s41, 0
KL_POLL2:
    s_bitcmp1_b32 s65, s57
    s_cbranch_scc0 KL_OK2
    buffer_load_dword v45, v46, s[72:75], s59 offen sc1
    s_add_u32 s41, s41, 1
    s_waitcnt vmcnt(0)
    v_cmp_ne_u32 vcc, 1, v45
    s_cmp_lt_u32 s41, 0x20000
    s_lshr_b32 s65, vcc_lo, s62
    s_sleep 1
    s_cmp_lt_u32 s41, 0x20000
    s_cbranch_scc1 KL_POLL2
KL_OK2:
    s_waitcnt vmcnt(9)
    s_barrier
    s_cmp_le_u32 s58, 1
    s_addc_u32 s38, 1, 0
    s_xor_b32 s38, s38, s62
    s_mul_i32 s38, s38, 36864
    s_add_u32 m0, s50, 0
    s_mov_b64 exec, s[44:45]
    buffer_load_dwordx4 v44, s[16:19], s38 offen sc1 lds
    s_mov_b64 exec, -1
    buffer_load_dwordx4 v44, s[16:19], s38 offen offset:512 sc1 lds
    buffer_load_dwordx4 v44, s[16:19], s38 offen offset:1536 sc1 lds
    buffer_load_dwordx4 v44, s[16:19], s38 offen offset:2560 sc1 lds
    buffer_load_dwordx4 v44, s[16:19], s38 offen offset:3584 sc1 lds
    s_cmp_le_u32 s58, 1
    s_addc_u32 s37, 1, 0
    s_lshl_b32 s37, s37, 8
    s_add_u32 s37, s37, 128
    s_xor_b32 s37, s37, s60
    s_add_u32 m0, s66, 34816
    s_nop 0
    buffer_load_dwordx4 v40, s[4:7], s37 offen offset:0 lds
    buffer_load_dwordx4 v41, s[4:7], s37 offen offset:1024 lds
    buffer_load_dwordx4 v42, s[4:7], s37 offen offset:2048 lds
    buffer_load_dwordx4 v43, s[4:7], s37 offen offset:3072 lds
    s_waitcnt vmcnt(13)
    s_barrier
    s_cmp_le_u32 s58, 1
    s_addc_u32 s38, 1, 0
    s_xor_b32 s38, s38, s62
    s_mul_i32 s38, s38, 36864
    s_add_u32 s38, s38, 18432
    s_add_u32 m0, s50, 34816
    s_mov_b64 exec, s[44:45]
    buffer_load_dwordx4 v44, s[16:19], s38 offen sc1 lds
    s_mov_b64 exec, -1
    buffer_load_dwordx4 v44, s[16:19], s38 offen offset:512 sc1 lds
    buffer_load_dwordx4 v44, s[16:19], s38 offen offset:1536 sc1 lds
    buffer_load_dwordx4 v44, s[16:19], s38 offen offset:2560 sc1 lds
    buffer_load_dwordx4 v44, s[16:19], s38 offen offset:3584 sc1 lds
    s_cmp_le_u32 s58, 2
    s_addc_u32 s37, 2, 0
    s_lshl_b32 s37, s37, 8
    s_xor_b32 s37, s37, s60
    s_add_u32 m0, s66, 69632
    s_nop 0
    buffer_load_dwordx4 v40, s[4:7], s37 offen offset:0 lds
    buffer_load_dwordx4 v41, s[4:7], s37 offen offset:1024 lds
    buffer_load_dwordx4 v42, s[4:7], s37 offen offset:2048 lds
    buffer_load_dwordx4 v43, s[4:7], s37 offen offset:3072 lds
    s_cmp_le_u32 s58, 2
    s_addc_u32 s57, 2, 0
    s_cmp_lg_u32 s34, 0
    s_cbranch_scc1 KL_OK3
    s_mov_b32 s41, 0
KL_POLL3:
    s_bitcmp1_b32 s65, s57
    s_cbranch_scc0 KL_OK3
    buffer_load_dword v45, v46, s[72:75], s59 offen sc1
    s_add_u32 s41, s41, 1
    s_waitcnt vmcnt(0)
    v_cmp_ne_u32 vcc, 1, v45
    s_cmp_lt_u32 s41, 0x20000
    s_lshr_b32 s65, vcc_lo, s62
    s_sleep 1
    s_cmp_lt_u32 s41, 0x20000
    s_cbranch_scc1 KL_POLL3
KL_OK3:
    s_waitcnt vmcnt(13)
    s_barrier
    s_cmp_le_u32 s58, 2
    s_addc_u32 s38, 2, 0
    s_xor_b32 s38, s38, s62
    s_mul_i32 s38, s38, 36864
    s_add_u32 m0, s50, 69632
    s_mov_b64 exec, s[44:45]
    buffer_load_dwordx4 v44, s[16:19], s38 offen sc1 lds
    s_mov_b64 exec, -1
    buffer_load_dwordx4 v44, s[16:19], s38 offen offset:512 sc1 lds
    buffer_load_dwordx4 v44, s[16:19], s38 offen offset:1536 sc1 lds
    buffer_load_dwordx4 v44, s[16:19], s38 offen offset:2560 sc1 lds
    buffer_load_dwordx4 v44, s[16:19], s38 offen offset:3584 sc1 lds
    s_cmp_le_u32 s58, 2
    s_addc_u32 s37, 2, 0
    s_lshl_b32 s37, s37, 8
    s_add_u32 s37, s37, 128
    s_xor_b32 s37, s37, s60
    s_add_u32 m0, s66, 104448
    s_nop 0
    buffer_load_dwordx4 v40, s[4:7], s37 offen offset:0 lds
    buffer_load_dwordx4 v41, s[4:7], s37 offen offset:1024 lds
    buffer_load_dwordx4 v42, s[4:7], s37 offen offset:2048 lds
    buffer_load_dwordx4 v43, s[4:7], s37 offen offset:3072 lds
    s_waitcnt vmcnt(13)
    s_barrier
    s_cmp_le_u32 s58, 2
    s_addc_u32 s38, 2, 0
    s_xor_b32 s38, s38, s62
    s_mul_i32 s38, s38, 36864
    s_add_u32 s38, s38, 18432
    s_add_u32 m0, s50, 104448
    s_mov_b64 exec, s[44:45]
    buffer_load_dwordx4 v44, s[16:19], s38 offen sc1 lds
    s_mov_b64 exec, -1
    buffer_load_dwordx4 v44, s[16:19], s38 offen offset:512 sc1 lds
    buffer_load_dwordx4 v44, s[16:19], s38 offen offset:1536 sc1 lds
    buffer_load_dwordx4 v44, s[16:19], s38 offen offset:2560 sc1 lds
    buffer_load_dwordx4 v44, s[16:19], s38 offen offset:3584 sc1 lds
    s_cmp_le_u32 s58, 3
    s_addc_u32 s37, 3, 0
    s_lshl_b32 s37, s37, 8
    s_xor_b32 s37, s37, s60
    s_add_u32 m0, s66, 0
    s_nop 0
    buffer_load_dwordx4 v40, s[4:7], s37 offen offset:0 lds
    buffer_load_dwordx4 v41, s[4:7], s37 offen offset:1024 lds
    buffer_load_dwordx4 v42, s[4:7], s37 offen offset:2048 lds
    buffer_load_dwordx4 v43, s[4:7], s37 offen offset:3072 lds
    s_cmp_le_u32 s58, 3
    s_addc_u32 s57, 3, 0
    s_cmp_lg_u32 s34, 0
    s_cbranch_scc1 KL_OK4
    s_mov_b32 s41, 0
KL_POLL4:
    s_bitcmp1_b32 s65, s57
    s_cbranch_scc0 KL_OK4
    buffer_load_dword v45, v46, s[72:75], s59 offen sc1
    s_add_u32 s41, s41, 1
    s_waitcnt vmcnt(0)
    v_cmp_ne_u32 vcc, 1, v45
    s_cmp_lt_u32 s41, 0x20000
    s_lshr_b32 s65, vcc_lo, s62
    s_sleep 1
    s_cmp_lt_u32 s41, 0x20000
    s_cbranch_scc1 KL_POLL4
KL_OK4:
    s_waitcnt vmcnt(13)
    s_barrier
    s_cmp_le_u32 s58, 3
    s_addc_u32 s38, 3, 0
    s_xor_b32 s38, s38, s62
    s_mul_i32 s38, s38, 36864
    s_add_u32 m0, s50, 0
    s_mov_b64 exec, s[44:45]
    buffer_load_dwordx4 v44, s[16:19], s38 offen sc1 lds
    s_mov_b64 exec, -1
    buffer_load_dwordx4 v44, s[16:19], s38 offen offset:512 sc1 lds
    buffer_load_dwordx4 v44, s[16:19], s38 offen offset:1536 sc1 lds
    buffer_load_dwordx4 v44, s[16:19], s38 offen offset:2560 sc1 lds
    buffer_load_dwordx4 v44, s[16:19], s38 offen offset:3584 sc1 lds
    s_cmp_le_u32 s58, 3
    s_addc_u32 s37, 3, 0
    s_lshl_b32 s37, s37, 8
    s_add_u32 s37, s37, 128
    s_xor_b32 s37, s37, s60
    s_add_u32 m0, s66, 34816
    s_nop 0
    buffer_load_dwordx4 v40, s[4:7], s37 offen offset:0 lds
    buffer_load_dwordx4 v41, s[4:7], s37 offen offset:1024 lds
    buffer_load_dwordx4 v42, s[4:7], s37 offen offset:2048 lds
    buffer_load_dwordx4 v43, s[4:7], s37 offen offset:3072 lds
    s_waitcnt vmcnt(13)
    s_barrier
    s_cmp_le_u32 s58, 3
    s_addc_u32 s38, 3, 0
    s_xor_b32 s38, s38, s62
    s_mul_i32 s38, s38, 36864
    s_add_u32 s38, s38, 18432
    s_add_u32 m0, s50, 34816
    s_mov_b64 exec, s[44:45]
    buffer_load_dwordx4 v44, s[16:19], s38 offen sc1 lds
    s_mov_b64 exec, -1
    buffer_load_dwordx4 v44, s[16:19], s38 offen offset:512 sc1 lds
    buffer_load_dwordx4 v44, s[16:19], s38 offen offset:1536 sc1 lds
    buffer_load_dwordx4 v44, s[16:19], s38 offen offset:2560 sc1 lds
    buffer_load_dwordx4 v44, s[16:19], s38 offen offset:3584 sc1 lds
    s_cmp_le_u32 s58, 4
    s_addc_u32 s37, 4, 0
    s_lshl_b32 s37, s37, 8
    s_xor_b32 s37, s37, s60
    s_add_u32 m0, s66, 69632
    s_nop 0
    buffer_load_dwordx4 v40, s[4:7], s37 offen offset:0 lds
    buffer_load_dwordx4 v41, s[4:7], s37 offen offset:1024 lds
    buffer_load_dwordx4 v42, s[4:7], s37 offen offset:2048 lds
    buffer_load_dwordx4 v43, s[4:7], s37 offen offset:3072 lds
    s_cmp_le_u32 s58, 4
    s_addc_u32 s57, 4, 0
    s_cmp_lg_u32 s34, 0
    s_cbranch_scc1 KL_OK5
    s_mov_b32 s41, 0
KL_POLL5:
    s_bitcmp1_b32 s65, s57
    s_cbranch_scc0 KL_OK5
    buffer_load_dword v45, v46, s[72:75], s59 offen sc1
    s_add_u32 s41, s41, 1
    s_waitcnt vmcnt(0)
    v_cmp_ne_u32 vcc, 1, v45
    s_cmp_lt_u32 s41, 0x20000
    s_lshr_b32 s65, vcc_lo, s62
    s_sleep 1
    s_cmp_lt_u32 s41, 0x20000
    s_cbranch_scc1 KL_POLL5
KL_OK5:
    s_waitcnt vmcnt(13)
    s_barrier
    s_cmp_le_u32 s58, 4
    s_addc_u32 s38, 4, 0
    s_xor_b32 s38, s38, s62
    s_mul_i32 s38, s38, 36864
    s_add_u32 m0, s50, 69632
    s_mov_b64 exec, s[44:45]
    buffer_load_dwordx4 v44, s[16:19], s38 offen sc1 lds
    s_mov_b64 exec, -1
    buffer_load_dwordx4 v44, s[16:19], s38 offen offset:512 sc1 lds
    buffer_load_dwordx4 v44, s[16:19], s38 offen offset:1536 sc1 lds
    buffer_load_dwordx4 v44, s[16:19], s38 offen offset:2560 sc1 lds
    buffer_load_dwordx4 v44, s[16:19], s38 offen offset:3584 sc1 lds
    s_cmp_le_u32 s58, 4
    s_addc_u32 s37, 4, 0
    s_lshl_b32 s37, s37, 8
    s_add_u32 s37, s37, 128
    s_xor_b32 s37, s37, s60
    s_add_u32 m0, s66, 104448
    s_nop 0
    buffer_load_dwordx4 v40, s[4:7], s37 offen offset:0 lds
    buffer_load_dwordx4 v41, s[4:7], s37 offen offset:1024 lds
    buffer_load_dwordx4 v42, s[4:7], s37 offen offset:2048 lds
    buffer_load_dwordx4 v43, s[4:7], s37 offen offset:3072 lds
    s_waitcnt vmcnt(13)
    s_barrier
    s_cmp_le_u32 s58, 4
    s_addc_u32 s38, 4, 0
    s_xor_b32 s38, s38, s62
    s_mul_i32 s38, s38, 36864
    s_add_u32 s38, s38, 18432
    s_add_u32 m0, s50, 104448
    s_mov_b64 exec, s[44:45]
    buffer_load_dwordx4 v44, s[16:19], s38 offen sc1 lds
    s_mov_b64 exec, -1
    buffer_load_dwordx4 v44, s[16:19], s38 offen offset:512 sc1 lds
    buffer_load_dwordx4 v44, s[16:19], s38 offen offset:1536 sc1 lds
    buffer_load_dwordx4 v44, s[16:19], s38 offen offset:2560 sc1 lds
    buffer_load_dwordx4 v44, s[16:19], s38 offen offset:3584 sc1 lds
    s_cmp_le_u32 s58, 5
    s_addc_u32 s37, 5, 0
    s_lshl_b32 s37, s37, 8
    s_xor_b32 s37, s37, s60
    s_add_u32 m0, s66, 0
    s_nop 0
    buffer_load_dwordx4 v40, s[4:7], s37 offen offset:0 lds
    buffer_load_dwordx4 v41, s[4:7], s37 offen offset:1024 lds
    buffer_load_dwordx4 v42, s[4:7], s37 offen offset:2048 lds
    buffer_load_dwordx4 v43, s[4:7], s37 offen offset:3072 lds
    s_cmp_le_u32 s58, 5
    s_addc_u32 s57, 5, 0
    s_cmp_lg_u32 s34, 0
    s_cbranch_scc1 KL_OK6
    s_mov_b32 s41, 0
KL_POLL6:
    s_bitcmp1_b32 s65, s57
    s_cbranch_scc0 KL_OK6
    buffer_load_dword v45, v46, s[72:75], s59 offen sc1
    s_add_u32 s41, s41, 1
    s_waitcnt vmcnt(0)
    v_cmp_ne_u32 vcc, 1, v45
    s_cmp_lt_u32 s41, 0x20000
    s_lshr_b32 s65, vcc_lo, s62
    s_sleep 1
    s_cmp_lt_u32 s41, 0x20000
    s_cbranch_scc1 KL_POLL6
KL_OK6:
    s_waitcnt vmcnt(13)
    s_barrier
    s_cmp_le_u32 s58, 5
    s_addc_u32 s38, 5, 0
    s_xor_b32 s38, s38, s62
    s_mul_i32 s38, s38, 36864
    s_add_u32 m0, s50, 0
    s_mov_b64 exec, s[44:45]
    buffer_load_dwordx4 v44, s[16:19], s38 offen sc1 lds
    s_mov_b64 exec, -1
    buffer_load_dwordx4 v44, s[16:19], s38 offen offset:512 sc1 lds
    buffer_load_dwordx4 v44, s[16:19], s38 offen offset:1536 sc1 lds
    buffer_load_dwordx4 v44, s[16:19], s38 offen offset:2560 sc1 lds
    buffer_load_dwordx4 v44, s[16:19], s38 offen offset:3584 sc1 lds
    s_cmp_le_u32 s58, 5
    s_addc_u32 s37, 5, 0
    s_lshl_b32 s37, s37, 8
    s_add_u32 s37, s37, 128
    s_xor_b32 s37, s37, s60
    s_add_u32 m0, s66, 34816
    s_nop 0
    buffer_load_dwordx4 v40, s[4:7], s37 offen offset:0 lds
    buffer_load_dwordx4 v41, s[4:7], s37 offen offset:1024 lds
    buffer_load_dwordx4 v42, s[4:7], s37 offen offset:2048 lds
    buffer_load_dwordx4 v43, s[4:7], s37 offen offset:3072 lds
    s_waitcnt vmcnt(13)
    s_barrier
    s_cmp_le_u32 s58, 5
    s_addc_u32 s38, 5, 0
    s_xor_b32 s38, s38, s62
    s_mul_i32 s38, s38, 36864
    s_add_u32 s38, s38, 18432
    s_add_u32 m0, s50, 34816
    s_mov_b64 exec, s[44:45]
    buffer_load_dwordx4 v44, s[16:19], s38 offen sc1 lds
    s_mov_b64 exec, -1
    buffer_load_dwordx4 v44, s[16:19], s38 offen offset:512 sc1 lds
    buffer_load_dwordx4 v44, s[16:19], s38 offen offset:1536 sc1 lds
    buffer_load_dwordx4 v44, s[16:19], s38 offen offset:2560 sc1 lds
    buffer_load_dwordx4 v44, s[16:19], s38 offen offset:3584 sc1 lds
    s_cmp_le_u32 s58, 6
    s_addc_u32 s37, 6, 0
    s_lshl_b32 s37, s37, 8
    s_xor_b32 s37, s37, s60
    s_add_u32 m0, s66, 69632
    s_nop 0
    buffer_load_dwordx4 v40, s[4:7], s37 offen offset:0 lds
    buffer_load_dwordx4 v41, s[4:7], s37 offen offset:1024 lds
    buffer_load_dwordx4 v42, s[4:7], s37 offen offset:2048 lds
    buffer_load_dwordx4 v43, s[4:7], s37 offen offset:3072 lds
    s_cmp_le_u32 s58, 6
    s_addc_u32 s57, 6, 0
    s_cmp_lg_u32 s34, 0
    s_cbranch_scc1 KL_OK7
    s_mov_b32 s41, 0
KL_POLL7:
    s_bitcmp1_b32 s65, s57
    s_cbranch_scc0 KL_OK7
    buffer_load_dword v45, v46, s[72:75], s59 offen sc1
    s_add_u32 s41, s41, 1
    s_waitcnt vmcnt(0)
    v_cmp_ne_u32 vcc, 1, v45
    s_cmp_lt_u32 s41, 0x20000
    s_lshr_b32 s65, vcc_lo, s62
    s_sleep 1
    s_cmp_lt_u32 s41, 0x20000
    s_cbranch_scc1 KL_POLL7
KL_OK7:
    s_waitcnt vmcnt(13)
    s_barrier
    s_cmp_le_u32 s58, 6
    s_addc_u32 s38, 6, 0
    s_xor_b32 s38, s38, s62
    s_mul_i32 s38, s38, 36864
    s_add_u32 m0, s50, 69632
    s_mov_b64 exec, s[44:45]
    buffer_load_dwordx4 v44, s[16:19], s38 offen sc1 lds
    s_mov_b64 exec, -1
    buffer_load_dwordx4 v44, s[16:19], s38 offen offset:512 sc1 lds
    buffer_load_dwordx4 v44, s[16:19], s38 offen offset:1536 sc1 lds
    buffer_load_dwordx4 v44, s[16:19], s38 offen offset:2560 sc1 lds
    buffer_load_dwordx4 v44, s[16:19], s38 offen offset:3584 sc1 lds
    s_cmp_le_u32 s58, 6
    s_addc_u32 s37, 6, 0
    s_lshl_b32 s37, s37, 8
    s_add_u32 s37, s37, 128
    s_xor_b32 s37, s37, s60
    s_add_u32 m0, s66, 104448
    s_nop 0
    buffer_load_dwordx4 v40, s[4:7], s37 offen offset:0 lds
    buffer_load_dwordx4 v41, s[4:7], s37 offen offset:1024 lds
    buffer_load_dwordx4 v42, s[4:7], s37 offen offset:2048 lds
    buffer_load_dwordx4 v43, s[4:7], s37 offen offset:3072 lds
    s_waitcnt vmcnt(13)
    s_barrier
    s_cmp_le_u32 s58, 6
    s_addc_u32 s38, 6, 0
    s_xor_b32 s38, s38, s62
    s_mul_i32 s38, s38, 36864
    s_add_u32 s38, s38, 18432
    s_add_u32 m0, s50, 104448
    s_mov_b64 exec, s[44:45]
    buffer_load_dwordx4 v44, s[16:19], s38 offen sc1 lds
    s_mov_b64 exec, -1
    buffer_load_dwordx4 v44, s[16:19], s38 offen offset:512 sc1 lds
    buffer_load_dwordx4 v44, s[16:19], s38 offen offset:1536 sc1 lds
    buffer_load_dwordx4 v44, s[16:19], s38 offen offset:2560 sc1 lds
    buffer_load_dwordx4 v44, s[16:19], s38 offen offset:3584 sc1 lds
    s_cmp_le_u32 s58, 7
    s_addc_u32 s37, 7, 0
    s_lshl_b32 s37, s37, 8
    s_xor_b32 s37, s37, s60
    s_add_u32 m0, s66, 0
    s_nop 0
    buffer_load_dwordx4 v40, s[4:7], s37 offen offset:0 lds
    buffer_load_dwordx4 v41, s[4:7], s37 offen offset:1024 lds
    buffer_load_dwordx4 v42, s[4:7], s37 offen offset:2048 lds
    buffer_load_dwordx4 v43, s[4:7], s37 offen offset:3072 lds
    s_cmp_le_u32 s58, 7
    s_addc_u32 s57, 7, 0
    s_cmp_lg_u32 s34, 0
    s_cbranch_scc1 KL_OK8
    s_mov_b32 s41, 0
KL_POLL8:
    s_bitcmp1_b32 s65, s57
    s_cbranch_scc0 KL_OK8
    buffer_load_dword v45, v46, s[72:75], s59 offen sc1
    s_add_u32 s41, s41, 1
    s_waitcnt vmcnt(0)
    v_cmp_ne_u32 vcc, 1, v45
    s_cmp_lt_u32 s41, 0x20000
    s_lshr_b32 s65, vcc_lo, s62
    s_sleep 1
    s_cmp_lt_u32 s41, 0x20000
    s_cbranch_scc1 KL_POLL8
KL_OK8:
    s_waitcnt vmcnt(13)
    s_barrier
    s_cmp_le_u32 s58, 7
    s_addc_u32 s38, 7, 0
    s_xor_b32 s38, s38, s62
    s_mul_i32 s38, s38, 36864
    s_add_u32 m0, s50, 0
    s_mov_b64 exec, s[44:45]
    buffer_load_dwordx4 v44, s[16:19], s38 offen sc1 lds
    s_mov_b64 exec, -1
    buffer_load_dwordx4 v44, s[16:19], s38 offen offset:512 sc1 lds
    buffer_load_dwordx4 v44, s[16:19], s38 offen offset:1536 sc1 lds
    buffer_load_dwordx4 v44, s[16:19], s38 offen offset:2560 sc1 lds
    buffer_load_dwordx4 v44, s[16:19], s38 offen offset:3584 sc1 lds
    s_cmp_le_u32 s58, 7
    s_addc_u32 s37, 7, 0
    s_lshl_b32 s37, s37, 8
    s_add_u32 s37, s37, 128
    s_xor_b32 s37, s37, s60
    s_add_u32 m0, s66, 34816
    s_nop 0
    buffer_load_dwordx4 v40, s[4:7], s37 offen offset:0 lds
    buffer_load_dwordx4 v41, s[4:7], s37 offen offset:1024 lds
    buffer_load_dwordx4 v42, s[4:7], s37 offen offset:2048 lds
    buffer_load_dwordx4 v43, s[4:7], s37 offen offset:3072 lds
    s_waitcnt vmcnt(13)
    s_barrier
    s_cmp_le_u32 s58, 7
    s_addc_u32 s38, 7, 0
    s_xor_b32 s38, s38, s62
    s_mul_i32 s38, s38, 36864
    s_add_u32 s38, s38, 18432
    s_add_u32 m0, s50, 34816
    s_mov_b64 exec, s[44:45]
    buffer_load_dwordx4 v44, s[16:19], s38 offen sc1 lds
    s_mov_b64 exec, -1
    buffer_load_dwordx4 v44, s[16:19], s38 offen offset:512 sc1 lds
    buffer_load_dwordx4 v44, s[16:19], s38 offen offset:1536 sc1 lds
    buffer_load_dwordx4 v44, s[16:19], s38 offen offset:2560 sc1 lds
    buffer_load_dwordx4 v44, s[16:19], s38 offen offset:3584 sc1 lds
    s_cmp_le_u32 s58, 8
    s_addc_u32 s37, 8, 0
    s_lshl_b32 s37, s37, 8
    s_xor_b32 s37, s37, s60
    s_add_u32 m0, s66, 69632
    s_nop 0
    buffer_load_dwordx4 v40, s[4:7], s37 offen offset:0 lds
    buffer_load_dwordx4 v41, s[4:7], s37 offen offset:1024 lds
    buffer_load_dwordx4 v42, s[4:7], s37 offen offset:2048 lds
    buffer_load_dwordx4 v43, s[4:7], s37 offen offset:3072 lds
    s_cmp_le_u32 s58, 8
    s_addc_u32 s57, 8, 0
    s_cmp_lg_u32 s34, 0
    s_cbranch_scc1 KL_OK9
    s_mov_b32 s41, 0
KL_POLL9:
    s_bitcmp1_b32 s65, s57
    s_cbranch_scc0 KL_OK9
    buffer_load_dword v45, v46, s[72:75], s59 offen sc1
    s_add_u32 s41, s41, 1
    s_waitcnt vmcnt(0)
    v_cmp_ne_u32 vcc, 1, v45
    s_cmp_lt_u32 s41, 0x20000
    s_lshr_b32 s65, vcc_lo, s62
    s_sleep 1
    s_cmp_lt_u32 s41, 0x20000
    s_cbranch_scc1 KL_POLL9
KL_OK9:
    s_waitcnt vmcnt(13)
    s_barrier
    s_cmp_le_u32 s58, 8
    s_addc_u32 s38, 8, 0
    s_xor_b32 s38, s38, s62
    s_mul_i32 s38, s38, 36864
    s_add_u32 m0, s50, 69632
    s_mov_b64 exec, s[44:45]
    buffer_load_dwordx4 v44, s[16:19], s38 offen sc1 lds
    s_mov_b64 exec, -1
    buffer_load_dwordx4 v44, s[16:19], s38 offen offset:512 sc1 lds
    buffer_load_dwordx4 v44, s[16:19], s38 offen offset:1536 sc1 lds
    buffer_load_dwordx4 v44, s[16:19], s38 offen offset:2560 sc1 lds
    buffer_load_dwordx4 v44, s[16:19], s38 offen offset:3584 sc1 lds
    s_cmp_le_u32 s58, 8
    s_addc_u32 s37, 8, 0
    s_lshl_b32 s37, s37, 8
    s_add_u32 s37, s37, 128
    s_xor_b32 s37, s37, s60
    s_add_u32 m0, s66, 104448
    s_nop 0
    buffer_load_dwordx4 v40, s[4:7], s37 offen offset:0 lds
    buffer_load_dwordx4 v41, s[4:7], s37 offen offset:1024 lds
    buffer_load_dwordx4 v42, s[4:7], s37 offen offset:2048 lds
    buffer_load_dwordx4 v43, s[4:7], s37 offen offset:3072 lds
    s_waitcnt vmcnt(13)
    s_barrier
    s_cmp_le_u32 s58, 8
    s_addc_u32 s38, 8, 0
    s_xor_b32 s38, s38, s62
    s_mul_i32 s38, s38, 36864
    s_add_u32 s38, s38, 18432
    s_add_u32 m0, s50, 104448
    s_mov_b64 exec, s[44:45]
    buffer_load_dwordx4 v44, s[16:19], s38 offen sc1 lds
    s_mov_b64 exec, -1
    buffer_load_dwordx4 v44, s[16:19], s38 offen offset:512 sc1 lds
    buffer_load_dwordx4 v44, s[16:19], s38 offen offset:1536 sc1 lds
    buffer_load_dwordx4 v44, s[16:19], s38 offen offset:2560 sc1 lds
    buffer_load_dwordx4 v44, s[16:19], s38 offen offset:3584 sc1 lds
    s_cmp_le_u32 s58, 9
    s_addc_u32 s37, 9, 0
    s_lshl_b32 s37, s37, 8
    s_xor_b32 s37, s37, s60
    s_add_u32 m0, s66, 0
    s_nop 0
    buffer_load_dwordx4 v40, s[4:7], s37 offen offset:0 lds
    buffer_load_dwordx4 v41, s[4:7], s37 offen offset:1024 lds
    buffer_load_dwordx4 v42, s[4:7], s37 offen offset:2048 lds
    buffer_load_dwordx4 v43, s[4:7], s37 offen offset:3072 lds
    s_cmp_le_u32 s58, 9
    s_addc_u32 s57, 9, 0
    s_cmp_lg_u32 s34, 0
    s_cbranch_scc1 KL_OK10
    s_mov_b32 s41, 0
KL_POLL10:
    s_bitcmp1_b32 s65, s57
    s_cbranch_scc0 KL_OK10
    buffer_load_dword v45, v46, s[72:75], s59 offen sc1
    s_add_u32 s41, s41, 1
    s_waitcnt vmcnt(0)
    v_cmp_ne_u32 vcc, 1, v45
    s_cmp_lt_u32 s41, 0x20000
    s_lshr_b32 s65, vcc_lo, s62
    s_sleep 1
    s_cmp_lt_u32 s41, 0x20000
    s_cbranch_scc1 KL_POLL10
KL_OK10:
    s_waitcnt vmcnt(13)
    s_barrier
    s_cmp_le_u32 s58, 9
    s_addc_u32 s38, 9, 0
    s_xor_b32 s38, s38, s62
    s_mul_i32 s38, s38, 36864
    s_add_u32 m0, s50, 0
    s_mov_b64 exec, s[44:45]
    buffer_load_dwordx4 v44, s[16:19], s38 offen sc1 lds
    s_mov_b64 exec, -1
    buffer_load_dwordx4 v44, s[16:19], s38 offen offset:512 sc1 lds
    buffer_load_dwordx4 v44, s[16:19], s38 offen offset:1536 sc1 lds
    buffer_load_dwordx4 v44, s[16:19], s38 offen offset:2560 sc1 lds
    buffer_load_dwordx4 v44, s[16:19], s38 offen offset:3584 sc1 lds
    s_cmp_le_u32 s58, 9
    s_addc_u32 s37, 9, 0
    s_lshl_b32 s37, s37, 8
    s_add_u32 s37, s37, 128
    s_xor_b32 s37, s37, s60
    s_add_u32 m0, s66, 34816
    s_nop 0
    buffer_load_dwordx4 v40, s[4:7], s37 offen offset:0 lds
    buffer_load_dwordx4 v41, s[4:7], s37 offen offset:1024 lds
    buffer_load_dwordx4 v42, s[4:7], s37 offen offset:2048 lds
    buffer_load_dwordx4 v43, s[4:7], s37 offen offset:3072 lds
    s_waitcnt vmcnt(13)
    s_barrier
    s_cmp_le_u32 s58, 9
    s_addc_u32 s38, 9, 0
    s_xor_b32 s38, s38, s62
    s_mul_i32 s38, s38, 36864
    s_add_u32 s38, s38, 18432
    s_add_u32 m0, s50, 34816
    s_mov_b64 exec, s[44:45]
    buffer_load_dwordx4 v44, s[16:19], s38 offen sc1 lds
    s_mov_b64 exec, -1
    buffer_load_dwordx4 v44, s[16:19], s38 offen offset:512 sc1 lds
    buffer_load_dwordx4 v44, s[16:19], s38 offen offset:1536 sc1 lds
    buffer_load_dwordx4 v44, s[16:19], s38 offen offset:2560 sc1 lds
    buffer_load_dwordx4 v44, s[16:19], s38 offen offset:3584 sc1 lds
    s_cmp_le_u32 s58, 10
    s_addc_u32 s37, 10, 0
    s_lshl_b32 s37, s37, 8
    s_xor_b32 s37, s37, s60
    s_add_u32 m0, s66, 69632
    s_nop 0
    buffer_load_dwordx4 v40, s[4:7], s37 offen offset:0 lds
    buffer_load_dwordx4 v41, s[4:7], s37 offen offset:1024 lds
    buffer_load_dwordx4 v42, s[4:7], s37 offen offset:2048 lds
    buffer_load_dwordx4 v43, s[4:7], s37 offen offset:3072 lds
    s_cmp_le_u32 s58, 10
    s_addc_u32 s57, 10, 0
    s_cmp_lg_u32 s34, 0
    s_cbranch_scc1 KL_OK11
    s_mov_b32 s41, 0
KL_POLL11:
    s_bitcmp1_b32 s65, s57
    s_cbranch_scc0 KL_OK11
    buffer_load_dword v45, v46, s[72:75], s59 offen sc1
    s_add_u32 s41, s41, 1
    s_waitcnt vmcnt(0)
    v_cmp_ne_u32 vcc, 1, v45
    s_cmp_lt_u32 s41, 0x20000
    s_lshr_b32 s65, vcc_lo, s62
    s_sleep 1
    s_cmp_lt_u32 s41, 0x20000
    s_cbranch_scc1 KL_POLL11
KL_OK11:
    s_waitcnt vmcnt(13)
    s_barrier
    s_cmp_le_u32 s58, 10
    s_addc_u32 s38, 10, 0
    s_xor_b32 s38, s38, s62
    s_mul_i32 s38, s38, 36864
    s_add_u32 m0, s50, 69632
    s_mov_b64 exec, s[44:45]
    buffer_load_dwordx4 v44, s[16:19], s38 offen sc1 lds
    s_mov_b64 exec, -1
    buffer_load_dwordx4 v44, s[16:19], s38 offen offset:512 sc1 lds
    buffer_load_dwordx4 v44, s[16:19], s38 offen offset:1536 sc1 lds
    buffer_load_dwordx4 v44, s[16:19], s38 offen offset:2560 sc1 lds
    buffer_load_dwordx4 v44, s[16:19], s38 offen offset:3584 sc1 lds
    s_cmp_le_u32 s58, 10
    s_addc_u32 s37, 10, 0
    s_lshl_b32 s37, s37, 8
    s_add_u32 s37, s37, 128
    s_xor_b32 s37, s37, s60
    s_add_u32 m0, s66, 104448
    s_nop 0
    buffer_load_dwordx4 v40, s[4:7], s37 offen offset:0 lds
    buffer_load_dwordx4 v41, s[4:7], s37 offen offset:1024 lds
    buffer_load_dwordx4 v42, s[4:7], s37 offen offset:2048 lds
    buffer_load_dwordx4 v43, s[4:7], s37 offen offset:3072 lds
    s_waitcnt vmcnt(13)
    s_barrier
    s_cmp_le_u32 s58, 10
    s_addc_u32 s38, 10, 0
    s_xor_b32 s38, s38, s62
    s_mul_i32 s38, s38, 36864
    s_add_u32 s38, s38, 18432
    s_add_u32 m0, s50, 104448
    s_mov_b64 exec, s[44:45]
    buffer_load_dwordx4 v44, s[16:19], s38 offen sc1 lds
    s_mov_b64 exec, -1
    buffer_load_dwordx4 v44, s[16:19], s38 offen offset:512 sc1 lds
    buffer_load_dwordx4 v44, s[16:19], s38 offen offset:1536 sc1 lds
    buffer_load_dwordx4 v44, s[16:19], s38 offen offset:2560 sc1 lds
    buffer_load_dwordx4 v44, s[16:19], s38 offen offset:3584 sc1 lds
    s_cmp_le_u32 s58, 11
    s_addc_u32 s37, 11, 0
    s_lshl_b32 s37, s37, 8
    s_xor_b32 s37, s37, s60
    s_add_u32 m0, s66, 0
    s_nop 0
    buffer_load_dwordx4 v40, s[4:7], s37 offen offset:0 lds
    buffer_load_dwordx4 v41, s[4:7], s37 offen offset:1024 lds
    buffer_load_dwordx4 v42, s[4:7], s37 offen offset:2048 lds
    buffer_load_dwordx4 v43, s[4:7], s37 offen offset:3072 lds
    s_and_b32 s43, s2, 7
    s_lshr_b32 s46, s2, 3
    s_mul_i32 s47, s43, 29
    s_min_u32 s43, s43, 2
    s_add_u32 s47, s47, s43
    s_add_u32 s47, s47, s46
    s_mul_hi_u32 s46, s47, 0x1c71c71d
    s_mul_i32 s46, s46, 80
    s_add_u32 s47, s46, 79
    s_lshr_b32 s46, s46, 7
    s_lshr_b32 s47, s47, 7
    s_min_u32 s46, s46, 15
    s_min_u32 s47, s47, 15
    s_lshl_b32 s46, s46, 14
    s_lshl_b32 s47, s47, 14
    v_mov_b32 v238, s47
    v_mov_b32 v239, s46
    v_cmp_gt_u32 vcc, 16, v2
    s_nop 1
    v_cndmask_b32 v238, v238, v239, vcc
    v_lshl_add_u32 v238, v3, 10, v238
    s_movk_i32 s64, 384
    buffer_load_dword v236, v238, s[72:75], s64 offen sc1
    s_cmp_le_u32 s58, 11
    s_addc_u32 s57, 11, 0
    s_cmp_lg_u32 s34, 0
    s_cbranch_scc1 KL_OK12
    s_mov_b32 s41, 0
KL_POLL12:
    s_bitcmp1_b32 s65, s57
    s_cbranch_scc0 KL_OK12
    buffer_load_dword v45, v46, s[72:75], s59 offen sc1
    s_add_u32 s41, s41, 1
    s_waitcnt vmcnt(0)
    v_cmp_ne_u32 vcc, 1, v45
    s_cmp_lt_u32 s41, 0x20000
    s_lshr_b32 s65, vcc_lo, s62
    s_sleep 1
    s_cmp_lt_u32 s41, 0x20000
    s_cbranch_scc1 KL_POLL12
KL_OK12:
    s_waitcnt vmcnt(14)
    s_barrier
    s_cmp_le_u32 s58, 11
    s_addc_u32 s38, 11, 0
    s_xor_b32 s38, s38, s62
    s_mul_i32 s38, s38, 36864
    s_add_u32 m0, s50, 0
    s_mov_b64 exec, s[44:45]
    buffer_load_dwordx4 v44, s[16:19], s38 offen sc1 lds
    s_mov_b64 exec, -1
    buffer_load_dwordx4 v44, s[16:19], s38 offen offset:512 sc1 lds
    buffer_load_dwordx4 v44, s[16:19], s38 offen offset:1536 sc1 lds
    buffer_load_dwordx4 v44, s[16:19], s38 offen offset:2560 sc1 lds
    buffer_load_dwordx4 v44, s[16:19], s38 offen offset:3584 sc1 lds
    s_cmp_le_u32 s58, 11
    s_addc_u32 s37, 11, 0
    s_lshl_b32 s37, s37, 8
    s_add_u32 s37, s37, 128
    s_xor_b32 s37, s37, s60
    s_add_u32 m0, s66, 34816
    s_nop 0
    buffer_load_dwordx4 v40, s[4:7], s37 offen offset:0 lds
    buffer_load_dwordx4 v41, s[4:7], s37 offen offset:1024 lds
    buffer_load_dwordx4 v42, s[4:7], s37 offen offset:2048 lds
    buffer_load_dwordx4 v43, s[4:7], s37 offen offset:3072 lds
    s_waitcnt vmcnt(14)
    s_barrier
    s_cmp_le_u32 s58, 11
    s_addc_u32 s38, 11, 0
    s_xor_b32 s38, s38, s62
    s_mul_i32 s38, s38, 36864
    s_add_u32 s38, s38, 18432
    s_add_u32 m0, s50, 34816
    s_mov_b64 exec, s[44:45]
    buffer_load_dwordx4 v44, s[16:19], s38 offen sc1 lds
    s_mov_b64 exec, -1
    buffer_load_dwordx4 v44, s[16:19], s38 offen offset:512 sc1 lds
    buffer_load_dwordx4 v44, s[16:19], s38 offen offset:1536 sc1 lds
    buffer_load_dwordx4 v44, s[16:19], s38 offen offset:2560 sc1 lds
    buffer_load_dwordx4 v44, s[16:19], s38 offen offset:3584 sc1 lds
    s_cmp_le_u32 s58, 12
    s_addc_u32 s37, 12, 0
    s_lshl_b32 s37, s37, 8
    s_xor_b32 s37, s37, s60
    s_add_u32 m0, s66, 69632
    s_nop 0
    buffer_load_dwordx4 v40, s[4:7], s37 offen offset:0 lds
    buffer_load_dwordx4 v41, s[4:7], s37 offen offset:1024 lds
    buffer_load_dwordx4 v42, s[4:7], s37 offen offset:2048 lds
    buffer_load_dwordx4 v43, s[4:7], s37 offen offset:3072 lds
    s_cmp_le_u32 s58, 12
    s_addc_u32 s57, 12, 0
    s_cmp_lg_u32 s34, 0
    s_cbranch_scc1 KL_OK13
    s_mov_b32 s41, 0
KL_POLL13:
    s_bitcmp1_b32 s65, s57
    s_cbranch_scc0 KL_OK13
    buffer_load_dword v45, v46, s[72:75], s59 offen sc1
    s_add_u32 s41, s41, 1
    s_waitcnt vmcnt(0)
    v_cmp_ne_u32 vcc, 1, v45
    s_cmp_lt_u32 s41, 0x20000
    s_lshr_b32 s65, vcc_lo, s62
    s_sleep 1
    s_cmp_lt_u32 s41, 0x20000
    s_cbranch_scc1 KL_POLL13
KL_OK13:
    s_waitcnt vmcnt(13)
    s_barrier
    s_cmp_le_u32 s58, 12
    s_addc_u32 s38, 12, 0
    s_xor_b32 s38, s38, s62
    s_mul_i32 s38, s38, 36864
    s_add_u32 m0, s50, 69632
    s_mov_b64 exec, s[44:45]
    buffer_load_dwordx4 v44, s[16:19], s38 offen sc1 lds
    s_mov_b64 exec, -1
    buffer_load_dwordx4 v44, s[16:19], s38 offen offset:512 sc1 lds
    buffer_load_dwordx4 v44, s[16:19], s38 offen offset:1536 sc1 lds
    buffer_load_dwordx4 v44, s[16:19], s38 offen offset:2560 sc1 lds
    buffer_load_dwordx4 v44, s[16:19], s38 offen offset:3584 sc1 lds
    s_cmp_le_u32 s58, 12
    s_addc_u32 s37, 12, 0
    s_lshl_b32 s37, s37, 8
    s_add_u32 s37, s37, 128
    s_xor_b32 s37, s37, s60
    s_add_u32 m0, s66, 104448
    s_nop 0
    buffer_load_dwordx4 v40, s[4:7], s37 offen offset:0 lds
    buffer_load_dwordx4 v41, s[4:7], s37 offen offset:1024 lds
    buffer_load_dwordx4 v42, s[4:7], s37 offen offset:2048 lds
    buffer_load_dwordx4 v43, s[4:7], s37 offen offset:3072 lds
    s_waitcnt vmcnt(13)
    s_barrier
    s_cmp_le_u32 s58, 12
    s_addc_u32 s38, 12, 0
    s_xor_b32 s38, s38, s62
    s_mul_i32 s38, s38, 36864
    s_add_u32 s38, s38, 18432
    s_add_u32 m0, s50, 104448
    s_mov_b64 exec, s[44:45]
    buffer_load_dwordx4 v44, s[16:19], s38 offen sc1 lds
    s_mov_b64 exec, -1
    buffer_load_dwordx4 v44, s[16:19], s38 offen offset:512 sc1 lds
    buffer_load_dwordx4 v44, s[16:19], s38 offen offset:1536 sc1 lds
    buffer_load_dwordx4 v44, s[16:19], s38 offen offset:2560 sc1 lds
    buffer_load_dwordx4 v44, s[16:19], s38 offen offset:3584 sc1 lds
    s_cmp_le_u32 s58, 13
    s_addc_u32 s37, 13, 0
    s_lshl_b32 s37, s37, 8
    s_xor_b32 s37, s37, s60
    s_add_u32 m0, s66, 0
    s_nop 0
    buffer_load_dwordx4 v40, s[4:7], s37 offen offset:0 lds
    buffer_load_dwordx4 v41, s[4:7], s37 offen offset:1024 lds
    buffer_load_dwordx4 v42, s[4:7], s37 offen offset:2048 lds
    buffer_load_dwordx4 v43, s[4:7], s37 offen offset:3072 lds
    v_cmp_ne_u32 vcc, 1, v236
    s_mov_b32 s41, 0
KO_POLL:
    s_cmp_eq_u32 vcc_lo, 0
    s_cbranch_scc1 KO_OK
    s_sleep 8
    buffer_load_dword v236, v238, s[72:75], s64 offen sc1
    s_add_u32 s41, s41, 1
    s_waitcnt vmcnt(0)
    v_cmp_ne_u32 vcc, 1, v236
    s_cmp_lt_u32 s41, 0x20000
    s_cbranch_scc1 KO_POLL
KO_OK:
    s_cmp_le_u32 s58, 13
    s_addc_u32 s57, 13, 0
    s_cmp_lg_u32 s34, 0
    s_cbranch_scc1 KL_OK14
    s_mov_b32 s41, 0
KL_POLL14:
    s_bitcmp1_b32 s65, s57
    s_cbranch_scc0 KL_OK14
    buffer_load_dword v45, v46, s[72:75], s59 offen sc1
    s_add_u32 s41, s41, 1
    s_waitcnt vmcnt(0)
    v_cmp_ne_u32 vcc, 1, v45
    s_cmp_lt_u32 s41, 0x20000
    s_lshr_b32 s65, vcc_lo, s62
    s_sleep 1
    s_cmp_lt_u32 s41, 0x20000
    s_cbranch_scc1 KL_POLL14
KL_OK14:
    s_waitcnt vmcnt(13)
    s_barrier
    s_cmp_le_u32 s58, 13
    s_addc_u32 s38, 13, 0
    s_xor_b32 s38, s38, s62
    s_mul_i32 s38, s38, 36864
    s_add_u32 m0, s50, 0
    s_mov_b64 exec, s[44:45]
    buffer_load_dwordx4 v44, s[16:19], s38 offen sc1 lds
    s_mov_b64 exec, -1
    buffer_load_dwordx4 v44, s[16:19], s38 offen offset:512 sc1 lds
    buffer_load_dwordx4 v44, s[16:19], s38 offen offset:1536 sc1 lds
    buffer_load_dwordx4 v44, s[16:19], s38 offen offset:2560 sc1 lds
    buffer_load_dwordx4 v44, s[16:19], s38 offen offset:3584 sc1 lds
    s_cmp_le_u32 s58, 13
    s_addc_u32 s37, 13, 0
    s_lshl_b32 s37, s37, 8
    s_add_u32 s37, s37, 128
    s_xor_b32 s37, s37, s60
    s_add_u32 m0, s66, 34816
    s_nop 0
    buffer_load_dwordx4 v40, s[4:7], s37 offen offset:0 lds
    buffer_load_dwordx4 v41, s[4:7], s37 offen offset:1024 lds
    buffer_load_dwordx4 v42, s[4:7], s37 offen offset:2048 lds
    buffer_load_dwordx4 v43, s[4:7], s37 offen offset:3072 lds
    s_waitcnt vmcnt(13)
    s_barrier
    s_cmp_le_u32 s58, 13
    s_addc_u32 s38, 13, 0
    s_xor_b32 s38, s38, s62
    s_mul_i32 s38, s38, 36864
    s_add_u32 s38, s38, 18432
    s_add_u32 m0, s50, 34816
    s_mov_b64 exec, s[44:45]
    buffer_load_dwordx4 v44, s[16:19], s38 offen sc1 lds
    s_mov_b64 exec, -1
    buffer_load_dwordx4 v44, s[16:19], s38 offen offset:512 sc1 lds
    buffer_load_dwordx4 v44, s[16:19], s38 offen offset:1536 sc1 lds
    buffer_load_dwordx4 v44, s[16:19], s38 offen offset:2560 sc1 lds
    buffer_load_dwordx4 v44, s[16:19], s38 offen offset:3584 sc1 lds
    s_cmp_le_u32 s58, 14
    s_addc_u32 s37, 14, 0
    s_lshl_b32 s37, s37, 8
    s_xor_b32 s37, s37, s60
    s_add_u32 m0, s66, 69632
    s_nop 0
    buffer_load_dwordx4 v40, s[4:7], s37 offen offset:0 lds
    buffer_load_dwordx4 v41, s[4:7], s37 offen offset:1024 lds
    buffer_load_dwordx4 v42, s[4:7], s37 offen offset:2048 lds
    buffer_load_dwordx4 v43, s[4:7], s37 offen offset:3072 lds
    s_cmp_le_u32 s58, 14
    s_addc_u32 s57, 14, 0
    s_cmp_lg_u32 s34, 0
    s_cbranch_scc1 KL_OK15
    s_mov_b32 s41, 0
KL_POLL15:
    s_bitcmp1_b32 s65, s57
    s_cbranch_scc0 KL_OK15
    buffer_load_dword v45, v46, s[72:75], s59 offen sc1
    s_add_u32 s41, s41, 1
    s_waitcnt vmcnt(0)
    v_cmp_ne_u32 vcc, 1, v45
    s_cmp_lt_u32 s41, 0x20000
    s_lshr_b32 s65, vcc_lo, s62
    s_sleep 1
    s_cmp_lt_u32 s41, 0x20000
    s_cbranch_scc1 KL_POLL15
KL_OK15:
    s_waitcnt vmcnt(13)
    s_barrier
    s_cmp_le_u32 s58, 14
    s_addc_u32 s38, 14, 0
    s_xor_b32 s38, s38, s62
    s_mul_i32 s38, s38, 36864
    s_add_u32 m0, s50, 69632
    s_mov_b64 exec, s[44:45]
    buffer_load_dwordx4 v44, s[16:19], s38 offen sc1 lds
    s_mov_b64 exec, -1
    buffer_load_dwordx4 v44, s[16:19], s38 offen offset:512 sc1 lds
    buffer_load_dwordx4 v44, s[16:19], s38 offen offset:1536 sc1 lds
    buffer_load_dwordx4 v44, s[16:19], s38 offen offset:2560 sc1 lds
    buffer_load_dwordx4 v44, s[16:19], s38 offen offset:3584 sc1 lds
    s_cmp_le_u32 s58, 14
    s_addc_u32 s37, 14, 0
    s_lshl_b32 s37, s37, 8
    s_add_u32 s37, s37, 128
    s_xor_b32 s37, s37, s60
    s_add_u32 m0, s66, 104448
    s_nop 0
    buffer_load_dwordx4 v40, s[4:7], s37 offen offset:0 lds
    buffer_load_dwordx4 v41, s[4:7], s37 offen offset:1024 lds
    buffer_load_dwordx4 v42, s[4:7], s37 offen offset:2048 lds
    buffer_load_dwordx4 v43, s[4:7], s37 offen offset:3072 lds
    s_waitcnt vmcnt(13)
    s_barrier
    s_cmp_le_u32 s58, 14
    s_addc_u32 s38, 14, 0
    s_xor_b32 s38, s38, s62
    s_mul_i32 s38, s38, 36864
    s_add_u32 s38, s38, 18432
    s_add_u32 m0, s50, 104448
    s_mov_b64 exec, s[44:45]
    buffer_load_dwordx4 v44, s[16:19], s38 offen sc1 lds
    s_mov_b64 exec, -1
    buffer_load_dwordx4 v44, s[16:19], s38 offen offset:512 sc1 lds
    buffer_load_dwordx4 v44, s[16:19], s38 offen offset:1536 sc1 lds
    buffer_load_dwordx4 v44, s[16:19], s38 offen offset:2560 sc1 lds
    buffer_load_dwordx4 v44, s[16:19], s38 offen offset:3584 sc1 lds
    s_movk_i32 s59, 256
    s_cmp_lt_u32 s2, 234
    s_cbranch_scc1 K3_START
    s_waitcnt vmcnt(0)
    s_barrier
    s_barrier
    s_barrier
    s_endpgm
K3_START:
    s_load_dwordx2 s[4:5], s[0:1], 0
    s_load_dwordx2 s[6:7], s[0:1], 16
    s_load_dwordx4 s[64:67], s[0:1], 56
    s_and_b32 s43, s2, 7
    s_lshr_b32 s46, s2, 3
    s_mul_i32 s47, s43, 29
    s_min_u32 s43, s43, 2
    s_add_u32 s47, s47, s43
    s_add_u32 s47, s47, s46
    s_mul_hi_u32 s32, s47, 0x1c71c71d
    s_mul_i32 s46, s32, 9
    s_sub_u32 s33, s47, s46
    s_mul_i32 s46, s32, 460800
    v_lshlrev_b32 v3, 4, v2
    v_add_u32 v200, s46, v3
    v_add_u32 v201, 92160, v200
    v_add_u32 v202, 184320, v200
    v_add_u32 v203, 276480, v200
    v_add_u32 v204, 368640, v200
    v_lshrrev_b32 v3, 3, v2
    v_and_b32 v4, 2, v3
    v_and_b32 v5, 7, v2
    v_xor_b32 v5, v5, v4
    v_lshlrev_b32 v5, 4, v5
    v_mul_u32_u24 v3, 1152, v3
    s_lshl_b32 s46, s33, 7
    v_add3_u32 v205, v3, v5, s46
    v_xor_b32 v5, 64, v5
    v_add3_u32 v6, v3, v5, s46
    v_add_u32 v206, 8192, v6
    v_add_u32 v207, 16384, v205
    v_add_u32 v208, 24576, v6
    s_lshl_b32 s49, s34, 12
    s_mul_i32 s36, s34, 36864
    s_lshl_b32 s38, s34, 10
    s_waitcnt lgkmcnt(0)
    s_mul_i32 s57, s33, 0
    s_mov_b32 s58, s57
    s_add_u32 s16, s8, 0x1200000
    s_addc_u32 s17, s9, 0
    s_mov_b32 s18, 0xb40000
    s_mov_b32 s19, 0x00020000
    s_mov_b32 s20, s6
    s_mov_b32 s21, s7
    s_mov_b32 s22, 0xa2000
    s_mov_b32 s23, 0x00020000
    s_mov_b32 s12, s64
    s_mov_b32 s13, s65
    s_mov_b32 s14, 0x288000
    s_mov_b32 s15, 0x00020000
    s_add_u32 s37, s36, 0
    s_add_u32 m0, s49, 0
    s_nop 0
    buffer_load_dwordx4 v205, s[20:23], s37 offen offset:0 lds
    buffer_load_dwordx4 v206, s[20:23], s37 offen offset:1024 lds
    buffer_load_dwordx4 v207, s[20:23], s37 offen offset:2048 lds
    buffer_load_dwordx4 v208, s[20:23], s37 offen offset:3072 lds
    s_add_u32 s37, s36, 147456
    s_add_u32 m0, s49, 16384
    s_nop 0
    buffer_load_dwordx4 v205, s[20:23], s37 offen offset:0 lds
    buffer_load_dwordx4 v206, s[20:23], s37 offen offset:1024 lds
    buffer_load_dwordx4 v207, s[20:23], s37 offen offset:2048 lds
    buffer_load_dwordx4 v208, s[20:23], s37 offen offset:3072 lds
    v_lshrrev_b32 v3, 4, v2
    v_bfe_u32 v4, v2, 2, 2
    v_and_b32 v5, 3, v2
    v_lshl_add_u32 v6, v3, 3, v4
    v_lshlrev_b32 v6, 7, v6
    v_add_u32 v6, s49, v6
    v_and_b32 v7, 1, v5
    v_lshl_add_u32 v6, v7, 3, v6
    v_lshrrev_b32 v5, 1, v5
    v_lshl_add_u32 v6, v5, 4, v6
    v_and_b32 v4, 2, v4
    v_and_b32 v3, 1, v3
    v_lshl_or_b32 v4, v3, 2, v4
    v_lshlrev_b32 v4, 4, v4
    v_xor_b32 v5, 0, v4
    v_add_u32 v209, v5, v6
    v_add_u32 v232, 65536, v209
    v_add_u32 v240, 131072, v209
    v_xor_b32 v5, 32, v4
    v_add_u32 v210, v5, v6
    v_add_u32 v233, 65536, v210
    v_add_u32 v241, 131072, v210
    v_xor_b32 v5, 64, v4
    v_add_u32 v211, v5, v6
    v_add_u32 v234, 65536, v211
    v_add_u32 v242, 131072, v211
    v_xor_b32 v5, 96, v4
    v_add_u32 v212, v5, v6
    v_add_u32 v235, 65536, v212
    v_add_u32 v243, 131072, v212
    s_mov_b32 s24, s4
    s_mov_b32 s25, s5
    s_mov_b32 s26, 0x240000
    s_mov_b32 s27, 0x00020000
    s_mov_b32 s28, s66
    s_mov_b32 s29, s67
    s_mov_b32 s30, 0x240000
    s_mov_b32 s31, 0x00020000
    s_lshl_b32 s46, s34, 6
    v_add_u32 v0, s46, v2
    v_lshrrev_b32 v3, 3, v0
    s_mul_i32 s46, s32, 80
    v_add_u32 v4, s46, v3
    v_mul_u32_u24 v4, 1152, v4
    v_and_b32 v5, 7, v0
    v_lshlrev_b32 v6, 4, v5
    s_lshl_b32 s47, s33, 7
    v_add3_u32 v213, v4, v6, s47
    v_mul_u32_u24 v3, 272, v3
    v_lshlrev_b32 v5, 5, v5
    v_add_u32 v214, v3, v5
    s_add_u32 s47, s46, 79
    s_min_u32 s47, s47, 2047
    s_lshr_b32 s46, s46, 7
    s_lshr_b32 s47, s47, 7
    s_lshl_b32 s46, s46, 8
    s_lshl_b32 s47, s47, 8
    v_mov_b32 v228, s46
    v_mov_b32 v229, s47
    v_mov_b32 v230, 159744
    s_mov_b32 s52, 0
    s_mov_b32 s53, 36864
    s_mov_b32 s54, 73728
    s_waitcnt vmcnt(17)
    s_barrier
    s_add_u32 s37, s36, 294912
    s_add_u32 m0, s49, 32768
    s_nop 0
    buffer_load_dwordx4 v205, s[20:23], s37 offen offset:0 lds
    buffer_load_dwordx4 v206, s[20:23], s37 offen offset:1024 lds
    buffer_load_dwordx4 v207, s[20:23], s37 offen offset:2048 lds
    buffer_load_dwordx4 v208, s[20:23], s37 offen offset:3072 lds
    s_add_u32 s37, s36, 442368
    s_add_u32 m0, s49, 49152
    s_nop 0
    buffer_load_dwordx4 v205, s[20:23], s37 offen offset:0 lds
    buffer_load_dwordx4 v206, s[20:23], s37 offen offset:1024 lds
    buffer_load_dwordx4 v207, s[20:23], s37 offen offset:2048 lds
    buffer_load_dwordx4 v208, s[20:23], s37 offen offset:3072 lds
    s_add_u32 s39, s38, 0
    buffer_load_dwordx4 v[88:91], v200, s[16:19], s39 offen sc1
    buffer_load_dwordx4 v[92:95], v201, s[16:19], s39 offen sc1
    buffer_load_dwordx4 v[96:99], v202, s[16:19], s39 offen sc1
    buffer_load_dwordx4 v[100:103], v203, s[16:19], s39 offen sc1
    buffer_load_dwordx4 v[104:107], v204, s[16:19], s39 offen sc1
    s_waitcnt vmcnt(21)
    s_barrier
    s_add_u32 s39, s38, 4096
    buffer_load_dwordx4 v[108:111], v200, s[16:19], s39 offen sc1
    buffer_load_dwordx4 v[112:115], v201, s[16:19], s39 offen sc1
    buffer_load_dwordx4 v[116:119], v202, s[16:19], s39 offen sc1
    buffer_load_dwordx4 v[120:123], v203, s[16:19], s39 offen sc1
    buffer_load_dwordx4 v[124:127], v204, s[16:19], s39 offen sc1
    s_cmp_lt_u32 s34, 2
    s_cselect_b32 s76, s20, s12
    s_cselect_b32 s77, s21, s13
    s_cselect_b32 s78, s22, s14
    s_mov_b32 s79, 0x00020000
    s_cselect_b32 s37, 663552, 0
    s_add_u32 s37, s37, s36
    s_sub_u32 s37, s37, 73728
    s_add_u32 m0, s49, 65536
    s_nop 0
    buffer_load_dwordx4 v205, s[76:79], s37 offen offset:0 lds
    buffer_load_dwordx4 v206, s[76:79], s37 offen offset:1024 lds
    buffer_load_dwordx4 v207, s[76:79], s37 offen offset:2048 lds
    buffer_load_dwordx4 v208, s[76:79], s37 offen offset:3072 lds
    s_barrier
    s_waitcnt vmcnt(26)
    ds_read_b64_tr_b16 v[168:169], v209 offset:0
    ds_read_b64_tr_b16 v[170:171], v209 offset:512
    ds_read_b64_tr_b16 v[172:173], v210 offset:0
    ds_read_b64_tr_b16 v[174:175], v210 offset:512
    ds_read_b64_tr_b16 v[176:177], v211 offset:0
    ds_read_b64_tr_b16 v[178:179], v211 offset:512
    ds_read_b64_tr_b16 v[180:181], v212 offset:0
    ds_read_b64_tr_b16 v[182:183], v212 offset:512
    s_waitcnt vmcnt(13) lgkmcnt(6)
    v_mfma_f32_16x16x32_bf16 v[8:11], v[168:171], v[88:91], 0
    s_waitcnt vmcnt(12)
    v_mfma_f32_16x16x32_bf16 v[12:15], v[168:171], v[92:95], 0
    s_waitcnt vmcnt(11)
    v_mfma_f32_16x16x32_bf16 v[16:19], v[168:171], v[96:99], 0
    s_waitcnt vmcnt(10)
    v_mfma_f32_16x16x32_bf16 v[20:23], v[168:171], v[100:103], 0
    ds_read_b64_tr_b16 v[184:185], v209 offset:16384
    s_waitcnt vmcnt(9)
    v_mfma_f32_16x16x32_bf16 v[24:27], v[168:171], v[104:107], 0
    ds_read_b64_tr_b16 v[186:187], v209 offset:16896
    s_waitcnt lgkmcnt(6)
    v_mfma_f32_16x16x32_bf16 v[28:31], v[172:175], v[88:91], 0
    v_mfma_f32_16x16x32_bf16 v[32:35], v[172:175], v[92:95], 0
    ds_read_b64_tr_b16 v[188:189], v210 offset:16384
    v_mfma_f32_16x16x32_bf16 v[36:39], v[172:175], v[96:99], 0
    ds_read_b64_tr_b16 v[190:191], v210 offset:16896
    v_mfma_f32_16x16x32_bf16 v[40:43], v[172:175], v[100:103], 0
    v_mfma_f32_16x16x32_bf16 v[44:47], v[172:175], v[104:107], 0
    ds_read_b64_tr_b16 v[192:193], v211 offset:16384
    s_waitcnt lgkmcnt(7)
    v_mfma_f32_16x16x32_bf16 v[48:51], v[176:179], v[88:91], 0
    ds_read_b64_tr_b16 v[194:195], v211 offset:16896
    v_mfma_f32_16x16x32_bf16 v[52:55], v[176:179], v[92:95], 0
    v_mfma_f32_16x16x32_bf16 v[56:59], v[176:179], v[96:99], 0
    ds_read_b64_tr_b16 v[196:197], v212 offset:16384
    v_mfma_f32_16x16x32_bf16 v[60:63], v[176:179], v[100:103], 0
    ds_read_b64_tr_b16 v[198:199], v212 offset:16896
    v_mfma_f32_16x16x32_bf16 v[64:67], v[176:179], v[104:107], 0
    s_waitcnt lgkmcnt(8)
    v_mfma_f32_16x16x32_bf16 v[68:71], v[180:183], v[88:91], 0
    v_mfma_f32_16x16x32_bf16 v[72:75], v[180:183], v[92:95], 0
    v_mfma_f32_16x16x32_bf16 v[76:79], v[180:183], v[96:99], 0
    v_mfma_f32_16x16x32_bf16 v[80:83], v[180:183], v[100:103], 0
    v_mfma_f32_16x16x32_bf16 v[84:87], v[180:183], v[104:107], 0
    s_mov_b32 s41, 1
K3_OWN:
    ds_read_b32 v236, v230
    s_waitcnt lgkmcnt(0)
    s_add_u32 s41, s41, 1
    v_readfirstlane_b32 s42, v236
    s_nop 0
    s_cmp_ge_u32 s42, 4
    s_cbranch_scc1 K3_OWNED
    s_sleep 2
    s_cmp_lt_u32 s41, 0x400000
    s_cbranch_scc1 K3_OWN
K3_OWNED:
    s_add_u32 s39, s38, 8192
    buffer_load_dwordx4 v[128:131], v200, s[16:19], s39 offen sc1
    buffer_load_dwordx4 v[132:135], v201, s[16:19], s39 offen sc1
    buffer_load_dwordx4 v[136:139], v202, s[16:19], s39 offen sc1
    buffer_load_dwordx4 v[140:143], v203, s[16:19], s39 offen sc1
    buffer_load_dwordx4 v[144:147], v204, s[16:19], s39 offen sc1
    s_add_u32 s39, s38, 12288
    buffer_load_dwordx4 v[148:151], v200, s[16:19], s39 offen sc1
    buffer_load_dwordx4 v[152:155], v201, s[16:19], s39 offen sc1
    buffer_load_dwordx4 v[156:159], v202, s[16:19], s39 offen sc1
    buffer_load_dwordx4 v[160:163], v203, s[16:19], s39 offen sc1
    buffer_load_dwordx4 v[164:167], v204, s[16:19], s39 offen sc1
    s_add_u32 s37, s36, 73728
    s_add_u32 m0, s49, 81920
    s_nop 0
    buffer_load_dwordx4 v205, s[12:15], s37 offen offset:0 lds
    buffer_load_dwordx4 v206, s[12:15], s37 offen offset:1024 lds
    buffer_load_dwordx4 v207, s[12:15], s37 offen offset:2048 lds
    buffer_load_dwordx4 v208, s[12:15], s37 offen offset:3072 lds
    s_add_u32 s37, s36, 221184
    s_add_u32 m0, s49, 98304
    s_nop 0
    buffer_load_dwordx4 v205, s[12:15], s37 offen offset:0 lds
    buffer_load_dwordx4 v206, s[12:15], s37 offen offset:1024 lds
    buffer_load_dwordx4 v207, s[12:15], s37 offen offset:2048 lds
    buffer_load_dwordx4 v208, s[12:15], s37 offen offset:3072 lds
    s_add_u32 s37, s36, 368640
    s_add_u32 m0, s49, 114688
    s_nop 0
    buffer_load_dwordx4 v205, s[12:15], s37 offen offset:0 lds
    buffer_load_dwordx4 v206, s[12:15], s37 offen offset:1024 lds
    buffer_load_dwordx4 v207, s[12:15], s37 offen offset:2048 lds
    buffer_load_dwordx4 v208, s[12:15], s37 offen offset:3072 lds
    s_add_u32 s37, s36, 516096
    s_add_u32 m0, s49, 131072
    s_nop 0
    buffer_load_dwordx4 v205, s[12:15], s37 offen offset:0 lds
    buffer_load_dwordx4 v206, s[12:15], s37 offen offset:1024 lds
    buffer_load_dwordx4 v207, s[12:15], s37 offen offset:2048 lds
    buffer_load_dwordx4 v208, s[12:15], s37 offen offset:3072 lds
    s_add_u32 s37, s36, 663552
    s_add_u32 m0, s49, 0
    s_nop 0
    buffer_load_dwordx4 v205, s[12:15], s37 offen offset:0 lds
    buffer_load_dwordx4 v206, s[12:15], s37 offen offset:1024 lds
    buffer_load_dwordx4 v207, s[12:15], s37 offen offset:2048 lds
    buffer_load_dwordx4 v208, s[12:15], s37 offen offset:3072 lds
    s_waitcnt vmcnt(38) lgkmcnt(6)
    v_mfma_f32_16x16x32_bf16 v[8:11], v[184:187], v[108:111], v[8:11]
    s_waitcnt vmcnt(37)
    v_mfma_f32_16x16x32_bf16 v[12:15], v[184:187], v[112:115], v[12:15]
    s_waitcnt vmcnt(36)
    v_mfma_f32_16x16x32_bf16 v[16:19], v[184:187], v[116:119], v[16:19]
    s_waitcnt vmcnt(35)
    v_mfma_f32_16x16x32_bf16 v[20:23], v[184:187], v[120:123], v[20:23]
    ds_read_b64_tr_b16 v[168:169], v209 offset:32768
    s_waitcnt vmcnt(34)
    v_mfma_f32_16x16x32_bf16 v[24:27], v[184:187], v[124:127], v[24:27]
    ds_read_b64_tr_b16 v[170:171], v209 offset:33280
    s_waitcnt lgkmcnt(6)
    v_mfma_f32_16x16x32_bf16 v[28:31], v[188:191], v[108:111], v[28:31]
    v_mfma_f32_16x16x32_bf16 v[32:35], v[188:191], v[112:115], v[32:35]
    ds_read_b64_tr_b16 v[172:173], v210 offset:32768
    v_mfma_f32_16x16x32_bf16 v[36:39], v[188:191], v[116:119], v[36:39]
    ds_read_b64_tr_b16 v[174:175], v210 offset:33280
    v_mfma_f32_16x16x32_bf16 v[40:43], v[188:191], v[120:123], v[40:43]
    v_mfma_f32_16x16x32_bf16 v[44:47], v[188:191], v[124:127], v[44:47]
    ds_read_b64_tr_b16 v[176:177], v211 offset:32768
    s_waitcnt lgkmcnt(7)
    v_mfma_f32_16x16x32_bf16 v[48:51], v[192:195], v[108:111], v[48:51]
    ds_read_b64_tr_b16 v[178:179], v211 offset:33280
    v_mfma_f32_16x16x32_bf16 v[52:55], v[192:195], v[112:115], v[52:55]
    v_mfma_f32_16x16x32_bf16 v[56:59], v[192:195], v[116:119], v[56:59]
    ds_read_b64_tr_b16 v[180:181], v212 offset:32768
    v_mfma_f32_16x16x32_bf16 v[60:63], v[192:195], v[120:123], v[60:63]
    ds_read_b64_tr_b16 v[182:183], v212 offset:33280
    v_mfma_f32_16x16x32_bf16 v[64:67], v[192:195], v[124:127], v[64:67]
    s_waitcnt lgkmcnt(8)
    v_mfma_f32_16x16x32_bf16 v[68:71], v[196:199], v[108:111], v[68:71]
    v_mfma_f32_16x16x32_bf16 v[72:75], v[196:199], v[112:115], v[72:75]
    v_mfma_f32_16x16x32_bf16 v[76:79], v[196:199], v[116:119], v[76:79]
    v_mfma_f32_16x16x32_bf16 v[80:83], v[196:199], v[120:123], v[80:83]
    v_mfma_f32_16x16x32_bf16 v[84:87], v[196:199], v[124:127], v[84:87]
    s_add_u32 s37, s36, 811008
    s_add_u32 m0, s49, 16384
    s_nop 0
    buffer_load_dwordx4 v205, s[12:15], s37 offen offset:0 lds
    buffer_load_dwordx4 v206, s[12:15], s37 offen offset:1024 lds
    buffer_load_dwordx4 v207, s[12:15], s37 offen offset:2048 lds
    buffer_load_dwordx4 v208, s[12:15], s37 offen offset:3072 lds
    s_waitcnt vmcnt(33) lgkmcnt(6)
    v_mfma_f32_16x16x32_bf16 v[8:11], v[168:171], v[128:131], v[8:11]
    s_waitcnt vmcnt(32)
    v_mfma_f32_16x16x32_bf16 v[12:15], v[168:171], v[132:135], v[12:15]
    s_waitcnt vmcnt(31)
    v_mfma_f32_16x16x32_bf16 v[16:19], v[168:171], v[136:139], v[16:19]
    s_waitcnt vmcnt(30)
    v_mfma_f32_16x16x32_bf16 v[20:23], v[168:171], v[140:143], v[20:23]
    ds_read_b64_tr_b16 v[184:185], v209 offset:49152
    s_waitcnt vmcnt(29)
    v_mfma_f32_16x16x32_bf16 v[24:27], v[168:171], v[144:147], v[24:27]
    ds_read_b64_tr_b16 v[186:187], v209 offset:49664
    s_waitcnt lgkmcnt(6)
    v_mfma_f32_16x16x32_bf16 v[28:31], v[172:175], v[128:131], v[28:31]
    v_mfma_f32_16x16x32_bf16 v[32:35], v[172:175], v[132:135], v[32:35]
    ds_read_b64_tr_b16 v[188:189], v210 offset:49152
    v_mfma_f32_16x16x32_bf16 v[36:39], v[172:175], v[136:139], v[36:39]
    ds_read_b64_tr_b16 v[190:191], v210 offset:49664
    v_mfma_f32_16x16x32_bf16 v[40:43], v[172:175], v[140:143], v[40:43]
    v_mfma_f32_16x16x32_bf16 v[44:47], v[172:175], v[144:147], v[44:47]
    ds_read_b64_tr_b16 v[192:193], v211 offset:49152
    s_waitcnt lgkmcnt(7)
    v_mfma_f32_16x16x32_bf16 v[48:51], v[176:179], v[128:131], v[48:51]
    ds_read_b64_tr_b16 v[194:195], v211 offset:49664
    v_mfma_f32_16x16x32_bf16 v[52:55], v[176:179], v[132:135], v[52:55]
    v_mfma_f32_16x16x32_bf16 v[56:59], v[176:179], v[136:139], v[56:59]
    ds_read_b64_tr_b16 v[196:197], v212 offset:49152
    v_mfma_f32_16x16x32_bf16 v[60:63], v[176:179], v[140:143], v[60:63]
    ds_read_b64_tr_b16 v[198:199], v212 offset:49664
    v_mfma_f32_16x16x32_bf16 v[64:67], v[176:179], v[144:147], v[64:67]
    s_waitcnt lgkmcnt(8)
    v_mfma_f32_16x16x32_bf16 v[68:71], v[180:183], v[128:131], v[68:71]
    v_mfma_f32_16x16x32_bf16 v[72:75], v[180:183], v[132:135], v[72:75]
    v_mfma_f32_16x16x32_bf16 v[76:79], v[180:183], v[136:139], v[76:79]
    v_mfma_f32_16x16x32_bf16 v[80:83], v[180:183], v[140:143], v[80:83]
    v_mfma_f32_16x16x32_bf16 v[84:87], v[180:183], v[144:147], v[84:87]
    s_add_u32 s37, s36, 958464
    s_add_u32 m0, s49, 32768
    s_nop 0
    buffer_load_dwordx4 v205, s[12:15], s37 offen offset:0 lds
    buffer_load_dwordx4 v206, s[12:15], s37 offen offset:1024 lds
    buffer_load_dwordx4 v207, s[12:15], s37 offen offset:2048 lds
    buffer_load_dwordx4 v208, s[12:15], s37 offen offset:3072 lds
    s_waitcnt vmcnt(32) lgkmcnt(6)
    v_mfma_f32_16x16x32_bf16 v[8:11], v[184:187], v[148:151], v[8:11]
    s_waitcnt vmcnt(31)
    v_mfma_f32_16x16x32_bf16 v[12:15], v[184:187], v[152:155], v[12:15]
    s_waitcnt vmcnt(30)
    v_mfma_f32_16x16x32_bf16 v[16:19], v[184:187], v[156:159], v[16:19]
    s_waitcnt vmcnt(29)
    v_mfma_f32_16x16x32_bf16 v[20:23], v[184:187], v[160:163], v[20:23]
    ds_read_b64_tr_b16 v[168:169], v232 offset:0
    s_waitcnt vmcnt(28)
    v_mfma_f32_16x16x32_bf16 v[24:27], v[184:187], v[164:167], v[24:27]
    ds_read_b64_tr_b16 v[170:171], v232 offset:512
    s_waitcnt lgkmcnt(6)
    v_mfma_f32_16x16x32_bf16 v[28:31], v[188:191], v[148:151], v[28:31]
    v_mfma_f32_16x16x32_bf16 v[32:35], v[188:191], v[152:155], v[32:35]
    ds_read_b64_tr_b16 v[172:173], v233 offset:0
    v_mfma_f32_16x16x32_bf16 v[36:39], v[188:191], v[156:159], v[36:39]
    ds_read_b64_tr_b16 v[174:175], v233 offset:512
    v_mfma_f32_16x16x32_bf16 v[40:43], v[188:191], v[160:163], v[40:43]
    v_mfma_f32_16x16x32_bf16 v[44:47], v[188:191], v[164:167], v[44:47]
    ds_read_b64_tr_b16 v[176:177], v234 offset:0
    s_waitcnt lgkmcnt(7)
    v_mfma_f32_16x16x32_bf16 v[48:51], v[192:195], v[148:151], v[48:51]
    ds_read_b64_tr_b16 v[178:179], v234 offset:512
    v_mfma_f32_16x16x32_bf16 v[52:55], v[192:195], v[152:155], v[52:55]
    v_mfma_f32_16x16x32_bf16 v[56:59], v[192:195], v[156:159], v[56:59]
    ds_read_b64_tr_b16 v[180:181], v235 offset:0
    v_mfma_f32_16x16x32_bf16 v[60:63], v[192:195], v[160:163], v[60:63]
    ds_read_b64_tr_b16 v[182:183], v235 offset:512
    v_mfma_f32_16x16x32_bf16 v[64:67], v[192:195], v[164:167], v[64:67]
    s_waitcnt lgkmcnt(8)
    v_mfma_f32_16x16x32_bf16 v[68:71], v[196:199], v[148:151], v[68:71]
    v_mfma_f32_16x16x32_bf16 v[72:75], v[196:199], v[152:155], v[72:75]
    v_mfma_f32_16x16x32_bf16 v[76:79], v[196:199], v[156:159], v[76:79]
    v_mfma_f32_16x16x32_bf16 v[80:83], v[196:199], v[160:163], v[80:83]
    v_mfma_f32_16x16x32_bf16 v[84:87], v[196:199], v[164:167], v[84:87]
    s_add_u32 s37, s36, 1105920
    s_add_u32 m0, s49, 49152
    s_nop 0
    buffer_load_dwordx4 v205, s[12:15], s37 offen offset:0 lds
    buffer_load_dwordx4 v206, s[12:15], s37 offen offset:1024 lds
    buffer_load_dwordx4 v207, s[12:15], s37 offen offset:2048 lds
    buffer_load_dwordx4 v208, s[12:15], s37 offen offset:3072 lds
    s_mov_b32 s41, 0
    s_cmp_lg_u32 s34, 0
    s_cbranch_scc1 K3_WAITL
K3_POLL:
    buffer_load_dword v236, v238, s[72:75], s59 offen sc1
    s_waitcnt vmcnt(0)
    v_cmp_ne_u32 vcc, 1, v236
    s_add_u32 s41, s41, 1
    s_cmp_eq_u32 vcc_lo, 0
    s_cbranch_scc1 K3_SET
    s_sleep 12
    s_cmp_lt_u32 s41, 0x20000
    s_cbranch_scc1 K3_POLL
K3_SET:
    v_mov_b32 v236, 1
    ds_write_b32 v230, v236 offset:4
    s_branch K3_GO
K3_WAITL:
    ds_read_b32 v236, v230 offset:4
    s_waitcnt lgkmcnt(0)
    s_add_u32 s41, s41, 1
    v_readfirstlane_b32 s42, v236
    s_nop 0
    s_cmp_lg_u32 s42, 0
    s_cbranch_scc1 K3_GO
    s_sleep 1
    s_cmp_lt_u32 s41, 0x400000
    s_cbranch_scc1 K3_WAITL
K3_GO:
    s_add_u32 s39, s38, 16384
    buffer_load_dwordx4 v[88:91], v200, s[16:19], s39 offen sc1
    buffer_load_dwordx4 v[92:95], v201, s[16:19], s39 offen sc1
    buffer_load_dwordx4 v[96:99], v202, s[16:19], s39 offen sc1
    buffer_load_dwordx4 v[100:103], v203, s[16:19], s39 offen sc1
    buffer_load_dwordx4 v[104:107], v204, s[16:19], s39 offen sc1
    s_add_u32 s39, s38, 20480
    buffer_load_dwordx4 v[108:111], v200, s[16:19], s39 offen sc1
    buffer_load_dwordx4 v[112:115], v201, s[16:19], s39 offen sc1
    buffer_load_dwordx4 v[116:119], v202, s[16:19], s39 offen sc1
    buffer_load_dwordx4 v[120:123], v203, s[16:19], s39 offen sc1
    buffer_load_dwordx4 v[124:127], v204, s[16:19], s39 offen sc1
    s_add_u32 s39, s38, 24576
    buffer_load_dwordx4 v[128:131], v200, s[16:19], s39 offen sc1
    buffer_load_dwordx4 v[132:135], v201, s[16:19], s39 offen sc1
    buffer_load_dwordx4 v[136:139], v202, s[16:19], s39 offen sc1
    buffer_load_dwordx4 v[140:143], v203, s[16:19], s39 offen sc1
    buffer_load_dwordx4 v[144:147], v204, s[16:19], s39 offen sc1
    s_add_u32 s39, s38, 28672
    buffer_load_dwordx4 v[148:151], v200, s[16:19], s39 offen sc1
    buffer_load_dwordx4 v[152:155], v201, s[16:19], s39 offen sc1
    buffer_load_dwordx4 v[156:159], v202, s[16:19], s39 offen sc1
    buffer_load_dwordx4 v[160:163], v203, s[16:19], s39 offen sc1
    buffer_load_dwordx4 v[164:167], v204, s[16:19], s39 offen sc1
    s_waitcnt vmcnt(19) lgkmcnt(6)
    v_mfma_f32_16x16x32_bf16 v[8:11], v[168:171], v[88:91], v[8:11]
    s_waitcnt vmcnt(18)
    v_mfma_f32_16x16x32_bf16 v[12:15], v[168:171], v[92:95], v[12:15]
    s_waitcnt vmcnt(17)
    v_mfma_f32_16x16x32_bf16 v[16:19], v[168:171], v[96:99], v[16:19]
    s_waitcnt vmcnt(16)
    v_mfma_f32_16x16x32_bf16 v[20:23], v[168:171], v[100:103], v[20:23]
    ds_read_b64_tr_b16 v[184:185], v232 offset:16384
    s_waitcnt vmcnt(15)
    v_mfma_f32_16x16x32_bf16 v[24:27], v[168:171], v[104:107], v[24:27]
    ds_read_b64_tr_b16 v[186:187], v232 offset:16896
    s_waitcnt lgkmcnt(6)
    v_mfma_f32_16x16x32_bf16 v[28:31], v[172:175], v[88:91], v[28:31]
    v_mfma_f32_16x16x32_bf16 v[32:35], v[172:175], v[92:95], v[32:35]
    ds_read_b64_tr_b16 v[188:189], v233 offset:16384
    v_mfma_f32_16x16x32_bf16 v[36:39], v[172:175], v[96:99], v[36:39]
    ds_read_b64_tr_b16 v[190:191], v233 offset:16896
    v_mfma_f32_16x16x32_bf16 v[40:43], v[172:175], v[100:103], v[40:43]
    v_mfma_f32_16x16x32_bf16 v[44:47], v[172:175], v[104:107], v[44:47]
    ds_read_b64_tr_b16 v[192:193], v234 offset:16384
    s_waitcnt lgkmcnt(7)
    v_mfma_f32_16x16x32_bf16 v[48:51], v[176:179], v[88:91], v[48:51]
    ds_read_b64_tr_b16 v[194:195], v234 offset:16896
    v_mfma_f32_16x16x32_bf16 v[52:55], v[176:179], v[92:95], v[52:55]
    v_mfma_f32_16x16x32_bf16 v[56:59], v[176:179], v[96:99], v[56:59]
    ds_read_b64_tr_b16 v[196:197], v235 offset:16384
    v_mfma_f32_16x16x32_bf16 v[60:63], v[176:179], v[100:103], v[60:63]
    ds_read_b64_tr_b16 v[198:199], v235 offset:16896
    v_mfma_f32_16x16x32_bf16 v[64:67], v[176:179], v[104:107], v[64:67]
    s_waitcnt lgkmcnt(8)
    v_mfma_f32_16x16x32_bf16 v[68:71], v[180:183], v[88:91], v[68:71]
    v_mfma_f32_16x16x32_bf16 v[72:75], v[180:183], v[92:95], v[72:75]
    v_mfma_f32_16x16x32_bf16 v[76:79], v[180:183], v[96:99], v[76:79]
    v_mfma_f32_16x16x32_bf16 v[80:83], v[180:183], v[100:103], v[80:83]
    v_mfma_f32_16x16x32_bf16 v[84:87], v[180:183], v[104:107], v[84:87]
    s_add_u32 s37, s36, 1253376
    s_add_u32 m0, s49, 65536
    s_nop 0
    buffer_load_dwordx4 v205, s[12:15], s37 offen offset:0 lds
    buffer_load_dwordx4 v206, s[12:15], s37 offen offset:1024 lds
    buffer_load_dwordx4 v207, s[12:15], s37 offen offset:2048 lds
    buffer_load_dwordx4 v208, s[12:15], s37 offen offset:3072 lds
    s_add_u32 s39, s38, 32768
    buffer_load_dwordx4 v[88:91], v200, s[16:19], s39 offen sc1
    buffer_load_dwordx4 v[92:95], v201, s[16:19], s39 offen sc1
    buffer_load_dwordx4 v[96:99], v202, s[16:19], s39 offen sc1
    buffer_load_dwordx4 v[100:103], v203, s[16:19], s39 offen sc1
    buffer_load_dwordx4 v[104:107], v204, s[16:19], s39 offen sc1
    s_waitcnt vmcnt(23) lgkmcnt(6)
    v_mfma_f32_16x16x32_bf16 v[8:11], v[184:187], v[108:111], v[8:11]
    s_waitcnt vmcnt(22)
    v_mfma_f32_16x16x32_bf16 v[12:15], v[184:187], v[112:115], v[12:15]
    s_waitcnt vmcnt(21)
    v_mfma_f32_16x16x32_bf16 v[16:19], v[184:187], v[116:119], v[16:19]
    s_waitcnt vmcnt(20)
    v_mfma_f32_16x16x32_bf16 v[20:23], v[184:187], v[120:123], v[20:23]
    ds_read_b64_tr_b16 v[168:169], v232 offset:32768
    s_waitcnt vmcnt(19)
    v_mfma_f32_16x16x32_bf16 v[24:27], v[184:187], v[124:127], v[24:27]
    ds_read_b64_tr_b16 v[170:171], v232 offset:33280
    s_waitcnt lgkmcnt(6)
    v_mfma_f32_16x16x32_bf16 v[28:31], v[188:191], v[108:111], v[28:31]
    v_mfma_f32_16x16x32_bf16 v[32:35], v[188:191], v[112:115], v[32:35]
    ds_read_b64_tr_b16 v[172:173], v233 offset:32768
    v_mfma_f32_16x16x32_bf16 v[36:39], v[188:191], v[116:119], v[36:39]
    ds_read_b64_tr_b16 v[174:175], v233 offset:33280
    v_mfma_f32_16x16x32_bf16 v[40:43], v[188:191], v[120:123], v[40:43]
    v_mfma_f32_16x16x32_bf16 v[44:47], v[188:191], v[124:127], v[44:47]
    ds_read_b64_tr_b16 v[176:177], v234 offset:32768
    s_waitcnt lgkmcnt(7)
    v_mfma_f32_16x16x32_bf16 v[48:51], v[192:195], v[108:111], v[48:51]
    ds_read_b64_tr_b16 v[178:179], v234 offset:33280
    v_mfma_f32_16x16x32_bf16 v[52:55], v[192:195], v[112:115], v[52:55]
    v_mfma_f32_16x16x32_bf16 v[56:59], v[192:195], v[116:119], v[56:59]
    ds_read_b64_tr_b16 v[180:181], v235 offset:32768
    v_mfma_f32_16x16x32_bf16 v[60:63], v[192:195], v[120:123], v[60:63]
    ds_read_b64_tr_b16 v[182:183], v235 offset:33280
    v_mfma_f32_16x16x32_bf16 v[64:67], v[192:195], v[124:127], v[64:67]
    s_waitcnt lgkmcnt(8)
    v_mfma_f32_16x16x32_bf16 v[68:71], v[196:199], v[108:111], v[68:71]
    v_mfma_f32_16x16x32_bf16 v[72:75], v[196:199], v[112:115], v[72:75]
    v_mfma_f32_16x16x32_bf16 v[76:79], v[196:199], v[116:119], v[76:79]
    v_mfma_f32_16x16x32_bf16 v[80:83], v[196:199], v[120:123], v[80:83]
    v_mfma_f32_16x16x32_bf16 v[84:87], v[196:199], v[124:127], v[84:87]
    s_add_u32 s37, s36, 1400832
    s_add_u32 m0, s49, 81920
    s_nop 0
    buffer_load_dwordx4 v205, s[12:15], s37 offen offset:0 lds
    buffer_load_dwordx4 v206, s[12:15], s37 offen offset:1024 lds
    buffer_load_dwordx4 v207, s[12:15], s37 offen offset:2048 lds
    buffer_load_dwordx4 v208, s[12:15], s37 offen offset:3072 lds
    s_add_u32 s39, s38, 36864
    buffer_load_dwordx4 v[108:111], v200, s[16:19], s39 offen sc1
    buffer_load_dwordx4 v[112:115], v201, s[16:19], s39 offen sc1
    buffer_load_dwordx4 v[116:119], v202, s[16:19], s39 offen sc1
    buffer_load_dwordx4 v[120:123], v203, s[16:19], s39 offen sc1
    buffer_load_dwordx4 v[124:127], v204, s[16:19], s39 offen sc1
    s_waitcnt vmcnt(27) lgkmcnt(6)
    v_mfma_f32_16x16x32_bf16 v[8:11], v[168:171], v[128:131], v[8:11]
    s_waitcnt vmcnt(26)
    v_mfma_f32_16x16x32_bf16 v[12:15], v[168:171], v[132:135], v[12:15]
    s_waitcnt vmcnt(25)
    v_mfma_f32_16x16x32_bf16 v[16:19], v[168:171], v[136:139], v[16:19]
    s_waitcnt vmcnt(24)
    v_mfma_f32_16x16x32_bf16 v[20:23], v[168:171], v[140:143], v[20:23]
    ds_read_b64_tr_b16 v[184:185], v232 offset:49152
    s_waitcnt vmcnt(23)
    v_mfma_f32_16x16x32_bf16 v[24:27], v[168:171], v[144:147], v[24:27]
    ds_read_b64_tr_b16 v[186:187], v232 offset:49664
    s_waitcnt lgkmcnt(6)
    v_mfma_f32_16x16x32_bf16 v[28:31], v[172:175], v[128:131], v[28:31]
    v_mfma_f32_16x16x32_bf16 v[32:35], v[172:175], v[132:135], v[32:35]
    ds_read_b64_tr_b16 v[188:189], v233 offset:49152
    v_mfma_f32_16x16x32_bf16 v[36:39], v[172:175], v[136:139], v[36:39]
    ds_read_b64_tr_b16 v[190:191], v233 offset:49664
    v_mfma_f32_16x16x32_bf16 v[40:43], v[172:175], v[140:143], v[40:43]
    v_mfma_f32_16x16x32_bf16 v[44:47], v[172:175], v[144:147], v[44:47]
    ds_read_b64_tr_b16 v[192:193], v234 offset:49152
    s_waitcnt lgkmcnt(7)
    v_mfma_f32_16x16x32_bf16 v[48:51], v[176:179], v[128:131], v[48:51]
    ds_read_b64_tr_b16 v[194:195], v234 offset:49664
    v_mfma_f32_16x16x32_bf16 v[52:55], v[176:179], v[132:135], v[52:55]
    v_mfma_f32_16x16x32_bf16 v[56:59], v[176:179], v[136:139], v[56:59]
    ds_read_b64_tr_b16 v[196:197], v235 offset:49152
    v_mfma_f32_16x16x32_bf16 v[60:63], v[176:179], v[140:143], v[60:63]
    ds_read_b64_tr_b16 v[198:199], v235 offset:49664
    v_mfma_f32_16x16x32_bf16 v[64:67], v[176:179], v[144:147], v[64:67]
    s_waitcnt lgkmcnt(8)
    v_mfma_f32_16x16x32_bf16 v[68:71], v[180:183], v[128:131], v[68:71]
    v_mfma_f32_16x16x32_bf16 v[72:75], v[180:183], v[132:135], v[72:75]
    v_mfma_f32_16x16x32_bf16 v[76:79], v[180:183], v[136:139], v[76:79]
    v_mfma_f32_16x16x32_bf16 v[80:83], v[180:183], v[140:143], v[80:83]
    v_mfma_f32_16x16x32_bf16 v[84:87], v[180:183], v[144:147], v[84:87]
    s_add_u32 s37, s36, 1548288
    s_add_u32 m0, s49, 98304
    s_nop 0
    buffer_load_dwordx4 v205, s[12:15], s37 offen offset:0 lds
    buffer_load_dwordx4 v206, s[12:15], s37 offen offset:1024 lds
    buffer_load_dwordx4 v207, s[12:15], s37 offen offset:2048 lds
    buffer_load_dwordx4 v208, s[12:15], s37 offen offset:3072 lds
    s_add_u32 s39, s38, 40960
    buffer_load_dwordx4 v[128:131], v200, s[16:19], s39 offen sc1
    buffer_load_dwordx4 v[132:135], v201, s[16:19], s39 offen sc1
    buffer_load_dwordx4 v[136:139], v202, s[16:19], s39 offen sc1
    buffer_load_dwordx4 v[140:143], v203, s[16:19], s39 offen sc1
    buffer_load_dwordx4 v[144:147], v204, s[16:19], s39 offen sc1
    s_waitcnt vmcnt(31) lgkmcnt(6)
    v_mfma_f32_16x16x32_bf16 v[8:11], v[184:187], v[148:151], v[8:11]
    s_waitcnt vmcnt(30)
    v_mfma_f32_16x16x32_bf16 v[12:15], v[184:187], v[152:155], v[12:15]
    s_waitcnt vmcnt(29)
    v_mfma_f32_16x16x32_bf16 v[16:19], v[184:187], v[156:159], v[16:19]
    s_waitcnt vmcnt(28)
    v_mfma_f32_16x16x32_bf16 v[20:23], v[184:187], v[160:163], v[20:23]
    ds_read_b64_tr_b16 v[168:169], v240 offset:0
    s_waitcnt vmcnt(27)
    v_mfma_f32_16x16x32_bf16 v[24:27], v[184:187], v[164:167], v[24:27]
    ds_read_b64_tr_b16 v[170:171], v240 offset:512
    s_waitcnt lgkmcnt(6)
    v_mfma_f32_16x16x32_bf16 v[28:31], v[188:191], v[148:151], v[28:31]
    v_mfma_f32_16x16x32_bf16 v[32:35], v[188:191], v[152:155], v[32:35]
    ds_read_b64_tr_b16 v[172:173], v241 offset:0
    v_mfma_f32_16x16x32_bf16 v[36:39], v[188:191], v[156:159], v[36:39]
    ds_read_b64_tr_b16 v[174:175], v241 offset:512
    v_mfma_f32_16x16x32_bf16 v[40:43], v[188:191], v[160:163], v[40:43]
    v_mfma_f32_16x16x32_bf16 v[44:47], v[188:191], v[164:167], v[44:47]
    ds_read_b64_tr_b16 v[176:177], v242 offset:0
    s_waitcnt lgkmcnt(7)
    v_mfma_f32_16x16x32_bf16 v[48:51], v[192:195], v[148:151], v[48:51]
    ds_read_b64_tr_b16 v[178:179], v242 offset:512
    v_mfma_f32_16x16x32_bf16 v[52:55], v[192:195], v[152:155], v[52:55]
    v_mfma_f32_16x16x32_bf16 v[56:59], v[192:195], v[156:159], v[56:59]
    ds_read_b64_tr_b16 v[180:181], v243 offset:0
    v_mfma_f32_16x16x32_bf16 v[60:63], v[192:195], v[160:163], v[60:63]
    ds_read_b64_tr_b16 v[182:183], v243 offset:512
    v_mfma_f32_16x16x32_bf16 v[64:67], v[192:195], v[164:167], v[64:67]
    s_waitcnt lgkmcnt(8)
    v_mfma_f32_16x16x32_bf16 v[68:71], v[196:199], v[148:151], v[68:71]
    v_mfma_f32_16x16x32_bf16 v[72:75], v[196:199], v[152:155], v[72:75]
    v_mfma_f32_16x16x32_bf16 v[76:79], v[196:199], v[156:159], v[76:79]
    v_mfma_f32_16x16x32_bf16 v[80:83], v[196:199], v[160:163], v[80:83]
    v_mfma_f32_16x16x32_bf16 v[84:87], v[196:199], v[164:167], v[84:87]
    s_add_u32 s37, s36, 1695744
    s_add_u32 m0, s49, 114688
    s_nop 0
    buffer_load_dwordx4 v205, s[12:15], s37 offen offset:0 lds
    buffer_load_dwordx4 v206, s[12:15], s37 offen offset:1024 lds
    buffer_load_dwordx4 v207, s[12:15], s37 offen offset:2048 lds
    buffer_load_dwordx4 v208, s[12:15], s37 offen offset:3072 lds
    s_add_u32 s39, s38, 45056
    buffer_load_dwordx4 v[148:151], v200, s[16:19], s39 offen sc1
    buffer_load_dwordx4 v[152:155], v201, s[16:19], s39 offen sc1
    buffer_load_dwordx4 v[156:159], v202, s[16:19], s39 offen sc1
    buffer_load_dwordx4 v[160:163], v203, s[16:19], s39 offen sc1
    buffer_load_dwordx4 v[164:167], v204, s[16:19], s39 offen sc1
    s_waitcnt vmcnt(31) lgkmcnt(6)
    v_mfma_f32_16x16x32_bf16 v[8:11], v[168:171], v[88:91], v[8:11]
    s_waitcnt vmcnt(30)
    v_mfma_f32_16x16x32_bf16 v[12:15], v[168:171], v[92:95], v[12:15]
    s_waitcnt vmcnt(29)
    v_mfma_f32_16x16x32_bf16 v[16:19], v[168:171], v[96:99], v[16:19]
    s_waitcnt vmcnt(28)
    v_mfma_f32_16x16x32_bf16 v[20:23], v[168:171], v[100:103], v[20:23]
    ds_read_b64_tr_b16 v[184:185], v209 offset:0
    s_waitcnt vmcnt(27)
    v_mfma_f32_16x16x32_bf16 v[24:27], v[168:171], v[104:107], v[24:27]
    ds_read_b64_tr_b16 v[186:187], v209 offset:512
    s_waitcnt lgkmcnt(6)
    v_mfma_f32_16x16x32_bf16 v[28:31], v[172:175], v[88:91], v[28:31]
    v_mfma_f32_16x16x32_bf16 v[32:35], v[172:175], v[92:95], v[32:35]
    ds_read_b64_tr_b16 v[188:189], v210 offset:0
    v_mfma_f32_16x16x32_bf16 v[36:39], v[172:175], v[96:99], v[36:39]
    ds_read_b64_tr_b16 v[190:191], v210 offset:512
    v_mfma_f32_16x16x32_bf16 v[40:43], v[172:175], v[100:103], v[40:43]
    v_mfma_f32_16x16x32_bf16 v[44:47], v[172:175], v[104:107], v[44:47]
    ds_read_b64_tr_b16 v[192:193], v211 offset:0
    s_waitcnt lgkmcnt(7)
    v_mfma_f32_16x16x32_bf16 v[48:51], v[176:179], v[88:91], v[48:51]
    ds_read_b64_tr_b16 v[194:195], v211 offset:512
    v_mfma_f32_16x16x32_bf16 v[52:55], v[176:179], v[92:95], v[52:55]
    v_mfma_f32_16x16x32_bf16 v[56:59], v[176:179], v[96:99], v[56:59]
    ds_read_b64_tr_b16 v[196:197], v212 offset:0
    v_mfma_f32_16x16x32_bf16 v[60:63], v[176:179], v[100:103], v[60:63]
    ds_read_b64_tr_b16 v[198:199], v212 offset:512
    v_mfma_f32_16x16x32_bf16 v[64:67], v[176:179], v[104:107], v[64:67]
    s_waitcnt lgkmcnt(8)
    v_mfma_f32_16x16x32_bf16 v[68:71], v[180:183], v[88:91], v[68:71]
    v_mfma_f32_16x16x32_bf16 v[72:75], v[180:183], v[92:95], v[72:75]
    v_mfma_f32_16x16x32_bf16 v[76:79], v[180:183], v[96:99], v[76:79]
    v_mfma_f32_16x16x32_bf16 v[80:83], v[180:183], v[100:103], v[80:83]
    v_mfma_f32_16x16x32_bf16 v[84:87], v[180:183], v[104:107], v[84:87]
    s_add_u32 s37, s36, 1843200
    s_add_u32 m0, s49, 131072
    s_nop 0
    buffer_load_dwordx4 v205, s[12:15], s37 offen offset:0 lds
    buffer_load_dwordx4 v206, s[12:15], s37 offen offset:1024 lds
    buffer_load_dwordx4 v207, s[12:15], s37 offen offset:2048 lds
    buffer_load_dwordx4 v208, s[12:15], s37 offen offset:3072 lds
    s_add_u32 s39, s38, 49152
    buffer_load_dwordx4 v[88:91], v200, s[16:19], s39 offen sc1
    buffer_load_dwordx4 v[92:95], v201, s[16:19], s39 offen sc1
    buffer_load_dwordx4 v[96:99], v202, s[16:19], s39 offen sc1
    buffer_load_dwordx4 v[100:103], v203, s[16:19], s39 offen sc1
    buffer_load_dwordx4 v[104:107], v204, s[16:19], s39 offen sc1
    s_waitcnt vmcnt(31) lgkmcnt(6)
    v_mfma_f32_16x16x32_bf16 v[8:11], v[184:187], v[108:111], v[8:11]
    s_waitcnt vmcnt(30)
    v_mfma_f32_16x16x32_bf16 v[12:15], v[184:187], v[112:115], v[12:15]
    s_waitcnt vmcnt(29)
    v_mfma_f32_16x16x32_bf16 v[16:19], v[184:187], v[116:119], v[16:19]
    s_waitcnt vmcnt(28)
    v_mfma_f32_16x16x32_bf16 v[20:23], v[184:187], v[120:123], v[20:23]
    ds_read_b64_tr_b16 v[168:169], v209 offset:16384
    s_waitcnt vmcnt(27)
    v_mfma_f32_16x16x32_bf16 v[24:27], v[184:187], v[124:127], v[24:27]
    ds_read_b64_tr_b16 v[170:171], v209 offset:16896
    s_waitcnt lgkmcnt(6)
    v_mfma_f32_16x16x32_bf16 v[28:31], v[188:191], v[108:111], v[28:31]
    v_mfma_f32_16x16x32_bf16 v[32:35], v[188:191], v[112:115], v[32:35]
    ds_read_b64_tr_b16 v[172:173], v210 offset:16384
    v_mfma_f32_16x16x32_bf16 v[36:39], v[188:191], v[116:119], v[36:39]
    ds_read_b64_tr_b16 v[174:175], v210 offset:16896
    v_mfma_f32_16x16x32_bf16 v[40:43], v[188:191], v[120:123], v[40:43]
    v_mfma_f32_16x16x32_bf16 v[44:47], v[188:191], v[124:127], v[44:47]
    ds_read_b64_tr_b16 v[176:177], v211 offset:16384
    s_waitcnt lgkmcnt(7)
    v_mfma_f32_16x16x32_bf16 v[48:51], v[192:195], v[108:111], v[48:51]
    ds_read_b64_tr_b16 v[178:179], v211 offset:16896
    v_mfma_f32_16x16x32_bf16 v[52:55], v[192:195], v[112:115], v[52:55]
    v_mfma_f32_16x16x32_bf16 v[56:59], v[192:195], v[116:119], v[56:59]
    ds_read_b64_tr_b16 v[180:181], v212 offset:16384
    v_mfma_f32_16x16x32_bf16 v[60:63], v[192:195], v[120:123], v[60:63]
    ds_read_b64_tr_b16 v[182:183], v212 offset:16896
    v_mfma_f32_16x16x32_bf16 v[64:67], v[192:195], v[124:127], v[64:67]
    s_waitcnt lgkmcnt(8)
    v_mfma_f32_16x16x32_bf16 v[68:71], v[196:199], v[108:111], v[68:71]
    v_mfma_f32_16x16x32_bf16 v[72:75], v[196:199], v[112:115], v[72:75]
    v_mfma_f32_16x16x32_bf16 v[76:79], v[196:199], v[116:119], v[76:79]
    v_mfma_f32_16x16x32_bf16 v[80:83], v[196:199], v[120:123], v[80:83]
    v_mfma_f32_16x16x32_bf16 v[84:87], v[196:199], v[124:127], v[84:87]
    s_add_u32 s37, s36, 1990656
    s_add_u32 m0, s49, 0
    s_nop 0
    buffer_load_dwordx4 v205, s[12:15], s37 offen offset:0 lds
    buffer_load_dwordx4 v206, s[12:15], s37 offen offset:1024 lds
    buffer_load_dwordx4 v207, s[12:15], s37 offen offset:2048 lds
    buffer_load_dwordx4 v208, s[12:15], s37 offen offset:3072 lds
    s_add_u32 s39, s38, 53248
    buffer_load_dwordx4 v[108:111], v200, s[16:19], s39 offen sc1
    buffer_load_dwordx4 v[112:115], v201, s[16:19], s39 offen sc1
    buffer_load_dwordx4 v[116:119], v202, s[16:19], s39 offen sc1
    buffer_load_dwordx4 v[120:123], v203, s[16:19], s39 offen sc1
    buffer_load_dwordx4 v[124:127], v204, s[16:19], s39 offen sc1
    s_waitcnt vmcnt(31) lgkmcnt(6)
    v_mfma_f32_16x16x32_bf16 v[8:11], v[168:171], v[128:131], v[8:11]
    s_waitcnt vmcnt(30)
    v_mfma_f32_16x16x32_bf16 v[12:15], v[168:171], v[132:135], v[12:15]
    s_waitcnt vmcnt(29)
    v_mfma_f32_16x16x32_bf16 v[16:19], v[168:171], v[136:139], v[16:19]
    s_waitcnt vmcnt(28)
    v_mfma_f32_16x16x32_bf16 v[20:23], v[168:171], v[140:143], v[20:23]
    ds_read_b64_tr_b16 v[184:185], v209 offset:32768
    s_waitcnt vmcnt(27)
    v_mfma_f32_16x16x32_bf16 v[24:27], v[168:171], v[144:147], v[24:27]
    ds_read_b64_tr_b16 v[186:187], v209 offset:33280
    s_waitcnt lgkmcnt(6)
    v_mfma_f32_16x16x32_bf16 v[28:31], v[172:175], v[128:131], v[28:31]
    v_mfma_f32_16x16x32_bf16 v[32:35], v[172:175], v[132:135], v[32:35]
    ds_read_b64_tr_b16 v[188:189], v210 offset:32768
    v_mfma_f32_16x16x32_bf16 v[36:39], v[172:175], v[136:139], v[36:39]
    ds_read_b64_tr_b16 v[190:191], v210 offset:33280
    v_mfma_f32_16x16x32_bf16 v[40:43], v[172:175], v[140:143], v[40:43]
    v_mfma_f32_16x16x32_bf16 v[44:47], v[172:175], v[144:147], v[44:47]
    ds_read_b64_tr_b16 v[192:193], v211 offset:32768
    s_waitcnt lgkmcnt(7)
    v_mfma_f32_16x16x32_bf16 v[48:51], v[176:179], v[128:131], v[48:51]
    ds_read_b64_tr_b16 v[194:195], v211 offset:33280
    v_mfma_f32_16x16x32_bf16 v[52:55], v[176:179], v[132:135], v[52:55]
    v_mfma_f32_16x16x32_bf16 v[56:59], v[176:179], v[136:139], v[56:59]
    ds_read_b64_tr_b16 v[196:197], v212 offset:32768
    v_mfma_f32_16x16x32_bf16 v[60:63], v[176:179], v[140:143], v[60:63]
    ds_read_b64_tr_b16 v[198:199], v212 offset:33280
    v_mfma_f32_16x16x32_bf16 v[64:67], v[176:179], v[144:147], v[64:67]
    s_waitcnt lgkmcnt(8)
    v_mfma_f32_16x16x32_bf16 v[68:71], v[180:183], v[128:131], v[68:71]
    v_mfma_f32_16x16x32_bf16 v[72:75], v[180:183], v[132:135], v[72:75]
    v_mfma_f32_16x16x32_bf16 v[76:79], v[180:183], v[136:139], v[76:79]
    v_mfma_f32_16x16x32_bf16 v[80:83], v[180:183], v[140:143], v[80:83]
    v_mfma_f32_16x16x32_bf16 v[84:87], v[180:183], v[144:147], v[84:87]
    s_add_u32 s37, s36, 2138112
    s_add_u32 m0, s49, 16384
    s_nop 0
    buffer_load_dwordx4 v205, s[12:15], s37 offen offset:0 lds
    buffer_load_dwordx4 v206, s[12:15], s37 offen offset:1024 lds
    buffer_load_dwordx4 v207, s[12:15], s37 offen offset:2048 lds
    buffer_load_dwordx4 v208, s[12:15], s37 offen offset:3072 lds
    s_add_u32 s39, s38, 57344
    buffer_load_dwordx4 v[128:131], v200, s[16:19], s39 offen sc1
    buffer_load_dwordx4 v[132:135], v201, s[16:19], s39 offen sc1
    buffer_load_dwordx4 v[136:139], v202, s[16:19], s39 offen sc1
    buffer_load_dwordx4 v[140:143], v203, s[16:19], s39 offen sc1
    buffer_load_dwordx4 v[144:147], v204, s[16:19], s39 offen sc1
    s_waitcnt vmcnt(31) lgkmcnt(6)
    v_mfma_f32_16x16x32_bf16 v[8:11], v[184:187], v[148:151], v[8:11]
    s_waitcnt vmcnt(30)
    v_mfma_f32_16x16x32_bf16 v[12:15], v[184:187], v[152:155], v[12:15]
    s_waitcnt vmcnt(29)
    v_mfma_f32_16x16x32_bf16 v[16:19], v[184:187], v[156:159], v[16:19]
    s_waitcnt vmcnt(28)
    v_mfma_f32_16x16x32_bf16 v[20:23], v[184:187], v[160:163], v[20:23]
    ds_read_b64_tr_b16 v[168:169], v209 offset:49152
    s_waitcnt vmcnt(27)
    v_mfma_f32_16x16x32_bf16 v[24:27], v[184:187], v[164:167], v[24:27]
    ds_read_b64_tr_b16 v[170:171], v209 offset:49664
    s_waitcnt lgkmcnt(6)
    v_mfma_f32_16x16x32_bf16 v[28:31], v[188:191], v[148:151], v[28:31]
    v_mfma_f32_16x16x32_bf16 v[32:35], v[188:191], v[152:155], v[32:35]
    ds_read_b64_tr_b16 v[172:173], v210 offset:49152
    v_mfma_f32_16x16x32_bf16 v[36:39], v[188:191], v[156:159], v[36:39]
    ds_read_b64_tr_b16 v[174:175], v210 offset:49664
    v_mfma_f32_16x16x32_bf16 v[40:43], v[188:191], v[160:163], v[40:43]
    v_mfma_f32_16x16x32_bf16 v[44:47], v[188:191], v[164:167], v[44:47]
    ds_read_b64_tr_b16 v[176:177], v211 offset:49152
    s_waitcnt lgkmcnt(7)
    v_mfma_f32_16x16x32_bf16 v[48:51], v[192:195], v[148:151], v[48:51]
    ds_read_b64_tr_b16 v[178:179], v211 offset:49664
    v_mfma_f32_16x16x32_bf16 v[52:55], v[192:195], v[152:155], v[52:55]
    v_mfma_f32_16x16x32_bf16 v[56:59], v[192:195], v[156:159], v[56:59]
    ds_read_b64_tr_b16 v[180:181], v212 offset:49152
    v_mfma_f32_16x16x32_bf16 v[60:63], v[192:195], v[160:163], v[60:63]
    ds_read_b64_tr_b16 v[182:183], v212 offset:49664
    v_mfma_f32_16x16x32_bf16 v[64:67], v[192:195], v[164:167], v[64:67]
    s_waitcnt lgkmcnt(8)
    v_mfma_f32_16x16x32_bf16 v[68:71], v[196:199], v[148:151], v[68:71]
    v_mfma_f32_16x16x32_bf16 v[72:75], v[196:199], v[152:155], v[72:75]
    v_mfma_f32_16x16x32_bf16 v[76:79], v[196:199], v[156:159], v[76:79]
    v_mfma_f32_16x16x32_bf16 v[80:83], v[196:199], v[160:163], v[80:83]
    v_mfma_f32_16x16x32_bf16 v[84:87], v[196:199], v[164:167], v[84:87]
    s_add_u32 s37, s36, 2285568
    s_add_u32 m0, s49, 32768
    s_nop 0
    buffer_load_dwordx4 v205, s[12:15], s37 offen offset:0 lds
    buffer_load_dwordx4 v206, s[12:15], s37 offen offset:1024 lds
    buffer_load_dwordx4 v207, s[12:15], s37 offen offset:2048 lds
    buffer_load_dwordx4 v208, s[12:15], s37 offen offset:3072 lds
    s_add_u32 s39, s38, 61440
    buffer_load_dwordx4 v[148:151], v200, s[16:19], s39 offen sc1
    buffer_load_dwordx4 v[152:155], v201, s[16:19], s39 offen sc1
    buffer_load_dwordx4 v[156:159], v202, s[16:19], s39 offen sc1
    buffer_load_dwordx4 v[160:163], v203, s[16:19], s39 offen sc1
    buffer_load_dwordx4 v[164:167], v204, s[16:19], s39 offen sc1
    s_waitcnt vmcnt(31) lgkmcnt(6)
    v_mfma_f32_16x16x32_bf16 v[8:11], v[168:171], v[88:91], v[8:11]
    s_waitcnt vmcnt(30)
    v_mfma_f32_16x16x32_bf16 v[12:15], v[168:171], v[92:95], v[12:15]
    s_waitcnt vmcnt(29)
    v_mfma_f32_16x16x32_bf16 v[16:19], v[168:171], v[96:99], v[16:19]
    s_waitcnt vmcnt(28)
    v_mfma_f32_16x16x32_bf16 v[20:23], v[168:171], v[100:103], v[20:23]
    ds_read_b64_tr_b16 v[184:185], v232 offset:0
    s_waitcnt vmcnt(27)
    v_mfma_f32_16x16x32_bf16 v[24:27], v[168:171], v[104:107], v[24:27]
    ds_read_b64_tr_b16 v[186:187], v232 offset:512
    s_waitcnt lgkmcnt(6)
    v_mfma_f32_16x16x32_bf16 v[28:31], v[172:175], v[88:91], v[28:31]
    v_mfma_f32_16x16x32_bf16 v[32:35], v[172:175], v[92:95], v[32:35]
    ds_read_b64_tr_b16 v[188:189], v233 offset:0
    v_mfma_f32_16x16x32_bf16 v[36:39], v[172:175], v[96:99], v[36:39]
    ds_read_b64_tr_b16 v[190:191], v233 offset:512
    v_mfma_f32_16x16x32_bf16 v[40:43], v[172:175], v[100:103], v[40:43]
    v_mfma_f32_16x16x32_bf16 v[44:47], v[172:175], v[104:107], v[44:47]
    ds_read_b64_tr_b16 v[192:193], v234 offset:0
    s_waitcnt lgkmcnt(7)
    v_mfma_f32_16x16x32_bf16 v[48:51], v[176:179], v[88:91], v[48:51]
    ds_read_b64_tr_b16 v[194:195], v234 offset:512
    v_mfma_f32_16x16x32_bf16 v[52:55], v[176:179], v[92:95], v[52:55]
    v_mfma_f32_16x16x32_bf16 v[56:59], v[176:179], v[96:99], v[56:59]
    ds_read_b64_tr_b16 v[196:197], v235 offset:0
    v_mfma_f32_16x16x32_bf16 v[60:63], v[176:179], v[100:103], v[60:63]
    ds_read_b64_tr_b16 v[198:199], v235 offset:512
    v_mfma_f32_16x16x32_bf16 v[64:67], v[176:179], v[104:107], v[64:67]
    s_waitcnt lgkmcnt(8)
    v_mfma_f32_16x16x32_bf16 v[68:71], v[180:183], v[88:91], v[68:71]
    v_mfma_f32_16x16x32_bf16 v[72:75], v[180:183], v[92:95], v[72:75]
    v_mfma_f32_16x16x32_bf16 v[76:79], v[180:183], v[96:99], v[76:79]
    v_mfma_f32_16x16x32_bf16 v[80:83], v[180:183], v[100:103], v[80:83]
    v_mfma_f32_16x16x32_bf16 v[84:87], v[180:183], v[104:107], v[84:87]
    s_add_u32 s37, s36, 2433024
    s_add_u32 m0, s49, 49152
    s_nop 0
    buffer_load_dwordx4 v205, s[12:15], s37 offen offset:0 lds
    buffer_load_dwordx4 v206, s[12:15], s37 offen offset:1024 lds
    buffer_load_dwordx4 v207, s[12:15], s37 offen offset:2048 lds
    buffer_load_dwordx4 v208, s[12:15], s37 offen offset:3072 lds
    s_add_u32 s39, s38, 65536
    buffer_load_dwordx4 v[88:91], v200, s[16:19], s39 offen sc1
    buffer_load_dwordx4 v[92:95], v201, s[16:19], s39 offen sc1
    buffer_load_dwordx4 v[96:99], v202, s[16:19], s39 offen sc1
    buffer_load_dwordx4 v[100:103], v203, s[16:19], s39 offen sc1
    buffer_load_dwordx4 v[104:107], v204, s[16:19], s39 offen sc1
    s_waitcnt vmcnt(31) lgkmcnt(6)
    v_mfma_f32_16x16x32_bf16 v[8:11], v[184:187], v[108:111], v[8:11]
    s_waitcnt vmcnt(30)
    v_mfma_f32_16x16x32_bf16 v[12:15], v[184:187], v[112:115], v[12:15]
    s_waitcnt vmcnt(29)
    v_mfma_f32_16x16x32_bf16 v[16:19], v[184:187], v[116:119], v[16:19]
    s_waitcnt vmcnt(28)
    v_mfma_f32_16x16x32_bf16 v[20:23], v[184:187], v[120:123], v[20:23]
    ds_read_b64_tr_b16 v[168:169], v232 offset:16384
    s_waitcnt vmcnt(27)
    v_mfma_f32_16x16x32_bf16 v[24:27], v[184:187], v[124:127], v[24:27]
    ds_read_b64_tr_b16 v[170:171], v232 offset:16896
    s_waitcnt lgkmcnt(6)
    v_mfma_f32_16x16x32_bf16 v[28:31], v[188:191], v[108:111], v[28:31]
    v_mfma_f32_16x16x32_bf16 v[32:35], v[188:191], v[112:115], v[32:35]
    ds_read_b64_tr_b16 v[172:173], v233 offset:16384
    v_mfma_f32_16x16x32_bf16 v[36:39], v[188:191], v[116:119], v[36:39]
    ds_read_b64_tr_b16 v[174:175], v233 offset:16896
    v_mfma_f32_16x16x32_bf16 v[40:43], v[188:191], v[120:123], v[40:43]
    v_mfma_f32_16x16x32_bf16 v[44:47], v[188:191], v[124:127], v[44:47]
    ds_read_b64_tr_b16 v[176:177], v234 offset:16384
    s_waitcnt lgkmcnt(7)
    v_mfma_f32_16x16x32_bf16 v[48:51], v[192:195], v[108:111], v[48:51]
    ds_read_b64_tr_b16 v[178:179], v234 offset:16896
    v_mfma_f32_16x16x32_bf16 v[52:55], v[192:195], v[112:115], v[52:55]
    v_mfma_f32_16x16x32_bf16 v[56:59], v[192:195], v[116:119], v[56:59]
    ds_read_b64_tr_b16 v[180:181], v235 offset:16384
    v_mfma_f32_16x16x32_bf16 v[60:63], v[192:195], v[120:123], v[60:63]
    ds_read_b64_tr_b16 v[182:183], v235 offset:16896
    v_mfma_f32_16x16x32_bf16 v[64:67], v[192:195], v[124:127], v[64:67]
    s_waitcnt lgkmcnt(8)
    v_mfma_f32_16x16x32_bf16 v[68:71], v[196:199], v[108:111], v[68:71]
    v_mfma_f32_16x16x32_bf16 v[72:75], v[196:199], v[112:115], v[72:75]
    v_mfma_f32_16x16x32_bf16 v[76:79], v[196:199], v[116:119], v[76:79]
    v_mfma_f32_16x16x32_bf16 v[80:83], v[196:199], v[120:123], v[80:83]
    v_mfma_f32_16x16x32_bf16 v[84:87], v[196:199], v[124:127], v[84:87]
    s_add_u32 s37, s36, 2580480
    s_add_u32 m0, s49, 65536
    s_nop 0
    buffer_load_dwordx4 v205, s[12:15], s37 offen offset:0 lds
    buffer_load_dwordx4 v206, s[12:15], s37 offen offset:1024 lds
    buffer_load_dwordx4 v207, s[12:15], s37 offen offset:2048 lds
    buffer_load_dwordx4 v208, s[12:15], s37 offen offset:3072 lds
    s_add_u32 s39, s38, 69632
    buffer_load_dwordx4 v[108:111], v200, s[16:19], s39 offen sc1
    buffer_load_dwordx4 v[112:115], v201, s[16:19], s39 offen sc1
    buffer_load_dwordx4 v[116:119], v202, s[16:19], s39 offen sc1
    buffer_load_dwordx4 v[120:123], v203, s[16:19], s39 offen sc1
    buffer_load_dwordx4 v[124:127], v204, s[16:19], s39 offen sc1
    s_waitcnt vmcnt(31) lgkmcnt(6)
    v_mfma_f32_16x16x32_bf16 v[8:11], v[168:171], v[128:131], v[8:11]
    s_waitcnt vmcnt(30)
    v_mfma_f32_16x16x32_bf16 v[12:15], v[168:171], v[132:135], v[12:15]
    s_waitcnt vmcnt(29)
    v_mfma_f32_16x16x32_bf16 v[16:19], v[168:171], v[136:139], v[16:19]
    s_waitcnt vmcnt(28)
    v_mfma_f32_16x16x32_bf16 v[20:23], v[168:171], v[140:143], v[20:23]
    ds_read_b64_tr_b16 v[184:185], v232 offset:32768
    s_waitcnt vmcnt(27)
    v_mfma_f32_16x16x32_bf16 v[24:27], v[168:171], v[144:147], v[24:27]
    ds_read_b64_tr_b16 v[186:187], v232 offset:33280
    s_waitcnt lgkmcnt(6)
    v_mfma_f32_16x16x32_bf16 v[28:31], v[172:175], v[128:131], v[28:31]
    v_mfma_f32_16x16x32_bf16 v[32:35], v[172:175], v[132:135], v[32:35]
    ds_read_b64_tr_b16 v[188:189], v233 offset:32768
    v_mfma_f32_16x16x32_bf16 v[36:39], v[172:175], v[136:139], v[36:39]
    ds_read_b64_tr_b16 v[190:191], v233 offset:33280
    v_mfma_f32_16x16x32_bf16 v[40:43], v[172:175], v[140:143], v[40:43]
    v_mfma_f32_16x16x32_bf16 v[44:47], v[172:175], v[144:147], v[44:47]
    ds_read_b64_tr_b16 v[192:193], v234 offset:32768
    s_waitcnt lgkmcnt(7)
    v_mfma_f32_16x16x32_bf16 v[48:51], v[176:179], v[128:131], v[48:51]
    ds_read_b64_tr_b16 v[194:195], v234 offset:33280
    v_mfma_f32_16x16x32_bf16 v[52:55], v[176:179], v[132:135], v[52:55]
    v_mfma_f32_16x16x32_bf16 v[56:59], v[176:179], v[136:139], v[56:59]
    ds_read_b64_tr_b16 v[196:197], v235 offset:32768
    v_mfma_f32_16x16x32_bf16 v[60:63], v[176:179], v[140:143], v[60:63]
    ds_read_b64_tr_b16 v[198:199], v235 offset:33280
    v_mfma_f32_16x16x32_bf16 v[64:67], v[176:179], v[144:147], v[64:67]
    s_waitcnt lgkmcnt(8)
    v_mfma_f32_16x16x32_bf16 v[68:71], v[180:183], v[128:131], v[68:71]
    v_mfma_f32_16x16x32_bf16 v[72:75], v[180:183], v[132:135], v[72:75]
    v_mfma_f32_16x16x32_bf16 v[76:79], v[180:183], v[136:139], v[76:79]
    v_mfma_f32_16x16x32_bf16 v[80:83], v[180:183], v[140:143], v[80:83]
    v_mfma_f32_16x16x32_bf16 v[84:87], v[180:183], v[144:147], v[84:87]
    s_add_u32 s39, s38, 73728
    buffer_load_dwordx4 v[128:131], v200, s[16:19], s39 offen sc1
    buffer_load_dwordx4 v[132:135], v201, s[16:19], s39 offen sc1
    buffer_load_dwordx4 v[136:139], v202, s[16:19], s39 offen sc1
    buffer_load_dwordx4 v[140:143], v203, s[16:19], s39 offen sc1
    buffer_load_dwordx4 v[144:147], v204, s[16:19], s39 offen sc1
    s_waitcnt vmcnt(27) lgkmcnt(6)
    v_mfma_f32_16x16x32_bf16 v[8:11], v[184:187], v[148:151], v[8:11]
    s_waitcnt vmcnt(26)
    v_mfma_f32_16x16x32_bf16 v[12:15], v[184:187], v[152:155], v[12:15]
    s_waitcnt vmcnt(25)
    v_mfma_f32_16x16x32_bf16 v[16:19], v[184:187], v[156:159], v[16:19]
    s_waitcnt vmcnt(24)
    v_mfma_f32_16x16x32_bf16 v[20:23], v[184:187], v[160:163], v[20:23]
    ds_read_b64_tr_b16 v[168:169], v232 offset:49152
    s_waitcnt vmcnt(23)
    v_mfma_f32_16x16x32_bf16 v[24:27], v[184:187], v[164:167], v[24:27]
    ds_read_b64_tr_b16 v[170:171], v232 offset:49664
    s_waitcnt lgkmcnt(6)
    v_mfma_f32_16x16x32_bf16 v[28:31], v[188:191], v[148:151], v[28:31]
    v_mfma_f32_16x16x32_bf16 v[32:35], v[188:191], v[152:155], v[32:35]
    ds_read_b64_tr_b16 v[172:173], v233 offset:49152
    v_mfma_f32_16x16x32_bf16 v[36:39], v[188:191], v[156:159], v[36:39]
    ds_read_b64_tr_b16 v[174:175], v233 offset:49664
    v_mfma_f32_16x16x32_bf16 v[40:43], v[188:191], v[160:163], v[40:43]
    v_mfma_f32_16x16x32_bf16 v[44:47], v[188:191], v[164:167], v[44:47]
    ds_read_b64_tr_b16 v[176:177], v234 offset:49152
    s_waitcnt lgkmcnt(7)
    v_mfma_f32_16x16x32_bf16 v[48:51], v[192:195], v[148:151], v[48:51]
    ds_read_b64_tr_b16 v[178:179], v234 offset:49664
    v_mfma_f32_16x16x32_bf16 v[52:55], v[192:195], v[152:155], v[52:55]
    v_mfma_f32_16x16x32_bf16 v[56:59], v[192:195], v[156:159], v[56:59]
    ds_read_b64_tr_b16 v[180:181], v235 offset:49152
    v_mfma_f32_16x16x32_bf16 v[60:63], v[192:195], v[160:163], v[60:63]
    ds_read_b64_tr_b16 v[182:183], v235 offset:49664
    v_mfma_f32_16x16x32_bf16 v[64:67], v[192:195], v[164:167], v[64:67]
    s_waitcnt lgkmcnt(8)
    v_mfma_f32_16x16x32_bf16 v[68:71], v[196:199], v[148:151], v[68:71]
    v_mfma_f32_16x16x32_bf16 v[72:75], v[196:199], v[152:155], v[72:75]
    v_mfma_f32_16x16x32_bf16 v[76:79], v[196:199], v[156:159], v[76:79]
    v_mfma_f32_16x16x32_bf16 v[80:83], v[196:199], v[160:163], v[80:83]
    v_mfma_f32_16x16x32_bf16 v[84:87], v[196:199], v[164:167], v[84:87]
    s_add_u32 s39, s38, 77824
    buffer_load_dwordx4 v[148:151], v200, s[16:19], s39 offen sc1
    buffer_load_dwordx4 v[152:155], v201, s[16:19], s39 offen sc1
    buffer_load_dwordx4 v[156:159], v202, s[16:19], s39 offen sc1
    buffer_load_dwordx4 v[160:163], v203, s[16:19], s39 offen sc1
    buffer_load_dwordx4 v[164:167], v204, s[16:19], s39 offen sc1
    s_waitcnt vmcnt(23) lgkmcnt(6)
    v_mfma_f32_16x16x32_bf16 v[8:11], v[168:171], v[88:91], v[8:11]
    s_waitcnt vmcnt(22)
    v_mfma_f32_16x16x32_bf16 v[12:15], v[168:171], v[92:95], v[12:15]
    s_waitcnt vmcnt(21)
    v_mfma_f32_16x16x32_bf16 v[16:19], v[168:171], v[96:99], v[16:19]
    s_waitcnt vmcnt(20)
    v_mfma_f32_16x16x32_bf16 v[20:23], v[168:171], v[100:103], v[20:23]
    ds_read_b64_tr_b16 v[184:185], v240 offset:0
    s_waitcnt vmcnt(19)
    v_mfma_f32_16x16x32_bf16 v[24:27], v[168:171], v[104:107], v[24:27]
    ds_read_b64_tr_b16 v[186:187], v240 offset:512
    s_waitcnt lgkmcnt(6)
    v_mfma_f32_16x16x32_bf16 v[28:31], v[172:175], v[88:91], v[28:31]
    v_mfma_f32_16x16x32_bf16 v[32:35], v[172:175], v[92:95], v[32:35]
    ds_read_b64_tr_b16 v[188:189], v241 offset:0
    v_mfma_f32_16x16x32_bf16 v[36:39], v[172:175], v[96:99], v[36:39]
    ds_read_b64_tr_b16 v[190:191], v241 offset:512
    v_mfma_f32_16x16x32_bf16 v[40:43], v[172:175], v[100:103], v[40:43]
    v_mfma_f32_16x16x32_bf16 v[44:47], v[172:175], v[104:107], v[44:47]
    ds_read_b64_tr_b16 v[192:193], v242 offset:0
    s_waitcnt lgkmcnt(7)
    v_mfma_f32_16x16x32_bf16 v[48:51], v[176:179], v[88:91], v[48:51]
    ds_read_b64_tr_b16 v[194:195], v242 offset:512
    v_mfma_f32_16x16x32_bf16 v[52:55], v[176:179], v[92:95], v[52:55]
    v_mfma_f32_16x16x32_bf16 v[56:59], v[176:179], v[96:99], v[56:59]
    ds_read_b64_tr_b16 v[196:197], v243 offset:0
    v_mfma_f32_16x16x32_bf16 v[60:63], v[176:179], v[100:103], v[60:63]
    ds_read_b64_tr_b16 v[198:199], v243 offset:512
    v_mfma_f32_16x16x32_bf16 v[64:67], v[176:179], v[104:107], v[64:67]
    s_waitcnt lgkmcnt(8)
    v_mfma_f32_16x16x32_bf16 v[68:71], v[180:183], v[88:91], v[68:71]
    v_mfma_f32_16x16x32_bf16 v[72:75], v[180:183], v[92:95], v[72:75]
    v_mfma_f32_16x16x32_bf16 v[76:79], v[180:183], v[96:99], v[76:79]
    v_mfma_f32_16x16x32_bf16 v[80:83], v[180:183], v[100:103], v[80:83]
    v_mfma_f32_16x16x32_bf16 v[84:87], v[180:183], v[104:107], v[84:87]
    s_add_u32 s39, s38, 81920
    buffer_load_dwordx4 v[88:91], v200, s[16:19], s39 offen sc1
    buffer_load_dwordx4 v[92:95], v201, s[16:19], s39 offen sc1
    buffer_load_dwordx4 v[96:99], v202, s[16:19], s39 offen sc1
    buffer_load_dwordx4 v[100:103], v203, s[16:19], s39 offen sc1
    buffer_load_dwordx4 v[104:107], v204, s[16:19], s39 offen sc1
    s_waitcnt vmcnt(19) lgkmcnt(6)
    v_mfma_f32_16x16x32_bf16 v[8:11], v[184:187], v[108:111], v[8:11]
    s_waitcnt vmcnt(18)
    v_mfma_f32_16x16x32_bf16 v[12:15], v[184:187], v[112:115], v[12:15]
    s_waitcnt vmcnt(17)
    v_mfma_f32_16x16x32_bf16 v[16:19], v[184:187], v[116:119], v[16:19]
    s_waitcnt vmcnt(16)
    v_mfma_f32_16x16x32_bf16 v[20:23], v[184:187], v[120:123], v[20:23]
    ds_read_b64_tr_b16 v[168:169], v209 offset:0
    s_waitcnt vmcnt(15)
    v_mfma_f32_16x16x32_bf16 v[24:27], v[184:187], v[124:127], v[24:27]
    ds_read_b64_tr_b16 v[170:171], v209 offset:512
    s_waitcnt lgkmcnt(6)
    v_mfma_f32_16x16x32_bf16 v[28:31], v[188:191], v[108:111], v[28:31]
    v_mfma_f32_16x16x32_bf16 v[32:35], v[188:191], v[112:115], v[32:35]
    ds_read_b64_tr_b16 v[172:173], v210 offset:0
    v_mfma_f32_16x16x32_bf16 v[36:39], v[188:191], v[116:119], v[36:39]
    ds_read_b64_tr_b16 v[174:175], v210 offset:512
    v_mfma_f32_16x16x32_bf16 v[40:43], v[188:191], v[120:123], v[40:43]
    v_mfma_f32_16x16x32_bf16 v[44:47], v[188:191], v[124:127], v[44:47]
    ds_read_b64_tr_b16 v[176:177], v211 offset:0
    s_waitcnt lgkmcnt(7)
    v_mfma_f32_16x16x32_bf16 v[48:51], v[192:195], v[108:111], v[48:51]
    ds_read_b64_tr_b16 v[178:179], v211 offset:512
    v_mfma_f32_16x16x32_bf16 v[52:55], v[192:195], v[112:115], v[52:55]
    v_mfma_f32_16x16x32_bf16 v[56:59], v[192:195], v[116:119], v[56:59]
    ds_read_b64_tr_b16 v[180:181], v212 offset:0
    v_mfma_f32_16x16x32_bf16 v[60:63], v[192:195], v[120:123], v[60:63]
    ds_read_b64_tr_b16 v[182:183], v212 offset:512
    v_mfma_f32_16x16x32_bf16 v[64:67], v[192:195], v[124:127], v[64:67]
    s_waitcnt lgkmcnt(8)
    v_mfma_f32_16x16x32_bf16 v[68:71], v[196:199], v[108:111], v[68:71]
    v_mfma_f32_16x16x32_bf16 v[72:75], v[196:199], v[112:115], v[72:75]
    v_mfma_f32_16x16x32_bf16 v[76:79], v[196:199], v[116:119], v[76:79]
    v_mfma_f32_16x16x32_bf16 v[80:83], v[196:199], v[120:123], v[80:83]
    v_mfma_f32_16x16x32_bf16 v[84:87], v[196:199], v[124:127], v[84:87]
    s_add_u32 s39, s38, 86016
    buffer_load_dwordx4 v[108:111], v200, s[16:19], s39 offen sc1
    buffer_load_dwordx4 v[112:115], v201, s[16:19], s39 offen sc1
    buffer_load_dwordx4 v[116:119], v202, s[16:19], s39 offen sc1
    buffer_load_dwordx4 v[120:123], v203, s[16:19], s39 offen sc1
    buffer_load_dwordx4 v[124:127], v204, s[16:19], s39 offen sc1
    s_waitcnt vmcnt(19) lgkmcnt(6)
    v_mfma_f32_16x16x32_bf16 v[8:11], v[168:171], v[128:131], v[8:11]
    s_waitcnt vmcnt(18)
    v_mfma_f32_16x16x32_bf16 v[12:15], v[168:171], v[132:135], v[12:15]
    s_waitcnt vmcnt(17)
    v_mfma_f32_16x16x32_bf16 v[16:19], v[168:171], v[136:139], v[16:19]
    s_waitcnt vmcnt(16)
    v_mfma_f32_16x16x32_bf16 v[20:23], v[168:171], v[140:143], v[20:23]
    ds_read_b64_tr_b16 v[184:185], v209 offset:16384
    s_waitcnt vmcnt(15)
    v_mfma_f32_16x16x32_bf16 v[24:27], v[168:171], v[144:147], v[24:27]
    ds_read_b64_tr_b16 v[186:187], v209 offset:16896
    s_waitcnt lgkmcnt(6)
    v_mfma_f32_16x16x32_bf16 v[28:31], v[172:175], v[128:131], v[28:31]
    v_mfma_f32_16x16x32_bf16 v[32:35], v[172:175], v[132:135], v[32:35]
    ds_read_b64_tr_b16 v[188:189], v210 offset:16384
    v_mfma_f32_16x16x32_bf16 v[36:39], v[172:175], v[136:139], v[36:39]
    ds_read_b64_tr_b16 v[190:191], v210 offset:16896
    v_mfma_f32_16x16x32_bf16 v[40:43], v[172:175], v[140:143], v[40:43]
    v_mfma_f32_16x16x32_bf16 v[44:47], v[172:175], v[144:147], v[44:47]
    ds_read_b64_tr_b16 v[192:193], v211 offset:16384
    s_waitcnt lgkmcnt(7)
    v_mfma_f32_16x16x32_bf16 v[48:51], v[176:179], v[128:131], v[48:51]
    ds_read_b64_tr_b16 v[194:195], v211 offset:16896
    v_mfma_f32_16x16x32_bf16 v[52:55], v[176:179], v[132:135], v[52:55]
    v_mfma_f32_16x16x32_bf16 v[56:59], v[176:179], v[136:139], v[56:59]
    ds_read_b64_tr_b16 v[196:197], v212 offset:16384
    v_mfma_f32_16x16x32_bf16 v[60:63], v[176:179], v[140:143], v[60:63]
    ds_read_b64_tr_b16 v[198:199], v212 offset:16896
    v_mfma_f32_16x16x32_bf16 v[64:67], v[176:179], v[144:147], v[64:67]
    s_waitcnt lgkmcnt(8)
    v_mfma_f32_16x16x32_bf16 v[68:71], v[180:183], v[128:131], v[68:71]
    v_mfma_f32_16x16x32_bf16 v[72:75], v[180:183], v[132:135], v[72:75]
    v_mfma_f32_16x16x32_bf16 v[76:79], v[180:183], v[136:139], v[76:79]
    v_mfma_f32_16x16x32_bf16 v[80:83], v[180:183], v[140:143], v[80:83]
    v_mfma_f32_16x16x32_bf16 v[84:87], v[180:183], v[144:147], v[84:87]
    s_add_u32 s39, s38, 90112
    s_cmp_lt_u32 s34, 2
    s_cselect_b32 s39, s39, 0x7f000000
    buffer_load_dwordx4 v[128:131], v200, s[16:19], s39 offen sc1
    buffer_load_dwordx4 v[132:135], v201, s[16:19], s39 offen sc1
    buffer_load_dwordx4 v[136:139], v202, s[16:19], s39 offen sc1
    buffer_load_dwordx4 v[140:143], v203, s[16:19], s39 offen sc1
    buffer_load_dwordx4 v[144:147], v204, s[16:19], s39 offen sc1
    s_waitcnt vmcnt(19) lgkmcnt(6)
    v_mfma_f32_16x16x32_bf16 v[8:11], v[184:187], v[148:151], v[8:11]
    s_waitcnt vmcnt(18)
    v_mfma_f32_16x16x32_bf16 v[12:15], v[184:187], v[152:155], v[12:15]
    s_waitcnt vmcnt(17)
    v_mfma_f32_16x16x32_bf16 v[16:19], v[184:187], v[156:159], v[16:19]
    s_waitcnt vmcnt(16)
    v_mfma_f32_16x16x32_bf16 v[20:23], v[184:187], v[160:163], v[20:23]
    ds_read_b64_tr_b16 v[168:169], v209 offset:32768
    s_waitcnt vmcnt(15)
    v_mfma_f32_16x16x32_bf16 v[24:27], v[184:187], v[164:167], v[24:27]
    ds_read_b64_tr_b16 v[170:171], v209 offset:33280
    s_waitcnt lgkmcnt(6)
    v_mfma_f32_16x16x32_bf16 v[28:31], v[188:191], v[148:151], v[28:31]
    v_mfma_f32_16x16x32_bf16 v[32:35], v[188:191], v[152:155], v[32:35]
    ds_read_b64_tr_b16 v[172:173], v210 offset:32768
    v_mfma_f32_16x16x32_bf16 v[36:39], v[188:191], v[156:159], v[36:39]
    ds_read_b64_tr_b16 v[174:175], v210 offset:33280
    v_mfma_f32_16x16x32_bf16 v[40:43], v[188:191], v[160:163], v[40:43]
    v_mfma_f32_16x16x32_bf16 v[44:47], v[188:191], v[164:167], v[44:47]
    ds_read_b64_tr_b16 v[176:177], v211 offset:32768
    s_waitcnt lgkmcnt(7)
    v_mfma_f32_16x16x32_bf16 v[48:51], v[192:195], v[148:151], v[48:51]
    ds_read_b64_tr_b16 v[178:179], v211 offset:33280
    v_mfma_f32_16x16x32_bf16 v[52:55], v[192:195], v[152:155], v[52:55]
    v_mfma_f32_16x16x32_bf16 v[56:59], v[192:195], v[156:159], v[56:59]
    ds_read_b64_tr_b16 v[180:181], v212 offset:32768
    v_mfma_f32_16x16x32_bf16 v[60:63], v[192:195], v[160:163], v[60:63]
    ds_read_b64_tr_b16 v[182:183], v212 offset:33280
    v_mfma_f32_16x16x32_bf16 v[64:67], v[192:195], v[164:167], v[64:67]
    s_waitcnt lgkmcnt(8)
    v_mfma_f32_16x16x32_bf16 v[68:71], v[196:199], v[148:151], v[68:71]
    v_mfma_f32_16x16x32_bf16 v[72:75], v[196:199], v[152:155], v[72:75]
    v_mfma_f32_16x16x32_bf16 v[76:79], v[196:199], v[156:159], v[76:79]
    v_mfma_f32_16x16x32_bf16 v[80:83], v[196:199], v[160:163], v[80:83]
    v_mfma_f32_16x16x32_bf16 v[84:87], v[196:199], v[164:167], v[84:87]
    buffer_load_dwordx4 v[216:219], v213, s[24:27], s52 offen
    buffer_load_dwordx4 v[220:223], v213, s[24:27], s53 offen
    buffer_load_dwordx4 v[224:227], v213, s[24:27], s54 offen
    s_waitcnt vmcnt(17) lgkmcnt(6)
    v_mfma_f32_16x16x32_bf16 v[8:11], v[168:171], v[88:91], v[8:11]
    s_waitcnt vmcnt(16)
    v_mfma_f32_16x16x32_bf16 v[12:15], v[168:171], v[92:95], v[12:15]
    s_waitcnt vmcnt(15)
    v_mfma_f32_16x16x32_bf16 v[16:19], v[168:171], v[96:99], v[16:19]
    s_waitcnt vmcnt(14)
    v_mfma_f32_16x16x32_bf16 v[20:23], v[168:171], v[100:103], v[20:23]
    ds_read_b64_tr_b16 v[184:185], v209 offset:49152
    s_waitcnt vmcnt(13)
    v_mfma_f32_16x16x32_bf16 v[24:27], v[168:171], v[104:107], v[24:27]
    ds_read_b64_tr_b16 v[186:187], v209 offset:49664
    s_waitcnt lgkmcnt(6)
    v_mfma_f32_16x16x32_bf16 v[28:31], v[172:175], v[88:91], v[28:31]
    v_mfma_f32_16x16x32_bf16 v[32:35], v[172:175], v[92:95], v[32:35]
    ds_read_b64_tr_b16 v[188:189], v210 offset:49152
    v_mfma_f32_16x16x32_bf16 v[36:39], v[172:175], v[96:99], v[36:39]
    ds_read_b64_tr_b16 v[190:191], v210 offset:49664
    v_mfma_f32_16x16x32_bf16 v[40:43], v[172:175], v[100:103], v[40:43]
    v_mfma_f32_16x16x32_bf16 v[44:47], v[172:175], v[104:107], v[44:47]
    ds_read_b64_tr_b16 v[192:193], v211 offset:49152
    s_waitcnt lgkmcnt(7)
    v_mfma_f32_16x16x32_bf16 v[48:51], v[176:179], v[88:91], v[48:51]
    ds_read_b64_tr_b16 v[194:195], v211 offset:49664
    v_mfma_f32_16x16x32_bf16 v[52:55], v[176:179], v[92:95], v[52:55]
    v_mfma_f32_16x16x32_bf16 v[56:59], v[176:179], v[96:99], v[56:59]
    ds_read_b64_tr_b16 v[196:197], v212 offset:49152
    v_mfma_f32_16x16x32_bf16 v[60:63], v[176:179], v[100:103], v[60:63]
    ds_read_b64_tr_b16 v[198:199], v212 offset:49664
    v_mfma_f32_16x16x32_bf16 v[64:67], v[176:179], v[104:107], v[64:67]
    s_waitcnt lgkmcnt(8)
    v_mfma_f32_16x16x32_bf16 v[68:71], v[180:183], v[88:91], v[68:71]
    v_mfma_f32_16x16x32_bf16 v[72:75], v[180:183], v[92:95], v[72:75]
    v_mfma_f32_16x16x32_bf16 v[76:79], v[180:183], v[96:99], v[76:79]
    v_mfma_f32_16x16x32_bf16 v[80:83], v[180:183], v[100:103], v[80:83]
    v_mfma_f32_16x16x32_bf16 v[84:87], v[180:183], v[104:107], v[84:87]
    v_and_b32 v3, 15, v2
    v_lshrrev_b32 v4, 4, v2
    v_lshrrev_b32 v5, 5, v2
    v_xor_b32 v3, v3, v5
    v_lshl_add_u32 v3, v4, 4, v3
    v_lshlrev_b32 v3, 4, v3
    v_add_u32 v244, s49, v3
    v_xor_b32 v245, 32, v244
    v_xor_b32 v246, 64, v244
    v_xor_b32 v247, 96, v244
    v_add_u32 v248, 81920, v244
    v_add_u32 v249, 81920, v245
    v_add_u32 v250, 81920, v246
    v_add_u32 v251, 81920, v247
    v_lshrrev_b32 v3, 3, v0
    v_and_b32 v4, 15, v3
    v_and_b32 v5, 7, v0
    v_xor_b32 v4, v4, v5
    v_lshlrev_b32 v4, 4, v4
    v_lshl_add_u32 v4, v5, 9, v4
    v_lshrrev_b32 v3, 4, v3
    v_lshl_add_u32 v214, v3, 14, v4
    v_add_u32 v252, 81920, v4
    s_waitcnt vmcnt(12) lgkmcnt(6)
    v_mfma_f32_16x16x32_bf16 v[8:11], v[184:187], v[108:111], v[8:11]
    s_waitcnt vmcnt(11)
    v_mfma_f32_16x16x32_bf16 v[12:15], v[184:187], v[112:115], v[12:15]
    s_waitcnt vmcnt(10)
    v_mfma_f32_16x16x32_bf16 v[16:19], v[184:187], v[116:119], v[16:19]
    s_waitcnt vmcnt(9)
    v_mfma_f32_16x16x32_bf16 v[20:23], v[184:187], v[120:123], v[20:23]
    ds_read_b64_tr_b16 v[168:169], v232 offset:0
    s_waitcnt vmcnt(8)
    v_mfma_f32_16x16x32_bf16 v[24:27], v[184:187], v[124:127], v[24:27]
    ds_read_b64_tr_b16 v[170:171], v232 offset:512
    s_waitcnt lgkmcnt(6)
    v_mfma_f32_16x16x32_bf16 v[28:31], v[188:191], v[108:111], v[28:31]
    v_mfma_f32_16x16x32_bf16 v[32:35], v[188:191], v[112:115], v[32:35]
    ds_read_b64_tr_b16 v[172:173], v233 offset:0
    v_mfma_f32_16x16x32_bf16 v[36:39], v[188:191], v[116:119], v[36:39]
    ds_read_b64_tr_b16 v[174:175], v233 offset:512
    v_mfma_f32_16x16x32_bf16 v[40:43], v[188:191], v[120:123], v[40:43]
    v_mfma_f32_16x16x32_bf16 v[44:47], v[188:191], v[124:127], v[44:47]
    ds_read_b64_tr_b16 v[176:177], v234 offset:0
    s_waitcnt lgkmcnt(7)
    v_mfma_f32_16x16x32_bf16 v[48:51], v[192:195], v[108:111], v[48:51]
    ds_read_b64_tr_b16 v[178:179], v234 offset:512
    v_mfma_f32_16x16x32_bf16 v[52:55], v[192:195], v[112:115], v[52:55]
    v_mfma_f32_16x16x32_bf16 v[56:59], v[192:195], v[116:119], v[56:59]
    ds_read_b64_tr_b16 v[180:181], v235 offset:0
    v_mfma_f32_16x16x32_bf16 v[60:63], v[192:195], v[120:123], v[60:63]
    ds_read_b64_tr_b16 v[182:183], v235 offset:512
    v_mfma_f32_16x16x32_bf16 v[64:67], v[192:195], v[124:127], v[64:67]
    s_waitcnt lgkmcnt(8)
    v_mfma_f32_16x16x32_bf16 v[68:71], v[196:199], v[108:111], v[68:71]
    v_mfma_f32_16x16x32_bf16 v[72:75], v[196:199], v[112:115], v[72:75]
    v_mfma_f32_16x16x32_bf16 v[76:79], v[196:199], v[116:119], v[76:79]
    v_mfma_f32_16x16x32_bf16 v[80:83], v[196:199], v[120:123], v[80:83]
    v_mfma_f32_16x16x32_bf16 v[84:87], v[196:199], v[124:127], v[84:87]
    s_waitcnt vmcnt(7) lgkmcnt(6)
    v_mfma_f32_16x16x32_bf16 v[8:11], v[168:171], v[128:131], v[8:11]
    s_waitcnt vmcnt(6)
    v_mfma_f32_16x16x32_bf16 v[12:15], v[168:171], v[132:135], v[12:15]
    s_waitcnt vmcnt(5)
    v_mfma_f32_16x16x32_bf16 v[16:19], v[168:171], v[136:139], v[16:19]
    s_waitcnt vmcnt(4)
    v_mfma_f32_16x16x32_bf16 v[20:23], v[168:171], v[140:143], v[20:23]
    s_waitcnt vmcnt(3)
    v_mfma_f32_16x16x32_bf16 v[24:27], v[168:171], v[144:147], v[24:27]
    s_waitcnt lgkmcnt(4)
    v_mfma_f32_16x16x32_bf16 v[28:31], v[172:175], v[128:131], v[28:31]
    v_mfma_f32_16x16x32_bf16 v[32:35], v[172:175], v[132:135], v[32:35]
    v_mfma_f32_16x16x32_bf16 v[36:39], v[172:175], v[136:139], v[36:39]
    v_mfma_f32_16x16x32_bf16 v[40:43], v[172:175], v[140:143], v[40:43]
    ds_write_b128 v244, v[8:11] offset:0
    v_mfma_f32_16x16x32_bf16 v[44:47], v[172:175], v[144:147], v[44:47]
    ds_write_b128 v244, v[12:15] offset:16384
    s_waitcnt lgkmcnt(4)
    v_mfma_f32_16x16x32_bf16 v[48:51], v[176:179], v[128:131], v[48:51]
    ds_write_b128 v244, v[16:19] offset:32768
    v_mfma_f32_16x16x32_bf16 v[52:55], v[176:179], v[132:135], v[52:55]
    ds_write_b128 v244, v[20:23] offset:49152
    v_mfma_f32_16x16x32_bf16 v[56:59], v[176:179], v[136:139], v[56:59]
    ds_write_b128 v248, v[24:27] offset:0
    v_mfma_f32_16x16x32_bf16 v[60:63], v[176:179], v[140:143], v[60:63]
    ds_write_b128 v245, v[28:31] offset:1024
    v_mfma_f32_16x16x32_bf16 v[64:67], v[176:179], v[144:147], v[64:67]
    ds_write_b128 v245, v[32:35] offset:17408
    s_waitcnt lgkmcnt(7)
    v_mfma_f32_16x16x32_bf16 v[68:71], v[180:183], v[128:131], v[68:71]
    ds_write_b128 v245, v[36:39] offset:33792
    v_mfma_f32_16x16x32_bf16 v[72:75], v[180:183], v[132:135], v[72:75]
    ds_write_b128 v245, v[40:43] offset:50176
    v_mfma_f32_16x16x32_bf16 v[76:79], v[180:183], v[136:139], v[76:79]
    ds_write_b128 v249, v[44:47] offset:1024
    v_mfma_f32_16x16x32_bf16 v[80:83], v[180:183], v[140:143], v[80:83]
    v_mfma_f32_16x16x32_bf16 v[84:87], v[180:183], v[144:147], v[84:87]
    ds_write_b128 v246, v[48:51] offset:2048
    ds_write_b128 v246, v[52:55] offset:18432
    ds_write_b128 v246, v[56:59] offset:34816
    ds_write_b128 v246, v[60:63] offset:51200
    ds_write_b128 v250, v[64:67] offset:2048
    ds_write_b128 v247, v[68:71] offset:3072
    ds_write_b128 v247, v[72:75] offset:19456
    ds_write_b128 v247, v[76:79] offset:35840
    ds_write_b128 v247, v[80:83] offset:52224
    ds_write_b128 v251, v[84:87] offset:3072
    s_waitcnt lgkmcnt(0)
    s_barrier
    ds_read_b128 v[88:91], v214 offset:0
    ds_read_b128 v[92:95], v214 offset:256
    ds_read_b128 v[96:99], v214 offset:4096
    ds_read_b128 v[100:103], v214 offset:4352
    ds_read_b128 v[104:107], v214 offset:8192
    ds_read_b128 v[108:111], v214 offset:8448
    ds_read_b128 v[112:115], v214 offset:12288
    ds_read_b128 v[116:119], v214 offset:12544
    ds_read_b128 v[120:123], v214 offset:32768
    ds_read_b128 v[124:127], v214 offset:33024
    ds_read_b128 v[128:131], v214 offset:36864
    ds_read_b128 v[132:135], v214 offset:37120
    ds_read_b128 v[136:139], v214 offset:40960
    ds_read_b128 v[140:143], v214 offset:41216
    ds_read_b128 v[144:147], v214 offset:45056
    ds_read_b128 v[148:151], v214 offset:45312
    s_waitcnt lgkmcnt(13)
    v_add_f32 v88, v88, v96
    s_waitcnt lgkmcnt(9)
    v_add_f32 v104, v104, v112
    v_add_f32 v89, v89, v97
    v_add_f32 v105, v105, v113
    v_add_f32 v90, v90, v98
    v_add_f32 v106, v106, v114
    v_add_f32 v91, v91, v99
    v_add_f32 v107, v107, v115
    v_add_f32 v92, v92, v100
    s_waitcnt lgkmcnt(8)
    v_add_f32 v108, v108, v116
    v_add_f32 v93, v93, v101
    v_add_f32 v109, v109, v117
    v_add_f32 v94, v94, v102
    v_add_f32 v110, v110, v118
    v_add_f32 v95, v95, v103
    v_add_f32 v111, v111, v119
    s_waitcnt vmcnt(2)
    v_lshlrev_b32 v5, 16, v216
    v_and_b32 v6, 0xffff0000, v216
    v_add_f32 v88, v88, v104
    v_add_f32 v89, v89, v105
    v_add_f32 v5, v5, v88
    v_add_f32 v6, v6, v89
    v_cvt_pk_bf16_f32 v216, v5, v6
    v_lshlrev_b32 v5, 16, v217
    v_and_b32 v6, 0xffff0000, v217
    v_add_f32 v90, v90, v106
    v_add_f32 v91, v91, v107
    v_add_f32 v5, v5, v90
    v_add_f32 v6, v6, v91
    v_cvt_pk_bf16_f32 v217, v5, v6
    v_lshlrev_b32 v5, 16, v218
    v_and_b32 v6, 0xffff0000, v218
    v_add_f32 v92, v92, v108
    v_add_f32 v93, v93, v109
    v_add_f32 v5, v5, v92
    v_add_f32 v6, v6, v93
    v_cvt_pk_bf16_f32 v218, v5, v6
    v_lshlrev_b32 v5, 16, v219
    v_and_b32 v6, 0xffff0000, v219
    v_add_f32 v94, v94, v110
    v_add_f32 v95, v95, v111
    v_add_f32 v5, v5, v94
    v_add_f32 v6, v6, v95
    v_cvt_pk_bf16_f32 v219, v5, v6
    buffer_store_dwordx4 v[216:219], v213, s[28:31], s52 offen sc1
    ds_read_b128 v[152:155], v252 offset:0
    ds_read_b128 v[156:159], v252 offset:256
    ds_read_b128 v[160:163], v252 offset:4096
    ds_read_b128 v[164:167], v252 offset:4352
    ds_read_b128 v[168:171], v252 offset:8192
    ds_read_b128 v[172:175], v252 offset:8448
    ds_read_b128 v[176:179], v252 offset:12288
    ds_read_b128 v[180:183], v252 offset:12544
    s_waitcnt lgkmcnt(13)
    v_add_f32 v120, v120, v128
    s_waitcnt lgkmcnt(9)
    v_add_f32 v136, v136, v144
    v_add_f32 v121, v121, v129
    v_add_f32 v137, v137, v145
    v_add_f32 v122, v122, v130
    v_add_f32 v138, v138, v146
    v_add_f32 v123, v123, v131
    v_add_f32 v139, v139, v147
    v_add_f32 v124, v124, v132
    s_waitcnt lgkmcnt(8)
    v_add_f32 v140, v140, v148
    v_add_f32 v125, v125, v133
    v_add_f32 v141, v141, v149
    v_add_f32 v126, v126, v134
    v_add_f32 v142, v142, v150
    v_add_f32 v127, v127, v135
    v_add_f32 v143, v143, v151
    s_waitcnt vmcnt(2)
    v_lshlrev_b32 v5, 16, v220
    v_and_b32 v6, 0xffff0000, v220
    v_add_f32 v120, v120, v136
    v_add_f32 v121, v121, v137
    v_add_f32 v5, v5, v120
    v_add_f32 v6, v6, v121
    v_cvt_pk_bf16_f32 v220, v5, v6
    v_lshlrev_b32 v5, 16, v221
    v_and_b32 v6, 0xffff0000, v221
    v_add_f32 v122, v122, v138
    v_add_f32 v123, v123, v139
    v_add_f32 v5, v5, v122
    v_add_f32 v6, v6, v123
    v_cvt_pk_bf16_f32 v221, v5, v6
    v_lshlrev_b32 v5, 16, v222
    v_and_b32 v6, 0xffff0000, v222
    v_add_f32 v124, v124, v140
    v_add_f32 v125, v125, v141
    v_add_f32 v5, v5, v124
    v_add_f32 v6, v6, v125
    v_cvt_pk_bf16_f32 v222, v5, v6
    v_lshlrev_b32 v5, 16, v223
    v_and_b32 v6, 0xffff0000, v223
    v_add_f32 v126, v126, v142
    v_add_f32 v127, v127, v143
    v_add_f32 v5, v5, v126
    v_add_f32 v6, v6, v127
    v_cvt_pk_bf16_f32 v223, v5, v6
    buffer_store_dwordx4 v[220:223], v213, s[28:31], s53 offen sc1
    s_cmp_ge_u32 s34, 2
    s_cbranch_scc1 K3_DONE
    s_waitcnt lgkmcnt(5)
    v_add_f32 v152, v152, v160
    s_waitcnt lgkmcnt(1)
    v_add_f32 v168, v168, v176
    v_add_f32 v153, v153, v161
    v_add_f32 v169, v169, v177
    v_add_f32 v154, v154, v162
    v_add_f32 v170, v170, v178
    v_add_f32 v155, v155, v163
    v_add_f32 v171, v171, v179
    v_add_f32 v156, v156, v164
    s_waitcnt lgkmcnt(0)
    v_add_f32 v172, v172, v180
    v_add_f32 v157, v157, v165
    v_add_f32 v173, v173, v181
    v_add_f32 v158, v158, v166
    v_add_f32 v174, v174, v182
    v_add_f32 v159, v159, v167
    v_add_f32 v175, v175, v183
    s_waitcnt vmcnt(2)
    v_lshlrev_b32 v5, 16, v224
    v_and_b32 v6, 0xffff0000, v224
    v_add_f32 v152, v152, v168
    v_add_f32 v153, v153, v169
    v_add_f32 v5, v5, v152
    v_add_f32 v6, v6, v153
    v_cvt_pk_bf16_f32 v224, v5, v6
    v_lshlrev_b32 v5, 16, v225
    v_and_b32 v6, 0xffff0000, v225
    v_add_f32 v154, v154, v170
    v_add_f32 v155, v155, v171
    v_add_f32 v5, v5, v154
    v_add_f32 v6, v6, v155
    v_cvt_pk_bf16_f32 v225, v5, v6
    v_lshlrev_b32 v5, 16, v226
    v_and_b32 v6, 0xffff0000, v226
    v_add_f32 v156, v156, v172
    v_add_f32 v157, v157, v173
    v_add_f32 v5, v5, v156
    v_add_f32 v6, v6, v157
    v_cvt_pk_bf16_f32 v226, v5, v6
    v_lshlrev_b32 v5, 16, v227
    v_and_b32 v6, 0xffff0000, v227
    v_add_f32 v158, v158, v174
    v_add_f32 v159, v159, v175
    v_add_f32 v5, v5, v158
    v_add_f32 v6, v6, v159
    v_cvt_pk_bf16_f32 v227, v5, v6
    buffer_store_dwordx4 v[224:227], v213, s[28:31], s54 offen sc1
K3_DONE:
K1_END:
    s_endpgm
K2_CONS:
    s_mov_b32 s32, s48
    s_mov_b32 s33, s49
    s_mov_b32 s34, s51
    s_mov_b32 s48, s52
    s_lshl_b32 s49, s34, 12
    s_mov_b32 s8, s14
    s_mov_b32 s9, s15
    v_mov_b32 v2, v1
    v_and_b32 v3, 15, v2
    v_lshrrev_b32 v4, 4, v2
    v_lshlrev_b32 v214, 4, v2
    s_add_u32 s72, s8, 0x1dc2000
    s_addc_u32 s73, s9, 0
    s_mov_b32 s74, 0x40000
    s_mov_b32 s75, 0x00020000
    s_add_u32 s24, s8, 0x1200000
    s_addc_u32 s25, s9, 0
    s_mov_b32 s26, 0xb40000
    s_mov_b32 s27, 0x00020000
    v_lshrrev_b32 v5, 1, v3
    v_xor_b32 v5, v5, v4
    v_lshlrev_b32 v5, 4, v5
    v_lshlrev_b32 v6, 7, v3
    v_add3_u32 v209, v5, v6, s49
    v_xor_b32 v210, 64, v209
    v_lshrrev_b32 v5, 3, v3
    v_add_u32 v5, s48, v5
    v_and_b32 v6, 1, v5
    v_lshlrev_b32 v6, 2, v6
    v_and_b32 v7, 3, v3
    v_bfe_u32 v1, v3, 2, 1
    v_lshl_add_u32 v7, v1, 3, v7
    v_xor_b32 v7, v7, v6
    v_lshl_add_u32 v7, v4, 4, v7
    v_lshlrev_b32 v7, 4, v7
    v_lshl_add_u32 v7, v5, 10, v7
    v_add_u32 v211, 16384, v7
    v_xor_b32 v212, 64, v211
    s_cmp_eq_u32 s48, 0
    s_cselect_b32 s46, 8192, 0
    s_add_u32 s46, s46, 16384
    v_add_u32 v213, s46, v214
    v_lshrrev_b32 v5, 1, v4
    v_lshlrev_b32 v5, 8, v5
    v_lshl_add_u32 v5, v3, 4, v5
    v_and_b32 v6, 1, v4
    v_lshl_add_u32 v215, v6, 3, v5
    s_lshl_b32 s46, s32, 3
    s_lshl_b32 s47, s34, 1
    s_add_u32 s46, s46, s47
    s_mul_i32 s47, s33, 9
    s_add_u32 s47, s47, s48
    s_lshr_b32 s47, s47, 1
    s_mul_i32 s51, s46, 72
    s_add_u32 s51, s51, s47
    s_lshl_b32 s51, s51, 10
    s_add_u32 s52, s51, 73728
    s_mul_i32 s53, s46, 90
    s_add_u32 s53, s53, s47
    s_add_u32 s53, s53, 18
    s_lshl_b32 s53, s53, 10
    s_add_u32 s54, s53, 92160
    s_cmp_eq_u32 s48, 0
    s_cselect_b32 s46, 4608, 0
    s_sub_u32 s46, s46, 512
    s_add_u32 s55, s51, s46
    s_add_u32 s56, s52, s46
    s_add_u32 s57, s53, s46
    s_add_u32 s58, s54, s46
    s_waitcnt vmcnt(6)
    v_lshlrev_b32 v216, 16, v216
    s_waitcnt vmcnt(5)
    v_lshlrev_b32 v217, 16, v217
    v_mov_b32 v8, v216
    v_mov_b32 v9, v216
    v_mov_b32 v10, v216
    v_mov_b32 v11, v216
    v_mov_b32 v12, v217
    v_mov_b32 v13, v217
    v_mov_b32 v14, v217
    v_mov_b32 v15, v217
    v_mov_b32 v16, v216
    v_mov_b32 v17, v216
    v_mov_b32 v18, v216
    v_mov_b32 v19, v216
    v_mov_b32 v20, v217
    v_mov_b32 v21, v217
    v_mov_b32 v22, v217
    v_mov_b32 v23, v217
    v_mov_b32 v24, v216
    v_mov_b32 v25, v216
    v_mov_b32 v26, v216
    v_mov_b32 v27, v216
    v_mov_b32 v28, v217
    v_mov_b32 v29, v217
    v_mov_b32 v30, v217
    v_mov_b32 v31, v217
    v_mov_b32 v32, v216
    v_mov_b32 v33, v216
    v_mov_b32 v34, v216
    v_mov_b32 v35, v216
    v_mov_b32 v36, v217
    v_mov_b32 v37, v217
    v_mov_b32 v38, v217
    v_mov_b32 v39, v217
    v_mov_b32 v40, v216
    v_mov_b32 v41, v216
    v_mov_b32 v42, v216
    v_mov_b32 v43, v216
    v_mov_b32 v44, v217
    v_mov_b32 v45, v217
    v_mov_b32 v46, v217
    v_mov_b32 v47, v217
    v_mov_b32 v48, v216
    v_mov_b32 v49, v216
    v_mov_b32 v50, v216
    v_mov_b32 v51, v216
    v_mov_b32 v52, v217
    v_mov_b32 v53, v217
    v_mov_b32 v54, v217
    v_mov_b32 v55, v217
    v_mov_b32 v56, v216
    v_mov_b32 v57, v216
    v_mov_b32 v58, v216
    v_mov_b32 v59, v216
    v_mov_b32 v60, v217
    v_mov_b32 v61, v217
    v_mov_b32 v62, v217
    v_mov_b32 v63, v217
    v_mov_b32 v64, v216
    v_mov_b32 v65, v216
    v_mov_b32 v66, v216
    v_mov_b32 v67, v216
    v_mov_b32 v68, v217
    v_mov_b32 v69, v217
    v_mov_b32 v70, v217
    v_mov_b32 v71, v217
    v_mov_b32 v72, v216
    v_mov_b32 v73, v216
    v_mov_b32 v74, v216
    v_mov_b32 v75, v216
    v_mov_b32 v76, v217
    v_mov_b32 v77, v217
    v_mov_b32 v78, v217
    v_mov_b32 v79, v217
    v_add_u32 v224, 69632, v209
    v_add_u32 v225, 69632, v210
    v_add_u32 v226, 69632, v211
    v_add_u32 v227, 69632, v212
    v_add_u32 v228, 69632, v213
    s_waitcnt lgkmcnt(0)
    s_mov_b32 s78, 0xc0135761
    v_mov_b32 v7, 0xbdd2d3e8
    s_setprio 1
    s_barrier
    ds_read_b128 v[80:83], v209 offset:0
    ds_read_b128 v[84:87], v209 offset:2048
    ds_read_b128 v[88:91], v211 offset:0
    ds_read_b128 v[92:95], v212 offset:0
    ds_read_b128 v[96:99], v211 offset:2048
    ds_read_b128 v[100:103], v212 offset:2048
    ds_read_b128 v[104:107], v211 offset:4096
    ds_read_b128 v[108:111], v212 offset:4096
    ds_read_b128 v[112:115], v211 offset:6144
    ds_read_b128 v[116:119], v212 offset:6144
    ds_read_b128 v[120:123], v213 offset:0
    s_waitcnt lgkmcnt(0)
    v_mfma_f32_16x16x32_bf16 v[8:11], v[88:91], v[80:83], v[8:11]
    ds_read_b128 v[124:127], v210 offset:0
    v_lshlrev_b32 v232, 16, v168
    v_mfma_f32_16x16x32_bf16 v[12:15], v[88:91], v[84:87], v[12:15]
    ds_read_b128 v[128:131], v210 offset:2048
    v_and_b32 v233, 0xffff0000, v168
    v_mfma_f32_16x16x32_bf16 v[16:19], v[92:95], v[80:83], v[16:19]
    ds_read_b128 v[132:135], v211 offset:9216
    v_lshlrev_b32 v234, 16, v169
    v_mfma_f32_16x16x32_bf16 v[20:23], v[92:95], v[84:87], v[20:23]
    ds_read_b128 v[136:139], v212 offset:9216
    v_and_b32 v235, 0xffff0000, v169
    v_mfma_f32_16x16x32_bf16 v[24:27], v[96:99], v[80:83], v[24:27]
    ds_read_b128 v[140:143], v211 offset:11264
    v_mul_f32 v236, v232, v232
    v_mfma_f32_16x16x32_bf16 v[28:31], v[96:99], v[84:87], v[28:31]
    ds_read_b128 v[144:147], v212 offset:11264
    v_mul_f32 v237, v233, v233
    v_mfma_f32_16x16x32_bf16 v[32:35], v[100:103], v[80:83], v[32:35]
    ds_read_b128 v[148:151], v211 offset:13312
    v_mul_f32 v238, v234, v234
    v_mfma_f32_16x16x32_bf16 v[36:39], v[100:103], v[84:87], v[36:39]
    ds_read_b128 v[152:155], v212 offset:13312
    v_mul_f32 v239, v235, v235
    v_mfma_f32_16x16x32_bf16 v[40:43], v[104:107], v[80:83], v[40:43]
    ds_read_b128 v[156:159], v211 offset:15360
    v_fma_f32 v236, v236, v7, s78
    v_mfma_f32_16x16x32_bf16 v[44:47], v[104:107], v[84:87], v[44:47]
    ds_read_b128 v[160:163], v212 offset:15360
    v_fma_f32 v237, v237, v7, s78
    v_mfma_f32_16x16x32_bf16 v[48:51], v[108:111], v[80:83], v[48:51]
    ds_read_b128 v[164:167], v213 offset:9216
    v_fma_f32 v238, v238, v7, s78
    v_mfma_f32_16x16x32_bf16 v[52:55], v[108:111], v[84:87], v[52:55]
    v_fma_f32 v239, v239, v7, s78
    v_mul_f32 v236, v236, v232
    v_mfma_f32_16x16x32_bf16 v[56:59], v[112:115], v[80:83], v[56:59]
    v_mfma_f32_16x16x32_bf16 v[60:63], v[112:115], v[84:87], v[60:63]
    v_mfma_f32_16x16x32_bf16 v[64:67], v[116:119], v[80:83], v[64:67]
    v_mfma_f32_16x16x32_bf16 v[68:71], v[116:119], v[84:87], v[68:71]
    v_mfma_f32_16x16x32_bf16 v[72:75], v[120:123], v[80:83], v[72:75]
    v_mfma_f32_16x16x32_bf16 v[76:79], v[120:123], v[84:87], v[76:79]
    s_waitcnt lgkmcnt(0)
    v_mov_b32 v218, 159744
    v_mov_b32 v219, 1
    s_waitcnt vmcnt(0) lgkmcnt(0)
    s_mov_b64 exec, 1
    ds_add_rtn_u32 v220, v218, v219 offset:8
    s_waitcnt lgkmcnt(0)
    v_readfirstlane_b32 s47, v220
    s_nop 0
    s_cmp_lg_u32 s47, 7
    s_cbranch_scc1 K1_SIGC
    s_mov_b64 exec, -1
    v_mov_b32 v219, 1
    v_lshlrev_b32 v218, 2, v2
    s_lshl_b32 s46, s32, 14
    s_lshl_b32 s47, s33, 10
    s_add_u32 s46, s46, s47
    s_mov_b32 exec_hi, 0
    buffer_store_dword v219, v218, s[72:75], s46 offen offset:128 sc1
K1_SIGC:
    s_mov_b64 exec, -1
    s_barrier
    v_mfma_f32_16x16x32_bf16 v[8:11], v[132:135], v[124:127], v[8:11]
    ds_read_b128 v[80:83], v209 offset:34816
    v_mul_f32 v237, v237, v233
    v_mfma_f32_16x16x32_bf16 v[12:15], v[132:135], v[128:131], v[12:15]
    ds_read_b128 v[84:87], v209 offset:36864
    v_mul_f32 v238, v238, v234
    v_mfma_f32_16x16x32_bf16 v[16:19], v[136:139], v[124:127], v[16:19]
    ds_read_b128 v[88:91], v211 offset:34816
    v_mul_f32 v239, v239, v235
    v_mfma_f32_16x16x32_bf16 v[20:23], v[136:139], v[128:131], v[20:23]
    ds_read_b128 v[92:95], v212 offset:34816
    v_mfma_f32_16x16x32_bf16 v[24:27], v[140:143], v[124:127], v[24:27]
    ds_read_b128 v[96:99], v211 offset:36864
    v_mfma_f32_16x16x32_bf16 v[28:31], v[140:143], v[128:131], v[28:31]
    ds_read_b128 v[100:103], v212 offset:36864
    v_mfma_f32_16x16x32_bf16 v[32:35], v[144:147], v[124:127], v[32:35]
    ds_read_b128 v[104:107], v211 offset:38912
    v_mfma_f32_16x16x32_bf16 v[36:39], v[144:147], v[128:131], v[36:39]
    ds_read_b128 v[108:111], v212 offset:38912
    v_mfma_f32_16x16x32_bf16 v[40:43], v[148:151], v[124:127], v[40:43]
    ds_read_b128 v[112:115], v211 offset:40960
    v_mfma_f32_16x16x32_bf16 v[44:47], v[148:151], v[128:131], v[44:47]
    ds_read_b128 v[116:119], v212 offset:40960
    v_mfma_f32_16x16x32_bf16 v[48:51], v[152:155], v[124:127], v[48:51]
    ds_read_b128 v[120:123], v213 offset:34816
    v_mfma_f32_16x16x32_bf16 v[52:55], v[152:155], v[128:131], v[52:55]
    v_exp_f32 v236, v236
    v_mfma_f32_16x16x32_bf16 v[56:59], v[156:159], v[124:127], v[56:59]
    v_exp_f32 v237, v237
    v_mfma_f32_16x16x32_bf16 v[60:63], v[156:159], v[128:131], v[60:63]
    v_exp_f32 v238, v238
    v_mfma_f32_16x16x32_bf16 v[64:67], v[160:163], v[124:127], v[64:67]
    v_exp_f32 v239, v239
    v_mfma_f32_16x16x32_bf16 v[68:71], v[160:163], v[128:131], v[68:71]
    v_add_f32 v236, 1.0, v236
    v_add_f32 v237, 1.0, v237
    v_mfma_f32_16x16x32_bf16 v[72:75], v[164:167], v[124:127], v[72:75]
    v_add_f32 v238, 1.0, v238
    v_add_f32 v239, 1.0, v239
    v_mfma_f32_16x16x32_bf16 v[76:79], v[164:167], v[128:131], v[76:79]
    s_waitcnt lgkmcnt(0)
    v_mfma_f32_16x16x32_bf16 v[8:11], v[88:91], v[80:83], v[8:11]
    ds_read_b128 v[124:127], v210 offset:34816
    v_mfma_f32_16x16x32_bf16 v[12:15], v[88:91], v[84:87], v[12:15]
    ds_read_b128 v[128:131], v210 offset:36864
    v_mfma_f32_16x16x32_bf16 v[16:19], v[92:95], v[80:83], v[16:19]
    ds_read_b128 v[132:135], v211 offset:44032
    v_mfma_f32_16x16x32_bf16 v[20:23], v[92:95], v[84:87], v[20:23]
    ds_read_b128 v[136:139], v212 offset:44032
    v_mfma_f32_16x16x32_bf16 v[24:27], v[96:99], v[80:83], v[24:27]
    ds_read_b128 v[140:143], v211 offset:46080
    v_mfma_f32_16x16x32_bf16 v[28:31], v[96:99], v[84:87], v[28:31]
    ds_read_b128 v[144:147], v212 offset:46080
    v_mfma_f32_16x16x32_bf16 v[32:35], v[100:103], v[80:83], v[32:35]
    ds_read_b128 v[148:151], v211 offset:48128
    v_mfma_f32_16x16x32_bf16 v[36:39], v[100:103], v[84:87], v[36:39]
    ds_read_b128 v[152:155], v212 offset:48128
    v_mfma_f32_16x16x32_bf16 v[40:43], v[104:107], v[80:83], v[40:43]
    ds_read_b128 v[156:159], v211 offset:50176
    v_mfma_f32_16x16x32_bf16 v[44:47], v[104:107], v[84:87], v[44:47]
    ds_read_b128 v[160:163], v212 offset:50176
    v_mfma_f32_16x16x32_bf16 v[48:51], v[108:111], v[80:83], v[48:51]
    ds_read_b128 v[164:167], v213 offset:44032
    v_mfma_f32_16x16x32_bf16 v[52:55], v[108:111], v[84:87], v[52:55]
    v_rcp_f32 v236, v236
    v_mfma_f32_16x16x32_bf16 v[56:59], v[112:115], v[80:83], v[56:59]
    v_rcp_f32 v237, v237
    v_mfma_f32_16x16x32_bf16 v[60:63], v[112:115], v[84:87], v[60:63]
    v_rcp_f32 v238, v238
    v_mfma_f32_16x16x32_bf16 v[64:67], v[116:119], v[80:83], v[64:67]
    v_rcp_f32 v239, v239
    v_mfma_f32_16x16x32_bf16 v[68:71], v[116:119], v[84:87], v[68:71]
    v_mul_f32 v232, v232, v236
    v_mul_f32 v233, v233, v237
    v_mfma_f32_16x16x32_bf16 v[72:75], v[120:123], v[80:83], v[72:75]
    v_mul_f32 v234, v234, v238
    v_mul_f32 v235, v235, v239
    v_mfma_f32_16x16x32_bf16 v[76:79], v[120:123], v[84:87], v[76:79]
    s_waitcnt lgkmcnt(0)
    s_barrier
    v_mfma_f32_16x16x32_bf16 v[8:11], v[132:135], v[124:127], v[8:11]
    ds_read_b128 v[80:83], v224 offset:0
    v_cvt_pk_bf16_f32 v168, v232, v233
    v_mfma_f32_16x16x32_bf16 v[12:15], v[132:135], v[128:131], v[12:15]
    ds_read_b128 v[84:87], v224 offset:2048
    v_cvt_pk_bf16_f32 v169, v234, v235
    v_mfma_f32_16x16x32_bf16 v[16:19], v[136:139], v[124:127], v[16:19]
    ds_read_b128 v[88:91], v226 offset:0
    v_lshlrev_b32 v240, 16, v170
    v_mfma_f32_16x16x32_bf16 v[20:23], v[136:139], v[128:131], v[20:23]
    ds_read_b128 v[92:95], v227 offset:0
    v_and_b32 v241, 0xffff0000, v170
    v_mfma_f32_16x16x32_bf16 v[24:27], v[140:143], v[124:127], v[24:27]
    ds_read_b128 v[96:99], v226 offset:2048
    v_lshlrev_b32 v242, 16, v171
    v_mfma_f32_16x16x32_bf16 v[28:31], v[140:143], v[128:131], v[28:31]
    ds_read_b128 v[100:103], v227 offset:2048
    v_and_b32 v243, 0xffff0000, v171
    v_mfma_f32_16x16x32_bf16 v[32:35], v[144:147], v[124:127], v[32:35]
    ds_read_b128 v[104:107], v226 offset:4096
    v_mul_f32 v244, v240, v240
    v_mfma_f32_16x16x32_bf16 v[36:39], v[144:147], v[128:131], v[36:39]
    ds_read_b128 v[108:111], v227 offset:4096
    v_mul_f32 v245, v241, v241
    v_mfma_f32_16x16x32_bf16 v[40:43], v[148:151], v[124:127], v[40:43]
    ds_read_b128 v[112:115], v226 offset:6144
    v_mul_f32 v246, v242, v242
    v_mfma_f32_16x16x32_bf16 v[44:47], v[148:151], v[128:131], v[44:47]
    ds_read_b128 v[116:119], v227 offset:6144
    v_mul_f32 v247, v243, v243
    v_mfma_f32_16x16x32_bf16 v[48:51], v[152:155], v[124:127], v[48:51]
    ds_read_b128 v[120:123], v228 offset:0
    v_fma_f32 v244, v244, v7, s78
    v_mfma_f32_16x16x32_bf16 v[52:55], v[152:155], v[128:131], v[52:55]
    v_fma_f32 v245, v245, v7, s78
    v_fma_f32 v246, v246, v7, s78
    v_mfma_f32_16x16x32_bf16 v[56:59], v[156:159], v[124:127], v[56:59]
    v_mfma_f32_16x16x32_bf16 v[60:63], v[156:159], v[128:131], v[60:63]
    v_mfma_f32_16x16x32_bf16 v[64:67], v[160:163], v[124:127], v[64:67]
    v_mfma_f32_16x16x32_bf16 v[68:71], v[160:163], v[128:131], v[68:71]
    v_mfma_f32_16x16x32_bf16 v[72:75], v[164:167], v[124:127], v[72:75]
    v_mfma_f32_16x16x32_bf16 v[76:79], v[164:167], v[128:131], v[76:79]
    s_waitcnt lgkmcnt(0)
    v_mfma_f32_16x16x32_bf16 v[8:11], v[88:91], v[80:83], v[8:11]
    ds_read_b128 v[124:127], v225 offset:0
    v_fma_f32 v247, v247, v7, s78
    v_mfma_f32_16x16x32_bf16 v[12:15], v[88:91], v[84:87], v[12:15]
    ds_read_b128 v[128:131], v225 offset:2048
    v_mul_f32 v244, v244, v240
    v_mfma_f32_16x16x32_bf16 v[16:19], v[92:95], v[80:83], v[16:19]
    ds_read_b128 v[132:135], v226 offset:9216
    v_mul_f32 v245, v245, v241
    v_mfma_f32_16x16x32_bf16 v[20:23], v[92:95], v[84:87], v[20:23]
    ds_read_b128 v[136:139], v227 offset:9216
    v_mul_f32 v246, v246, v242
    v_mfma_f32_16x16x32_bf16 v[24:27], v[96:99], v[80:83], v[24:27]
    ds_read_b128 v[140:143], v226 offset:11264
    v_mul_f32 v247, v247, v243
    v_mfma_f32_16x16x32_bf16 v[28:31], v[96:99], v[84:87], v[28:31]
    ds_read_b128 v[144:147], v227 offset:11264
    v_mfma_f32_16x16x32_bf16 v[32:35], v[100:103], v[80:83], v[32:35]
    ds_read_b128 v[148:151], v226 offset:13312
    v_mfma_f32_16x16x32_bf16 v[36:39], v[100:103], v[84:87], v[36:39]
    ds_read_b128 v[152:155], v227 offset:13312
    v_mfma_f32_16x16x32_bf16 v[40:43], v[104:107], v[80:83], v[40:43]
    ds_read_b128 v[156:159], v226 offset:15360
    v_mfma_f32_16x16x32_bf16 v[44:47], v[104:107], v[84:87], v[44:47]
    ds_read_b128 v[160:163], v227 offset:15360
    v_mfma_f32_16x16x32_bf16 v[48:51], v[108:111], v[80:83], v[48:51]
    ds_read_b128 v[164:167], v228 offset:9216
    v_mfma_f32_16x16x32_bf16 v[52:55], v[108:111], v[84:87], v[52:55]
    v_exp_f32 v244, v244
    v_mfma_f32_16x16x32_bf16 v[56:59], v[112:115], v[80:83], v[56:59]
    v_exp_f32 v245, v245
    v_mfma_f32_16x16x32_bf16 v[60:63], v[112:115], v[84:87], v[60:63]
    v_exp_f32 v246, v246
    v_mfma_f32_16x16x32_bf16 v[64:67], v[116:119], v[80:83], v[64:67]
    v_exp_f32 v247, v247
    v_mfma_f32_16x16x32_bf16 v[68:71], v[116:119], v[84:87], v[68:71]
    v_add_f32 v244, 1.0, v244
    v_add_f32 v245, 1.0, v245
    v_mfma_f32_16x16x32_bf16 v[72:75], v[120:123], v[80:83], v[72:75]
    v_add_f32 v246, 1.0, v246
    v_add_f32 v247, 1.0, v247
    v_mfma_f32_16x16x32_bf16 v[76:79], v[120:123], v[84:87], v[76:79]
    s_waitcnt lgkmcnt(0)
    s_barrier
    v_mfma_f32_16x16x32_bf16 v[8:11], v[132:135], v[124:127], v[8:11]
    ds_read_b128 v[80:83], v224 offset:34816
    v_mfma_f32_16x16x32_bf16 v[12:15], v[132:135], v[128:131], v[12:15]
    ds_read_b128 v[84:87], v224 offset:36864
    v_mfma_f32_16x16x32_bf16 v[16:19], v[136:139], v[124:127], v[16:19]
    ds_read_b128 v[88:91], v226 offset:34816
    v_mfma_f32_16x16x32_bf16 v[20:23], v[136:139], v[128:131], v[20:23]
    ds_read_b128 v[92:95], v227 offset:34816
    v_mfma_f32_16x16x32_bf16 v[24:27], v[140:143], v[124:127], v[24:27]
    ds_read_b128 v[96:99], v226 offset:36864
    v_mfma_f32_16x16x32_bf16 v[28:31], v[140:143], v[128:131], v[28:31]
    ds_read_b128 v[100:103], v227 offset:36864
    v_mfma_f32_16x16x32_bf16 v[32:35], v[144:147], v[124:127], v[32:35]
    ds_read_b128 v[104:107], v226 offset:38912
    v_mfma_f32_16x16x32_bf16 v[36:39], v[144:147], v[128:131], v[36:39]
    ds_read_b128 v[108:111], v227 offset:38912
    v_mfma_f32_16x16x32_bf16 v[40:43], v[148:151], v[124:127], v[40:43]
    ds_read_b128 v[112:115], v226 offset:40960
    v_mfma_f32_16x16x32_bf16 v[44:47], v[148:151], v[128:131], v[44:47]
    ds_read_b128 v[116:119], v227 offset:40960
    v_mfma_f32_16x16x32_bf16 v[48:51], v[152:155], v[124:127], v[48:51]
    ds_read_b128 v[120:123], v228 offset:34816
    v_mfma_f32_16x16x32_bf16 v[52:55], v[152:155], v[128:131], v[52:55]
    v_rcp_f32 v244, v244
    v_mfma_f32_16x16x32_bf16 v[56:59], v[156:159], v[124:127], v[56:59]
    v_rcp_f32 v245, v245
    v_mfma_f32_16x16x32_bf16 v[60:63], v[156:159], v[128:131], v[60:63]
    v_rcp_f32 v246, v246
    v_mfma_f32_16x16x32_bf16 v[64:67], v[160:163], v[124:127], v[64:67]
    v_rcp_f32 v247, v247
    v_mfma_f32_16x16x32_bf16 v[68:71], v[160:163], v[128:131], v[68:71]
    v_mul_f32 v240, v240, v244
    v_mul_f32 v241, v241, v245
    v_mfma_f32_16x16x32_bf16 v[72:75], v[164:167], v[124:127], v[72:75]
    v_mul_f32 v242, v242, v246
    v_mul_f32 v243, v243, v247
    v_mfma_f32_16x16x32_bf16 v[76:79], v[164:167], v[128:131], v[76:79]
    s_waitcnt lgkmcnt(0)
    v_mfma_f32_16x16x32_bf16 v[8:11], v[88:91], v[80:83], v[8:11]
    ds_read_b128 v[124:127], v225 offset:34816
    v_cvt_pk_bf16_f32 v170, v240, v241
    v_mfma_f32_16x16x32_bf16 v[12:15], v[88:91], v[84:87], v[12:15]
    ds_read_b128 v[128:131], v225 offset:36864
    v_cvt_pk_bf16_f32 v171, v242, v243
    v_mfma_f32_16x16x32_bf16 v[16:19], v[92:95], v[80:83], v[16:19]
    ds_read_b128 v[132:135], v226 offset:44032
    v_lshlrev_b32 v232, 16, v172
    v_mfma_f32_16x16x32_bf16 v[20:23], v[92:95], v[84:87], v[20:23]
    ds_read_b128 v[136:139], v227 offset:44032
    v_and_b32 v233, 0xffff0000, v172
    v_mfma_f32_16x16x32_bf16 v[24:27], v[96:99], v[80:83], v[24:27]
    ds_read_b128 v[140:143], v226 offset:46080
    v_lshlrev_b32 v234, 16, v173
    v_mfma_f32_16x16x32_bf16 v[28:31], v[96:99], v[84:87], v[28:31]
    ds_read_b128 v[144:147], v227 offset:46080
    v_and_b32 v235, 0xffff0000, v173
    v_mfma_f32_16x16x32_bf16 v[32:35], v[100:103], v[80:83], v[32:35]
    ds_read_b128 v[148:151], v226 offset:48128
    v_mul_f32 v236, v232, v232
    v_mfma_f32_16x16x32_bf16 v[36:39], v[100:103], v[84:87], v[36:39]
    ds_read_b128 v[152:155], v227 offset:48128
    v_mul_f32 v237, v233, v233
    v_mfma_f32_16x16x32_bf16 v[40:43], v[104:107], v[80:83], v[40:43]
    ds_read_b128 v[156:159], v226 offset:50176
    v_mul_f32 v238, v234, v234
    v_mfma_f32_16x16x32_bf16 v[44:47], v[104:107], v[84:87], v[44:47]
    ds_read_b128 v[160:163], v227 offset:50176
    v_mul_f32 v239, v235, v235
    v_mfma_f32_16x16x32_bf16 v[48:51], v[108:111], v[80:83], v[48:51]
    ds_read_b128 v[164:167], v228 offset:44032
    v_fma_f32 v236, v236, v7, s78
    v_mfma_f32_16x16x32_bf16 v[52:55], v[108:111], v[84:87], v[52:55]
    v_fma_f32 v237, v237, v7, s78
    v_fma_f32 v238, v238, v7, s78
    v_mfma_f32_16x16x32_bf16 v[56:59], v[112:115], v[80:83], v[56:59]
    v_mfma_f32_16x16x32_bf16 v[60:63], v[112:115], v[84:87], v[60:63]
    v_mfma_f32_16x16x32_bf16 v[64:67], v[116:119], v[80:83], v[64:67]
    v_mfma_f32_16x16x32_bf16 v[68:71], v[116:119], v[84:87], v[68:71]
    v_mfma_f32_16x16x32_bf16 v[72:75], v[120:123], v[80:83], v[72:75]
    v_mfma_f32_16x16x32_bf16 v[76:79], v[120:123], v[84:87], v[76:79]
    s_waitcnt lgkmcnt(0)
    s_barrier
    v_mfma_f32_16x16x32_bf16 v[8:11], v[132:135], v[124:127], v[8:11]
    ds_read_b128 v[80:83], v209 offset:0
    v_fma_f32 v239, v239, v7, s78
    v_mfma_f32_16x16x32_bf16 v[12:15], v[132:135], v[128:131], v[12:15]
    ds_read_b128 v[84:87], v209 offset:2048
    v_mul_f32 v236, v236, v232
    v_mfma_f32_16x16x32_bf16 v[16:19], v[136:139], v[124:127], v[16:19]
    ds_read_b128 v[88:91], v211 offset:0
    v_mul_f32 v237, v237, v233
    v_mfma_f32_16x16x32_bf16 v[20:23], v[136:139], v[128:131], v[20:23]
    ds_read_b128 v[92:95], v212 offset:0
    v_mul_f32 v238, v238, v234
    v_mfma_f32_16x16x32_bf16 v[24:27], v[140:143], v[124:127], v[24:27]
    ds_read_b128 v[96:99], v211 offset:2048
    v_mul_f32 v239, v239, v235
    v_mfma_f32_16x16x32_bf16 v[28:31], v[140:143], v[128:131], v[28:31]
    ds_read_b128 v[100:103], v212 offset:2048
    v_mfma_f32_16x16x32_bf16 v[32:35], v[144:147], v[124:127], v[32:35]
    ds_read_b128 v[104:107], v211 offset:4096
    v_mfma_f32_16x16x32_bf16 v[36:39], v[144:147], v[128:131], v[36:39]
    ds_read_b128 v[108:111], v212 offset:4096
    v_mfma_f32_16x16x32_bf16 v[40:43], v[148:151], v[124:127], v[40:43]
    ds_read_b128 v[112:115], v211 offset:6144
    v_mfma_f32_16x16x32_bf16 v[44:47], v[148:151], v[128:131], v[44:47]
    ds_read_b128 v[116:119], v212 offset:6144
    v_mfma_f32_16x16x32_bf16 v[48:51], v[152:155], v[124:127], v[48:51]
    ds_read_b128 v[120:123], v213 offset:0
    v_mfma_f32_16x16x32_bf16 v[52:55], v[152:155], v[128:131], v[52:55]
    v_exp_f32 v236, v236
    v_mfma_f32_16x16x32_bf16 v[56:59], v[156:159], v[124:127], v[56:59]
    v_exp_f32 v237, v237
    v_mfma_f32_16x16x32_bf16 v[60:63], v[156:159], v[128:131], v[60:63]
    v_exp_f32 v238, v238
    v_mfma_f32_16x16x32_bf16 v[64:67], v[160:163], v[124:127], v[64:67]
    v_exp_f32 v239, v239
    v_mfma_f32_16x16x32_bf16 v[68:71], v[160:163], v[128:131], v[68:71]
    v_add_f32 v236, 1.0, v236
    v_add_f32 v237, 1.0, v237
    v_mfma_f32_16x16x32_bf16 v[72:75], v[164:167], v[124:127], v[72:75]
    v_add_f32 v238, 1.0, v238
    v_add_f32 v239, 1.0, v239
    v_mfma_f32_16x16x32_bf16 v[76:79], v[164:167], v[128:131], v[76:79]
    s_waitcnt lgkmcnt(0)
    v_mfma_f32_16x16x32_bf16 v[8:11], v[88:91], v[80:83], v[8:11]
    ds_read_b128 v[124:127], v210 offset:0
    v_mfma_f32_16x16x32_bf16 v[12:15], v[88:91], v[84:87], v[12:15]
    ds_read_b128 v[128:131], v210 offset:2048
    v_mfma_f32_16x16x32_bf16 v[16:19], v[92:95], v[80:83], v[16:19]
    ds_read_b128 v[132:135], v211 offset:9216
    v_mfma_f32_16x16x32_bf16 v[20:23], v[92:95], v[84:87], v[20:23]
    ds_read_b128 v[136:139], v212 offset:9216
    v_mfma_f32_16x16x32_bf16 v[24:27], v[96:99], v[80:83], v[24:27]
    ds_read_b128 v[140:143], v211 offset:11264
    v_mfma_f32_16x16x32_bf16 v[28:31], v[96:99], v[84:87], v[28:31]
    ds_read_b128 v[144:147], v212 offset:11264
    v_mfma_f32_16x16x32_bf16 v[32:35], v[100:103], v[80:83], v[32:35]
    ds_read_b128 v[148:151], v211 offset:13312
    v_mfma_f32_16x16x32_bf16 v[36:39], v[100:103], v[84:87], v[36:39]
    ds_read_b128 v[152:155], v212 offset:13312
    v_mfma_f32_16x16x32_bf16 v[40:43], v[104:107], v[80:83], v[40:43]
    ds_read_b128 v[156:159], v211 offset:15360
    v_mfma_f32_16x16x32_bf16 v[44:47], v[104:107], v[84:87], v[44:47]
    ds_read_b128 v[160:163], v212 offset:15360
    v_mfma_f32_16x16x32_bf16 v[48:51], v[108:111], v[80:83], v[48:51]
    ds_read_b128 v[164:167], v213 offset:9216
    v_mfma_f32_16x16x32_bf16 v[52:55], v[108:111], v[84:87], v[52:55]
    v_rcp_f32 v236, v236
    v_mfma_f32_16x16x32_bf16 v[56:59], v[112:115], v[80:83], v[56:59]
    v_rcp_f32 v237, v237
    v_mfma_f32_16x16x32_bf16 v[60:63], v[112:115], v[84:87], v[60:63]
    v_rcp_f32 v238, v238
    v_mfma_f32_16x16x32_bf16 v[64:67], v[116:119], v[80:83], v[64:67]
    v_rcp_f32 v239, v239
    v_mfma_f32_16x16x32_bf16 v[68:71], v[116:119], v[84:87], v[68:71]
    v_mul_f32 v232, v232, v236
    v_mul_f32 v233, v233, v237
    v_mfma_f32_16x16x32_bf16 v[72:75], v[120:123], v[80:83], v[72:75]
    v_mul_f32 v234, v234, v238
    v_mul_f32 v235, v235, v239
    v_mfma_f32_16x16x32_bf16 v[76:79], v[120:123], v[84:87], v[76:79]
    s_waitcnt lgkmcnt(0)
    s_barrier
    v_mfma_f32_16x16x32_bf16 v[8:11], v[132:135], v[124:127], v[8:11]
    ds_read_b128 v[80:83], v209 offset:34816
    v_cvt_pk_bf16_f32 v172, v232, v233
    v_mfma_f32_16x16x32_bf16 v[12:15], v[132:135], v[128:131], v[12:15]
    ds_read_b128 v[84:87], v209 offset:36864
    v_cvt_pk_bf16_f32 v173, v234, v235
    v_mfma_f32_16x16x32_bf16 v[16:19], v[136:139], v[124:127], v[16:19]
    ds_read_b128 v[88:91], v211 offset:34816
    v_lshlrev_b32 v240, 16, v174
    v_mfma_f32_16x16x32_bf16 v[20:23], v[136:139], v[128:131], v[20:23]
    ds_read_b128 v[92:95], v212 offset:34816
    v_and_b32 v241, 0xffff0000, v174
    v_mfma_f32_16x16x32_bf16 v[24:27], v[140:143], v[124:127], v[24:27]
    ds_read_b128 v[96:99], v211 offset:36864
    v_lshlrev_b32 v242, 16, v175
    v_mfma_f32_16x16x32_bf16 v[28:31], v[140:143], v[128:131], v[28:31]
    ds_read_b128 v[100:103], v212 offset:36864
    v_and_b32 v243, 0xffff0000, v175
    v_mfma_f32_16x16x32_bf16 v[32:35], v[144:147], v[124:127], v[32:35]
    ds_read_b128 v[104:107], v211 offset:38912
    v_mul_f32 v244, v240, v240
    v_mfma_f32_16x16x32_bf16 v[36:39], v[144:147], v[128:131], v[36:39]
    ds_read_b128 v[108:111], v212 offset:38912
    v_mul_f32 v245, v241, v241
    v_mfma_f32_16x16x32_bf16 v[40:43], v[148:151], v[124:127], v[40:43]
    ds_read_b128 v[112:115], v211 offset:40960
    v_mul_f32 v246, v242, v242
    v_mfma_f32_16x16x32_bf16 v[44:47], v[148:151], v[128:131], v[44:47]
    ds_read_b128 v[116:119], v212 offset:40960
    v_mul_f32 v247, v243, v243
    v_mfma_f32_16x16x32_bf16 v[48:51], v[152:155], v[124:127], v[48:51]
    ds_read_b128 v[120:123], v213 offset:34816
    v_fma_f32 v244, v244, v7, s78
    v_mfma_f32_16x16x32_bf16 v[52:55], v[152:155], v[128:131], v[52:55]
    v_fma_f32 v245, v245, v7, s78
    v_fma_f32 v246, v246, v7, s78
    v_mfma_f32_16x16x32_bf16 v[56:59], v[156:159], v[124:127], v[56:59]
    v_mfma_f32_16x16x32_bf16 v[60:63], v[156:159], v[128:131], v[60:63]
    v_mfma_f32_16x16x32_bf16 v[64:67], v[160:163], v[124:127], v[64:67]
    v_mfma_f32_16x16x32_bf16 v[68:71], v[160:163], v[128:131], v[68:71]
    v_mfma_f32_16x16x32_bf16 v[72:75], v[164:167], v[124:127], v[72:75]
    v_mfma_f32_16x16x32_bf16 v[76:79], v[164:167], v[128:131], v[76:79]
    s_waitcnt lgkmcnt(0)
    v_mfma_f32_16x16x32_bf16 v[8:11], v[88:91], v[80:83], v[8:11]
    ds_read_b128 v[124:127], v210 offset:34816
    v_fma_f32 v247, v247, v7, s78
    v_mfma_f32_16x16x32_bf16 v[12:15], v[88:91], v[84:87], v[12:15]
    ds_read_b128 v[128:131], v210 offset:36864
    v_mul_f32 v244, v244, v240
    v_mfma_f32_16x16x32_bf16 v[16:19], v[92:95], v[80:83], v[16:19]
    ds_read_b128 v[132:135], v211 offset:44032
    v_mul_f32 v245, v245, v241
    v_mfma_f32_16x16x32_bf16 v[20:23], v[92:95], v[84:87], v[20:23]
    ds_read_b128 v[136:139], v212 offset:44032
    v_mul_f32 v246, v246, v242
    v_mfma_f32_16x16x32_bf16 v[24:27], v[96:99], v[80:83], v[24:27]
    ds_read_b128 v[140:143], v211 offset:46080
    v_mul_f32 v247, v247, v243
    v_mfma_f32_16x16x32_bf16 v[28:31], v[96:99], v[84:87], v[28:31]
    ds_read_b128 v[144:147], v212 offset:46080
    v_mfma_f32_16x16x32_bf16 v[32:35], v[100:103], v[80:83], v[32:35]
    ds_read_b128 v[148:151], v211 offset:48128
    v_mfma_f32_16x16x32_bf16 v[36:39], v[100:103], v[84:87], v[36:39]
    ds_read_b128 v[152:155], v212 offset:48128
    v_mfma_f32_16x16x32_bf16 v[40:43], v[104:107], v[80:83], v[40:43]
    ds_read_b128 v[156:159], v211 offset:50176
    v_mfma_f32_16x16x32_bf16 v[44:47], v[104:107], v[84:87], v[44:47]
    ds_read_b128 v[160:163], v212 offset:50176
    v_mfma_f32_16x16x32_bf16 v[48:51], v[108:111], v[80:83], v[48:51]
    ds_read_b128 v[164:167], v213 offset:44032
    v_mfma_f32_16x16x32_bf16 v[52:55], v[108:111], v[84:87], v[52:55]
    v_exp_f32 v244, v244
    v_mfma_f32_16x16x32_bf16 v[56:59], v[112:115], v[80:83], v[56:59]
    v_exp_f32 v245, v245
    v_mfma_f32_16x16x32_bf16 v[60:63], v[112:115], v[84:87], v[60:63]
    v_exp_f32 v246, v246
    v_mfma_f32_16x16x32_bf16 v[64:67], v[116:119], v[80:83], v[64:67]
    v_exp_f32 v247, v247
    v_mfma_f32_16x16x32_bf16 v[68:71], v[116:119], v[84:87], v[68:71]
    v_add_f32 v244, 1.0, v244
    v_add_f32 v245, 1.0, v245
    v_mfma_f32_16x16x32_bf16 v[72:75], v[120:123], v[80:83], v[72:75]
    v_add_f32 v246, 1.0, v246
    v_add_f32 v247, 1.0, v247
    v_mfma_f32_16x16x32_bf16 v[76:79], v[120:123], v[84:87], v[76:79]
    s_waitcnt lgkmcnt(0)
    s_barrier
    v_mfma_f32_16x16x32_bf16 v[8:11], v[132:135], v[124:127], v[8:11]
    ds_read_b128 v[80:83], v224 offset:0
    v_mfma_f32_16x16x32_bf16 v[12:15], v[132:135], v[128:131], v[12:15]
    ds_read_b128 v[84:87], v224 offset:2048
    v_mfma_f32_16x16x32_bf16 v[16:19], v[136:139], v[124:127], v[16:19]
    ds_read_b128 v[88:91], v226 offset:0
    v_mfma_f32_16x16x32_bf16 v[20:23], v[136:139], v[128:131], v[20:23]
    ds_read_b128 v[92:95], v227 offset:0
    v_mfma_f32_16x16x32_bf16 v[24:27], v[140:143], v[124:127], v[24:27]
    ds_read_b128 v[96:99], v226 offset:2048
    v_mfma_f32_16x16x32_bf16 v[28:31], v[140:143], v[128:131], v[28:31]
    ds_read_b128 v[100:103], v227 offset:2048
    v_mfma_f32_16x16x32_bf16 v[32:35], v[144:147], v[124:127], v[32:35]
    ds_read_b128 v[104:107], v226 offset:4096
    v_mfma_f32_16x16x32_bf16 v[36:39], v[144:147], v[128:131], v[36:39]
    ds_read_b128 v[108:111], v227 offset:4096
    v_mfma_f32_16x16x32_bf16 v[40:43], v[148:151], v[124:127], v[40:43]
    ds_read_b128 v[112:115], v226 offset:6144
    v_mfma_f32_16x16x32_bf16 v[44:47], v[148:151], v[128:131], v[44:47]
    ds_read_b128 v[116:119], v227 offset:6144
    v_mfma_f32_16x16x32_bf16 v[48:51], v[152:155], v[124:127], v[48:51]
    ds_read_b128 v[120:123], v228 offset:0
    v_mfma_f32_16x16x32_bf16 v[52:55], v[152:155], v[128:131], v[52:55]
    v_rcp_f32 v244, v244
    v_mfma_f32_16x16x32_bf16 v[56:59], v[156:159], v[124:127], v[56:59]
    v_rcp_f32 v245, v245
    v_mfma_f32_16x16x32_bf16 v[60:63], v[156:159], v[128:131], v[60:63]
    v_rcp_f32 v246, v246
    v_mfma_f32_16x16x32_bf16 v[64:67], v[160:163], v[124:127], v[64:67]
    v_rcp_f32 v247, v247
    v_mfma_f32_16x16x32_bf16 v[68:71], v[160:163], v[128:131], v[68:71]
    v_mul_f32 v240, v240, v244
    v_mul_f32 v241, v241, v245
    v_mfma_f32_16x16x32_bf16 v[72:75], v[164:167], v[124:127], v[72:75]
    v_mul_f32 v242, v242, v246
    v_mul_f32 v243, v243, v247
    v_mfma_f32_16x16x32_bf16 v[76:79], v[164:167], v[128:131], v[76:79]
    s_waitcnt lgkmcnt(0)
    v_mfma_f32_16x16x32_bf16 v[8:11], v[88:91], v[80:83], v[8:11]
    ds_read_b128 v[124:127], v225 offset:0
    v_cvt_pk_bf16_f32 v174, v240, v241
    v_mfma_f32_16x16x32_bf16 v[12:15], v[88:91], v[84:87], v[12:15]
    ds_read_b128 v[128:131], v225 offset:2048
    v_cvt_pk_bf16_f32 v175, v242, v243
    v_mfma_f32_16x16x32_bf16 v[16:19], v[92:95], v[80:83], v[16:19]
    ds_read_b128 v[132:135], v226 offset:9216
    v_lshlrev_b32 v232, 16, v176
    v_mfma_f32_16x16x32_bf16 v[20:23], v[92:95], v[84:87], v[20:23]
    ds_read_b128 v[136:139], v227 offset:9216
    v_and_b32 v233, 0xffff0000, v176
    v_mfma_f32_16x16x32_bf16 v[24:27], v[96:99], v[80:83], v[24:27]
    ds_read_b128 v[140:143], v226 offset:11264
    v_lshlrev_b32 v234, 16, v177
    v_mfma_f32_16x16x32_bf16 v[28:31], v[96:99], v[84:87], v[28:31]
    ds_read_b128 v[144:147], v227 offset:11264
    v_and_b32 v235, 0xffff0000, v177
    v_mfma_f32_16x16x32_bf16 v[32:35], v[100:103], v[80:83], v[32:35]
    ds_read_b128 v[148:151], v226 offset:13312
    v_mul_f32 v236, v232, v232
    v_mfma_f32_16x16x32_bf16 v[36:39], v[100:103], v[84:87], v[36:39]
    ds_read_b128 v[152:155], v227 offset:13312
    v_mul_f32 v237, v233, v233
    v_mfma_f32_16x16x32_bf16 v[40:43], v[104:107], v[80:83], v[40:43]
    ds_read_b128 v[156:159], v226 offset:15360
    v_mul_f32 v238, v234, v234
    v_mfma_f32_16x16x32_bf16 v[44:47], v[104:107], v[84:87], v[44:47]
    ds_read_b128 v[160:163], v227 offset:15360
    v_mul_f32 v239, v235, v235
    v_mfma_f32_16x16x32_bf16 v[48:51], v[108:111], v[80:83], v[48:51]
    ds_read_b128 v[164:167], v228 offset:9216
    v_fma_f32 v236, v236, v7, s78
    v_mfma_f32_16x16x32_bf16 v[52:55], v[108:111], v[84:87], v[52:55]
    v_fma_f32 v237, v237, v7, s78
    v_fma_f32 v238, v238, v7, s78
    v_mfma_f32_16x16x32_bf16 v[56:59], v[112:115], v[80:83], v[56:59]
    v_mfma_f32_16x16x32_bf16 v[60:63], v[112:115], v[84:87], v[60:63]
    v_mfma_f32_16x16x32_bf16 v[64:67], v[116:119], v[80:83], v[64:67]
    v_mfma_f32_16x16x32_bf16 v[68:71], v[116:119], v[84:87], v[68:71]
    v_mfma_f32_16x16x32_bf16 v[72:75], v[120:123], v[80:83], v[72:75]
    v_mfma_f32_16x16x32_bf16 v[76:79], v[120:123], v[84:87], v[76:79]
    s_waitcnt lgkmcnt(0)
    s_barrier
    v_mfma_f32_16x16x32_bf16 v[8:11], v[132:135], v[124:127], v[8:11]
    ds_read_b128 v[80:83], v224 offset:34816
    v_fma_f32 v239, v239, v7, s78
    v_mfma_f32_16x16x32_bf16 v[12:15], v[132:135], v[128:131], v[12:15]
    ds_read_b128 v[84:87], v224 offset:36864
    v_mul_f32 v236, v236, v232
    v_mfma_f32_16x16x32_bf16 v[16:19], v[136:139], v[124:127], v[16:19]
    ds_read_b128 v[88:91], v226 offset:34816
    v_mul_f32 v237, v237, v233
    v_mfma_f32_16x16x32_bf16 v[20:23], v[136:139], v[128:131], v[20:23]
    ds_read_b128 v[92:95], v227 offset:34816
    v_mul_f32 v238, v238, v234
    v_mfma_f32_16x16x32_bf16 v[24:27], v[140:143], v[124:127], v[24:27]
    ds_read_b128 v[96:99], v226 offset:36864
    v_mul_f32 v239, v239, v235
    v_mfma_f32_16x16x32_bf16 v[28:31], v[140:143], v[128:131], v[28:31]
    ds_read_b128 v[100:103], v227 offset:36864
    v_mfma_f32_16x16x32_bf16 v[32:35], v[144:147], v[124:127], v[32:35]
    ds_read_b128 v[104:107], v226 offset:38912
    v_mfma_f32_16x16x32_bf16 v[36:39], v[144:147], v[128:131], v[36:39]
    ds_read_b128 v[108:111], v227 offset:38912
    v_mfma_f32_16x16x32_bf16 v[40:43], v[148:151], v[124:127], v[40:43]
    ds_read_b128 v[112:115], v226 offset:40960
    v_mfma_f32_16x16x32_bf16 v[44:47], v[148:151], v[128:131], v[44:47]
    ds_read_b128 v[116:119], v227 offset:40960
    v_mfma_f32_16x16x32_bf16 v[48:51], v[152:155], v[124:127], v[48:51]
    ds_read_b128 v[120:123], v228 offset:34816
    v_mfma_f32_16x16x32_bf16 v[52:55], v[152:155], v[128:131], v[52:55]
    v_exp_f32 v236, v236
    v_mfma_f32_16x16x32_bf16 v[56:59], v[156:159], v[124:127], v[56:59]
    v_exp_f32 v237, v237
    v_mfma_f32_16x16x32_bf16 v[60:63], v[156:159], v[128:131], v[60:63]
    v_exp_f32 v238, v238
    v_mfma_f32_16x16x32_bf16 v[64:67], v[160:163], v[124:127], v[64:67]
    v_exp_f32 v239, v239
    v_mfma_f32_16x16x32_bf16 v[68:71], v[160:163], v[128:131], v[68:71]
    v_add_f32 v236, 1.0, v236
    v_add_f32 v237, 1.0, v237
    v_mfma_f32_16x16x32_bf16 v[72:75], v[164:167], v[124:127], v[72:75]
    v_add_f32 v238, 1.0, v238
    v_add_f32 v239, 1.0, v239
    v_mfma_f32_16x16x32_bf16 v[76:79], v[164:167], v[128:131], v[76:79]
    s_waitcnt lgkmcnt(0)
    v_mfma_f32_16x16x32_bf16 v[8:11], v[88:91], v[80:83], v[8:11]
    ds_read_b128 v[124:127], v225 offset:34816
    v_mfma_f32_16x16x32_bf16 v[12:15], v[88:91], v[84:87], v[12:15]
    ds_read_b128 v[128:131], v225 offset:36864
    v_mfma_f32_16x16x32_bf16 v[16:19], v[92:95], v[80:83], v[16:19]
    ds_read_b128 v[132:135], v226 offset:44032
    v_mfma_f32_16x16x32_bf16 v[20:23], v[92:95], v[84:87], v[20:23]
    ds_read_b128 v[136:139], v227 offset:44032
    v_mfma_f32_16x16x32_bf16 v[24:27], v[96:99], v[80:83], v[24:27]
    ds_read_b128 v[140:143], v226 offset:46080
    v_mfma_f32_16x16x32_bf16 v[28:31], v[96:99], v[84:87], v[28:31]
    ds_read_b128 v[144:147], v227 offset:46080
    v_mfma_f32_16x16x32_bf16 v[32:35], v[100:103], v[80:83], v[32:35]
    ds_read_b128 v[148:151], v226 offset:48128
    v_mfma_f32_16x16x32_bf16 v[36:39], v[100:103], v[84:87], v[36:39]
    ds_read_b128 v[152:155], v227 offset:48128
    v_mfma_f32_16x16x32_bf16 v[40:43], v[104:107], v[80:83], v[40:43]
    ds_read_b128 v[156:159], v226 offset:50176
    v_mfma_f32_16x16x32_bf16 v[44:47], v[104:107], v[84:87], v[44:47]
    ds_read_b128 v[160:163], v227 offset:50176
    v_mfma_f32_16x16x32_bf16 v[48:51], v[108:111], v[80:83], v[48:51]
    ds_read_b128 v[164:167], v228 offset:44032
    v_mfma_f32_16x16x32_bf16 v[52:55], v[108:111], v[84:87], v[52:55]
    v_rcp_f32 v236, v236
    v_mfma_f32_16x16x32_bf16 v[56:59], v[112:115], v[80:83], v[56:59]
    v_rcp_f32 v237, v237
    v_mfma_f32_16x16x32_bf16 v[60:63], v[112:115], v[84:87], v[60:63]
    v_rcp_f32 v238, v238
    v_mfma_f32_16x16x32_bf16 v[64:67], v[116:119], v[80:83], v[64:67]
    v_rcp_f32 v239, v239
    v_mfma_f32_16x16x32_bf16 v[68:71], v[116:119], v[84:87], v[68:71]
    v_mul_f32 v232, v232, v236
    v_mul_f32 v233, v233, v237
    v_mfma_f32_16x16x32_bf16 v[72:75], v[120:123], v[80:83], v[72:75]
    v_mul_f32 v234, v234, v238
    v_mul_f32 v235, v235, v239
    v_mfma_f32_16x16x32_bf16 v[76:79], v[120:123], v[84:87], v[76:79]
    s_waitcnt lgkmcnt(0)
    s_barrier
    v_mfma_f32_16x16x32_bf16 v[8:11], v[132:135], v[124:127], v[8:11]
    ds_read_b128 v[80:83], v209 offset:0
    v_cvt_pk_bf16_f32 v176, v232, v233
    v_mfma_f32_16x16x32_bf16 v[12:15], v[132:135], v[128:131], v[12:15]
    ds_read_b128 v[84:87], v209 offset:2048
    v_cvt_pk_bf16_f32 v177, v234, v235
    v_mfma_f32_16x16x32_bf16 v[16:19], v[136:139], v[124:127], v[16:19]
    ds_read_b128 v[88:91], v211 offset:0
    v_lshlrev_b32 v240, 16, v178
    v_mfma_f32_16x16x32_bf16 v[20:23], v[136:139], v[128:131], v[20:23]
    ds_read_b128 v[92:95], v212 offset:0
    v_and_b32 v241, 0xffff0000, v178
    v_mfma_f32_16x16x32_bf16 v[24:27], v[140:143], v[124:127], v[24:27]
    ds_read_b128 v[96:99], v211 offset:2048
    v_lshlrev_b32 v242, 16, v179
    v_mfma_f32_16x16x32_bf16 v[28:31], v[140:143], v[128:131], v[28:31]
    ds_read_b128 v[100:103], v212 offset:2048
    v_and_b32 v243, 0xffff0000, v179
    v_mfma_f32_16x16x32_bf16 v[32:35], v[144:147], v[124:127], v[32:35]
    ds_read_b128 v[104:107], v211 offset:4096
    v_mul_f32 v244, v240, v240
    v_mfma_f32_16x16x32_bf16 v[36:39], v[144:147], v[128:131], v[36:39]
    ds_read_b128 v[108:111], v212 offset:4096
    v_mul_f32 v245, v241, v241
    v_mfma_f32_16x16x32_bf16 v[40:43], v[148:151], v[124:127], v[40:43]
    ds_read_b128 v[112:115], v211 offset:6144
    v_mul_f32 v246, v242, v242
    v_mfma_f32_16x16x32_bf16 v[44:47], v[148:151], v[128:131], v[44:47]
    ds_read_b128 v[116:119], v212 offset:6144
    v_mul_f32 v247, v243, v243
    v_mfma_f32_16x16x32_bf16 v[48:51], v[152:155], v[124:127], v[48:51]
    ds_read_b128 v[120:123], v213 offset:0
    v_fma_f32 v244, v244, v7, s78
    v_mfma_f32_16x16x32_bf16 v[52:55], v[152:155], v[128:131], v[52:55]
    v_fma_f32 v245, v245, v7, s78
    v_fma_f32 v246, v246, v7, s78
    v_mfma_f32_16x16x32_bf16 v[56:59], v[156:159], v[124:127], v[56:59]
    v_mfma_f32_16x16x32_bf16 v[60:63], v[156:159], v[128:131], v[60:63]
    v_mfma_f32_16x16x32_bf16 v[64:67], v[160:163], v[124:127], v[64:67]
    v_mfma_f32_16x16x32_bf16 v[68:71], v[160:163], v[128:131], v[68:71]
    v_mfma_f32_16x16x32_bf16 v[72:75], v[164:167], v[124:127], v[72:75]
    v_mfma_f32_16x16x32_bf16 v[76:79], v[164:167], v[128:131], v[76:79]
    s_waitcnt lgkmcnt(0)
    v_mfma_f32_16x16x32_bf16 v[8:11], v[88:91], v[80:83], v[8:11]
    ds_read_b128 v[124:127], v210 offset:0
    v_fma_f32 v247, v247, v7, s78
    v_mfma_f32_16x16x32_bf16 v[12:15], v[88:91], v[84:87], v[12:15]
    ds_read_b128 v[128:131], v210 offset:2048
    v_mul_f32 v244, v244, v240
    v_mfma_f32_16x16x32_bf16 v[16:19], v[92:95], v[80:83], v[16:19]
    ds_read_b128 v[132:135], v211 offset:9216
    v_mul_f32 v245, v245, v241
    v_mfma_f32_16x16x32_bf16 v[20:23], v[92:95], v[84:87], v[20:23]
    ds_read_b128 v[136:139], v212 offset:9216
    v_mul_f32 v246, v246, v242
    v_mfma_f32_16x16x32_bf16 v[24:27], v[96:99], v[80:83], v[24:27]
    ds_read_b128 v[140:143], v211 offset:11264
    v_mul_f32 v247, v247, v243
    v_mfma_f32_16x16x32_bf16 v[28:31], v[96:99], v[84:87], v[28:31]
    ds_read_b128 v[144:147], v212 offset:11264
    v_mfma_f32_16x16x32_bf16 v[32:35], v[100:103], v[80:83], v[32:35]
    ds_read_b128 v[148:151], v211 offset:13312
    v_mfma_f32_16x16x32_bf16 v[36:39], v[100:103], v[84:87], v[36:39]
    ds_read_b128 v[152:155], v212 offset:13312
    v_mfma_f32_16x16x32_bf16 v[40:43], v[104:107], v[80:83], v[40:43]
    ds_read_b128 v[156:159], v211 offset:15360
    v_mfma_f32_16x16x32_bf16 v[44:47], v[104:107], v[84:87], v[44:47]
    ds_read_b128 v[160:163], v212 offset:15360
    v_mfma_f32_16x16x32_bf16 v[48:51], v[108:111], v[80:83], v[48:51]
    ds_read_b128 v[164:167], v213 offset:9216
    v_mfma_f32_16x16x32_bf16 v[52:55], v[108:111], v[84:87], v[52:55]
    v_exp_f32 v244, v244
    v_mfma_f32_16x16x32_bf16 v[56:59], v[112:115], v[80:83], v[56:59]
    v_exp_f32 v245, v245
    v_mfma_f32_16x16x32_bf16 v[60:63], v[112:115], v[84:87], v[60:63]
    v_exp_f32 v246, v246
    v_mfma_f32_16x16x32_bf16 v[64:67], v[116:119], v[80:83], v[64:67]
    v_exp_f32 v247, v247
    v_mfma_f32_16x16x32_bf16 v[68:71], v[116:119], v[84:87], v[68:71]
    v_add_f32 v244, 1.0, v244
    v_add_f32 v245, 1.0, v245
    v_mfma_f32_16x16x32_bf16 v[72:75], v[120:123], v[80:83], v[72:75]
    v_add_f32 v246, 1.0, v246
    v_add_f32 v247, 1.0, v247
    v_mfma_f32_16x16x32_bf16 v[76:79], v[120:123], v[84:87], v[76:79]
    s_waitcnt lgkmcnt(0)
    s_barrier
    v_mfma_f32_16x16x32_bf16 v[8:11], v[132:135], v[124:127], v[8:11]
    ds_read_b128 v[80:83], v209 offset:34816
    v_mfma_f32_16x16x32_bf16 v[12:15], v[132:135], v[128:131], v[12:15]
    ds_read_b128 v[84:87], v209 offset:36864
    v_mfma_f32_16x16x32_bf16 v[16:19], v[136:139], v[124:127], v[16:19]
    ds_read_b128 v[88:91], v211 offset:34816
    v_mfma_f32_16x16x32_bf16 v[20:23], v[136:139], v[128:131], v[20:23]
    ds_read_b128 v[92:95], v212 offset:34816
    v_mfma_f32_16x16x32_bf16 v[24:27], v[140:143], v[124:127], v[24:27]
    ds_read_b128 v[96:99], v211 offset:36864
    v_mfma_f32_16x16x32_bf16 v[28:31], v[140:143], v[128:131], v[28:31]
    ds_read_b128 v[100:103], v212 offset:36864
    v_mfma_f32_16x16x32_bf16 v[32:35], v[144:147], v[124:127], v[32:35]
    ds_read_b128 v[104:107], v211 offset:38912
    v_mfma_f32_16x16x32_bf16 v[36:39], v[144:147], v[128:131], v[36:39]
    ds_read_b128 v[108:111], v212 offset:38912
    v_mfma_f32_16x16x32_bf16 v[40:43], v[148:151], v[124:127], v[40:43]
    ds_read_b128 v[112:115], v211 offset:40960
    v_mfma_f32_16x16x32_bf16 v[44:47], v[148:151], v[128:131], v[44:47]
    ds_read_b128 v[116:119], v212 offset:40960
    v_mfma_f32_16x16x32_bf16 v[48:51], v[152:155], v[124:127], v[48:51]
    ds_read_b128 v[120:123], v213 offset:34816
    v_mfma_f32_16x16x32_bf16 v[52:55], v[152:155], v[128:131], v[52:55]
    v_rcp_f32 v244, v244
    v_mfma_f32_16x16x32_bf16 v[56:59], v[156:159], v[124:127], v[56:59]
    v_rcp_f32 v245, v245
    v_mfma_f32_16x16x32_bf16 v[60:63], v[156:159], v[128:131], v[60:63]
    v_rcp_f32 v246, v246
    v_mfma_f32_16x16x32_bf16 v[64:67], v[160:163], v[124:127], v[64:67]
    v_rcp_f32 v247, v247
    v_mfma_f32_16x16x32_bf16 v[68:71], v[160:163], v[128:131], v[68:71]
    v_mul_f32 v240, v240, v244
    v_mul_f32 v241, v241, v245
    v_mfma_f32_16x16x32_bf16 v[72:75], v[164:167], v[124:127], v[72:75]
    v_mul_f32 v242, v242, v246
    v_mul_f32 v243, v243, v247
    v_mfma_f32_16x16x32_bf16 v[76:79], v[164:167], v[128:131], v[76:79]
    s_waitcnt lgkmcnt(0)
    v_mfma_f32_16x16x32_bf16 v[8:11], v[88:91], v[80:83], v[8:11]
    ds_read_b128 v[124:127], v210 offset:34816
    v_cvt_pk_bf16_f32 v178, v240, v241
    v_mfma_f32_16x16x32_bf16 v[12:15], v[88:91], v[84:87], v[12:15]
    ds_read_b128 v[128:131], v210 offset:36864
    v_cvt_pk_bf16_f32 v179, v242, v243
    v_mfma_f32_16x16x32_bf16 v[16:19], v[92:95], v[80:83], v[16:19]
    ds_read_b128 v[132:135], v211 offset:44032
    v_lshlrev_b32 v232, 16, v180
    v_mfma_f32_16x16x32_bf16 v[20:23], v[92:95], v[84:87], v[20:23]
    ds_read_b128 v[136:139], v212 offset:44032
    v_and_b32 v233, 0xffff0000, v180
    v_mfma_f32_16x16x32_bf16 v[24:27], v[96:99], v[80:83], v[24:27]
    ds_read_b128 v[140:143], v211 offset:46080
    v_lshlrev_b32 v234, 16, v181
    v_mfma_f32_16x16x32_bf16 v[28:31], v[96:99], v[84:87], v[28:31]
    ds_read_b128 v[144:147], v212 offset:46080
    v_and_b32 v235, 0xffff0000, v181
    v_mfma_f32_16x16x32_bf16 v[32:35], v[100:103], v[80:83], v[32:35]
    ds_read_b128 v[148:151], v211 offset:48128
    v_mul_f32 v236, v232, v232
    v_mfma_f32_16x16x32_bf16 v[36:39], v[100:103], v[84:87], v[36:39]
    ds_read_b128 v[152:155], v212 offset:48128
    v_mul_f32 v237, v233, v233
    v_mfma_f32_16x16x32_bf16 v[40:43], v[104:107], v[80:83], v[40:43]
    ds_read_b128 v[156:159], v211 offset:50176
    v_mul_f32 v238, v234, v234
    v_mfma_f32_16x16x32_bf16 v[44:47], v[104:107], v[84:87], v[44:47]
    ds_read_b128 v[160:163], v212 offset:50176
    v_mul_f32 v239, v235, v235
    v_mfma_f32_16x16x32_bf16 v[48:51], v[108:111], v[80:83], v[48:51]
    ds_read_b128 v[164:167], v213 offset:44032
    v_fma_f32 v236, v236, v7, s78
    v_mfma_f32_16x16x32_bf16 v[52:55], v[108:111], v[84:87], v[52:55]
    v_fma_f32 v237, v237, v7, s78
    v_fma_f32 v238, v238, v7, s78
    v_mfma_f32_16x16x32_bf16 v[56:59], v[112:115], v[80:83], v[56:59]
    v_mfma_f32_16x16x32_bf16 v[60:63], v[112:115], v[84:87], v[60:63]
    v_mfma_f32_16x16x32_bf16 v[64:67], v[116:119], v[80:83], v[64:67]
    v_mfma_f32_16x16x32_bf16 v[68:71], v[116:119], v[84:87], v[68:71]
    v_mfma_f32_16x16x32_bf16 v[72:75], v[120:123], v[80:83], v[72:75]
    v_mfma_f32_16x16x32_bf16 v[76:79], v[120:123], v[84:87], v[76:79]
    s_waitcnt lgkmcnt(0)
    s_barrier
    v_mfma_f32_16x16x32_bf16 v[8:11], v[132:135], v[124:127], v[8:11]
    ds_read_b128 v[80:83], v224 offset:0
    v_fma_f32 v239, v239, v7, s78
    v_mfma_f32_16x16x32_bf16 v[12:15], v[132:135], v[128:131], v[12:15]
    ds_read_b128 v[84:87], v224 offset:2048
    v_mul_f32 v236, v236, v232
    v_mfma_f32_16x16x32_bf16 v[16:19], v[136:139], v[124:127], v[16:19]
    ds_read_b128 v[88:91], v226 offset:0
    v_mul_f32 v237, v237, v233
    v_mfma_f32_16x16x32_bf16 v[20:23], v[136:139], v[128:131], v[20:23]
    ds_read_b128 v[92:95], v227 offset:0
    v_mul_f32 v238, v238, v234
    v_mfma_f32_16x16x32_bf16 v[24:27], v[140:143], v[124:127], v[24:27]
    ds_read_b128 v[96:99], v226 offset:2048
    v_mul_f32 v239, v239, v235
    v_mfma_f32_16x16x32_bf16 v[28:31], v[140:143], v[128:131], v[28:31]
    ds_read_b128 v[100:103], v227 offset:2048
    v_mfma_f32_16x16x32_bf16 v[32:35], v[144:147], v[124:127], v[32:35]
    ds_read_b128 v[104:107], v226 offset:4096
    v_mfma_f32_16x16x32_bf16 v[36:39], v[144:147], v[128:131], v[36:39]
    ds_read_b128 v[108:111], v227 offset:4096
    v_mfma_f32_16x16x32_bf16 v[40:43], v[148:151], v[124:127], v[40:43]
    ds_read_b128 v[112:115], v226 offset:6144
    v_mfma_f32_16x16x32_bf16 v[44:47], v[148:151], v[128:131], v[44:47]
    ds_read_b128 v[116:119], v227 offset:6144
    v_mfma_f32_16x16x32_bf16 v[48:51], v[152:155], v[124:127], v[48:51]
    ds_read_b128 v[120:123], v228 offset:0
    v_mfma_f32_16x16x32_bf16 v[52:55], v[152:155], v[128:131], v[52:55]
    v_exp_f32 v236, v236
    v_mfma_f32_16x16x32_bf16 v[56:59], v[156:159], v[124:127], v[56:59]
    v_exp_f32 v237, v237
    v_mfma_f32_16x16x32_bf16 v[60:63], v[156:159], v[128:131], v[60:63]
    v_exp_f32 v238, v238
    v_mfma_f32_16x16x32_bf16 v[64:67], v[160:163], v[124:127], v[64:67]
    v_exp_f32 v239, v239
    v_mfma_f32_16x16x32_bf16 v[68:71], v[160:163], v[128:131], v[68:71]
    v_add_f32 v236, 1.0, v236
    v_add_f32 v237, 1.0, v237
    v_mfma_f32_16x16x32_bf16 v[72:75], v[164:167], v[124:127], v[72:75]
    v_add_f32 v238, 1.0, v238
    v_add_f32 v239, 1.0, v239
    v_mfma_f32_16x16x32_bf16 v[76:79], v[164:167], v[128:131], v[76:79]
    s_waitcnt lgkmcnt(0)
    v_mfma_f32_16x16x32_bf16 v[8:11], v[88:91], v[80:83], v[8:11]
    ds_read_b128 v[124:127], v225 offset:0
    v_mfma_f32_16x16x32_bf16 v[12:15], v[88:91], v[84:87], v[12:15]
    ds_read_b128 v[128:131], v225 offset:2048
    v_mfma_f32_16x16x32_bf16 v[16:19], v[92:95], v[80:83], v[16:19]
    ds_read_b128 v[132:135], v226 offset:9216
    v_mfma_f32_16x16x32_bf16 v[20:23], v[92:95], v[84:87], v[20:23]
    ds_read_b128 v[136:139], v227 offset:9216
    v_mfma_f32_16x16x32_bf16 v[24:27], v[96:99], v[80:83], v[24:27]
    ds_read_b128 v[140:143], v226 offset:11264
    v_mfma_f32_16x16x32_bf16 v[28:31], v[96:99], v[84:87], v[28:31]
    ds_read_b128 v[144:147], v227 offset:11264
    v_mfma_f32_16x16x32_bf16 v[32:35], v[100:103], v[80:83], v[32:35]
    ds_read_b128 v[148:151], v226 offset:13312
    v_mfma_f32_16x16x32_bf16 v[36:39], v[100:103], v[84:87], v[36:39]
    ds_read_b128 v[152:155], v227 offset:13312
    v_mfma_f32_16x16x32_bf16 v[40:43], v[104:107], v[80:83], v[40:43]
    ds_read_b128 v[156:159], v226 offset:15360
    v_mfma_f32_16x16x32_bf16 v[44:47], v[104:107], v[84:87], v[44:47]
    ds_read_b128 v[160:163], v227 offset:15360
    v_mfma_f32_16x16x32_bf16 v[48:51], v[108:111], v[80:83], v[48:51]
    ds_read_b128 v[164:167], v228 offset:9216
    v_mfma_f32_16x16x32_bf16 v[52:55], v[108:111], v[84:87], v[52:55]
    v_rcp_f32 v236, v236
    v_mfma_f32_16x16x32_bf16 v[56:59], v[112:115], v[80:83], v[56:59]
    v_rcp_f32 v237, v237
    v_mfma_f32_16x16x32_bf16 v[60:63], v[112:115], v[84:87], v[60:63]
    v_rcp_f32 v238, v238
    v_mfma_f32_16x16x32_bf16 v[64:67], v[116:119], v[80:83], v[64:67]
    v_rcp_f32 v239, v239
    v_mfma_f32_16x16x32_bf16 v[68:71], v[116:119], v[84:87], v[68:71]
    v_mul_f32 v232, v232, v236
    v_mul_f32 v233, v233, v237
    v_mfma_f32_16x16x32_bf16 v[72:75], v[120:123], v[80:83], v[72:75]
    v_mul_f32 v234, v234, v238
    v_mul_f32 v235, v235, v239
    v_mfma_f32_16x16x32_bf16 v[76:79], v[120:123], v[84:87], v[76:79]
    s_waitcnt lgkmcnt(0)
    s_barrier
    v_mfma_f32_16x16x32_bf16 v[8:11], v[132:135], v[124:127], v[8:11]
    ds_read_b128 v[80:83], v224 offset:34816
    v_cvt_pk_bf16_f32 v180, v232, v233
    v_mfma_f32_16x16x32_bf16 v[12:15], v[132:135], v[128:131], v[12:15]
    ds_read_b128 v[84:87], v224 offset:36864
    v_cvt_pk_bf16_f32 v181, v234, v235
    v_mfma_f32_16x16x32_bf16 v[16:19], v[136:139], v[124:127], v[16:19]
    ds_read_b128 v[88:91], v226 offset:34816
    v_lshlrev_b32 v240, 16, v182
    v_mfma_f32_16x16x32_bf16 v[20:23], v[136:139], v[128:131], v[20:23]
    ds_read_b128 v[92:95], v227 offset:34816
    v_and_b32 v241, 0xffff0000, v182
    v_mfma_f32_16x16x32_bf16 v[24:27], v[140:143], v[124:127], v[24:27]
    ds_read_b128 v[96:99], v226 offset:36864
    v_lshlrev_b32 v242, 16, v183
    v_mfma_f32_16x16x32_bf16 v[28:31], v[140:143], v[128:131], v[28:31]
    ds_read_b128 v[100:103], v227 offset:36864
    v_and_b32 v243, 0xffff0000, v183
    v_mfma_f32_16x16x32_bf16 v[32:35], v[144:147], v[124:127], v[32:35]
    ds_read_b128 v[104:107], v226 offset:38912
    v_mul_f32 v244, v240, v240
    v_mfma_f32_16x16x32_bf16 v[36:39], v[144:147], v[128:131], v[36:39]
    ds_read_b128 v[108:111], v227 offset:38912
    v_mul_f32 v245, v241, v241
    v_mfma_f32_16x16x32_bf16 v[40:43], v[148:151], v[124:127], v[40:43]
    ds_read_b128 v[112:115], v226 offset:40960
    v_mul_f32 v246, v242, v242
    v_mfma_f32_16x16x32_bf16 v[44:47], v[148:151], v[128:131], v[44:47]
    ds_read_b128 v[116:119], v227 offset:40960
    v_mul_f32 v247, v243, v243
    v_mfma_f32_16x16x32_bf16 v[48:51], v[152:155], v[124:127], v[48:51]
    ds_read_b128 v[120:123], v228 offset:34816
    v_fma_f32 v244, v244, v7, s78
    v_mfma_f32_16x16x32_bf16 v[52:55], v[152:155], v[128:131], v[52:55]
    v_fma_f32 v245, v245, v7, s78
    v_fma_f32 v246, v246, v7, s78
    v_mfma_f32_16x16x32_bf16 v[56:59], v[156:159], v[124:127], v[56:59]
    v_mfma_f32_16x16x32_bf16 v[60:63], v[156:159], v[128:131], v[60:63]
    v_mfma_f32_16x16x32_bf16 v[64:67], v[160:163], v[124:127], v[64:67]
    v_mfma_f32_16x16x32_bf16 v[68:71], v[160:163], v[128:131], v[68:71]
    v_mfma_f32_16x16x32_bf16 v[72:75], v[164:167], v[124:127], v[72:75]
    v_mfma_f32_16x16x32_bf16 v[76:79], v[164:167], v[128:131], v[76:79]
    s_waitcnt lgkmcnt(0)
    v_mfma_f32_16x16x32_bf16 v[8:11], v[88:91], v[80:83], v[8:11]
    ds_read_b128 v[124:127], v225 offset:34816
    v_fma_f32 v247, v247, v7, s78
    v_mfma_f32_16x16x32_bf16 v[12:15], v[88:91], v[84:87], v[12:15]
    ds_read_b128 v[128:131], v225 offset:36864
    v_mul_f32 v244, v244, v240
    v_mfma_f32_16x16x32_bf16 v[16:19], v[92:95], v[80:83], v[16:19]
    ds_read_b128 v[132:135], v226 offset:44032
    v_mul_f32 v245, v245, v241
    v_mfma_f32_16x16x32_bf16 v[20:23], v[92:95], v[84:87], v[20:23]
    ds_read_b128 v[136:139], v227 offset:44032
    v_mul_f32 v246, v246, v242
    v_mfma_f32_16x16x32_bf16 v[24:27], v[96:99], v[80:83], v[24:27]
    ds_read_b128 v[140:143], v226 offset:46080
    v_mul_f32 v247, v247, v243
    v_mfma_f32_16x16x32_bf16 v[28:31], v[96:99], v[84:87], v[28:31]
    ds_read_b128 v[144:147], v227 offset:46080
    v_mfma_f32_16x16x32_bf16 v[32:35], v[100:103], v[80:83], v[32:35]
    ds_read_b128 v[148:151], v226 offset:48128
    v_mfma_f32_16x16x32_bf16 v[36:39], v[100:103], v[84:87], v[36:39]
    ds_read_b128 v[152:155], v227 offset:48128
    v_mfma_f32_16x16x32_bf16 v[40:43], v[104:107], v[80:83], v[40:43]
    ds_read_b128 v[156:159], v226 offset:50176
    v_mfma_f32_16x16x32_bf16 v[44:47], v[104:107], v[84:87], v[44:47]
    ds_read_b128 v[160:163], v227 offset:50176
    v_mfma_f32_16x16x32_bf16 v[48:51], v[108:111], v[80:83], v[48:51]
    ds_read_b128 v[164:167], v228 offset:44032
    v_mfma_f32_16x16x32_bf16 v[52:55], v[108:111], v[84:87], v[52:55]
    v_exp_f32 v244, v244
    v_mfma_f32_16x16x32_bf16 v[56:59], v[112:115], v[80:83], v[56:59]
    v_exp_f32 v245, v245
    v_mfma_f32_16x16x32_bf16 v[60:63], v[112:115], v[84:87], v[60:63]
    v_exp_f32 v246, v246
    v_mfma_f32_16x16x32_bf16 v[64:67], v[116:119], v[80:83], v[64:67]
    v_exp_f32 v247, v247
    v_mfma_f32_16x16x32_bf16 v[68:71], v[116:119], v[84:87], v[68:71]
    v_add_f32 v244, 1.0, v244
    v_add_f32 v245, 1.0, v245
    v_mfma_f32_16x16x32_bf16 v[72:75], v[120:123], v[80:83], v[72:75]
    v_add_f32 v246, 1.0, v246
    v_add_f32 v247, 1.0, v247
    v_mfma_f32_16x16x32_bf16 v[76:79], v[120:123], v[84:87], v[76:79]
    s_waitcnt lgkmcnt(0)
    s_barrier
    v_mfma_f32_16x16x32_bf16 v[8:11], v[132:135], v[124:127], v[8:11]
    ds_read_b128 v[80:83], v209 offset:0
    v_mfma_f32_16x16x32_bf16 v[12:15], v[132:135], v[128:131], v[12:15]
    ds_read_b128 v[84:87], v209 offset:2048
    v_mfma_f32_16x16x32_bf16 v[16:19], v[136:139], v[124:127], v[16:19]
    ds_read_b128 v[88:91], v211 offset:0
    v_mfma_f32_16x16x32_bf16 v[20:23], v[136:139], v[128:131], v[20:23]
    ds_read_b128 v[92:95], v212 offset:0
    v_mfma_f32_16x16x32_bf16 v[24:27], v[140:143], v[124:127], v[24:27]
    ds_read_b128 v[96:99], v211 offset:2048
    v_mfma_f32_16x16x32_bf16 v[28:31], v[140:143], v[128:131], v[28:31]
    ds_read_b128 v[100:103], v212 offset:2048
    v_mfma_f32_16x16x32_bf16 v[32:35], v[144:147], v[124:127], v[32:35]
    ds_read_b128 v[104:107], v211 offset:4096
    v_mfma_f32_16x16x32_bf16 v[36:39], v[144:147], v[128:131], v[36:39]
    ds_read_b128 v[108:111], v212 offset:4096
    v_mfma_f32_16x16x32_bf16 v[40:43], v[148:151], v[124:127], v[40:43]
    ds_read_b128 v[112:115], v211 offset:6144
    v_mfma_f32_16x16x32_bf16 v[44:47], v[148:151], v[128:131], v[44:47]
    ds_read_b128 v[116:119], v212 offset:6144
    v_mfma_f32_16x16x32_bf16 v[48:51], v[152:155], v[124:127], v[48:51]
    ds_read_b128 v[120:123], v213 offset:0
    v_mfma_f32_16x16x32_bf16 v[52:55], v[152:155], v[128:131], v[52:55]
    v_rcp_f32 v244, v244
    v_mfma_f32_16x16x32_bf16 v[56:59], v[156:159], v[124:127], v[56:59]
    v_rcp_f32 v245, v245
    v_mfma_f32_16x16x32_bf16 v[60:63], v[156:159], v[128:131], v[60:63]
    v_rcp_f32 v246, v246
    v_mfma_f32_16x16x32_bf16 v[64:67], v[160:163], v[124:127], v[64:67]
    v_rcp_f32 v247, v247
    v_mfma_f32_16x16x32_bf16 v[68:71], v[160:163], v[128:131], v[68:71]
    v_mul_f32 v240, v240, v244
    v_mul_f32 v241, v241, v245
    v_mfma_f32_16x16x32_bf16 v[72:75], v[164:167], v[124:127], v[72:75]
    v_mul_f32 v242, v242, v246
    v_mul_f32 v243, v243, v247
    v_mfma_f32_16x16x32_bf16 v[76:79], v[164:167], v[128:131], v[76:79]
    s_waitcnt lgkmcnt(0)
    v_mov_b32 v218, 159744
    v_mov_b32 v219, 1
    s_waitcnt vmcnt(0) lgkmcnt(0)
    s_mov_b64 exec, 1
    ds_add_rtn_u32 v220, v218, v219 offset:16
    s_waitcnt lgkmcnt(0)
    v_readfirstlane_b32 s47, v220
    s_nop 0
    s_cmp_lg_u32 s47, 3
    s_cbranch_scc1 KO_NOFL
    s_mov_b64 exec, -1
    v_mov_b32 v219, 1
    v_lshlrev_b32 v218, 2, v2
    s_lshl_b32 s46, s32, 14
    s_lshl_b32 s47, s33, 10
    s_add_u32 s46, s46, s47
    s_mov_b32 exec_hi, 0
    buffer_store_dword v219, v218, s[72:75], s46 offen offset:384 sc1
KO_NOFL:
    s_mov_b64 exec, -1
    v_mfma_f32_16x16x32_bf16 v[8:11], v[88:91], v[80:83], v[8:11]
    ds_read_b128 v[124:127], v210 offset:0
    v_cvt_pk_bf16_f32 v182, v240, v241
    v_mfma_f32_16x16x32_bf16 v[12:15], v[88:91], v[84:87], v[12:15]
    ds_read_b128 v[128:131], v210 offset:2048
    v_cvt_pk_bf16_f32 v183, v242, v243
    v_mfma_f32_16x16x32_bf16 v[16:19], v[92:95], v[80:83], v[16:19]
    ds_read_b128 v[132:135], v211 offset:9216
    v_lshlrev_b32 v232, 16, v184
    v_mfma_f32_16x16x32_bf16 v[20:23], v[92:95], v[84:87], v[20:23]
    ds_read_b128 v[136:139], v212 offset:9216
    v_and_b32 v233, 0xffff0000, v184
    v_mfma_f32_16x16x32_bf16 v[24:27], v[96:99], v[80:83], v[24:27]
    ds_read_b128 v[140:143], v211 offset:11264
    v_lshlrev_b32 v234, 16, v185
    v_mfma_f32_16x16x32_bf16 v[28:31], v[96:99], v[84:87], v[28:31]
    ds_read_b128 v[144:147], v212 offset:11264
    v_and_b32 v235, 0xffff0000, v185
    v_mfma_f32_16x16x32_bf16 v[32:35], v[100:103], v[80:83], v[32:35]
    ds_read_b128 v[148:151], v211 offset:13312
    v_mul_f32 v236, v232, v232
    v_mfma_f32_16x16x32_bf16 v[36:39], v[100:103], v[84:87], v[36:39]
    ds_read_b128 v[152:155], v212 offset:13312
    v_mul_f32 v237, v233, v233
    v_mfma_f32_16x16x32_bf16 v[40:43], v[104:107], v[80:83], v[40:43]
    ds_read_b128 v[156:159], v211 offset:15360
    v_mul_f32 v238, v234, v234
    v_mfma_f32_16x16x32_bf16 v[44:47], v[104:107], v[84:87], v[44:47]
    ds_read_b128 v[160:163], v212 offset:15360
    v_mul_f32 v239, v235, v235
    v_mfma_f32_16x16x32_bf16 v[48:51], v[108:111], v[80:83], v[48:51]
    ds_read_b128 v[164:167], v213 offset:9216
    v_fma_f32 v236, v236, v7, s78
    v_mfma_f32_16x16x32_bf16 v[52:55], v[108:111], v[84:87], v[52:55]
    v_fma_f32 v237, v237, v7, s78
    v_fma_f32 v238, v238, v7, s78
    v_mfma_f32_16x16x32_bf16 v[56:59], v[112:115], v[80:83], v[56:59]
    v_mfma_f32_16x16x32_bf16 v[60:63], v[112:115], v[84:87], v[60:63]
    v_mfma_f32_16x16x32_bf16 v[64:67], v[116:119], v[80:83], v[64:67]
    v_mfma_f32_16x16x32_bf16 v[68:71], v[116:119], v[84:87], v[68:71]
    v_mfma_f32_16x16x32_bf16 v[72:75], v[120:123], v[80:83], v[72:75]
    v_mfma_f32_16x16x32_bf16 v[76:79], v[120:123], v[84:87], v[76:79]
    s_waitcnt lgkmcnt(0)
    s_barrier
    v_mfma_f32_16x16x32_bf16 v[8:11], v[132:135], v[124:127], v[8:11]
    ds_read_b128 v[80:83], v209 offset:34816
    v_fma_f32 v239, v239, v7, s78
    v_mfma_f32_16x16x32_bf16 v[12:15], v[132:135], v[128:131], v[12:15]
    ds_read_b128 v[84:87], v209 offset:36864
    v_mul_f32 v236, v236, v232
    v_mfma_f32_16x16x32_bf16 v[16:19], v[136:139], v[124:127], v[16:19]
    ds_read_b128 v[88:91], v211 offset:34816
    v_mul_f32 v237, v237, v233
    v_mfma_f32_16x16x32_bf16 v[20:23], v[136:139], v[128:131], v[20:23]
    ds_read_b128 v[92:95], v212 offset:34816
    v_mul_f32 v238, v238, v234
    v_mfma_f32_16x16x32_bf16 v[24:27], v[140:143], v[124:127], v[24:27]
    ds_read_b128 v[96:99], v211 offset:36864
    v_mul_f32 v239, v239, v235
    v_mfma_f32_16x16x32_bf16 v[28:31], v[140:143], v[128:131], v[28:31]
    ds_read_b128 v[100:103], v212 offset:36864
    v_mfma_f32_16x16x32_bf16 v[32:35], v[144:147], v[124:127], v[32:35]
    ds_read_b128 v[104:107], v211 offset:38912
    v_mfma_f32_16x16x32_bf16 v[36:39], v[144:147], v[128:131], v[36:39]
    ds_read_b128 v[108:111], v212 offset:38912
    v_mfma_f32_16x16x32_bf16 v[40:43], v[148:151], v[124:127], v[40:43]
    ds_read_b128 v[112:115], v211 offset:40960
    v_mfma_f32_16x16x32_bf16 v[44:47], v[148:151], v[128:131], v[44:47]
    ds_read_b128 v[116:119], v212 offset:40960
    v_mfma_f32_16x16x32_bf16 v[48:51], v[152:155], v[124:127], v[48:51]
    ds_read_b128 v[120:123], v213 offset:34816
    v_mfma_f32_16x16x32_bf16 v[52:55], v[152:155], v[128:131], v[52:55]
    v_exp_f32 v236, v236
    v_mfma_f32_16x16x32_bf16 v[56:59], v[156:159], v[124:127], v[56:59]
    v_exp_f32 v237, v237
    v_mfma_f32_16x16x32_bf16 v[60:63], v[156:159], v[128:131], v[60:63]
    v_exp_f32 v238, v238
    v_mfma_f32_16x16x32_bf16 v[64:67], v[160:163], v[124:127], v[64:67]
    v_exp_f32 v239, v239
    v_mfma_f32_16x16x32_bf16 v[68:71], v[160:163], v[128:131], v[68:71]
    v_add_f32 v236, 1.0, v236
    v_add_f32 v237, 1.0, v237
    v_mfma_f32_16x16x32_bf16 v[72:75], v[164:167], v[124:127], v[72:75]
    v_add_f32 v238, 1.0, v238
    v_add_f32 v239, 1.0, v239
    v_mfma_f32_16x16x32_bf16 v[76:79], v[164:167], v[128:131], v[76:79]
    s_waitcnt lgkmcnt(0)
    v_mfma_f32_16x16x32_bf16 v[8:11], v[88:91], v[80:83], v[8:11]
    ds_read_b128 v[124:127], v210 offset:34816
    v_mfma_f32_16x16x32_bf16 v[12:15], v[88:91], v[84:87], v[12:15]
    ds_read_b128 v[128:131], v210 offset:36864
    v_mfma_f32_16x16x32_bf16 v[16:19], v[92:95], v[80:83], v[16:19]
    ds_read_b128 v[132:135], v211 offset:44032
    v_mfma_f32_16x16x32_bf16 v[20:23], v[92:95], v[84:87], v[20:23]
    ds_read_b128 v[136:139], v212 offset:44032
    v_mfma_f32_16x16x32_bf16 v[24:27], v[96:99], v[80:83], v[24:27]
    ds_read_b128 v[140:143], v211 offset:46080
    v_mfma_f32_16x16x32_bf16 v[28:31], v[96:99], v[84:87], v[28:31]
    ds_read_b128 v[144:147], v212 offset:46080
    v_mfma_f32_16x16x32_bf16 v[32:35], v[100:103], v[80:83], v[32:35]
    ds_read_b128 v[148:151], v211 offset:48128
    v_mfma_f32_16x16x32_bf16 v[36:39], v[100:103], v[84:87], v[36:39]
    ds_read_b128 v[152:155], v212 offset:48128
    v_mfma_f32_16x16x32_bf16 v[40:43], v[104:107], v[80:83], v[40:43]
    ds_read_b128 v[156:159], v211 offset:50176
    v_mfma_f32_16x16x32_bf16 v[44:47], v[104:107], v[84:87], v[44:47]
    ds_read_b128 v[160:163], v212 offset:50176
    v_mfma_f32_16x16x32_bf16 v[48:51], v[108:111], v[80:83], v[48:51]
    ds_read_b128 v[164:167], v213 offset:44032
    v_mfma_f32_16x16x32_bf16 v[52:55], v[108:111], v[84:87], v[52:55]
    v_rcp_f32 v236, v236
    v_mfma_f32_16x16x32_bf16 v[56:59], v[112:115], v[80:83], v[56:59]
    v_rcp_f32 v237, v237
    v_mfma_f32_16x16x32_bf16 v[60:63], v[112:115], v[84:87], v[60:63]
    v_rcp_f32 v238, v238
    v_mfma_f32_16x16x32_bf16 v[64:67], v[116:119], v[80:83], v[64:67]
    v_rcp_f32 v239, v239
    v_mfma_f32_16x16x32_bf16 v[68:71], v[116:119], v[84:87], v[68:71]
    v_mul_f32 v232, v232, v236
    v_mul_f32 v233, v233, v237
    v_mfma_f32_16x16x32_bf16 v[72:75], v[120:123], v[80:83], v[72:75]
    v_mul_f32 v234, v234, v238
    v_mul_f32 v235, v235, v239
    v_mfma_f32_16x16x32_bf16 v[76:79], v[120:123], v[84:87], v[76:79]
    s_waitcnt lgkmcnt(0)
    s_barrier
    v_mfma_f32_16x16x32_bf16 v[8:11], v[132:135], v[124:127], v[8:11]
    ds_read_b128 v[80:83], v224 offset:0
    v_cvt_pk_bf16_f32 v184, v232, v233
    v_mfma_f32_16x16x32_bf16 v[12:15], v[132:135], v[128:131], v[12:15]
    ds_read_b128 v[84:87], v224 offset:2048
    v_cvt_pk_bf16_f32 v185, v234, v235
    v_mfma_f32_16x16x32_bf16 v[16:19], v[136:139], v[124:127], v[16:19]
    ds_read_b128 v[88:91], v226 offset:0
    v_lshlrev_b32 v240, 16, v186
    v_mfma_f32_16x16x32_bf16 v[20:23], v[136:139], v[128:131], v[20:23]
    ds_read_b128 v[92:95], v227 offset:0
    v_and_b32 v241, 0xffff0000, v186
    v_mfma_f32_16x16x32_bf16 v[24:27], v[140:143], v[124:127], v[24:27]
    ds_read_b128 v[96:99], v226 offset:2048
    v_lshlrev_b32 v242, 16, v187
    v_mfma_f32_16x16x32_bf16 v[28:31], v[140:143], v[128:131], v[28:31]
    ds_read_b128 v[100:103], v227 offset:2048
    v_and_b32 v243, 0xffff0000, v187
    v_mfma_f32_16x16x32_bf16 v[32:35], v[144:147], v[124:127], v[32:35]
    ds_read_b128 v[104:107], v226 offset:4096
    v_mul_f32 v244, v240, v240
    v_mfma_f32_16x16x32_bf16 v[36:39], v[144:147], v[128:131], v[36:39]
    ds_read_b128 v[108:111], v227 offset:4096
    v_mul_f32 v245, v241, v241
    v_mfma_f32_16x16x32_bf16 v[40:43], v[148:151], v[124:127], v[40:43]
    ds_read_b128 v[112:115], v226 offset:6144
    v_mul_f32 v246, v242, v242
    v_mfma_f32_16x16x32_bf16 v[44:47], v[148:151], v[128:131], v[44:47]
    ds_read_b128 v[116:119], v227 offset:6144
    v_mul_f32 v247, v243, v243
    v_mfma_f32_16x16x32_bf16 v[48:51], v[152:155], v[124:127], v[48:51]
    ds_read_b128 v[120:123], v228 offset:0
    v_fma_f32 v244, v244, v7, s78
    v_mfma_f32_16x16x32_bf16 v[52:55], v[152:155], v[128:131], v[52:55]
    v_fma_f32 v245, v245, v7, s78
    v_fma_f32 v246, v246, v7, s78
    v_mfma_f32_16x16x32_bf16 v[56:59], v[156:159], v[124:127], v[56:59]
    v_mfma_f32_16x16x32_bf16 v[60:63], v[156:159], v[128:131], v[60:63]
    v_mfma_f32_16x16x32_bf16 v[64:67], v[160:163], v[124:127], v[64:67]
    v_mfma_f32_16x16x32_bf16 v[68:71], v[160:163], v[128:131], v[68:71]
    v_mfma_f32_16x16x32_bf16 v[72:75], v[164:167], v[124:127], v[72:75]
    v_mfma_f32_16x16x32_bf16 v[76:79], v[164:167], v[128:131], v[76:79]
    s_waitcnt lgkmcnt(0)
    v_mfma_f32_16x16x32_bf16 v[8:11], v[88:91], v[80:83], v[8:11]
    ds_read_b128 v[124:127], v225 offset:0
    v_fma_f32 v247, v247, v7, s78
    v_mfma_f32_16x16x32_bf16 v[12:15], v[88:91], v[84:87], v[12:15]
    ds_read_b128 v[128:131], v225 offset:2048
    v_mul_f32 v244, v244, v240
    v_mfma_f32_16x16x32_bf16 v[16:19], v[92:95], v[80:83], v[16:19]
    ds_read_b128 v[132:135], v226 offset:9216
    v_mul_f32 v245, v245, v241
    v_mfma_f32_16x16x32_bf16 v[20:23], v[92:95], v[84:87], v[20:23]
    ds_read_b128 v[136:139], v227 offset:9216
    v_mul_f32 v246, v246, v242
    v_mfma_f32_16x16x32_bf16 v[24:27], v[96:99], v[80:83], v[24:27]
    ds_read_b128 v[140:143], v226 offset:11264
    v_mul_f32 v247, v247, v243
    v_mfma_f32_16x16x32_bf16 v[28:31], v[96:99], v[84:87], v[28:31]
    ds_read_b128 v[144:147], v227 offset:11264
    v_mfma_f32_16x16x32_bf16 v[32:35], v[100:103], v[80:83], v[32:35]
    ds_read_b128 v[148:151], v226 offset:13312
    v_mfma_f32_16x16x32_bf16 v[36:39], v[100:103], v[84:87], v[36:39]
    ds_read_b128 v[152:155], v227 offset:13312
    v_mfma_f32_16x16x32_bf16 v[40:43], v[104:107], v[80:83], v[40:43]
    ds_read_b128 v[156:159], v226 offset:15360
    v_mfma_f32_16x16x32_bf16 v[44:47], v[104:107], v[84:87], v[44:47]
    ds_read_b128 v[160:163], v227 offset:15360
    v_mfma_f32_16x16x32_bf16 v[48:51], v[108:111], v[80:83], v[48:51]
    ds_read_b128 v[164:167], v228 offset:9216
    v_mfma_f32_16x16x32_bf16 v[52:55], v[108:111], v[84:87], v[52:55]
    v_exp_f32 v244, v244
    v_mfma_f32_16x16x32_bf16 v[56:59], v[112:115], v[80:83], v[56:59]
    v_exp_f32 v245, v245
    v_mfma_f32_16x16x32_bf16 v[60:63], v[112:115], v[84:87], v[60:63]
    v_exp_f32 v246, v246
    v_mfma_f32_16x16x32_bf16 v[64:67], v[116:119], v[80:83], v[64:67]
    v_exp_f32 v247, v247
    v_mfma_f32_16x16x32_bf16 v[68:71], v[116:119], v[84:87], v[68:71]
    v_add_f32 v244, 1.0, v244
    v_add_f32 v245, 1.0, v245
    v_mfma_f32_16x16x32_bf16 v[72:75], v[120:123], v[80:83], v[72:75]
    v_add_f32 v246, 1.0, v246
    v_add_f32 v247, 1.0, v247
    v_mfma_f32_16x16x32_bf16 v[76:79], v[120:123], v[84:87], v[76:79]
    s_waitcnt lgkmcnt(0)
    s_barrier
    v_mfma_f32_16x16x32_bf16 v[8:11], v[132:135], v[124:127], v[8:11]
    ds_read_b128 v[80:83], v224 offset:34816
    v_mfma_f32_16x16x32_bf16 v[12:15], v[132:135], v[128:131], v[12:15]
    ds_read_b128 v[84:87], v224 offset:36864
    v_mfma_f32_16x16x32_bf16 v[16:19], v[136:139], v[124:127], v[16:19]
    ds_read_b128 v[88:91], v226 offset:34816
    v_mfma_f32_16x16x32_bf16 v[20:23], v[136:139], v[128:131], v[20:23]
    ds_read_b128 v[92:95], v227 offset:34816
    v_mfma_f32_16x16x32_bf16 v[24:27], v[140:143], v[124:127], v[24:27]
    ds_read_b128 v[96:99], v226 offset:36864
    v_mfma_f32_16x16x32_bf16 v[28:31], v[140:143], v[128:131], v[28:31]
    ds_read_b128 v[100:103], v227 offset:36864
    v_mfma_f32_16x16x32_bf16 v[32:35], v[144:147], v[124:127], v[32:35]
    ds_read_b128 v[104:107], v226 offset:38912
    v_mfma_f32_16x16x32_bf16 v[36:39], v[144:147], v[128:131], v[36:39]
    ds_read_b128 v[108:111], v227 offset:38912
    v_mfma_f32_16x16x32_bf16 v[40:43], v[148:151], v[124:127], v[40:43]
    ds_read_b128 v[112:115], v226 offset:40960
    v_mfma_f32_16x16x32_bf16 v[44:47], v[148:151], v[128:131], v[44:47]
    ds_read_b128 v[116:119], v227 offset:40960
    v_mfma_f32_16x16x32_bf16 v[48:51], v[152:155], v[124:127], v[48:51]
    ds_read_b128 v[120:123], v228 offset:34816
    v_mfma_f32_16x16x32_bf16 v[52:55], v[152:155], v[128:131], v[52:55]
    v_rcp_f32 v244, v244
    v_mfma_f32_16x16x32_bf16 v[56:59], v[156:159], v[124:127], v[56:59]
    v_rcp_f32 v245, v245
    v_mfma_f32_16x16x32_bf16 v[60:63], v[156:159], v[128:131], v[60:63]
    v_rcp_f32 v246, v246
    v_mfma_f32_16x16x32_bf16 v[64:67], v[160:163], v[124:127], v[64:67]
    v_rcp_f32 v247, v247
    v_mfma_f32_16x16x32_bf16 v[68:71], v[160:163], v[128:131], v[68:71]
    v_mul_f32 v240, v240, v244
    v_mul_f32 v241, v241, v245
    v_mfma_f32_16x16x32_bf16 v[72:75], v[164:167], v[124:127], v[72:75]
    v_mul_f32 v242, v242, v246
    v_mul_f32 v243, v243, v247
    v_mfma_f32_16x16x32_bf16 v[76:79], v[164:167], v[128:131], v[76:79]
    s_waitcnt lgkmcnt(0)
    v_mfma_f32_16x16x32_bf16 v[8:11], v[88:91], v[80:83], v[8:11]
    ds_read_b128 v[124:127], v225 offset:34816
    v_cvt_pk_bf16_f32 v186, v240, v241
    v_mfma_f32_16x16x32_bf16 v[12:15], v[88:91], v[84:87], v[12:15]
    ds_read_b128 v[128:131], v225 offset:36864
    v_cvt_pk_bf16_f32 v187, v242, v243
    v_mfma_f32_16x16x32_bf16 v[16:19], v[92:95], v[80:83], v[16:19]
    ds_read_b128 v[132:135], v226 offset:44032
    v_lshlrev_b32 v232, 16, v188
    v_mfma_f32_16x16x32_bf16 v[20:23], v[92:95], v[84:87], v[20:23]
    ds_read_b128 v[136:139], v227 offset:44032
    v_and_b32 v233, 0xffff0000, v188
    v_mfma_f32_16x16x32_bf16 v[24:27], v[96:99], v[80:83], v[24:27]
    ds_read_b128 v[140:143], v226 offset:46080
    v_lshlrev_b32 v234, 16, v189
    v_mfma_f32_16x16x32_bf16 v[28:31], v[96:99], v[84:87], v[28:31]
    ds_read_b128 v[144:147], v227 offset:46080
    v_and_b32 v235, 0xffff0000, v189
    v_mfma_f32_16x16x32_bf16 v[32:35], v[100:103], v[80:83], v[32:35]
    ds_read_b128 v[148:151], v226 offset:48128
    v_mul_f32 v236, v232, v232
    v_mfma_f32_16x16x32_bf16 v[36:39], v[100:103], v[84:87], v[36:39]
    ds_read_b128 v[152:155], v227 offset:48128
    v_mul_f32 v237, v233, v233
    v_mfma_f32_16x16x32_bf16 v[40:43], v[104:107], v[80:83], v[40:43]
    ds_read_b128 v[156:159], v226 offset:50176
    v_mul_f32 v238, v234, v234
    v_mfma_f32_16x16x32_bf16 v[44:47], v[104:107], v[84:87], v[44:47]
    ds_read_b128 v[160:163], v227 offset:50176
    v_mul_f32 v239, v235, v235
    v_mfma_f32_16x16x32_bf16 v[48:51], v[108:111], v[80:83], v[48:51]
    ds_read_b128 v[164:167], v228 offset:44032
    v_fma_f32 v236, v236, v7, s78
    v_mfma_f32_16x16x32_bf16 v[52:55], v[108:111], v[84:87], v[52:55]
    v_fma_f32 v237, v237, v7, s78
    v_fma_f32 v238, v238, v7, s78
    v_mfma_f32_16x16x32_bf16 v[56:59], v[112:115], v[80:83], v[56:59]
    v_mfma_f32_16x16x32_bf16 v[60:63], v[112:115], v[84:87], v[60:63]
    v_mfma_f32_16x16x32_bf16 v[64:67], v[116:119], v[80:83], v[64:67]
    v_mfma_f32_16x16x32_bf16 v[68:71], v[116:119], v[84:87], v[68:71]
    v_mfma_f32_16x16x32_bf16 v[72:75], v[120:123], v[80:83], v[72:75]
    v_mfma_f32_16x16x32_bf16 v[76:79], v[120:123], v[84:87], v[76:79]
    s_waitcnt lgkmcnt(0)
    s_barrier
    v_mfma_f32_16x16x32_bf16 v[8:11], v[132:135], v[124:127], v[8:11]
    ds_read_b128 v[80:83], v209 offset:0
    v_fma_f32 v239, v239, v7, s78
    v_mfma_f32_16x16x32_bf16 v[12:15], v[132:135], v[128:131], v[12:15]
    ds_read_b128 v[84:87], v209 offset:2048
    v_mul_f32 v236, v236, v232
    v_mfma_f32_16x16x32_bf16 v[16:19], v[136:139], v[124:127], v[16:19]
    ds_read_b128 v[88:91], v211 offset:0
    v_mul_f32 v237, v237, v233
    v_mfma_f32_16x16x32_bf16 v[20:23], v[136:139], v[128:131], v[20:23]
    ds_read_b128 v[92:95], v212 offset:0
    v_mul_f32 v238, v238, v234
    v_mfma_f32_16x16x32_bf16 v[24:27], v[140:143], v[124:127], v[24:27]
    ds_read_b128 v[96:99], v211 offset:2048
    v_mul_f32 v239, v239, v235
    v_mfma_f32_16x16x32_bf16 v[28:31], v[140:143], v[128:131], v[28:31]
    ds_read_b128 v[100:103], v212 offset:2048
    v_mfma_f32_16x16x32_bf16 v[32:35], v[144:147], v[124:127], v[32:35]
    ds_read_b128 v[104:107], v211 offset:4096
    v_mfma_f32_16x16x32_bf16 v[36:39], v[144:147], v[128:131], v[36:39]
    ds_read_b128 v[108:111], v212 offset:4096
    v_mfma_f32_16x16x32_bf16 v[40:43], v[148:151], v[124:127], v[40:43]
    ds_read_b128 v[112:115], v211 offset:6144
    v_mfma_f32_16x16x32_bf16 v[44:47], v[148:151], v[128:131], v[44:47]
    ds_read_b128 v[116:119], v212 offset:6144
    v_mfma_f32_16x16x32_bf16 v[48:51], v[152:155], v[124:127], v[48:51]
    ds_read_b128 v[120:123], v213 offset:0
    v_mfma_f32_16x16x32_bf16 v[52:55], v[152:155], v[128:131], v[52:55]
    v_exp_f32 v236, v236
    v_mfma_f32_16x16x32_bf16 v[56:59], v[156:159], v[124:127], v[56:59]
    v_exp_f32 v237, v237
    v_mfma_f32_16x16x32_bf16 v[60:63], v[156:159], v[128:131], v[60:63]
    v_exp_f32 v238, v238
    v_mfma_f32_16x16x32_bf16 v[64:67], v[160:163], v[124:127], v[64:67]
    v_exp_f32 v239, v239
    v_mfma_f32_16x16x32_bf16 v[68:71], v[160:163], v[128:131], v[68:71]
    v_add_f32 v236, 1.0, v236
    v_add_f32 v237, 1.0, v237
    v_mfma_f32_16x16x32_bf16 v[72:75], v[164:167], v[124:127], v[72:75]
    v_add_f32 v238, 1.0, v238
    v_add_f32 v239, 1.0, v239
    v_mfma_f32_16x16x32_bf16 v[76:79], v[164:167], v[128:131], v[76:79]
    s_waitcnt lgkmcnt(0)
    v_mfma_f32_16x16x32_bf16 v[8:11], v[88:91], v[80:83], v[8:11]
    ds_read_b128 v[124:127], v210 offset:0
    v_mfma_f32_16x16x32_bf16 v[12:15], v[88:91], v[84:87], v[12:15]
    ds_read_b128 v[128:131], v210 offset:2048
    v_mfma_f32_16x16x32_bf16 v[16:19], v[92:95], v[80:83], v[16:19]
    ds_read_b128 v[132:135], v211 offset:9216
    v_mfma_f32_16x16x32_bf16 v[20:23], v[92:95], v[84:87], v[20:23]
    ds_read_b128 v[136:139], v212 offset:9216
    v_mfma_f32_16x16x32_bf16 v[24:27], v[96:99], v[80:83], v[24:27]
    ds_read_b128 v[140:143], v211 offset:11264
    v_mfma_f32_16x16x32_bf16 v[28:31], v[96:99], v[84:87], v[28:31]
    ds_read_b128 v[144:147], v212 offset:11264
    v_mfma_f32_16x16x32_bf16 v[32:35], v[100:103], v[80:83], v[32:35]
    ds_read_b128 v[148:151], v211 offset:13312
    v_mfma_f32_16x16x32_bf16 v[36:39], v[100:103], v[84:87], v[36:39]
    ds_read_b128 v[152:155], v212 offset:13312
    v_mfma_f32_16x16x32_bf16 v[40:43], v[104:107], v[80:83], v[40:43]
    ds_read_b128 v[156:159], v211 offset:15360
    v_mfma_f32_16x16x32_bf16 v[44:47], v[104:107], v[84:87], v[44:47]
    ds_read_b128 v[160:163], v212 offset:15360
    v_mfma_f32_16x16x32_bf16 v[48:51], v[108:111], v[80:83], v[48:51]
    ds_read_b128 v[164:167], v213 offset:9216
    v_mfma_f32_16x16x32_bf16 v[52:55], v[108:111], v[84:87], v[52:55]
    v_rcp_f32 v236, v236
    v_mfma_f32_16x16x32_bf16 v[56:59], v[112:115], v[80:83], v[56:59]
    v_rcp_f32 v237, v237
    v_mfma_f32_16x16x32_bf16 v[60:63], v[112:115], v[84:87], v[60:63]
    v_rcp_f32 v238, v238
    v_mfma_f32_16x16x32_bf16 v[64:67], v[116:119], v[80:83], v[64:67]
    v_rcp_f32 v239, v239
    v_mfma_f32_16x16x32_bf16 v[68:71], v[116:119], v[84:87], v[68:71]
    v_mul_f32 v232, v232, v236
    v_mul_f32 v233, v233, v237
    v_mfma_f32_16x16x32_bf16 v[72:75], v[120:123], v[80:83], v[72:75]
    v_mul_f32 v234, v234, v238
    v_mul_f32 v235, v235, v239
    v_mfma_f32_16x16x32_bf16 v[76:79], v[120:123], v[84:87], v[76:79]
    s_waitcnt lgkmcnt(0)
    s_barrier
    v_mfma_f32_16x16x32_bf16 v[8:11], v[132:135], v[124:127], v[8:11]
    ds_read_b128 v[80:83], v209 offset:34816
    v_cvt_pk_bf16_f32 v188, v232, v233
    v_mfma_f32_16x16x32_bf16 v[12:15], v[132:135], v[128:131], v[12:15]
    ds_read_b128 v[84:87], v209 offset:36864
    v_cvt_pk_bf16_f32 v189, v234, v235
    v_mfma_f32_16x16x32_bf16 v[16:19], v[136:139], v[124:127], v[16:19]
    ds_read_b128 v[88:91], v211 offset:34816
    v_lshlrev_b32 v240, 16, v190
    v_mfma_f32_16x16x32_bf16 v[20:23], v[136:139], v[128:131], v[20:23]
    ds_read_b128 v[92:95], v212 offset:34816
    v_and_b32 v241, 0xffff0000, v190
    v_mfma_f32_16x16x32_bf16 v[24:27], v[140:143], v[124:127], v[24:27]
    ds_read_b128 v[96:99], v211 offset:36864
    v_lshlrev_b32 v242, 16, v191
    v_mfma_f32_16x16x32_bf16 v[28:31], v[140:143], v[128:131], v[28:31]
    ds_read_b128 v[100:103], v212 offset:36864
    v_and_b32 v243, 0xffff0000, v191
    v_mfma_f32_16x16x32_bf16 v[32:35], v[144:147], v[124:127], v[32:35]
    ds_read_b128 v[104:107], v211 offset:38912
    v_mul_f32 v244, v240, v240
    v_mfma_f32_16x16x32_bf16 v[36:39], v[144:147], v[128:131], v[36:39]
    ds_read_b128 v[108:111], v212 offset:38912
    v_mul_f32 v245, v241, v241
    v_mfma_f32_16x16x32_bf16 v[40:43], v[148:151], v[124:127], v[40:43]
    ds_read_b128 v[112:115], v211 offset:40960
    v_mul_f32 v246, v242, v242
    v_mfma_f32_16x16x32_bf16 v[44:47], v[148:151], v[128:131], v[44:47]
    ds_read_b128 v[116:119], v212 offset:40960
    v_mul_f32 v247, v243, v243
    v_mfma_f32_16x16x32_bf16 v[48:51], v[152:155], v[124:127], v[48:51]
    ds_read_b128 v[120:123], v213 offset:34816
    v_fma_f32 v244, v244, v7, s78
    v_mfma_f32_16x16x32_bf16 v[52:55], v[152:155], v[128:131], v[52:55]
    v_fma_f32 v245, v245, v7, s78
    v_fma_f32 v246, v246, v7, s78
    v_mfma_f32_16x16x32_bf16 v[56:59], v[156:159], v[124:127], v[56:59]
    v_mfma_f32_16x16x32_bf16 v[60:63], v[156:159], v[128:131], v[60:63]
    v_mfma_f32_16x16x32_bf16 v[64:67], v[160:163], v[124:127], v[64:67]
    v_mfma_f32_16x16x32_bf16 v[68:71], v[160:163], v[128:131], v[68:71]
    v_mfma_f32_16x16x32_bf16 v[72:75], v[164:167], v[124:127], v[72:75]
    v_mfma_f32_16x16x32_bf16 v[76:79], v[164:167], v[128:131], v[76:79]
    s_waitcnt lgkmcnt(0)
    v_mfma_f32_16x16x32_bf16 v[8:11], v[88:91], v[80:83], v[8:11]
    ds_read_b128 v[124:127], v210 offset:34816
    v_fma_f32 v247, v247, v7, s78
    v_mfma_f32_16x16x32_bf16 v[12:15], v[88:91], v[84:87], v[12:15]
    ds_read_b128 v[128:131], v210 offset:36864
    v_mul_f32 v244, v244, v240
    v_mfma_f32_16x16x32_bf16 v[16:19], v[92:95], v[80:83], v[16:19]
    ds_read_b128 v[132:135], v211 offset:44032
    v_mul_f32 v245, v245, v241
    v_mfma_f32_16x16x32_bf16 v[20:23], v[92:95], v[84:87], v[20:23]
    ds_read_b128 v[136:139], v212 offset:44032
    v_mul_f32 v246, v246, v242
    v_mfma_f32_16x16x32_bf16 v[24:27], v[96:99], v[80:83], v[24:27]
    ds_read_b128 v[140:143], v211 offset:46080
    v_mul_f32 v247, v247, v243
    v_mfma_f32_16x16x32_bf16 v[28:31], v[96:99], v[84:87], v[28:31]
    ds_read_b128 v[144:147], v212 offset:46080
    v_mfma_f32_16x16x32_bf16 v[32:35], v[100:103], v[80:83], v[32:35]
    ds_read_b128 v[148:151], v211 offset:48128
    v_mfma_f32_16x16x32_bf16 v[36:39], v[100:103], v[84:87], v[36:39]
    ds_read_b128 v[152:155], v212 offset:48128
    v_mfma_f32_16x16x32_bf16 v[40:43], v[104:107], v[80:83], v[40:43]
    ds_read_b128 v[156:159], v211 offset:50176
    v_mfma_f32_16x16x32_bf16 v[44:47], v[104:107], v[84:87], v[44:47]
    ds_read_b128 v[160:163], v212 offset:50176
    v_mfma_f32_16x16x32_bf16 v[48:51], v[108:111], v[80:83], v[48:51]
    ds_read_b128 v[164:167], v213 offset:44032
    v_mfma_f32_16x16x32_bf16 v[52:55], v[108:111], v[84:87], v[52:55]
    v_exp_f32 v244, v244
    v_mfma_f32_16x16x32_bf16 v[56:59], v[112:115], v[80:83], v[56:59]
    v_exp_f32 v245, v245
    v_mfma_f32_16x16x32_bf16 v[60:63], v[112:115], v[84:87], v[60:63]
    v_exp_f32 v246, v246
    v_mfma_f32_16x16x32_bf16 v[64:67], v[116:119], v[80:83], v[64:67]
    v_exp_f32 v247, v247
    v_mfma_f32_16x16x32_bf16 v[68:71], v[116:119], v[84:87], v[68:71]
    v_add_f32 v244, 1.0, v244
    v_add_f32 v245, 1.0, v245
    v_mfma_f32_16x16x32_bf16 v[72:75], v[120:123], v[80:83], v[72:75]
    v_add_f32 v246, 1.0, v246
    v_add_f32 v247, 1.0, v247
    v_mfma_f32_16x16x32_bf16 v[76:79], v[120:123], v[84:87], v[76:79]
    s_waitcnt lgkmcnt(0)
    s_barrier
    v_mfma_f32_16x16x32_bf16 v[8:11], v[132:135], v[124:127], v[8:11]
    ds_read_b128 v[80:83], v224 offset:0
    v_mfma_f32_16x16x32_bf16 v[12:15], v[132:135], v[128:131], v[12:15]
    ds_read_b128 v[84:87], v224 offset:2048
    v_mfma_f32_16x16x32_bf16 v[16:19], v[136:139], v[124:127], v[16:19]
    ds_read_b128 v[88:91], v226 offset:0
    v_mfma_f32_16x16x32_bf16 v[20:23], v[136:139], v[128:131], v[20:23]
    ds_read_b128 v[92:95], v227 offset:0
    v_mfma_f32_16x16x32_bf16 v[24:27], v[140:143], v[124:127], v[24:27]
    ds_read_b128 v[96:99], v226 offset:2048
    v_mfma_f32_16x16x32_bf16 v[28:31], v[140:143], v[128:131], v[28:31]
    ds_read_b128 v[100:103], v227 offset:2048
    v_mfma_f32_16x16x32_bf16 v[32:35], v[144:147], v[124:127], v[32:35]
    ds_read_b128 v[104:107], v226 offset:4096
    v_mfma_f32_16x16x32_bf16 v[36:39], v[144:147], v[128:131], v[36:39]
    ds_read_b128 v[108:111], v227 offset:4096
    v_mfma_f32_16x16x32_bf16 v[40:43], v[148:151], v[124:127], v[40:43]
    ds_read_b128 v[112:115], v226 offset:6144
    v_mfma_f32_16x16x32_bf16 v[44:47], v[148:151], v[128:131], v[44:47]
    ds_read_b128 v[116:119], v227 offset:6144
    v_mfma_f32_16x16x32_bf16 v[48:51], v[152:155], v[124:127], v[48:51]
    ds_read_b128 v[120:123], v228 offset:0
    v_mfma_f32_16x16x32_bf16 v[52:55], v[152:155], v[128:131], v[52:55]
    v_rcp_f32 v244, v244
    v_mfma_f32_16x16x32_bf16 v[56:59], v[156:159], v[124:127], v[56:59]
    v_rcp_f32 v245, v245
    v_mfma_f32_16x16x32_bf16 v[60:63], v[156:159], v[128:131], v[60:63]
    v_rcp_f32 v246, v246
    v_mfma_f32_16x16x32_bf16 v[64:67], v[160:163], v[124:127], v[64:67]
    v_rcp_f32 v247, v247
    v_mfma_f32_16x16x32_bf16 v[68:71], v[160:163], v[128:131], v[68:71]
    v_mul_f32 v240, v240, v244
    v_mul_f32 v241, v241, v245
    v_mfma_f32_16x16x32_bf16 v[72:75], v[164:167], v[124:127], v[72:75]
    v_mul_f32 v242, v242, v246
    v_mul_f32 v243, v243, v247
    v_mfma_f32_16x16x32_bf16 v[76:79], v[164:167], v[128:131], v[76:79]
    s_waitcnt lgkmcnt(0)
    v_mfma_f32_16x16x32_bf16 v[8:11], v[88:91], v[80:83], v[8:11]
    ds_read_b128 v[124:127], v225 offset:0
    v_cvt_pk_bf16_f32 v190, v240, v241
    v_mfma_f32_16x16x32_bf16 v[12:15], v[88:91], v[84:87], v[12:15]
    ds_read_b128 v[128:131], v225 offset:2048
    v_cvt_pk_bf16_f32 v191, v242, v243
    v_mfma_f32_16x16x32_bf16 v[16:19], v[92:95], v[80:83], v[16:19]
    ds_read_b128 v[132:135], v226 offset:9216
    v_lshlrev_b32 v232, 16, v192
    v_mfma_f32_16x16x32_bf16 v[20:23], v[92:95], v[84:87], v[20:23]
    ds_read_b128 v[136:139], v227 offset:9216
    v_and_b32 v233, 0xffff0000, v192
    v_mfma_f32_16x16x32_bf16 v[24:27], v[96:99], v[80:83], v[24:27]
    ds_read_b128 v[140:143], v226 offset:11264
    v_lshlrev_b32 v234, 16, v193
    v_mfma_f32_16x16x32_bf16 v[28:31], v[96:99], v[84:87], v[28:31]
    ds_read_b128 v[144:147], v227 offset:11264
    v_and_b32 v235, 0xffff0000, v193
    v_mfma_f32_16x16x32_bf16 v[32:35], v[100:103], v[80:83], v[32:35]
    ds_read_b128 v[148:151], v226 offset:13312
    v_mul_f32 v236, v232, v232
    v_mfma_f32_16x16x32_bf16 v[36:39], v[100:103], v[84:87], v[36:39]
    ds_read_b128 v[152:155], v227 offset:13312
    v_mul_f32 v237, v233, v233
    v_mfma_f32_16x16x32_bf16 v[40:43], v[104:107], v[80:83], v[40:43]
    ds_read_b128 v[156:159], v226 offset:15360
    v_mul_f32 v238, v234, v234
    v_mfma_f32_16x16x32_bf16 v[44:47], v[104:107], v[84:87], v[44:47]
    ds_read_b128 v[160:163], v227 offset:15360
    v_mul_f32 v239, v235, v235
    v_mfma_f32_16x16x32_bf16 v[48:51], v[108:111], v[80:83], v[48:51]
    ds_read_b128 v[164:167], v228 offset:9216
    v_fma_f32 v236, v236, v7, s78
    v_mfma_f32_16x16x32_bf16 v[52:55], v[108:111], v[84:87], v[52:55]
    v_fma_f32 v237, v237, v7, s78
    v_fma_f32 v238, v238, v7, s78
    v_mfma_f32_16x16x32_bf16 v[56:59], v[112:115], v[80:83], v[56:59]
    v_mfma_f32_16x16x32_bf16 v[60:63], v[112:115], v[84:87], v[60:63]
    v_mfma_f32_16x16x32_bf16 v[64:67], v[116:119], v[80:83], v[64:67]
    v_mfma_f32_16x16x32_bf16 v[68:71], v[116:119], v[84:87], v[68:71]
    v_mfma_f32_16x16x32_bf16 v[72:75], v[120:123], v[80:83], v[72:75]
    v_mfma_f32_16x16x32_bf16 v[76:79], v[120:123], v[84:87], v[76:79]
    s_waitcnt lgkmcnt(0)
    s_barrier
    v_mfma_f32_16x16x32_bf16 v[8:11], v[132:135], v[124:127], v[8:11]
    ds_read_b128 v[80:83], v224 offset:34816
    v_fma_f32 v239, v239, v7, s78
    v_mfma_f32_16x16x32_bf16 v[12:15], v[132:135], v[128:131], v[12:15]
    ds_read_b128 v[84:87], v224 offset:36864
    v_mul_f32 v236, v236, v232
    v_mfma_f32_16x16x32_bf16 v[16:19], v[136:139], v[124:127], v[16:19]
    ds_read_b128 v[88:91], v226 offset:34816
    v_mul_f32 v237, v237, v233
    v_mfma_f32_16x16x32_bf16 v[20:23], v[136:139], v[128:131], v[20:23]
    ds_read_b128 v[92:95], v227 offset:34816
    v_mul_f32 v238, v238, v234
    v_mfma_f32_16x16x32_bf16 v[24:27], v[140:143], v[124:127], v[24:27]
    ds_read_b128 v[96:99], v226 offset:36864
    v_mul_f32 v239, v239, v235
    v_mfma_f32_16x16x32_bf16 v[28:31], v[140:143], v[128:131], v[28:31]
    ds_read_b128 v[100:103], v227 offset:36864
    v_mfma_f32_16x16x32_bf16 v[32:35], v[144:147], v[124:127], v[32:35]
    ds_read_b128 v[104:107], v226 offset:38912
    v_mfma_f32_16x16x32_bf16 v[36:39], v[144:147], v[128:131], v[36:39]
    ds_read_b128 v[108:111], v227 offset:38912
    v_mfma_f32_16x16x32_bf16 v[40:43], v[148:151], v[124:127], v[40:43]
    ds_read_b128 v[112:115], v226 offset:40960
    v_mfma_f32_16x16x32_bf16 v[44:47], v[148:151], v[128:131], v[44:47]
    ds_read_b128 v[116:119], v227 offset:40960
    v_mfma_f32_16x16x32_bf16 v[48:51], v[152:155], v[124:127], v[48:51]
    ds_read_b128 v[120:123], v228 offset:34816
    v_mfma_f32_16x16x32_bf16 v[52:55], v[152:155], v[128:131], v[52:55]
    v_exp_f32 v236, v236
    v_mfma_f32_16x16x32_bf16 v[56:59], v[156:159], v[124:127], v[56:59]
    v_exp_f32 v237, v237
    v_mfma_f32_16x16x32_bf16 v[60:63], v[156:159], v[128:131], v[60:63]
    v_exp_f32 v238, v238
    v_mfma_f32_16x16x32_bf16 v[64:67], v[160:163], v[124:127], v[64:67]
    v_exp_f32 v239, v239
    v_mfma_f32_16x16x32_bf16 v[68:71], v[160:163], v[128:131], v[68:71]
    v_add_f32 v236, 1.0, v236
    v_add_f32 v237, 1.0, v237
    v_mfma_f32_16x16x32_bf16 v[72:75], v[164:167], v[124:127], v[72:75]
    v_add_f32 v238, 1.0, v238
    v_add_f32 v239, 1.0, v239
    v_mfma_f32_16x16x32_bf16 v[76:79], v[164:167], v[128:131], v[76:79]
    s_waitcnt lgkmcnt(0)
    v_mfma_f32_16x16x32_bf16 v[8:11], v[88:91], v[80:83], v[8:11]
    ds_read_b128 v[124:127], v225 offset:34816
    v_mfma_f32_16x16x32_bf16 v[12:15], v[88:91], v[84:87], v[12:15]
    ds_read_b128 v[128:131], v225 offset:36864
    v_mfma_f32_16x16x32_bf16 v[16:19], v[92:95], v[80:83], v[16:19]
    ds_read_b128 v[132:135], v226 offset:44032
    v_mfma_f32_16x16x32_bf16 v[20:23], v[92:95], v[84:87], v[20:23]
    ds_read_b128 v[136:139], v227 offset:44032
    v_mfma_f32_16x16x32_bf16 v[24:27], v[96:99], v[80:83], v[24:27]
    ds_read_b128 v[140:143], v226 offset:46080
    v_mfma_f32_16x16x32_bf16 v[28:31], v[96:99], v[84:87], v[28:31]
    ds_read_b128 v[144:147], v227 offset:46080
    v_mfma_f32_16x16x32_bf16 v[32:35], v[100:103], v[80:83], v[32:35]
    ds_read_b128 v[148:151], v226 offset:48128
    v_mfma_f32_16x16x32_bf16 v[36:39], v[100:103], v[84:87], v[36:39]
    ds_read_b128 v[152:155], v227 offset:48128
    v_mfma_f32_16x16x32_bf16 v[40:43], v[104:107], v[80:83], v[40:43]
    ds_read_b128 v[156:159], v226 offset:50176
    v_mfma_f32_16x16x32_bf16 v[44:47], v[104:107], v[84:87], v[44:47]
    ds_read_b128 v[160:163], v227 offset:50176
    v_mfma_f32_16x16x32_bf16 v[48:51], v[108:111], v[80:83], v[48:51]
    ds_read_b128 v[164:167], v228 offset:44032
    v_mfma_f32_16x16x32_bf16 v[52:55], v[108:111], v[84:87], v[52:55]
    v_rcp_f32 v236, v236
    v_mfma_f32_16x16x32_bf16 v[56:59], v[112:115], v[80:83], v[56:59]
    v_rcp_f32 v237, v237
    v_mfma_f32_16x16x32_bf16 v[60:63], v[112:115], v[84:87], v[60:63]
    v_rcp_f32 v238, v238
    v_mfma_f32_16x16x32_bf16 v[64:67], v[116:119], v[80:83], v[64:67]
    v_rcp_f32 v239, v239
    v_mfma_f32_16x16x32_bf16 v[68:71], v[116:119], v[84:87], v[68:71]
    v_mul_f32 v232, v232, v236
    v_mul_f32 v233, v233, v237
    v_mfma_f32_16x16x32_bf16 v[72:75], v[120:123], v[80:83], v[72:75]
    v_mul_f32 v234, v234, v238
    v_mul_f32 v235, v235, v239
    v_mfma_f32_16x16x32_bf16 v[76:79], v[120:123], v[84:87], v[76:79]
    s_waitcnt lgkmcnt(0)
    s_barrier
    v_mfma_f32_16x16x32_bf16 v[8:11], v[132:135], v[124:127], v[8:11]
    ds_read_b128 v[80:83], v209 offset:0
    v_cvt_pk_bf16_f32 v192, v232, v233
    v_mfma_f32_16x16x32_bf16 v[12:15], v[132:135], v[128:131], v[12:15]
    ds_read_b128 v[84:87], v209 offset:2048
    v_cvt_pk_bf16_f32 v193, v234, v235
    v_mfma_f32_16x16x32_bf16 v[16:19], v[136:139], v[124:127], v[16:19]
    ds_read_b128 v[88:91], v211 offset:0
    v_lshlrev_b32 v240, 16, v194
    v_mfma_f32_16x16x32_bf16 v[20:23], v[136:139], v[128:131], v[20:23]
    ds_read_b128 v[92:95], v212 offset:0
    v_and_b32 v241, 0xffff0000, v194
    v_mfma_f32_16x16x32_bf16 v[24:27], v[140:143], v[124:127], v[24:27]
    ds_read_b128 v[96:99], v211 offset:2048
    v_lshlrev_b32 v242, 16, v195
    v_mfma_f32_16x16x32_bf16 v[28:31], v[140:143], v[128:131], v[28:31]
    ds_read_b128 v[100:103], v212 offset:2048
    v_and_b32 v243, 0xffff0000, v195
    v_mfma_f32_16x16x32_bf16 v[32:35], v[144:147], v[124:127], v[32:35]
    ds_read_b128 v[104:107], v211 offset:4096
    v_mul_f32 v244, v240, v240
    v_mfma_f32_16x16x32_bf16 v[36:39], v[144:147], v[128:131], v[36:39]
    ds_read_b128 v[108:111], v212 offset:4096
    v_mul_f32 v245, v241, v241
    v_mfma_f32_16x16x32_bf16 v[40:43], v[148:151], v[124:127], v[40:43]
    ds_read_b128 v[112:115], v211 offset:6144
    v_mul_f32 v246, v242, v242
    v_mfma_f32_16x16x32_bf16 v[44:47], v[148:151], v[128:131], v[44:47]
    ds_read_b128 v[116:119], v212 offset:6144
    v_mul_f32 v247, v243, v243
    v_mfma_f32_16x16x32_bf16 v[48:51], v[152:155], v[124:127], v[48:51]
    ds_read_b128 v[120:123], v213 offset:0
    v_fma_f32 v244, v244, v7, s78
    v_mfma_f32_16x16x32_bf16 v[52:55], v[152:155], v[128:131], v[52:55]
    v_fma_f32 v245, v245, v7, s78
    v_fma_f32 v246, v246, v7, s78
    v_mfma_f32_16x16x32_bf16 v[56:59], v[156:159], v[124:127], v[56:59]
    v_mfma_f32_16x16x32_bf16 v[60:63], v[156:159], v[128:131], v[60:63]
    v_mfma_f32_16x16x32_bf16 v[64:67], v[160:163], v[124:127], v[64:67]
    v_mfma_f32_16x16x32_bf16 v[68:71], v[160:163], v[128:131], v[68:71]
    v_mfma_f32_16x16x32_bf16 v[72:75], v[164:167], v[124:127], v[72:75]
    v_mfma_f32_16x16x32_bf16 v[76:79], v[164:167], v[128:131], v[76:79]
    s_waitcnt lgkmcnt(0)
    v_mfma_f32_16x16x32_bf16 v[8:11], v[88:91], v[80:83], v[8:11]
    ds_read_b128 v[124:127], v210 offset:0
    v_fma_f32 v247, v247, v7, s78
    v_mfma_f32_16x16x32_bf16 v[12:15], v[88:91], v[84:87], v[12:15]
    ds_read_b128 v[128:131], v210 offset:2048
    v_mul_f32 v244, v244, v240
    v_mfma_f32_16x16x32_bf16 v[16:19], v[92:95], v[80:83], v[16:19]
    ds_read_b128 v[132:135], v211 offset:9216
    v_mul_f32 v245, v245, v241
    v_mfma_f32_16x16x32_bf16 v[20:23], v[92:95], v[84:87], v[20:23]
    ds_read_b128 v[136:139], v212 offset:9216
    v_mul_f32 v246, v246, v242
    v_mfma_f32_16x16x32_bf16 v[24:27], v[96:99], v[80:83], v[24:27]
    ds_read_b128 v[140:143], v211 offset:11264
    v_mul_f32 v247, v247, v243
    v_mfma_f32_16x16x32_bf16 v[28:31], v[96:99], v[84:87], v[28:31]
    ds_read_b128 v[144:147], v212 offset:11264
    v_mfma_f32_16x16x32_bf16 v[32:35], v[100:103], v[80:83], v[32:35]
    ds_read_b128 v[148:151], v211 offset:13312
    v_mfma_f32_16x16x32_bf16 v[36:39], v[100:103], v[84:87], v[36:39]
    ds_read_b128 v[152:155], v212 offset:13312
    v_mfma_f32_16x16x32_bf16 v[40:43], v[104:107], v[80:83], v[40:43]
    ds_read_b128 v[156:159], v211 offset:15360
    v_mfma_f32_16x16x32_bf16 v[44:47], v[104:107], v[84:87], v[44:47]
    ds_read_b128 v[160:163], v212 offset:15360
    v_mfma_f32_16x16x32_bf16 v[48:51], v[108:111], v[80:83], v[48:51]
    ds_read_b128 v[164:167], v213 offset:9216
    v_mfma_f32_16x16x32_bf16 v[52:55], v[108:111], v[84:87], v[52:55]
    v_exp_f32 v244, v244
    v_mfma_f32_16x16x32_bf16 v[56:59], v[112:115], v[80:83], v[56:59]
    v_exp_f32 v245, v245
    v_mfma_f32_16x16x32_bf16 v[60:63], v[112:115], v[84:87], v[60:63]
    v_exp_f32 v246, v246
    v_mfma_f32_16x16x32_bf16 v[64:67], v[116:119], v[80:83], v[64:67]
    v_exp_f32 v247, v247
    v_mfma_f32_16x16x32_bf16 v[68:71], v[116:119], v[84:87], v[68:71]
    v_add_f32 v244, 1.0, v244
    v_add_f32 v245, 1.0, v245
    v_mfma_f32_16x16x32_bf16 v[72:75], v[120:123], v[80:83], v[72:75]
    v_add_f32 v246, 1.0, v246
    v_add_f32 v247, 1.0, v247
    v_mfma_f32_16x16x32_bf16 v[76:79], v[120:123], v[84:87], v[76:79]
    s_waitcnt lgkmcnt(0)
    s_barrier
    v_mfma_f32_16x16x32_bf16 v[8:11], v[132:135], v[124:127], v[8:11]
    ds_read_b128 v[80:83], v209 offset:34816
    v_mfma_f32_16x16x32_bf16 v[12:15], v[132:135], v[128:131], v[12:15]
    ds_read_b128 v[84:87], v209 offset:36864
    v_mfma_f32_16x16x32_bf16 v[16:19], v[136:139], v[124:127], v[16:19]
    ds_read_b128 v[88:91], v211 offset:34816
    v_mfma_f32_16x16x32_bf16 v[20:23], v[136:139], v[128:131], v[20:23]
    ds_read_b128 v[92:95], v212 offset:34816
    v_mfma_f32_16x16x32_bf16 v[24:27], v[140:143], v[124:127], v[24:27]
    ds_read_b128 v[96:99], v211 offset:36864
    v_mfma_f32_16x16x32_bf16 v[28:31], v[140:143], v[128:131], v[28:31]
    ds_read_b128 v[100:103], v212 offset:36864
    v_mfma_f32_16x16x32_bf16 v[32:35], v[144:147], v[124:127], v[32:35]
    ds_read_b128 v[104:107], v211 offset:38912
    v_mfma_f32_16x16x32_bf16 v[36:39], v[144:147], v[128:131], v[36:39]
    ds_read_b128 v[108:111], v212 offset:38912
    v_mfma_f32_16x16x32_bf16 v[40:43], v[148:151], v[124:127], v[40:43]
    ds_read_b128 v[112:115], v211 offset:40960
    v_mfma_f32_16x16x32_bf16 v[44:47], v[148:151], v[128:131], v[44:47]
    ds_read_b128 v[116:119], v212 offset:40960
    v_mfma_f32_16x16x32_bf16 v[48:51], v[152:155], v[124:127], v[48:51]
    ds_read_b128 v[120:123], v213 offset:34816
    v_mfma_f32_16x16x32_bf16 v[52:55], v[152:155], v[128:131], v[52:55]
    v_rcp_f32 v244, v244
    v_mfma_f32_16x16x32_bf16 v[56:59], v[156:159], v[124:127], v[56:59]
    v_rcp_f32 v245, v245
    v_mfma_f32_16x16x32_bf16 v[60:63], v[156:159], v[128:131], v[60:63]
    v_rcp_f32 v246, v246
    v_mfma_f32_16x16x32_bf16 v[64:67], v[160:163], v[124:127], v[64:67]
    v_rcp_f32 v247, v247
    v_mfma_f32_16x16x32_bf16 v[68:71], v[160:163], v[128:131], v[68:71]
    v_mul_f32 v240, v240, v244
    v_mul_f32 v241, v241, v245
    v_mfma_f32_16x16x32_bf16 v[72:75], v[164:167], v[124:127], v[72:75]
    v_mul_f32 v242, v242, v246
    v_mul_f32 v243, v243, v247
    v_mfma_f32_16x16x32_bf16 v[76:79], v[164:167], v[128:131], v[76:79]
    s_waitcnt lgkmcnt(0)
    v_mfma_f32_16x16x32_bf16 v[8:11], v[88:91], v[80:83], v[8:11]
    ds_read_b128 v[124:127], v210 offset:34816
    v_cvt_pk_bf16_f32 v194, v240, v241
    v_mfma_f32_16x16x32_bf16 v[12:15], v[88:91], v[84:87], v[12:15]
    ds_read_b128 v[128:131], v210 offset:36864
    v_cvt_pk_bf16_f32 v195, v242, v243
    v_mfma_f32_16x16x32_bf16 v[16:19], v[92:95], v[80:83], v[16:19]
    ds_read_b128 v[132:135], v211 offset:44032
    v_lshlrev_b32 v232, 16, v196
    v_mfma_f32_16x16x32_bf16 v[20:23], v[92:95], v[84:87], v[20:23]
    ds_read_b128 v[136:139], v212 offset:44032
    v_and_b32 v233, 0xffff0000, v196
    v_mfma_f32_16x16x32_bf16 v[24:27], v[96:99], v[80:83], v[24:27]
    ds_read_b128 v[140:143], v211 offset:46080
    v_lshlrev_b32 v234, 16, v197
    v_mfma_f32_16x16x32_bf16 v[28:31], v[96:99], v[84:87], v[28:31]
    ds_read_b128 v[144:147], v212 offset:46080
    v_and_b32 v235, 0xffff0000, v197
    v_mfma_f32_16x16x32_bf16 v[32:35], v[100:103], v[80:83], v[32:35]
    ds_read_b128 v[148:151], v211 offset:48128
    v_mul_f32 v236, v232, v232
    v_mfma_f32_16x16x32_bf16 v[36:39], v[100:103], v[84:87], v[36:39]
    ds_read_b128 v[152:155], v212 offset:48128
    v_mul_f32 v237, v233, v233
    v_mfma_f32_16x16x32_bf16 v[40:43], v[104:107], v[80:83], v[40:43]
    ds_read_b128 v[156:159], v211 offset:50176
    v_mul_f32 v238, v234, v234
    v_mfma_f32_16x16x32_bf16 v[44:47], v[104:107], v[84:87], v[44:47]
    ds_read_b128 v[160:163], v212 offset:50176
    v_mul_f32 v239, v235, v235
    v_mfma_f32_16x16x32_bf16 v[48:51], v[108:111], v[80:83], v[48:51]
    ds_read_b128 v[164:167], v213 offset:44032
    v_fma_f32 v236, v236, v7, s78
    v_mfma_f32_16x16x32_bf16 v[52:55], v[108:111], v[84:87], v[52:55]
    v_fma_f32 v237, v237, v7, s78
    v_fma_f32 v238, v238, v7, s78
    v_mfma_f32_16x16x32_bf16 v[56:59], v[112:115], v[80:83], v[56:59]
    v_mfma_f32_16x16x32_bf16 v[60:63], v[112:115], v[84:87], v[60:63]
    v_mfma_f32_16x16x32_bf16 v[64:67], v[116:119], v[80:83], v[64:67]
    v_mfma_f32_16x16x32_bf16 v[68:71], v[116:119], v[84:87], v[68:71]
    v_mfma_f32_16x16x32_bf16 v[72:75], v[120:123], v[80:83], v[72:75]
    v_mfma_f32_16x16x32_bf16 v[76:79], v[120:123], v[84:87], v[76:79]
    s_waitcnt lgkmcnt(0)
    s_barrier
    v_mfma_f32_16x16x32_bf16 v[8:11], v[132:135], v[124:127], v[8:11]
    ds_read_b128 v[80:83], v224 offset:0
    v_fma_f32 v239, v239, v7, s78
    v_mfma_f32_16x16x32_bf16 v[12:15], v[132:135], v[128:131], v[12:15]
    ds_read_b128 v[84:87], v224 offset:2048
    v_mul_f32 v236, v236, v232
    v_mfma_f32_16x16x32_bf16 v[16:19], v[136:139], v[124:127], v[16:19]
    ds_read_b128 v[88:91], v226 offset:0
    v_mul_f32 v237, v237, v233
    v_mfma_f32_16x16x32_bf16 v[20:23], v[136:139], v[128:131], v[20:23]
    ds_read_b128 v[92:95], v227 offset:0
    v_mul_f32 v238, v238, v234
    v_mfma_f32_16x16x32_bf16 v[24:27], v[140:143], v[124:127], v[24:27]
    ds_read_b128 v[96:99], v226 offset:2048
    v_mul_f32 v239, v239, v235
    v_mfma_f32_16x16x32_bf16 v[28:31], v[140:143], v[128:131], v[28:31]
    ds_read_b128 v[100:103], v227 offset:2048
    v_mfma_f32_16x16x32_bf16 v[32:35], v[144:147], v[124:127], v[32:35]
    ds_read_b128 v[104:107], v226 offset:4096
    v_mfma_f32_16x16x32_bf16 v[36:39], v[144:147], v[128:131], v[36:39]
    ds_read_b128 v[108:111], v227 offset:4096
    v_mfma_f32_16x16x32_bf16 v[40:43], v[148:151], v[124:127], v[40:43]
    ds_read_b128 v[112:115], v226 offset:6144
    v_mfma_f32_16x16x32_bf16 v[44:47], v[148:151], v[128:131], v[44:47]
    ds_read_b128 v[116:119], v227 offset:6144
    v_mfma_f32_16x16x32_bf16 v[48:51], v[152:155], v[124:127], v[48:51]
    ds_read_b128 v[120:123], v228 offset:0
    v_mfma_f32_16x16x32_bf16 v[52:55], v[152:155], v[128:131], v[52:55]
    v_exp_f32 v236, v236
    v_mfma_f32_16x16x32_bf16 v[56:59], v[156:159], v[124:127], v[56:59]
    v_exp_f32 v237, v237
    v_mfma_f32_16x16x32_bf16 v[60:63], v[156:159], v[128:131], v[60:63]
    v_exp_f32 v238, v238
    v_mfma_f32_16x16x32_bf16 v[64:67], v[160:163], v[124:127], v[64:67]
    v_exp_f32 v239, v239
    v_mfma_f32_16x16x32_bf16 v[68:71], v[160:163], v[128:131], v[68:71]
    v_add_f32 v236, 1.0, v236
    v_add_f32 v237, 1.0, v237
    v_mfma_f32_16x16x32_bf16 v[72:75], v[164:167], v[124:127], v[72:75]
    v_add_f32 v238, 1.0, v238
    v_add_f32 v239, 1.0, v239
    v_mfma_f32_16x16x32_bf16 v[76:79], v[164:167], v[128:131], v[76:79]
    s_waitcnt lgkmcnt(0)
    v_mfma_f32_16x16x32_bf16 v[8:11], v[88:91], v[80:83], v[8:11]
    ds_read_b128 v[124:127], v225 offset:0
    v_mfma_f32_16x16x32_bf16 v[12:15], v[88:91], v[84:87], v[12:15]
    ds_read_b128 v[128:131], v225 offset:2048
    v_mfma_f32_16x16x32_bf16 v[16:19], v[92:95], v[80:83], v[16:19]
    ds_read_b128 v[132:135], v226 offset:9216
    v_mfma_f32_16x16x32_bf16 v[20:23], v[92:95], v[84:87], v[20:23]
    ds_read_b128 v[136:139], v227 offset:9216
    v_mfma_f32_16x16x32_bf16 v[24:27], v[96:99], v[80:83], v[24:27]
    ds_read_b128 v[140:143], v226 offset:11264
    v_mfma_f32_16x16x32_bf16 v[28:31], v[96:99], v[84:87], v[28:31]
    ds_read_b128 v[144:147], v227 offset:11264
    v_mfma_f32_16x16x32_bf16 v[32:35], v[100:103], v[80:83], v[32:35]
    ds_read_b128 v[148:151], v226 offset:13312
    v_mfma_f32_16x16x32_bf16 v[36:39], v[100:103], v[84:87], v[36:39]
    ds_read_b128 v[152:155], v227 offset:13312
    v_mfma_f32_16x16x32_bf16 v[40:43], v[104:107], v[80:83], v[40:43]
    ds_read_b128 v[156:159], v226 offset:15360
    v_mfma_f32_16x16x32_bf16 v[44:47], v[104:107], v[84:87], v[44:47]
    ds_read_b128 v[160:163], v227 offset:15360
    v_mfma_f32_16x16x32_bf16 v[48:51], v[108:111], v[80:83], v[48:51]
    ds_read_b128 v[164:167], v228 offset:9216
    v_mfma_f32_16x16x32_bf16 v[52:55], v[108:111], v[84:87], v[52:55]
    v_rcp_f32 v236, v236
    v_mfma_f32_16x16x32_bf16 v[56:59], v[112:115], v[80:83], v[56:59]
    v_rcp_f32 v237, v237
    v_mfma_f32_16x16x32_bf16 v[60:63], v[112:115], v[84:87], v[60:63]
    v_rcp_f32 v238, v238
    v_mfma_f32_16x16x32_bf16 v[64:67], v[116:119], v[80:83], v[64:67]
    v_rcp_f32 v239, v239
    v_mfma_f32_16x16x32_bf16 v[68:71], v[116:119], v[84:87], v[68:71]
    v_mul_f32 v232, v232, v236
    v_mul_f32 v233, v233, v237
    v_mfma_f32_16x16x32_bf16 v[72:75], v[120:123], v[80:83], v[72:75]
    v_mul_f32 v234, v234, v238
    v_mul_f32 v235, v235, v239
    v_mfma_f32_16x16x32_bf16 v[76:79], v[120:123], v[84:87], v[76:79]
    s_waitcnt lgkmcnt(0)
    s_barrier
    v_mfma_f32_16x16x32_bf16 v[8:11], v[132:135], v[124:127], v[8:11]
    ds_read_b128 v[80:83], v224 offset:34816
    v_cvt_pk_bf16_f32 v196, v232, v233
    v_mfma_f32_16x16x32_bf16 v[12:15], v[132:135], v[128:131], v[12:15]
    ds_read_b128 v[84:87], v224 offset:36864
    v_cvt_pk_bf16_f32 v197, v234, v235
    v_mfma_f32_16x16x32_bf16 v[16:19], v[136:139], v[124:127], v[16:19]
    ds_read_b128 v[88:91], v226 offset:34816
    v_lshlrev_b32 v240, 16, v198
    v_mfma_f32_16x16x32_bf16 v[20:23], v[136:139], v[128:131], v[20:23]
    ds_read_b128 v[92:95], v227 offset:34816
    v_and_b32 v241, 0xffff0000, v198
    v_mfma_f32_16x16x32_bf16 v[24:27], v[140:143], v[124:127], v[24:27]
    ds_read_b128 v[96:99], v226 offset:36864
    v_lshlrev_b32 v242, 16, v199
    v_mfma_f32_16x16x32_bf16 v[28:31], v[140:143], v[128:131], v[28:31]
    ds_read_b128 v[100:103], v227 offset:36864
    v_and_b32 v243, 0xffff0000, v199
    v_mfma_f32_16x16x32_bf16 v[32:35], v[144:147], v[124:127], v[32:35]
    ds_read_b128 v[104:107], v226 offset:38912
    v_mul_f32 v244, v240, v240
    v_mfma_f32_16x16x32_bf16 v[36:39], v[144:147], v[128:131], v[36:39]
    ds_read_b128 v[108:111], v227 offset:38912
    v_mul_f32 v245, v241, v241
    v_mfma_f32_16x16x32_bf16 v[40:43], v[148:151], v[124:127], v[40:43]
    ds_read_b128 v[112:115], v226 offset:40960
    v_mul_f32 v246, v242, v242
    v_mfma_f32_16x16x32_bf16 v[44:47], v[148:151], v[128:131], v[44:47]
    ds_read_b128 v[116:119], v227 offset:40960
    v_mul_f32 v247, v243, v243
    v_mfma_f32_16x16x32_bf16 v[48:51], v[152:155], v[124:127], v[48:51]
    ds_read_b128 v[120:123], v228 offset:34816
    v_fma_f32 v244, v244, v7, s78
    v_mfma_f32_16x16x32_bf16 v[52:55], v[152:155], v[128:131], v[52:55]
    v_fma_f32 v245, v245, v7, s78
    v_fma_f32 v246, v246, v7, s78
    v_mfma_f32_16x16x32_bf16 v[56:59], v[156:159], v[124:127], v[56:59]
    v_mfma_f32_16x16x32_bf16 v[60:63], v[156:159], v[128:131], v[60:63]
    v_mfma_f32_16x16x32_bf16 v[64:67], v[160:163], v[124:127], v[64:67]
    v_mfma_f32_16x16x32_bf16 v[68:71], v[160:163], v[128:131], v[68:71]
    v_mfma_f32_16x16x32_bf16 v[72:75], v[164:167], v[124:127], v[72:75]
    v_mfma_f32_16x16x32_bf16 v[76:79], v[164:167], v[128:131], v[76:79]
    s_waitcnt lgkmcnt(0)
    v_mfma_f32_16x16x32_bf16 v[8:11], v[88:91], v[80:83], v[8:11]
    ds_read_b128 v[124:127], v225 offset:34816
    v_fma_f32 v247, v247, v7, s78
    v_mfma_f32_16x16x32_bf16 v[12:15], v[88:91], v[84:87], v[12:15]
    ds_read_b128 v[128:131], v225 offset:36864
    v_mul_f32 v244, v244, v240
    v_mfma_f32_16x16x32_bf16 v[16:19], v[92:95], v[80:83], v[16:19]
    ds_read_b128 v[132:135], v226 offset:44032
    v_mul_f32 v245, v245, v241
    v_mfma_f32_16x16x32_bf16 v[20:23], v[92:95], v[84:87], v[20:23]
    ds_read_b128 v[136:139], v227 offset:44032
    v_mul_f32 v246, v246, v242
    v_mfma_f32_16x16x32_bf16 v[24:27], v[96:99], v[80:83], v[24:27]
    ds_read_b128 v[140:143], v226 offset:46080
    v_mul_f32 v247, v247, v243
    v_mfma_f32_16x16x32_bf16 v[28:31], v[96:99], v[84:87], v[28:31]
    ds_read_b128 v[144:147], v227 offset:46080
    v_mfma_f32_16x16x32_bf16 v[32:35], v[100:103], v[80:83], v[32:35]
    ds_read_b128 v[148:151], v226 offset:48128
    v_mfma_f32_16x16x32_bf16 v[36:39], v[100:103], v[84:87], v[36:39]
    ds_read_b128 v[152:155], v227 offset:48128
    v_mfma_f32_16x16x32_bf16 v[40:43], v[104:107], v[80:83], v[40:43]
    ds_read_b128 v[156:159], v226 offset:50176
    v_mfma_f32_16x16x32_bf16 v[44:47], v[104:107], v[84:87], v[44:47]
    ds_read_b128 v[160:163], v227 offset:50176
    v_mfma_f32_16x16x32_bf16 v[48:51], v[108:111], v[80:83], v[48:51]
    ds_read_b128 v[164:167], v228 offset:44032
    v_mfma_f32_16x16x32_bf16 v[52:55], v[108:111], v[84:87], v[52:55]
    v_exp_f32 v244, v244
    v_mfma_f32_16x16x32_bf16 v[56:59], v[112:115], v[80:83], v[56:59]
    v_exp_f32 v245, v245
    v_mfma_f32_16x16x32_bf16 v[60:63], v[112:115], v[84:87], v[60:63]
    v_exp_f32 v246, v246
    v_mfma_f32_16x16x32_bf16 v[64:67], v[116:119], v[80:83], v[64:67]
    v_exp_f32 v247, v247
    v_mfma_f32_16x16x32_bf16 v[68:71], v[116:119], v[84:87], v[68:71]
    v_add_f32 v244, 1.0, v244
    v_add_f32 v245, 1.0, v245
    v_mfma_f32_16x16x32_bf16 v[72:75], v[120:123], v[80:83], v[72:75]
    v_add_f32 v246, 1.0, v246
    v_add_f32 v247, 1.0, v247
    v_mfma_f32_16x16x32_bf16 v[76:79], v[120:123], v[84:87], v[76:79]
    s_waitcnt lgkmcnt(0)
    s_barrier
    v_mfma_f32_16x16x32_bf16 v[8:11], v[132:135], v[124:127], v[8:11]
    ds_read_b128 v[80:83], v209 offset:0
    v_mfma_f32_16x16x32_bf16 v[12:15], v[132:135], v[128:131], v[12:15]
    ds_read_b128 v[84:87], v209 offset:2048
    v_mfma_f32_16x16x32_bf16 v[16:19], v[136:139], v[124:127], v[16:19]
    ds_read_b128 v[88:91], v211 offset:0
    v_mfma_f32_16x16x32_bf16 v[20:23], v[136:139], v[128:131], v[20:23]
    ds_read_b128 v[92:95], v212 offset:0
    v_mfma_f32_16x16x32_bf16 v[24:27], v[140:143], v[124:127], v[24:27]
    ds_read_b128 v[96:99], v211 offset:2048
    v_mfma_f32_16x16x32_bf16 v[28:31], v[140:143], v[128:131], v[28:31]
    ds_read_b128 v[100:103], v212 offset:2048
    v_mfma_f32_16x16x32_bf16 v[32:35], v[144:147], v[124:127], v[32:35]
    ds_read_b128 v[104:107], v211 offset:4096
    v_mfma_f32_16x16x32_bf16 v[36:39], v[144:147], v[128:131], v[36:39]
    ds_read_b128 v[108:111], v212 offset:4096
    v_mfma_f32_16x16x32_bf16 v[40:43], v[148:151], v[124:127], v[40:43]
    ds_read_b128 v[112:115], v211 offset:6144
    v_mfma_f32_16x16x32_bf16 v[44:47], v[148:151], v[128:131], v[44:47]
    ds_read_b128 v[116:119], v212 offset:6144
    v_mfma_f32_16x16x32_bf16 v[48:51], v[152:155], v[124:127], v[48:51]
    ds_read_b128 v[120:123], v213 offset:0
    v_mfma_f32_16x16x32_bf16 v[52:55], v[152:155], v[128:131], v[52:55]
    v_rcp_f32 v244, v244
    v_mfma_f32_16x16x32_bf16 v[56:59], v[156:159], v[124:127], v[56:59]
    v_rcp_f32 v245, v245
    v_mfma_f32_16x16x32_bf16 v[60:63], v[156:159], v[128:131], v[60:63]
    v_rcp_f32 v246, v246
    v_mfma_f32_16x16x32_bf16 v[64:67], v[160:163], v[124:127], v[64:67]
    v_rcp_f32 v247, v247
    v_mfma_f32_16x16x32_bf16 v[68:71], v[160:163], v[128:131], v[68:71]
    v_mul_f32 v240, v240, v244
    v_mul_f32 v241, v241, v245
    v_mfma_f32_16x16x32_bf16 v[72:75], v[164:167], v[124:127], v[72:75]
    v_mul_f32 v242, v242, v246
    v_mul_f32 v243, v243, v247
    v_mfma_f32_16x16x32_bf16 v[76:79], v[164:167], v[128:131], v[76:79]
    s_waitcnt lgkmcnt(0)
    v_mfma_f32_16x16x32_bf16 v[8:11], v[88:91], v[80:83], v[8:11]
    ds_read_b128 v[124:127], v210 offset:0
    v_cvt_pk_bf16_f32 v198, v240, v241
    v_mfma_f32_16x16x32_bf16 v[12:15], v[88:91], v[84:87], v[12:15]
    ds_read_b128 v[128:131], v210 offset:2048
    v_cvt_pk_bf16_f32 v199, v242, v243
    v_mfma_f32_16x16x32_bf16 v[16:19], v[92:95], v[80:83], v[16:19]
    ds_read_b128 v[132:135], v211 offset:9216
    v_lshlrev_b32 v232, 16, v200
    v_mfma_f32_16x16x32_bf16 v[20:23], v[92:95], v[84:87], v[20:23]
    ds_read_b128 v[136:139], v212 offset:9216
    v_and_b32 v233, 0xffff0000, v200
    v_mfma_f32_16x16x32_bf16 v[24:27], v[96:99], v[80:83], v[24:27]
    ds_read_b128 v[140:143], v211 offset:11264
    v_lshlrev_b32 v234, 16, v201
    v_mfma_f32_16x16x32_bf16 v[28:31], v[96:99], v[84:87], v[28:31]
    ds_read_b128 v[144:147], v212 offset:11264
    v_and_b32 v235, 0xffff0000, v201
    v_mfma_f32_16x16x32_bf16 v[32:35], v[100:103], v[80:83], v[32:35]
    ds_read_b128 v[148:151], v211 offset:13312
    v_mul_f32 v236, v232, v232
    v_mfma_f32_16x16x32_bf16 v[36:39], v[100:103], v[84:87], v[36:39]
    ds_read_b128 v[152:155], v212 offset:13312
    v_mul_f32 v237, v233, v233
    v_mfma_f32_16x16x32_bf16 v[40:43], v[104:107], v[80:83], v[40:43]
    ds_read_b128 v[156:159], v211 offset:15360
    v_mul_f32 v238, v234, v234
    v_mfma_f32_16x16x32_bf16 v[44:47], v[104:107], v[84:87], v[44:47]
    ds_read_b128 v[160:163], v212 offset:15360
    v_mul_f32 v239, v235, v235
    v_mfma_f32_16x16x32_bf16 v[48:51], v[108:111], v[80:83], v[48:51]
    ds_read_b128 v[164:167], v213 offset:9216
    v_fma_f32 v236, v236, v7, s78
    v_mfma_f32_16x16x32_bf16 v[52:55], v[108:111], v[84:87], v[52:55]
    v_fma_f32 v237, v237, v7, s78
    v_fma_f32 v238, v238, v7, s78
    v_mfma_f32_16x16x32_bf16 v[56:59], v[112:115], v[80:83], v[56:59]
    v_mfma_f32_16x16x32_bf16 v[60:63], v[112:115], v[84:87], v[60:63]
    v_mfma_f32_16x16x32_bf16 v[64:67], v[116:119], v[80:83], v[64:67]
    v_mfma_f32_16x16x32_bf16 v[68:71], v[116:119], v[84:87], v[68:71]
    v_mfma_f32_16x16x32_bf16 v[72:75], v[120:123], v[80:83], v[72:75]
    v_mfma_f32_16x16x32_bf16 v[76:79], v[120:123], v[84:87], v[76:79]
    s_waitcnt lgkmcnt(0)
    s_barrier
    v_mfma_f32_16x16x32_bf16 v[8:11], v[132:135], v[124:127], v[8:11]
    ds_read_b128 v[80:83], v209 offset:34816
    v_fma_f32 v239, v239, v7, s78
    v_mfma_f32_16x16x32_bf16 v[12:15], v[132:135], v[128:131], v[12:15]
    ds_read_b128 v[84:87], v209 offset:36864
    v_mul_f32 v236, v236, v232
    v_mfma_f32_16x16x32_bf16 v[16:19], v[136:139], v[124:127], v[16:19]
    ds_read_b128 v[88:91], v211 offset:34816
    v_mul_f32 v237, v237, v233
    v_mfma_f32_16x16x32_bf16 v[20:23], v[136:139], v[128:131], v[20:23]
    ds_read_b128 v[92:95], v212 offset:34816
    v_mul_f32 v238, v238, v234
    v_mfma_f32_16x16x32_bf16 v[24:27], v[140:143], v[124:127], v[24:27]
    ds_read_b128 v[96:99], v211 offset:36864
    v_mul_f32 v239, v239, v235
    v_mfma_f32_16x16x32_bf16 v[28:31], v[140:143], v[128:131], v[28:31]
    ds_read_b128 v[100:103], v212 offset:36864
    v_mfma_f32_16x16x32_bf16 v[32:35], v[144:147], v[124:127], v[32:35]
    ds_read_b128 v[104:107], v211 offset:38912
    v_mfma_f32_16x16x32_bf16 v[36:39], v[144:147], v[128:131], v[36:39]
    ds_read_b128 v[108:111], v212 offset:38912
    v_mfma_f32_16x16x32_bf16 v[40:43], v[148:151], v[124:127], v[40:43]
    ds_read_b128 v[112:115], v211 offset:40960
    v_mfma_f32_16x16x32_bf16 v[44:47], v[148:151], v[128:131], v[44:47]
    ds_read_b128 v[116:119], v212 offset:40960
    v_mfma_f32_16x16x32_bf16 v[48:51], v[152:155], v[124:127], v[48:51]
    ds_read_b128 v[120:123], v213 offset:34816
    v_mfma_f32_16x16x32_bf16 v[52:55], v[152:155], v[128:131], v[52:55]
    v_exp_f32 v236, v236
    v_mfma_f32_16x16x32_bf16 v[56:59], v[156:159], v[124:127], v[56:59]
    v_exp_f32 v237, v237
    v_mfma_f32_16x16x32_bf16 v[60:63], v[156:159], v[128:131], v[60:63]
    v_exp_f32 v238, v238
    v_mfma_f32_16x16x32_bf16 v[64:67], v[160:163], v[124:127], v[64:67]
    v_exp_f32 v239, v239
    v_mfma_f32_16x16x32_bf16 v[68:71], v[160:163], v[128:131], v[68:71]
    v_add_f32 v236, 1.0, v236
    v_add_f32 v237, 1.0, v237
    v_mfma_f32_16x16x32_bf16 v[72:75], v[164:167], v[124:127], v[72:75]
    v_add_f32 v238, 1.0, v238
    v_add_f32 v239, 1.0, v239
    v_mfma_f32_16x16x32_bf16 v[76:79], v[164:167], v[128:131], v[76:79]
    s_waitcnt lgkmcnt(0)
    v_mfma_f32_16x16x32_bf16 v[8:11], v[88:91], v[80:83], v[8:11]
    ds_read_b128 v[124:127], v210 offset:34816
    v_mfma_f32_16x16x32_bf16 v[12:15], v[88:91], v[84:87], v[12:15]
    ds_read_b128 v[128:131], v210 offset:36864
    v_mfma_f32_16x16x32_bf16 v[16:19], v[92:95], v[80:83], v[16:19]
    ds_read_b128 v[132:135], v211 offset:44032
    v_mfma_f32_16x16x32_bf16 v[20:23], v[92:95], v[84:87], v[20:23]
    ds_read_b128 v[136:139], v212 offset:44032
    v_mfma_f32_16x16x32_bf16 v[24:27], v[96:99], v[80:83], v[24:27]
    ds_read_b128 v[140:143], v211 offset:46080
    v_mfma_f32_16x16x32_bf16 v[28:31], v[96:99], v[84:87], v[28:31]
    ds_read_b128 v[144:147], v212 offset:46080
    v_mfma_f32_16x16x32_bf16 v[32:35], v[100:103], v[80:83], v[32:35]
    ds_read_b128 v[148:151], v211 offset:48128
    v_mfma_f32_16x16x32_bf16 v[36:39], v[100:103], v[84:87], v[36:39]
    ds_read_b128 v[152:155], v212 offset:48128
    v_mfma_f32_16x16x32_bf16 v[40:43], v[104:107], v[80:83], v[40:43]
    ds_read_b128 v[156:159], v211 offset:50176
    v_mfma_f32_16x16x32_bf16 v[44:47], v[104:107], v[84:87], v[44:47]
    ds_read_b128 v[160:163], v212 offset:50176
    v_mfma_f32_16x16x32_bf16 v[48:51], v[108:111], v[80:83], v[48:51]
    ds_read_b128 v[164:167], v213 offset:44032
    v_mfma_f32_16x16x32_bf16 v[52:55], v[108:111], v[84:87], v[52:55]
    v_rcp_f32 v236, v236
    v_mfma_f32_16x16x32_bf16 v[56:59], v[112:115], v[80:83], v[56:59]
    v_rcp_f32 v237, v237
    v_mfma_f32_16x16x32_bf16 v[60:63], v[112:115], v[84:87], v[60:63]
    v_rcp_f32 v238, v238
    v_mfma_f32_16x16x32_bf16 v[64:67], v[116:119], v[80:83], v[64:67]
    v_rcp_f32 v239, v239
    v_mfma_f32_16x16x32_bf16 v[68:71], v[116:119], v[84:87], v[68:71]
    v_mul_f32 v232, v232, v236
    v_mul_f32 v233, v233, v237
    v_mfma_f32_16x16x32_bf16 v[72:75], v[120:123], v[80:83], v[72:75]
    v_mul_f32 v234, v234, v238
    v_mul_f32 v235, v235, v239
    v_mfma_f32_16x16x32_bf16 v[76:79], v[120:123], v[84:87], v[76:79]
    s_waitcnt lgkmcnt(0)
    s_barrier
    v_mfma_f32_16x16x32_bf16 v[8:11], v[132:135], v[124:127], v[8:11]
    ds_read_b128 v[80:83], v224 offset:0
    v_cvt_pk_bf16_f32 v200, v232, v233
    v_mfma_f32_16x16x32_bf16 v[12:15], v[132:135], v[128:131], v[12:15]
    ds_read_b128 v[84:87], v224 offset:2048
    v_cvt_pk_bf16_f32 v201, v234, v235
    v_mfma_f32_16x16x32_bf16 v[16:19], v[136:139], v[124:127], v[16:19]
    ds_read_b128 v[88:91], v226 offset:0
    v_lshlrev_b32 v240, 16, v202
    v_mfma_f32_16x16x32_bf16 v[20:23], v[136:139], v[128:131], v[20:23]
    ds_read_b128 v[92:95], v227 offset:0
    v_and_b32 v241, 0xffff0000, v202
    v_mfma_f32_16x16x32_bf16 v[24:27], v[140:143], v[124:127], v[24:27]
    ds_read_b128 v[96:99], v226 offset:2048
    v_lshlrev_b32 v242, 16, v203
    v_mfma_f32_16x16x32_bf16 v[28:31], v[140:143], v[128:131], v[28:31]
    ds_read_b128 v[100:103], v227 offset:2048
    v_and_b32 v243, 0xffff0000, v203
    v_mfma_f32_16x16x32_bf16 v[32:35], v[144:147], v[124:127], v[32:35]
    ds_read_b128 v[104:107], v226 offset:4096
    v_mul_f32 v244, v240, v240
    v_mfma_f32_16x16x32_bf16 v[36:39], v[144:147], v[128:131], v[36:39]
    ds_read_b128 v[108:111], v227 offset:4096
    v_mul_f32 v245, v241, v241
    v_mfma_f32_16x16x32_bf16 v[40:43], v[148:151], v[124:127], v[40:43]
    ds_read_b128 v[112:115], v226 offset:6144
    v_mul_f32 v246, v242, v242
    v_mfma_f32_16x16x32_bf16 v[44:47], v[148:151], v[128:131], v[44:47]
    ds_read_b128 v[116:119], v227 offset:6144
    v_mul_f32 v247, v243, v243
    v_mfma_f32_16x16x32_bf16 v[48:51], v[152:155], v[124:127], v[48:51]
    ds_read_b128 v[120:123], v228 offset:0
    v_fma_f32 v244, v244, v7, s78
    v_mfma_f32_16x16x32_bf16 v[52:55], v[152:155], v[128:131], v[52:55]
    v_fma_f32 v245, v245, v7, s78
    v_fma_f32 v246, v246, v7, s78
    v_mfma_f32_16x16x32_bf16 v[56:59], v[156:159], v[124:127], v[56:59]
    v_mfma_f32_16x16x32_bf16 v[60:63], v[156:159], v[128:131], v[60:63]
    v_mfma_f32_16x16x32_bf16 v[64:67], v[160:163], v[124:127], v[64:67]
    v_mfma_f32_16x16x32_bf16 v[68:71], v[160:163], v[128:131], v[68:71]
    v_mfma_f32_16x16x32_bf16 v[72:75], v[164:167], v[124:127], v[72:75]
    v_mfma_f32_16x16x32_bf16 v[76:79], v[164:167], v[128:131], v[76:79]
    s_waitcnt lgkmcnt(0)
    v_mfma_f32_16x16x32_bf16 v[8:11], v[88:91], v[80:83], v[8:11]
    ds_read_b128 v[124:127], v225 offset:0
    v_fma_f32 v247, v247, v7, s78
    v_mfma_f32_16x16x32_bf16 v[12:15], v[88:91], v[84:87], v[12:15]
    ds_read_b128 v[128:131], v225 offset:2048
    v_mul_f32 v244, v244, v240
    v_mfma_f32_16x16x32_bf16 v[16:19], v[92:95], v[80:83], v[16:19]
    ds_read_b128 v[132:135], v226 offset:9216
    v_mul_f32 v245, v245, v241
    v_mfma_f32_16x16x32_bf16 v[20:23], v[92:95], v[84:87], v[20:23]
    ds_read_b128 v[136:139], v227 offset:9216
    v_mul_f32 v246, v246, v242
    v_mfma_f32_16x16x32_bf16 v[24:27], v[96:99], v[80:83], v[24:27]
    ds_read_b128 v[140:143], v226 offset:11264
    v_mul_f32 v247, v247, v243
    v_mfma_f32_16x16x32_bf16 v[28:31], v[96:99], v[84:87], v[28:31]
    ds_read_b128 v[144:147], v227 offset:11264
    v_mfma_f32_16x16x32_bf16 v[32:35], v[100:103], v[80:83], v[32:35]
    ds_read_b128 v[148:151], v226 offset:13312
    v_mfma_f32_16x16x32_bf16 v[36:39], v[100:103], v[84:87], v[36:39]
    ds_read_b128 v[152:155], v227 offset:13312
    v_mfma_f32_16x16x32_bf16 v[40:43], v[104:107], v[80:83], v[40:43]
    ds_read_b128 v[156:159], v226 offset:15360
    v_mfma_f32_16x16x32_bf16 v[44:47], v[104:107], v[84:87], v[44:47]
    ds_read_b128 v[160:163], v227 offset:15360
    v_mfma_f32_16x16x32_bf16 v[48:51], v[108:111], v[80:83], v[48:51]
    ds_read_b128 v[164:167], v228 offset:9216
    v_mfma_f32_16x16x32_bf16 v[52:55], v[108:111], v[84:87], v[52:55]
    v_exp_f32 v244, v244
    v_mfma_f32_16x16x32_bf16 v[56:59], v[112:115], v[80:83], v[56:59]
    v_exp_f32 v245, v245
    v_mfma_f32_16x16x32_bf16 v[60:63], v[112:115], v[84:87], v[60:63]
    v_exp_f32 v246, v246
    v_mfma_f32_16x16x32_bf16 v[64:67], v[116:119], v[80:83], v[64:67]
    v_exp_f32 v247, v247
    v_mfma_f32_16x16x32_bf16 v[68:71], v[116:119], v[84:87], v[68:71]
    v_add_f32 v244, 1.0, v244
    v_add_f32 v245, 1.0, v245
    v_mfma_f32_16x16x32_bf16 v[72:75], v[120:123], v[80:83], v[72:75]
    v_add_f32 v246, 1.0, v246
    v_add_f32 v247, 1.0, v247
    v_mfma_f32_16x16x32_bf16 v[76:79], v[120:123], v[84:87], v[76:79]
    s_waitcnt lgkmcnt(0)
    s_barrier
    v_mfma_f32_16x16x32_bf16 v[8:11], v[132:135], v[124:127], v[8:11]
    ds_read_b128 v[80:83], v224 offset:34816
    v_mfma_f32_16x16x32_bf16 v[12:15], v[132:135], v[128:131], v[12:15]
    ds_read_b128 v[84:87], v224 offset:36864
    v_mfma_f32_16x16x32_bf16 v[16:19], v[136:139], v[124:127], v[16:19]
    ds_read_b128 v[88:91], v226 offset:34816
    v_mfma_f32_16x16x32_bf16 v[20:23], v[136:139], v[128:131], v[20:23]
    ds_read_b128 v[92:95], v227 offset:34816
    v_mfma_f32_16x16x32_bf16 v[24:27], v[140:143], v[124:127], v[24:27]
    ds_read_b128 v[96:99], v226 offset:36864
    v_mfma_f32_16x16x32_bf16 v[28:31], v[140:143], v[128:131], v[28:31]
    ds_read_b128 v[100:103], v227 offset:36864
    v_mfma_f32_16x16x32_bf16 v[32:35], v[144:147], v[124:127], v[32:35]
    ds_read_b128 v[104:107], v226 offset:38912
    v_mfma_f32_16x16x32_bf16 v[36:39], v[144:147], v[128:131], v[36:39]
    ds_read_b128 v[108:111], v227 offset:38912
    v_mfma_f32_16x16x32_bf16 v[40:43], v[148:151], v[124:127], v[40:43]
    ds_read_b128 v[112:115], v226 offset:40960
    v_mfma_f32_16x16x32_bf16 v[44:47], v[148:151], v[128:131], v[44:47]
    ds_read_b128 v[116:119], v227 offset:40960
    v_mfma_f32_16x16x32_bf16 v[48:51], v[152:155], v[124:127], v[48:51]
    ds_read_b128 v[120:123], v228 offset:34816
    v_mfma_f32_16x16x32_bf16 v[52:55], v[152:155], v[128:131], v[52:55]
    v_rcp_f32 v244, v244
    v_mfma_f32_16x16x32_bf16 v[56:59], v[156:159], v[124:127], v[56:59]
    v_rcp_f32 v245, v245
    v_mfma_f32_16x16x32_bf16 v[60:63], v[156:159], v[128:131], v[60:63]
    v_rcp_f32 v246, v246
    v_mfma_f32_16x16x32_bf16 v[64:67], v[160:163], v[124:127], v[64:67]
    v_rcp_f32 v247, v247
    v_mfma_f32_16x16x32_bf16 v[68:71], v[160:163], v[128:131], v[68:71]
    v_mul_f32 v240, v240, v244
    v_mul_f32 v241, v241, v245
    v_mfma_f32_16x16x32_bf16 v[72:75], v[164:167], v[124:127], v[72:75]
    v_mul_f32 v242, v242, v246
    v_mul_f32 v243, v243, v247
    v_mfma_f32_16x16x32_bf16 v[76:79], v[164:167], v[128:131], v[76:79]
    s_waitcnt lgkmcnt(0)
    v_mfma_f32_16x16x32_bf16 v[8:11], v[88:91], v[80:83], v[8:11]
    ds_read_b128 v[124:127], v225 offset:34816
    v_cvt_pk_bf16_f32 v202, v240, v241
    v_mfma_f32_16x16x32_bf16 v[12:15], v[88:91], v[84:87], v[12:15]
    ds_read_b128 v[128:131], v225 offset:36864
    v_cvt_pk_bf16_f32 v203, v242, v243
    v_mfma_f32_16x16x32_bf16 v[16:19], v[92:95], v[80:83], v[16:19]
    ds_read_b128 v[132:135], v226 offset:44032
    v_mfma_f32_16x16x32_bf16 v[20:23], v[92:95], v[84:87], v[20:23]
    ds_read_b128 v[136:139], v227 offset:44032
    v_mfma_f32_16x16x32_bf16 v[24:27], v[96:99], v[80:83], v[24:27]
    ds_read_b128 v[140:143], v226 offset:46080
    v_mfma_f32_16x16x32_bf16 v[28:31], v[96:99], v[84:87], v[28:31]
    ds_read_b128 v[144:147], v227 offset:46080
    v_mfma_f32_16x16x32_bf16 v[32:35], v[100:103], v[80:83], v[32:35]
    ds_read_b128 v[148:151], v226 offset:48128
    v_mfma_f32_16x16x32_bf16 v[36:39], v[100:103], v[84:87], v[36:39]
    ds_read_b128 v[152:155], v227 offset:48128
    v_mfma_f32_16x16x32_bf16 v[40:43], v[104:107], v[80:83], v[40:43]
    ds_read_b128 v[156:159], v226 offset:50176
    v_mfma_f32_16x16x32_bf16 v[44:47], v[104:107], v[84:87], v[44:47]
    ds_read_b128 v[160:163], v227 offset:50176
    v_mfma_f32_16x16x32_bf16 v[48:51], v[108:111], v[80:83], v[48:51]
    ds_read_b128 v[164:167], v228 offset:44032
    v_mfma_f32_16x16x32_bf16 v[52:55], v[108:111], v[84:87], v[52:55]
    v_mfma_f32_16x16x32_bf16 v[56:59], v[112:115], v[80:83], v[56:59]
    v_mfma_f32_16x16x32_bf16 v[60:63], v[112:115], v[84:87], v[60:63]
    v_mfma_f32_16x16x32_bf16 v[64:67], v[116:119], v[80:83], v[64:67]
    v_mfma_f32_16x16x32_bf16 v[68:71], v[116:119], v[84:87], v[68:71]
    v_mfma_f32_16x16x32_bf16 v[72:75], v[120:123], v[80:83], v[72:75]
    v_mfma_f32_16x16x32_bf16 v[76:79], v[120:123], v[84:87], v[76:79]
    s_waitcnt lgkmcnt(0)
    s_barrier
    v_mfma_f32_16x16x32_bf16 v[8:11], v[132:135], v[124:127], v[8:11]
    ds_read_b128 v[80:83], v209 offset:0
    v_mfma_f32_16x16x32_bf16 v[12:15], v[132:135], v[128:131], v[12:15]
    ds_read_b128 v[84:87], v209 offset:2048
    v_mfma_f32_16x16x32_bf16 v[16:19], v[136:139], v[124:127], v[16:19]
    ds_read_b128 v[88:91], v211 offset:0
    v_mfma_f32_16x16x32_bf16 v[20:23], v[136:139], v[128:131], v[20:23]
    ds_read_b128 v[92:95], v212 offset:0
    v_mfma_f32_16x16x32_bf16 v[24:27], v[140:143], v[124:127], v[24:27]
    ds_read_b128 v[96:99], v211 offset:2048
    v_mfma_f32_16x16x32_bf16 v[28:31], v[140:143], v[128:131], v[28:31]
    ds_read_b128 v[100:103], v212 offset:2048
    v_mfma_f32_16x16x32_bf16 v[32:35], v[144:147], v[124:127], v[32:35]
    ds_read_b128 v[104:107], v211 offset:4096
    v_mfma_f32_16x16x32_bf16 v[36:39], v[144:147], v[128:131], v[36:39]
    ds_read_b128 v[108:111], v212 offset:4096
    v_mfma_f32_16x16x32_bf16 v[40:43], v[148:151], v[124:127], v[40:43]
    ds_read_b128 v[112:115], v211 offset:6144
    v_mfma_f32_16x16x32_bf16 v[44:47], v[148:151], v[128:131], v[44:47]
    ds_read_b128 v[116:119], v212 offset:6144
    v_mfma_f32_16x16x32_bf16 v[48:51], v[152:155], v[124:127], v[48:51]
    ds_read_b128 v[120:123], v213 offset:0
    v_mfma_f32_16x16x32_bf16 v[52:55], v[152:155], v[128:131], v[52:55]
    v_mfma_f32_16x16x32_bf16 v[56:59], v[156:159], v[124:127], v[56:59]
    v_mfma_f32_16x16x32_bf16 v[60:63], v[156:159], v[128:131], v[60:63]
    v_mfma_f32_16x16x32_bf16 v[64:67], v[160:163], v[124:127], v[64:67]
    v_mfma_f32_16x16x32_bf16 v[68:71], v[160:163], v[128:131], v[68:71]
    v_mfma_f32_16x16x32_bf16 v[72:75], v[164:167], v[124:127], v[72:75]
    v_mfma_f32_16x16x32_bf16 v[76:79], v[164:167], v[128:131], v[76:79]
    s_waitcnt lgkmcnt(0)
    v_mfma_f32_16x16x32_bf16 v[8:11], v[88:91], v[80:83], v[8:11]
    ds_read_b128 v[124:127], v210 offset:0
    v_mfma_f32_16x16x32_bf16 v[12:15], v[88:91], v[84:87], v[12:15]
    ds_read_b128 v[128:131], v210 offset:2048
    v_mfma_f32_16x16x32_bf16 v[16:19], v[92:95], v[80:83], v[16:19]
    ds_read_b128 v[132:135], v211 offset:9216
    v_mfma_f32_16x16x32_bf16 v[20:23], v[92:95], v[84:87], v[20:23]
    ds_read_b128 v[136:139], v212 offset:9216
    v_mfma_f32_16x16x32_bf16 v[24:27], v[96:99], v[80:83], v[24:27]
    ds_read_b128 v[140:143], v211 offset:11264
    v_mfma_f32_16x16x32_bf16 v[28:31], v[96:99], v[84:87], v[28:31]
    ds_read_b128 v[144:147], v212 offset:11264
    v_mfma_f32_16x16x32_bf16 v[32:35], v[100:103], v[80:83], v[32:35]
    ds_read_b128 v[148:151], v211 offset:13312
    v_mfma_f32_16x16x32_bf16 v[36:39], v[100:103], v[84:87], v[36:39]
    ds_read_b128 v[152:155], v212 offset:13312
    v_mfma_f32_16x16x32_bf16 v[40:43], v[104:107], v[80:83], v[40:43]
    ds_read_b128 v[156:159], v211 offset:15360
    v_mfma_f32_16x16x32_bf16 v[44:47], v[104:107], v[84:87], v[44:47]
    ds_read_b128 v[160:163], v212 offset:15360
    v_mfma_f32_16x16x32_bf16 v[48:51], v[108:111], v[80:83], v[48:51]
    ds_read_b128 v[164:167], v213 offset:9216
    v_mfma_f32_16x16x32_bf16 v[52:55], v[108:111], v[84:87], v[52:55]
    v_mfma_f32_16x16x32_bf16 v[56:59], v[112:115], v[80:83], v[56:59]
    v_mfma_f32_16x16x32_bf16 v[60:63], v[112:115], v[84:87], v[60:63]
    v_mfma_f32_16x16x32_bf16 v[64:67], v[116:119], v[80:83], v[64:67]
    v_mfma_f32_16x16x32_bf16 v[68:71], v[116:119], v[84:87], v[68:71]
    v_mfma_f32_16x16x32_bf16 v[72:75], v[120:123], v[80:83], v[72:75]
    v_mfma_f32_16x16x32_bf16 v[76:79], v[120:123], v[84:87], v[76:79]
    s_waitcnt lgkmcnt(0)
    s_barrier
    v_mfma_f32_16x16x32_bf16 v[8:11], v[132:135], v[124:127], v[8:11]
    ds_read_b128 v[80:83], v209 offset:34816
    v_mfma_f32_16x16x32_bf16 v[12:15], v[132:135], v[128:131], v[12:15]
    ds_read_b128 v[84:87], v209 offset:36864
    v_mfma_f32_16x16x32_bf16 v[16:19], v[136:139], v[124:127], v[16:19]
    ds_read_b128 v[88:91], v211 offset:34816
    v_mfma_f32_16x16x32_bf16 v[20:23], v[136:139], v[128:131], v[20:23]
    ds_read_b128 v[92:95], v212 offset:34816
    v_mfma_f32_16x16x32_bf16 v[24:27], v[140:143], v[124:127], v[24:27]
    ds_read_b128 v[96:99], v211 offset:36864
    v_mfma_f32_16x16x32_bf16 v[28:31], v[140:143], v[128:131], v[28:31]
    ds_read_b128 v[100:103], v212 offset:36864
    v_mfma_f32_16x16x32_bf16 v[32:35], v[144:147], v[124:127], v[32:35]
    ds_read_b128 v[104:107], v211 offset:38912
    v_mfma_f32_16x16x32_bf16 v[36:39], v[144:147], v[128:131], v[36:39]
    ds_read_b128 v[108:111], v212 offset:38912
    v_mfma_f32_16x16x32_bf16 v[40:43], v[148:151], v[124:127], v[40:43]
    ds_read_b128 v[112:115], v211 offset:40960
    v_mfma_f32_16x16x32_bf16 v[44:47], v[148:151], v[128:131], v[44:47]
    ds_read_b128 v[116:119], v212 offset:40960
    v_mfma_f32_16x16x32_bf16 v[48:51], v[152:155], v[124:127], v[48:51]
    ds_read_b128 v[120:123], v213 offset:34816
    v_mfma_f32_16x16x32_bf16 v[52:55], v[152:155], v[128:131], v[52:55]
    v_mfma_f32_16x16x32_bf16 v[56:59], v[156:159], v[124:127], v[56:59]
    v_mfma_f32_16x16x32_bf16 v[60:63], v[156:159], v[128:131], v[60:63]
    v_mfma_f32_16x16x32_bf16 v[64:67], v[160:163], v[124:127], v[64:67]
    v_mfma_f32_16x16x32_bf16 v[68:71], v[160:163], v[128:131], v[68:71]
    v_mfma_f32_16x16x32_bf16 v[72:75], v[164:167], v[124:127], v[72:75]
    v_mfma_f32_16x16x32_bf16 v[76:79], v[164:167], v[128:131], v[76:79]
    s_waitcnt lgkmcnt(0)
    v_mfma_f32_16x16x32_bf16 v[8:11], v[88:91], v[80:83], v[8:11]
    ds_read_b128 v[124:127], v210 offset:34816
    v_mfma_f32_16x16x32_bf16 v[12:15], v[88:91], v[84:87], v[12:15]
    ds_read_b128 v[128:131], v210 offset:36864
    v_mfma_f32_16x16x32_bf16 v[16:19], v[92:95], v[80:83], v[16:19]
    ds_read_b128 v[132:135], v211 offset:44032
    v_mfma_f32_16x16x32_bf16 v[20:23], v[92:95], v[84:87], v[20:23]
    ds_read_b128 v[136:139], v212 offset:44032
    v_mfma_f32_16x16x32_bf16 v[24:27], v[96:99], v[80:83], v[24:27]
    ds_read_b128 v[140:143], v211 offset:46080
    v_mfma_f32_16x16x32_bf16 v[28:31], v[96:99], v[84:87], v[28:31]
    ds_read_b128 v[144:147], v212 offset:46080
    v_mfma_f32_16x16x32_bf16 v[32:35], v[100:103], v[80:83], v[32:35]
    ds_read_b128 v[148:151], v211 offset:48128
    v_mfma_f32_16x16x32_bf16 v[36:39], v[100:103], v[84:87], v[36:39]
    ds_read_b128 v[152:155], v212 offset:48128
    v_mfma_f32_16x16x32_bf16 v[40:43], v[104:107], v[80:83], v[40:43]
    ds_read_b128 v[156:159], v211 offset:50176
    v_mfma_f32_16x16x32_bf16 v[44:47], v[104:107], v[84:87], v[44:47]
    ds_read_b128 v[160:163], v212 offset:50176
    v_mfma_f32_16x16x32_bf16 v[48:51], v[108:111], v[80:83], v[48:51]
    ds_read_b128 v[164:167], v213 offset:44032
    v_mfma_f32_16x16x32_bf16 v[52:55], v[108:111], v[84:87], v[52:55]
    v_mfma_f32_16x16x32_bf16 v[56:59], v[112:115], v[80:83], v[56:59]
    v_mfma_f32_16x16x32_bf16 v[60:63], v[112:115], v[84:87], v[60:63]
    v_mfma_f32_16x16x32_bf16 v[64:67], v[116:119], v[80:83], v[64:67]
    v_mfma_f32_16x16x32_bf16 v[68:71], v[116:119], v[84:87], v[68:71]
    v_mfma_f32_16x16x32_bf16 v[72:75], v[120:123], v[80:83], v[72:75]
    v_mfma_f32_16x16x32_bf16 v[76:79], v[120:123], v[84:87], v[76:79]
    s_waitcnt lgkmcnt(0)
    s_barrier
    v_mfma_f32_16x16x32_bf16 v[8:11], v[132:135], v[124:127], v[8:11]
    ds_read_b128 v[80:83], v224 offset:0
    v_mfma_f32_16x16x32_bf16 v[12:15], v[132:135], v[128:131], v[12:15]
    ds_read_b128 v[84:87], v224 offset:2048
    v_mfma_f32_16x16x32_bf16 v[16:19], v[136:139], v[124:127], v[16:19]
    ds_read_b128 v[88:91], v226 offset:0
    v_mfma_f32_16x16x32_bf16 v[20:23], v[136:139], v[128:131], v[20:23]
    ds_read_b128 v[92:95], v227 offset:0
    v_mfma_f32_16x16x32_bf16 v[24:27], v[140:143], v[124:127], v[24:27]
    ds_read_b128 v[96:99], v226 offset:2048
    v_mfma_f32_16x16x32_bf16 v[28:31], v[140:143], v[128:131], v[28:31]
    ds_read_b128 v[100:103], v227 offset:2048
    v_mfma_f32_16x16x32_bf16 v[32:35], v[144:147], v[124:127], v[32:35]
    ds_read_b128 v[104:107], v226 offset:4096
    v_mfma_f32_16x16x32_bf16 v[36:39], v[144:147], v[128:131], v[36:39]
    ds_read_b128 v[108:111], v227 offset:4096
    v_mfma_f32_16x16x32_bf16 v[40:43], v[148:151], v[124:127], v[40:43]
    ds_read_b128 v[112:115], v226 offset:6144
    v_mfma_f32_16x16x32_bf16 v[44:47], v[148:151], v[128:131], v[44:47]
    ds_read_b128 v[116:119], v227 offset:6144
    v_mfma_f32_16x16x32_bf16 v[48:51], v[152:155], v[124:127], v[48:51]
    ds_read_b128 v[120:123], v228 offset:0
    v_mfma_f32_16x16x32_bf16 v[52:55], v[152:155], v[128:131], v[52:55]
    v_mfma_f32_16x16x32_bf16 v[56:59], v[156:159], v[124:127], v[56:59]
    v_mfma_f32_16x16x32_bf16 v[60:63], v[156:159], v[128:131], v[60:63]
    v_mfma_f32_16x16x32_bf16 v[64:67], v[160:163], v[124:127], v[64:67]
    v_mfma_f32_16x16x32_bf16 v[68:71], v[160:163], v[128:131], v[68:71]
    v_mfma_f32_16x16x32_bf16 v[72:75], v[164:167], v[124:127], v[72:75]
    v_mfma_f32_16x16x32_bf16 v[76:79], v[164:167], v[128:131], v[76:79]
    s_waitcnt lgkmcnt(0)
    v_mfma_f32_16x16x32_bf16 v[8:11], v[88:91], v[80:83], v[8:11]
    ds_read_b128 v[124:127], v225 offset:0
    v_mfma_f32_16x16x32_bf16 v[12:15], v[88:91], v[84:87], v[12:15]
    ds_read_b128 v[128:131], v225 offset:2048
    v_mfma_f32_16x16x32_bf16 v[16:19], v[92:95], v[80:83], v[16:19]
    ds_read_b128 v[132:135], v226 offset:9216
    v_mfma_f32_16x16x32_bf16 v[20:23], v[92:95], v[84:87], v[20:23]
    ds_read_b128 v[136:139], v227 offset:9216
    v_mfma_f32_16x16x32_bf16 v[24:27], v[96:99], v[80:83], v[24:27]
    ds_read_b128 v[140:143], v226 offset:11264
    v_mfma_f32_16x16x32_bf16 v[28:31], v[96:99], v[84:87], v[28:31]
    ds_read_b128 v[144:147], v227 offset:11264
    v_mfma_f32_16x16x32_bf16 v[32:35], v[100:103], v[80:83], v[32:35]
    ds_read_b128 v[148:151], v226 offset:13312
    v_mfma_f32_16x16x32_bf16 v[36:39], v[100:103], v[84:87], v[36:39]
    ds_read_b128 v[152:155], v227 offset:13312
    v_mfma_f32_16x16x32_bf16 v[40:43], v[104:107], v[80:83], v[40:43]
    ds_read_b128 v[156:159], v226 offset:15360
    v_mfma_f32_16x16x32_bf16 v[44:47], v[104:107], v[84:87], v[44:47]
    ds_read_b128 v[160:163], v227 offset:15360
    v_mfma_f32_16x16x32_bf16 v[48:51], v[108:111], v[80:83], v[48:51]
    ds_read_b128 v[164:167], v228 offset:9216
    v_mfma_f32_16x16x32_bf16 v[52:55], v[108:111], v[84:87], v[52:55]
    v_mfma_f32_16x16x32_bf16 v[56:59], v[112:115], v[80:83], v[56:59]
    v_mfma_f32_16x16x32_bf16 v[60:63], v[112:115], v[84:87], v[60:63]
    v_mfma_f32_16x16x32_bf16 v[64:67], v[116:119], v[80:83], v[64:67]
    v_mfma_f32_16x16x32_bf16 v[68:71], v[116:119], v[84:87], v[68:71]
    v_mfma_f32_16x16x32_bf16 v[72:75], v[120:123], v[80:83], v[72:75]
    v_mfma_f32_16x16x32_bf16 v[76:79], v[120:123], v[84:87], v[76:79]
    s_waitcnt lgkmcnt(0)
    s_barrier
    v_mfma_f32_16x16x32_bf16 v[8:11], v[132:135], v[124:127], v[8:11]
    ds_read_b128 v[80:83], v224 offset:34816
    v_mfma_f32_16x16x32_bf16 v[12:15], v[132:135], v[128:131], v[12:15]
    ds_read_b128 v[84:87], v224 offset:36864
    v_mfma_f32_16x16x32_bf16 v[16:19], v[136:139], v[124:127], v[16:19]
    ds_read_b128 v[88:91], v226 offset:34816
    v_mfma_f32_16x16x32_bf16 v[20:23], v[136:139], v[128:131], v[20:23]
    ds_read_b128 v[92:95], v227 offset:34816
    v_mfma_f32_16x16x32_bf16 v[24:27], v[140:143], v[124:127], v[24:27]
    ds_read_b128 v[96:99], v226 offset:36864
    v_mfma_f32_16x16x32_bf16 v[28:31], v[140:143], v[128:131], v[28:31]
    ds_read_b128 v[100:103], v227 offset:36864
    v_mfma_f32_16x16x32_bf16 v[32:35], v[144:147], v[124:127], v[32:35]
    ds_read_b128 v[104:107], v226 offset:38912
    v_mfma_f32_16x16x32_bf16 v[36:39], v[144:147], v[128:131], v[36:39]
    ds_read_b128 v[108:111], v227 offset:38912
    v_mfma_f32_16x16x32_bf16 v[40:43], v[148:151], v[124:127], v[40:43]
    ds_read_b128 v[112:115], v226 offset:40960
    v_mfma_f32_16x16x32_bf16 v[44:47], v[148:151], v[128:131], v[44:47]
    ds_read_b128 v[116:119], v227 offset:40960
    v_mfma_f32_16x16x32_bf16 v[48:51], v[152:155], v[124:127], v[48:51]
    ds_read_b128 v[120:123], v228 offset:34816
    v_mfma_f32_16x16x32_bf16 v[52:55], v[152:155], v[128:131], v[52:55]
    v_mfma_f32_16x16x32_bf16 v[56:59], v[156:159], v[124:127], v[56:59]
    v_mfma_f32_16x16x32_bf16 v[60:63], v[156:159], v[128:131], v[60:63]
    v_mfma_f32_16x16x32_bf16 v[64:67], v[160:163], v[124:127], v[64:67]
    v_mfma_f32_16x16x32_bf16 v[68:71], v[160:163], v[128:131], v[68:71]
    v_mfma_f32_16x16x32_bf16 v[72:75], v[164:167], v[124:127], v[72:75]
    v_mfma_f32_16x16x32_bf16 v[76:79], v[164:167], v[128:131], v[76:79]
    s_waitcnt lgkmcnt(0)
    v_mfma_f32_16x16x32_bf16 v[8:11], v[88:91], v[80:83], v[8:11]
    ds_read_b128 v[124:127], v225 offset:34816
    v_mfma_f32_16x16x32_bf16 v[16:19], v[92:95], v[80:83], v[16:19]
    ds_read_b128 v[128:131], v225 offset:36864
    v_mfma_f32_16x16x32_bf16 v[24:27], v[96:99], v[80:83], v[24:27]
    ds_read_b128 v[132:135], v226 offset:44032
    v_mfma_f32_16x16x32_bf16 v[32:35], v[100:103], v[80:83], v[32:35]
    ds_read_b128 v[136:139], v227 offset:44032
    v_mfma_f32_16x16x32_bf16 v[40:43], v[104:107], v[80:83], v[40:43]
    ds_read_b128 v[140:143], v226 offset:46080
    v_mfma_f32_16x16x32_bf16 v[48:51], v[108:111], v[80:83], v[48:51]
    ds_read_b128 v[144:147], v227 offset:46080
    v_mfma_f32_16x16x32_bf16 v[56:59], v[112:115], v[80:83], v[56:59]
    ds_read_b128 v[148:151], v226 offset:48128
    v_mfma_f32_16x16x32_bf16 v[64:67], v[116:119], v[80:83], v[64:67]
    ds_read_b128 v[152:155], v227 offset:48128
    v_mfma_f32_16x16x32_bf16 v[72:75], v[120:123], v[80:83], v[72:75]
    ds_read_b128 v[156:159], v226 offset:50176
    v_mfma_f32_16x16x32_bf16 v[12:15], v[88:91], v[84:87], v[12:15]
    ds_read_b128 v[160:163], v227 offset:50176
    v_mfma_f32_16x16x32_bf16 v[20:23], v[92:95], v[84:87], v[20:23]
    ds_read_b128 v[164:167], v228 offset:44032
    s_waitcnt lgkmcnt(0)
    s_barrier
    v_mfma_f32_16x16x32_bf16 v[8:11], v[132:135], v[124:127], v[8:11]
    v_mfma_f32_16x16x32_bf16 v[16:19], v[136:139], v[124:127], v[16:19]
    v_mfma_f32_16x16x32_bf16 v[24:27], v[140:143], v[124:127], v[24:27]
    v_mfma_f32_16x16x32_bf16 v[32:35], v[144:147], v[124:127], v[32:35]
    v_mfma_f32_16x16x32_bf16 v[40:43], v[148:151], v[124:127], v[40:43]
    v_mfma_f32_16x16x32_bf16 v[48:51], v[152:155], v[124:127], v[48:51]
    v_mfma_f32_16x16x32_bf16 v[56:59], v[156:159], v[124:127], v[56:59]
    v_mfma_f32_16x16x32_bf16 v[64:67], v[160:163], v[124:127], v[64:67]
    v_mfma_f32_16x16x32_bf16 v[72:75], v[164:167], v[124:127], v[72:75]
    v_mfma_f32_16x16x32_bf16 v[28:31], v[96:99], v[84:87], v[28:31]
    v_lshlrev_b32 v220, 16, v168
    v_and_b32 v221, 0xffff0000, v168
    v_mul_f32 v220, v220, v8
    v_mul_f32 v221, v221, v9
    v_cvt_pk_bf16_f32 v168, v220, v221
    v_lshlrev_b32 v222, 16, v169
    v_mfma_f32_16x16x32_bf16 v[36:39], v[100:103], v[84:87], v[36:39]
    v_and_b32 v223, 0xffff0000, v169
    v_mul_f32 v222, v222, v10
    v_mul_f32 v223, v223, v11
    v_cvt_pk_bf16_f32 v169, v222, v223
    v_lshlrev_b32 v220, 16, v170
    v_and_b32 v221, 0xffff0000, v170
    v_mfma_f32_16x16x32_bf16 v[44:47], v[104:107], v[84:87], v[44:47]
    v_mul_f32 v220, v220, v16
    v_mul_f32 v221, v221, v17
    v_cvt_pk_bf16_f32 v170, v220, v221
    v_lshlrev_b32 v222, 16, v171
    v_and_b32 v223, 0xffff0000, v171
    v_mul_f32 v222, v222, v18
    v_mfma_f32_16x16x32_bf16 v[52:55], v[108:111], v[84:87], v[52:55]
    v_mul_f32 v223, v223, v19
    v_cvt_pk_bf16_f32 v171, v222, v223
    buffer_store_dwordx4 v[168:171], v214, s[24:27], s53 offen offset:0 sc1
    v_lshlrev_b32 v220, 16, v172
    v_and_b32 v221, 0xffff0000, v172
    v_mul_f32 v220, v220, v24
    v_mfma_f32_16x16x32_bf16 v[60:63], v[112:115], v[84:87], v[60:63]
    v_mul_f32 v221, v221, v25
    v_cvt_pk_bf16_f32 v172, v220, v221
    v_lshlrev_b32 v222, 16, v173
    v_and_b32 v223, 0xffff0000, v173
    v_mul_f32 v222, v222, v26
    v_mul_f32 v223, v223, v27
    v_mfma_f32_16x16x32_bf16 v[68:71], v[116:119], v[84:87], v[68:71]
    v_cvt_pk_bf16_f32 v173, v222, v223
    v_lshlrev_b32 v220, 16, v174
    v_and_b32 v221, 0xffff0000, v174
    v_mul_f32 v220, v220, v32
    v_mul_f32 v221, v221, v33
    v_cvt_pk_bf16_f32 v174, v220, v221
    v_mfma_f32_16x16x32_bf16 v[76:79], v[120:123], v[84:87], v[76:79]
    v_lshlrev_b32 v222, 16, v175
    v_and_b32 v223, 0xffff0000, v175
    v_mul_f32 v222, v222, v34
    v_mul_f32 v223, v223, v35
    v_cvt_pk_bf16_f32 v175, v222, v223
    buffer_store_dwordx4 v[172:175], v214, s[24:27], s53 offen offset:1024 sc1
    v_mfma_f32_16x16x32_bf16 v[12:15], v[132:135], v[128:131], v[12:15]
    v_lshlrev_b32 v220, 16, v176
    v_and_b32 v221, 0xffff0000, v176
    v_mul_f32 v220, v220, v40
    v_mul_f32 v221, v221, v41
    v_cvt_pk_bf16_f32 v176, v220, v221
    v_lshlrev_b32 v222, 16, v177
    v_mfma_f32_16x16x32_bf16 v[20:23], v[136:139], v[128:131], v[20:23]
    v_and_b32 v223, 0xffff0000, v177
    v_mul_f32 v222, v222, v42
    v_mul_f32 v223, v223, v43
    v_cvt_pk_bf16_f32 v177, v222, v223
    v_lshlrev_b32 v220, 16, v178
    v_and_b32 v221, 0xffff0000, v178
    v_mfma_f32_16x16x32_bf16 v[28:31], v[140:143], v[128:131], v[28:31]
    v_mul_f32 v220, v220, v48
    v_mul_f32 v221, v221, v49
    v_cvt_pk_bf16_f32 v178, v220, v221
    v_lshlrev_b32 v222, 16, v179
    v_and_b32 v223, 0xffff0000, v179
    v_mul_f32 v222, v222, v50
    v_mfma_f32_16x16x32_bf16 v[36:39], v[144:147], v[128:131], v[36:39]
    v_mul_f32 v223, v223, v51
    v_cvt_pk_bf16_f32 v179, v222, v223
    buffer_store_dwordx4 v[176:179], v214, s[24:27], s53 offen offset:2048 sc1
    v_lshlrev_b32 v220, 16, v180
    v_and_b32 v221, 0xffff0000, v180
    v_mul_f32 v220, v220, v56
    v_mfma_f32_16x16x32_bf16 v[44:47], v[148:151], v[128:131], v[44:47]
    v_mul_f32 v221, v221, v57
    v_cvt_pk_bf16_f32 v180, v220, v221
    v_lshlrev_b32 v222, 16, v181
    v_and_b32 v223, 0xffff0000, v181
    v_mul_f32 v222, v222, v58
    v_mul_f32 v223, v223, v59
    v_mfma_f32_16x16x32_bf16 v[52:55], v[152:155], v[128:131], v[52:55]
    v_cvt_pk_bf16_f32 v181, v222, v223
    v_lshlrev_b32 v220, 16, v182
    v_and_b32 v221, 0xffff0000, v182
    v_mul_f32 v220, v220, v64
    v_mul_f32 v221, v221, v65
    v_cvt_pk_bf16_f32 v182, v220, v221
    v_mfma_f32_16x16x32_bf16 v[60:63], v[156:159], v[128:131], v[60:63]
    v_lshlrev_b32 v222, 16, v183
    v_and_b32 v223, 0xffff0000, v183
    v_mul_f32 v222, v222, v66
    v_mul_f32 v223, v223, v67
    v_cvt_pk_bf16_f32 v183, v222, v223
    buffer_store_dwordx4 v[180:183], v214, s[24:27], s53 offen offset:3072 sc1
    v_mfma_f32_16x16x32_bf16 v[68:71], v[160:163], v[128:131], v[68:71]
    v_lshlrev_b32 v220, 16, v200
    v_and_b32 v221, 0xffff0000, v200
    v_mul_f32 v220, v220, v72
    v_mul_f32 v221, v221, v73
    v_cvt_pk_bf16_f32 v200, v220, v221
    v_lshlrev_b32 v222, 16, v201
    v_mfma_f32_16x16x32_bf16 v[76:79], v[164:167], v[128:131], v[76:79]
    v_and_b32 v223, 0xffff0000, v201
    v_mul_f32 v222, v222, v74
    v_mul_f32 v223, v223, v75
    v_cvt_pk_bf16_f32 v201, v222, v223
    buffer_store_dwordx2 v[200:201], v215, s[24:27], s57 offen sc1
    v_lshlrev_b32 v220, 16, v184
    v_and_b32 v221, 0xffff0000, v184
    v_pk_mul_f32 v[220:221], v[220:221], v[12:13]
    v_cvt_pk_bf16_f32 v184, v220, v221
    v_lshlrev_b32 v222, 16, v185
    v_and_b32 v223, 0xffff0000, v185
    v_pk_mul_f32 v[222:223], v[222:223], v[14:15]
    v_cvt_pk_bf16_f32 v185, v222, v223
    v_lshlrev_b32 v220, 16, v186
    v_and_b32 v221, 0xffff0000, v186
    v_pk_mul_f32 v[220:221], v[220:221], v[20:21]
    v_cvt_pk_bf16_f32 v186, v220, v221
    v_lshlrev_b32 v222, 16, v187
    v_and_b32 v223, 0xffff0000, v187
    v_pk_mul_f32 v[222:223], v[222:223], v[22:23]
    v_cvt_pk_bf16_f32 v187, v222, v223
    buffer_store_dwordx4 v[184:187], v214, s[24:27], s54 offen offset:0 sc1
    v_lshlrev_b32 v220, 16, v188
    v_and_b32 v221, 0xffff0000, v188
    v_pk_mul_f32 v[220:221], v[220:221], v[28:29]
    v_cvt_pk_bf16_f32 v188, v220, v221
    v_lshlrev_b32 v222, 16, v189
    v_and_b32 v223, 0xffff0000, v189
    v_pk_mul_f32 v[222:223], v[222:223], v[30:31]
    v_cvt_pk_bf16_f32 v189, v222, v223
    v_lshlrev_b32 v220, 16, v190
    v_and_b32 v221, 0xffff0000, v190
    v_pk_mul_f32 v[220:221], v[220:221], v[36:37]
    v_cvt_pk_bf16_f32 v190, v220, v221
    v_lshlrev_b32 v222, 16, v191
    v_and_b32 v223, 0xffff0000, v191
    v_pk_mul_f32 v[222:223], v[222:223], v[38:39]
    v_cvt_pk_bf16_f32 v191, v222, v223
    buffer_store_dwordx4 v[188:191], v214, s[24:27], s54 offen offset:1024 sc1
    v_lshlrev_b32 v220, 16, v192
    v_and_b32 v221, 0xffff0000, v192
    v_pk_mul_f32 v[220:221], v[220:221], v[44:45]
    v_cvt_pk_bf16_f32 v192, v220, v221
    v_lshlrev_b32 v222, 16, v193
    v_and_b32 v223, 0xffff0000, v193
    v_pk_mul_f32 v[222:223], v[222:223], v[46:47]
    v_cvt_pk_bf16_f32 v193, v222, v223
    v_lshlrev_b32 v220, 16, v194
    v_and_b32 v221, 0xffff0000, v194
    v_pk_mul_f32 v[220:221], v[220:221], v[52:53]
    v_cvt_pk_bf16_f32 v194, v220, v221
    v_lshlrev_b32 v222, 16, v195
    v_and_b32 v223, 0xffff0000, v195
    v_pk_mul_f32 v[222:223], v[222:223], v[54:55]
    v_cvt_pk_bf16_f32 v195, v222, v223
    buffer_store_dwordx4 v[192:195], v214, s[24:27], s54 offen offset:2048 sc1
    v_lshlrev_b32 v220, 16, v196
    v_and_b32 v221, 0xffff0000, v196
    v_pk_mul_f32 v[220:221], v[220:221], v[60:61]
    v_cvt_pk_bf16_f32 v196, v220, v221
    v_lshlrev_b32 v222, 16, v197
    v_and_b32 v223, 0xffff0000, v197
    v_pk_mul_f32 v[222:223], v[222:223], v[62:63]
    v_cvt_pk_bf16_f32 v197, v222, v223
    v_lshlrev_b32 v220, 16, v198
    v_and_b32 v221, 0xffff0000, v198
    v_pk_mul_f32 v[220:221], v[220:221], v[68:69]
    v_cvt_pk_bf16_f32 v198, v220, v221
    v_lshlrev_b32 v222, 16, v199
    v_and_b32 v223, 0xffff0000, v199
    v_pk_mul_f32 v[222:223], v[222:223], v[70:71]
    v_cvt_pk_bf16_f32 v199, v222, v223
    buffer_store_dwordx4 v[196:199], v214, s[24:27], s54 offen offset:3072 sc1
    v_lshlrev_b32 v220, 16, v202
    v_and_b32 v221, 0xffff0000, v202
    v_pk_mul_f32 v[220:221], v[220:221], v[76:77]
    v_cvt_pk_bf16_f32 v202, v220, v221
    v_lshlrev_b32 v222, 16, v203
    v_and_b32 v223, 0xffff0000, v203
    v_pk_mul_f32 v[222:223], v[222:223], v[78:79]
    v_cvt_pk_bf16_f32 v203, v222, v223
    buffer_store_dwordx2 v[202:203], v215, s[24:27], s58 offen sc1
    v_mov_b32 v5, 159744
    v_mov_b32 v6, 1
    s_waitcnt vmcnt(0) lgkmcnt(0)
    s_mov_b64 exec, 1
    ds_add_rtn_u32 v7, v5, v6 offset:0
    s_waitcnt lgkmcnt(0)
    v_readfirstlane_b32 s47, v7
    s_nop 0
    s_cmp_lg_u32 s47, 3
    s_cbranch_scc1 K2_NOSIG
    s_mov_b64 exec, -1
    v_mov_b32 v6, 1
    v_lshlrev_b32 v5, 2, v2
    s_lshl_b32 s46, s32, 14
    s_lshl_b32 s47, s33, 10
    s_add_u32 s46, s46, s47
    s_mov_b32 exec_hi, 0
    buffer_store_dword v6, v5, s[72:75], s46 offen offset:256 sc1
K2_NOSIG:
    s_mov_b64 exec, -1
    s_endpgm

TEXT_END:
    s_endpgm
.section .rodata,"a"
.p2align 8
K1_TAB:
.long 0,110880,230624,350336,16,110896,230640,350352,32,110848,230592,350368,48,110864,230608,350384
.long 64,119840,230688,350400,80,119856,230704,350416,96,119808,230656,350432,112,119824,230672,350448
.long 128,119904,239648,350464,144,119920,239664,350480,160,119872,239616,350496,176,119888,239632,350512
.long 192,119968,239712,359424,208,119984,239728,359440,224,119936,239680,359456,240,119952,239696,359472
.long 256,120032,239776,359488,272,120048,239792,359504,288,120000,239744,359520,304,120016,239760,359536
.long 9216,120096,239840,359552,9232,120112,239856,359568,9248,120064,239808,359584,9264,120080,239824,359600
.long 9280,129056,239904,359616,9296,129072,239920,359632,9312,129024,239872,359648,9328,129040,239888,359664
.long 9344,129120,248864,359680,9360,129136,248880,359696,9376,129088,248832,359712,9392,129104,248848,359728
.long 9408,129184,248928,368672,9424,129200,248944,368688,9440,129152,248896,368640,9456,129168,248912,368656
.long 9472,129248,248992,368736,9488,129264,249008,368752,9504,129216,248960,368704,9520,129232,248976,368720
.long 18432,129312,249056,368800,18448,129328,249072,368816,18464,129280,249024,368768,18480,129296,249040,368784
.long 18496,138272,249120,368864,18512,138288,249136,368880,18528,138240,249088,368832,18544,138256,249104,368848
.long 18560,138336,258080,368928,18576,138352,258096,368944,18592,138304,258048,368896,18608,138320,258064,368912
.long 18624,138400,258144,377888,18640,138416,258160,377904,18656,138368,258112,377856,18672,138384,258128,377872
.long 18688,138464,258208,377952,18704,138480,258224,377968,18720,138432,258176,377920,18736,138448,258192,377936
.long 27648,138528,258272,378016,27664,138544,258288,378032,27680,138496,258240,377984,27696,138512,258256,378000
.long 470080,1152,41504,88768,470096,1168,41520,88784,470112,1184,41536,86400,470128,1200,41552,86416
.long 470144,1216,2130706432,86432,470160,1232,2130706432,86448,470176,2304,46080,86464,470192,2320,46096,86480
.long 470208,2336,46112,2130706432,470224,2352,46128,2130706432,470240,2368,46144,91008,470256,2384,46160,91024
.long 470272,0,47232,91040,470288,16,47248,91056,470304,32,47264,91072,470320,48,47280,91088
.long 479232,64,47296,92160,479248,80,47312,92176,479264,2130706432,44928,92192,479280,2130706432,44944,92208
.long 479296,4608,44960,92224,479312,4624,44976,92240,479328,4640,44992,89856,479344,4656,45008,89872
.long 479360,4672,2130706432,89888,479376,4688,2130706432,89904,479392,5760,49536,89920,479408,5776,49552,89936
.long 479424,5792,49568,2130706432,479440,5808,49584,2130706432,479456,5824,49600,94464,479472,5840,49616,94480
.long 479488,3456,50688,94496,479504,3472,50704,94512,479520,3488,50720,94528,479536,3504,50736,94544
.long 488448,3520,50752,95616,488464,3536,50768,95632,488480,2130706432,48384,95648,488496,2130706432,48400,95664
.long 488512,8064,48416,95680,488528,8080,48432,95696,488544,8096,48448,93312,488560,8112,48464,93328
.long 488576,8128,2130706432,93344,488592,8144,2130706432,93360,488608,9216,52992,93376,488624,9232,53008,93392
.long 488640,9248,53024,2130706432,488656,9264,53040,2130706432,488672,9280,53056,97920,488688,9296,53072,97936
.long 488704,6912,54144,97952,488720,6928,54160,97968,488736,6944,54176,97984,488752,6960,54192,98000
.long 497664,6976,54208,99072,497680,6992,54224,99088,497696,2130706432,51840,99104,497712,2130706432,51856,99120
.long 497728,11520,51872,99136,497744,11536,51888,99152,497760,11552,51904,96768,497776,11568,51920,96784
.long 133664,177472,143360,0,133680,177488,143632,16,133696,178560,143904,32,133712,178576,144176,48
.long 131328,178592,144384,64,131344,178608,144656,80,131360,178624,144928,96,131376,178640,145200,112
.long 131392,176256,145408,0,131408,176272,145680,16,2130706432,176288,145952,32,2130706432,176304,146224,48
.long 135936,176320,146432,64,135952,176336,146704,80,135968,2130706432,146976,96,135984,2130706432,147248,112
.long 136000,180864,143376,1152,136016,180880,143616,1168,137088,180896,143920,1184,137104,180912,144160,1200
.long 137120,180928,144400,1216,137136,180944,144640,1232,137152,182016,144944,1248,137168,182032,145184,1264
.long 134784,182048,145424,1152,134800,182064,145664,1168,134816,182080,145968,1184,134832,182096,146208,1200
.long 134848,179712,146448,1216,134864,179728,146688,1232,2130706432,179744,146992,1248,2130706432,179760,147232,1264
.long 2130706432,179776,143392,2304,2130706432,179792,143664,2320,139392,2130706432,143872,2336,139408,2130706432,144144,2352
.long 139424,184320,144416,2368,139440,184336,144688,2384,139456,184352,144896,2400,139472,184368,145168,2416
.long 140544,184384,145440,2304,140560,184400,145712,2320,140576,185472,145920,2336,140592,185488,146192,2352
.long 140608,185504,146464,2368,140624,185520,146736,2384,138240,185536,146944,2400,138256,185552,147216,2416
.long 138272,183168,143408,3456,138288,183184,143648,3472,138304,183200,143888,3488,138320,183216,144128,3504
.long 2130706432,183232,144432,3520,2130706432,183248,144672,3536,142848,2130706432,144912,3552,142864,2130706432,145152,3568
.long 142880,187776,145456,3456,142896,187792,145696,3472,142912,187808,145936,3488,142928,187824,146176,3504
.long 144000,187840,146480,3520,144016,187856,146720,3536,144032,188928,146960,3552,144048,188944,147200,3568
.long 1152,12736,25376,0,1168,12752,25392,0,1184,10368,25408,0,1200,10384,25424,0
.long 1216,10400,26496,0,1232,10416,26512,0,2304,10432,26528,0,2320,10448,26544,0
.long 2336,14976,26560,0,2352,14992,26576,0,2368,15008,24192,0,2384,15024,24208,0
.long 0,15040,24224,0,16,15056,24240,0,32,16128,24256,0,48,16144,24272,0
.long 64,16160,28800,0,80,16176,28816,0,4608,16192,28832,0,4624,16208,28848,0
.long 4640,13824,28864,0,4656,13840,28880,0,4672,13856,29952,0,4688,13872,29968,0
.long 5760,13888,29984,0,5776,13904,30000,0,5792,18432,30016,0,5808,18448,30032,0
.long 5824,18464,27648,0,5840,18480,27664,0,3456,18496,27680,0,3472,18512,27696,0
.long 3488,19584,27712,0,3504,19600,27728,0,3520,19616,2130706432,0,3536,19632,2130706432,0
.long 8064,19648,2130706432,0,8080,19664,2130706432,0,8096,17280,2130706432,0,8112,17296,2130706432,0
.long 8128,17312,2130706432,0,8144,17328,2130706432,0,9216,17344,2130706432,0,9232,17360,2130706432,0
.long 9248,21888,2130706432,0,9264,21904,2130706432,0,9280,21920,2130706432,0,9296,21936,2130706432,0
.long 6912,21952,2130706432,0,6928,21968,2130706432,0,6944,23040,2130706432,0,6960,23056,2130706432,0
.long 6976,23072,2130706432,0,6992,23088,2130706432,0,11520,23104,2130706432,0,11536,23120,2130706432,0
.long 11552,20736,2130706432,0,11568,20752,2130706432,0,11584,20768,2130706432,0,11600,20784,2130706432,0
.long 12672,20800,2130706432,0,12688,20816,2130706432,0,12704,25344,2130706432,0,12720,25360,2130706432,0
.long 27712,147456,258336,378080,27728,147472,258352,378096,27744,147488,258304,378048,27760,147504,258320,378064
.long 27776,147520,267296,378144,27792,147536,267312,378160,27808,147552,267264,378112,27824,147568,267280,378128
.long 27840,147584,267360,387104,27856,147600,267376,387120,27872,147616,267328,387072,27888,147632,267344,387088
.long 27904,147648,267424,387168,27920,147664,267440,387184,27936,147680,267392,387136,27952,147696,267408,387152
.long 36864,147712,267488,387232,36880,147728,267504,387248,36896,147744,267456,387200,36912,147760,267472,387216
.long 36928,156672,267552,387296,36944,156688,267568,387312,36960,156704,267520,387264,36976,156720,267536,387280
.long 36992,156736,276512,387360,37008,156752,276528,387376,37024,156768,276480,387328,37040,156784,276496,387344
.long 37056,156800,276576,396320,37072,156816,276592,396336,37088,156832,276544,396288,37104,156848,276560,396304
.long 37120,156864,276640,396384,37136,156880,276656,396400,37152,156896,276608,396352,37168,156912,276624,396368
.long 46080,156928,276704,396448,46096,156944,276720,396464,46112,156960,276672,396416,46128,156976,276688,396432
.long 46144,165888,276768,396512,46160,165904,276784,396528,46176,165920,276736,396480,46192,165936,276752,396496
.long 46208,165952,285728,396576,46224,165968,285744,396592,46240,165984,285696,396544,46256,166000,285712,396560
.long 46272,166016,285792,405536,46288,166032,285808,405552,46304,166048,285760,405504,46320,166064,285776,405520
.long 46336,166080,285856,405600,46352,166096,285872,405616,46368,166112,285824,405568,46384,166128,285840,405584
.long 55296,166144,285920,405664,55312,166160,285936,405680,55328,166176,285888,405632,55344,166192,285904,405648
.long 55360,175104,285984,405728,55376,175120,286000,405744,55392,175136,285952,405696,55408,175152,285968,405712
.long 497792,11584,56448,96800,497808,11600,56464,96816,497824,12672,56480,96832,497840,12688,56496,96848
.long 497856,12704,56512,2130706432,497872,12720,56528,2130706432,497888,12736,57600,101376,497904,12752,57616,101392
.long 497920,10368,57632,101408,497936,10384,57648,101424,497952,10400,57664,101440,497968,10416,57680,101456
.long 506880,10432,55296,102528,506896,10448,55312,102544,506912,2130706432,55328,102560,506928,2130706432,55344,102576
.long 506944,14976,55360,102592,506960,14992,55376,102608,506976,15008,2130706432,100224,506992,15024,2130706432,100240
.long 507008,15040,59904,100256,507024,15056,59920,100272,507040,16128,59936,100288,507056,16144,59952,100304
.long 507072,16160,59968,2130706432,507088,16176,59984,2130706432,507104,16192,61056,104832,507120,16208,61072,104848
.long 507136,13824,61088,104864,507152,13840,61104,104880,507168,13856,61120,104896,507184,13872,61136,104912
.long 516128,13888,58752,105984,516144,13904,58768,106000,516096,2130706432,58784,106016,516112,2130706432,58800,106032
.long 516192,18432,58816,106048,516208,18448,58832,106064,516160,18464,2130706432,103680,516176,18480,2130706432,103696
.long 516256,18496,63360,103712,516272,18512,63376,103728,516224,19584,63392,103744,516240,19600,63408,103760
.long 516320,19616,63424,2130706432,516336,19632,63440,2130706432,516288,19648,64512,108288,516304,19664,64528,108304
.long 516384,17280,64544,108320,516400,17296,64560,108336,516352,17312,64576,108352,516368,17328,64592,108368
.long 525344,17344,62208,109440,525360,17360,62224,109456,525312,2130706432,62240,109472,525328,2130706432,62256,109488
.long 525408,21888,62272,109504,525424,21904,62288,109520,525376,21920,2130706432,107136,525392,21936,2130706432,107152
.long 525472,21952,66816,107168,525488,21968,66832,107184,525440,23040,66848,107200,525456,23056,66864,107216
.long 144064,188960,143424,4608,144080,188976,143696,4624,141696,188992,143968,4640,141712,189008,144240,4656
.long 141728,186624,144448,4672,141744,186640,144720,4688,141760,186656,144992,4704,141776,186672,145264,4720
.long 2130706432,186688,145472,4608,2130706432,186704,145744,4624,146304,2130706432,146016,4640,146320,2130706432,146288,4656
.long 146336,191232,146496,4672,146352,191248,146768,4688,146368,191264,147040,4704,146384,191280,147312,4720
.long 147456,191296,143440,5760,147472,191312,143680,5776,147488,192384,143984,5792,147504,192400,144224,5808
.long 147520,192416,144464,5824,147536,192432,144704,5840,145152,192448,145008,5856,145168,192464,145248,5872
.long 145184,190080,145488,5760,145200,190096,145728,5776,145216,190112,146032,5792,145232,190128,146272,5808
.long 2130706432,190144,146512,5824,2130706432,190160,146752,5840,149760,2130706432,147056,5856,149776,2130706432,147296,5872
.long 149792,2130706432,143456,6912,149808,2130706432,143728,6928,149824,194688,143936,6944,149840,194704,144208,6960
.long 150912,194720,144480,6976,150928,194736,144752,6992,150944,194752,144960,7008,150960,194768,145232,7024
.long 150976,195840,145504,6912,150992,195856,145776,6928,148608,195872,145984,6944,148624,195888,146256,6960
.long 148640,195904,146528,6976,148656,195920,146800,6992,148672,193536,147008,7008,148688,193552,147280,7024
.long 2130706432,193568,143472,8064,2130706432,193584,143712,8080,153216,193600,143952,8096,153232,193616,144192,8112
.long 153248,2130706432,144496,8128,153264,2130706432,144736,8144,153280,198144,144976,8160,153296,198160,145216,8176
.long 154368,198176,145520,8064,154384,198192,145760,8080,154400,198208,146000,8096,154416,198224,146240,8112
.long 154432,199296,146544,8128,154448,199312,146784,8144,152064,199328,147024,8160,152080,199344,147264,8176
.long 32256,43840,56480,0,32272,43856,56496,0,32288,41472,56512,0,32304,41488,56528,0
.long 32320,41504,57600,0,32336,41520,57616,0,33408,41536,57632,0,33424,41552,57648,0
.long 33440,46080,57664,0,33456,46096,57680,0,33472,46112,55296,0,33488,46128,55312,0
.long 31104,46144,55328,0,31120,46160,55344,0,31136,47232,55360,0,31152,47248,55376,0
.long 31168,47264,59904,0,31184,47280,59920,0,35712,47296,59936,0,35728,47312,59952,0
.long 35744,44928,59968,0,35760,44944,59984,0,35776,44960,61056,0,35792,44976,61072,0
.long 36864,44992,61088,0,36880,45008,61104,0,36896,49536,61120,0,36912,49552,61136,0
.long 36928,49568,58752,0,36944,49584,58768,0,34560,49600,58784,0,34576,49616,58800,0
.long 34592,50688,58816,0,34608,50704,58832,0,34624,50720,2130706432,0,34640,50736,2130706432,0
.long 39168,50752,2130706432,0,39184,50768,2130706432,0,39200,48384,2130706432,0,39216,48400,2130706432,0
.long 39232,48416,2130706432,0,39248,48432,2130706432,0,40320,48448,2130706432,0,40336,48464,2130706432,0
.long 40352,52992,2130706432,0,40368,53008,2130706432,0,40384,53024,2130706432,0,40400,53040,2130706432,0
.long 38016,53056,2130706432,0,38032,53072,2130706432,0,38048,54144,2130706432,0,38064,54160,2130706432,0
.long 38080,54176,2130706432,0,38096,54192,2130706432,0,42624,54208,2130706432,0,42640,54224,2130706432,0
.long 42656,51840,2130706432,0,42672,51856,2130706432,0,42688,51872,2130706432,0,42704,51888,2130706432,0
.long 43776,51904,2130706432,0,43792,51920,2130706432,0,43808,56448,2130706432,0,43824,56464,2130706432,0
.long 55424,175168,294912,405792,55440,175184,294928,405808,55456,175200,294944,405760,55472,175216,294960,405776
.long 55488,175232,294976,414752,55504,175248,294992,414768,55520,175264,295008,414720,55536,175280,295024,414736
.long 55552,175296,295040,414816,55568,175312,295056,414832,55584,175328,295072,414784,55600,175344,295088,414800
.long 64512,175360,295104,414880,64528,175376,295120,414896,64544,175392,295136,414848,64560,175408,295152,414864
.long 64576,184320,295168,414944,64592,184336,295184,414960,64608,184352,295200,414912,64624,184368,295216,414928
.long 64640,184384,304128,415008,64656,184400,304144,415024,64672,184416,304160,414976,64688,184432,304176,414992
.long 64704,184448,304192,423968,64720,184464,304208,423984,64736,184480,304224,423936,64752,184496,304240,423952
.long 64768,184512,304256,424032,64784,184528,304272,424048,64800,184544,304288,424000,64816,184560,304304,424016
.long 73760,184576,304320,424096,73776,184592,304336,424112,73728,184608,304352,424064,73744,184624,304368,424080
.long 73824,193536,304384,424160,73840,193552,304400,424176,73792,193568,304416,424128,73808,193584,304432,424144
.long 73888,193600,313344,424224,73904,193616,313360,424240,73856,193632,313376,424192,73872,193648,313392,424208
.long 73952,193664,313408,433184,73968,193680,313424,433200,73920,193696,313440,433152,73936,193712,313456,433168
.long 74016,193728,313472,433248,74032,193744,313488,433264,73984,193760,313504,433216,74000,193776,313520,433232
.long 82976,193792,313536,433312,82992,193808,313552,433328,82944,193824,313568,433280,82960,193840,313584,433296
.long 83040,202752,313600,433376,83056,202768,313616,433392,83008,202784,313632,433344,83024,202800,313648,433360
.long 83104,202816,322560,433440,83120,202832,322576,433456,83072,202848,322592,433408,83088,202864,322608,433424
.long 525536,23072,66880,111744,525552,23088,66896,111760,525504,23104,67968,111776,525520,23120,67984,111792
.long 525600,20736,68000,111808,525616,20752,68016,111824,525568,20768,68032,112896,525584,20784,68048,112912
.long 534560,20800,65664,112928,534576,20816,65680,112944,534528,2130706432,65696,112960,534544,2130706432,65712,112976
.long 534624,25344,65728,110592,534640,25360,65744,110608,534592,25376,2130706432,110624,534608,25392,2130706432,110640
.long 534688,25408,70272,110656,534704,25424,70288,110672,534656,26496,70304,2130706432,534672,26512,70320,2130706432
.long 534752,26528,70336,115200,534768,26544,70352,115216,534720,26560,71424,115232,534736,26576,71440,115248
.long 534816,24192,71456,115264,534832,24208,71472,115280,534784,24224,71488,116352,534800,24240,71504,116368
.long 543776,24256,69120,116384,543792,24272,69136,116400,543744,2130706432,69152,116416,543760,2130706432,69168,116432
.long 543840,2130706432,69184,114048,543856,2130706432,69200,114064,543808,28800,2130706432,114080,543824,28816,2130706432,114096
.long 543904,28832,73728,114112,543920,28848,73744,114128,543872,28864,73760,2130706432,543888,28880,73776,2130706432
.long 543968,29952,73792,118656,543984,29968,73808,118672,543936,29984,74880,118688,543952,30000,74896,118704
.long 544032,30016,74912,118720,544048,30032,74928,118736,544000,27648,74944,119808,544016,27664,74960,119824
.long 552992,27680,72576,119840,553008,27696,72592,119856,552960,27712,72608,119872,552976,27728,72624,119888
.long 553056,2130706432,72640,117504,553072,2130706432,72656,117520,553024,32256,2130706432,117536,553040,32272,2130706432,117552
.long 553120,32288,77184,117568,553136,32304,77200,117584,553088,32320,77216,2130706432,553104,32336,77232,2130706432
.long 553184,33408,77248,122112,553200,33424,77264,122128,553152,33440,78336,122144,553168,33456,78352,122160
.long 152096,199360,143488,9216,152112,199376,143760,9232,152128,196992,144032,9248,152144,197008,144304,9264
.long 2130706432,197024,144512,9280,2130706432,197040,144784,9296,156672,197056,145056,9312,156688,197072,145328,9328
.long 156704,2130706432,145536,9216,156720,2130706432,145808,9232,156736,201600,146080,9248,156752,201616,146352,9264
.long 157824,201632,146560,9280,157840,201648,146832,9296,157856,201664,147104,9312,157872,201680,147376,9328
.long 157888,202752,143504,10368,157904,202768,143744,10384,155520,202784,144048,10400,155536,202800,144288,10416
.long 155552,202816,144528,10432,155568,202832,144768,10448,155584,200448,145072,10464,155600,200464,145312,10480
.long 2130706432,200480,145552,10368,2130706432,200496,145792,10384,160128,200512,146096,10400,160144,200528,146336,10416
.long 160160,2130706432,146576,10432,160176,2130706432,146816,10448,160192,205056,147120,10464,160208,205072,147360,10480
.long 161280,205088,143520,11520,161296,205104,143792,11536,161312,205120,144000,11552,161328,205136,144272,11568
.long 161344,206208,144544,11584,161360,206224,144816,11600,158976,206240,145024,11616,158992,206256,145296,11632
.long 159008,206272,145568,11520,159024,206288,145840,11536,159040,203904,146048,11552,159056,203920,146320,11568
.long 2130706432,203936,146592,11584,2130706432,203952,146864,11600,163584,203968,147072,11616,163600,203984,147344,11632
.long 163616,2130706432,143536,12672,163632,2130706432,143776,12688,163648,208512,144016,12704,163664,208528,144256,12720
.long 164736,208544,144560,12736,164752,208560,144800,12752,164768,208576,145040,12768,164784,208592,145280,12784
.long 164800,209664,145584,12672,164816,209680,145824,12688,162432,209696,146064,12704,162448,209712,146304,12720
.long 162464,209728,146608,12736,162480,209744,146848,12752,162496,207360,147088,12768,162512,207376,147328,12784
.long 63360,74944,87584,0,63376,74960,87600,0,63392,72576,87616,0,63408,72592,87632,0
.long 63424,72608,88704,0,63440,72624,88720,0,64512,72640,88736,0,64528,72656,88752,0
.long 64544,77184,88768,0,64560,77200,88784,0,64576,77216,86400,0,64592,77232,86416,0
.long 62208,77248,86432,0,62224,77264,86448,0,62240,78336,86464,0,62256,78352,86480,0
.long 62272,78368,91008,0,62288,78384,91024,0,66816,78400,91040,0,66832,78416,91056,0
.long 66848,76032,91072,0,66864,76048,91088,0,66880,76064,92160,0,66896,76080,92176,0
.long 67968,76096,92192,0,67984,76112,92208,0,68000,80640,92224,0,68016,80656,92240,0
.long 68032,80672,89856,0,68048,80688,89872,0,65664,80704,89888,0,65680,80720,89904,0
.long 65696,81792,89920,0,65712,81808,89936,0,65728,81824,2130706432,0,65744,81840,2130706432,0
.long 70272,81856,2130706432,0,70288,81872,2130706432,0,70304,79488,2130706432,0,70320,79504,2130706432,0
.long 70336,79520,2130706432,0,70352,79536,2130706432,0,71424,79552,2130706432,0,71440,79568,2130706432,0
.long 71456,84096,2130706432,0,71472,84112,2130706432,0,71488,84128,2130706432,0,71504,84144,2130706432,0
.long 69120,84160,2130706432,0,69136,84176,2130706432,0,69152,85248,2130706432,0,69168,85264,2130706432,0
.long 69184,85280,2130706432,0,69200,85296,2130706432,0,73728,85312,2130706432,0,73744,85328,2130706432,0
.long 73760,82944,2130706432,0,73776,82960,2130706432,0,73792,82976,2130706432,0,73808,82992,2130706432,0
.long 74880,83008,2130706432,0,74896,83024,2130706432,0,74912,87552,2130706432,0,74928,87568,2130706432,0
.long 83168,202880,322624,442368,83184,202896,322640,442384,83136,202912,322656,442400,83152,202928,322672,442416
.long 83232,202944,322688,442432,83248,202960,322704,442448,83200,202976,322720,442464,83216,202992,322736,442480
.long 92192,203008,322752,442496,92208,203024,322768,442512,92160,203040,322784,442528,92176,203056,322800,442544
.long 92256,211968,322816,442560,92272,211984,322832,442576,92224,212000,322848,442592,92240,212016,322864,442608
.long 92320,212032,331776,442624,92336,212048,331792,442640,92288,212064,331808,442656,92304,212080,331824,442672
.long 92384,212096,331840,451584,92400,212112,331856,451600,92352,212128,331872,451616,92368,212144,331888,451632
.long 92448,212160,331904,451648,92464,212176,331920,451664,92416,212192,331936,451680,92432,212208,331952,451696
.long 101408,212224,331968,451712,101424,212240,331984,451728,101376,212256,332000,451744,101392,212272,332016,451760
.long 101472,221216,332032,451776,101488,221232,332048,451792,101440,221184,332064,451808,101456,221200,332080,451824
.long 101536,221280,340992,451840,101552,221296,341008,451856,101504,221248,341024,451872,101520,221264,341040,451888
.long 101600,221344,341056,460800,101616,221360,341072,460816,101568,221312,341088,460832,101584,221328,341104,460848
.long 101664,221408,341120,460864,101680,221424,341136,460880,101632,221376,341152,460896,101648,221392,341168,460912
.long 110624,221472,341184,460928,110640,221488,341200,460944,110592,221440,341216,460960,110608,221456,341232,460976
.long 110688,230432,341248,460992,110704,230448,341264,461008,110656,230400,341280,461024,110672,230416,341296,461040
.long 110752,230496,350208,461056,110768,230512,350224,461072,110720,230464,350240,461088,110736,230480,350256,461104
.long 110816,230560,350272,470016,110832,230576,350288,470032,110784,230528,350304,470048,110800,230544,350320,470064
.long 553248,33472,78368,122176,553264,33488,78384,122192,553216,31104,78400,123264,553232,31120,78416,123280
.long 562208,31136,76032,123296,562224,31152,76048,123312,562176,31168,76064,123328,562192,31184,76080,123344
.long 562272,2130706432,76096,120960,562288,2130706432,76112,120976,562240,35712,2130706432,120992,562256,35728,2130706432,121008
.long 562336,35744,80640,121024,562352,35760,80656,121040,562304,35776,80672,2130706432,562320,35792,80688,2130706432
.long 562400,36864,80704,125568,562416,36880,80720,125584,562368,36896,81792,125600,562384,36912,81808,125616
.long 562464,36928,81824,125632,562480,36944,81840,125648,562432,34560,81856,126720,562448,34576,81872,126736
.long 571424,34592,79488,126752,571440,34608,79504,126768,571392,34624,79520,126784,571408,34640,79536,126800
.long 571488,2130706432,79552,124416,571504,2130706432,79568,124432,571456,39168,2130706432,124448,571472,39184,2130706432,124464
.long 571552,39200,2130706432,124480,571568,39216,2130706432,124496,571520,39232,84096,2130706432,571536,39248,84112,2130706432
.long 571616,40320,84128,129024,571632,40336,84144,129040,571584,40352,84160,129056,571600,40368,84176,129072
.long 571680,40384,85248,129088,571696,40400,85264,129104,571648,38016,85280,130176,571664,38032,85296,130192
.long 580640,38048,85312,130208,580656,38064,85328,130224,580608,38080,82944,130240,580624,38096,82960,130256
.long 580704,2130706432,82976,127872,580720,2130706432,82992,127888,580672,42624,83008,127904,580688,42640,83024,127920
.long 580768,42656,2130706432,127936,580784,42672,2130706432,127952,580736,42688,87552,2130706432,580752,42704,87568,2130706432
.long 580832,43776,87584,132480,580848,43792,87600,132496,580800,43808,87616,132512,580816,43824,87632,132528
.long 580896,43840,88704,132544,580912,43856,88720,132560,580864,41472,88736,133632,580880,41488,88752,133648
.long 167040,207392,143552,13824,167056,207408,143824,13840,167072,207424,144096,13856,167088,207440,144368,13872
.long 167104,2130706432,144576,13888,167120,2130706432,144848,13904,168192,211968,145120,13920,168208,211984,145392,13936
.long 168224,212000,145600,13824,168240,212016,145872,13840,168256,212032,146144,13856,168272,212048,146416,13872
.long 165888,213120,146624,13888,165904,213136,146896,13904,165920,213152,147168,13920,165936,213168,147440,13936
.long 165952,213184,143568,14976,165968,213200,143808,14992,2130706432,210816,144112,15008,2130706432,210832,144352,15024
.long 170496,210848,144592,15040,170512,210864,144832,15056,170528,210880,145136,15072,170544,210896,145376,15088
.long 170560,2130706432,145616,14976,170576,2130706432,145856,14992,171648,215424,146160,15008,171664,215440,146400,15024
.long 171680,215456,146640,15040,171696,215472,146880,15056,171712,215488,147184,15072,171728,215504,147424,15088
.long 169344,216576,143584,16128,169360,216592,143856,16144,169376,216608,144064,16160,169392,216624,144336,16176
.long 169408,216640,144608,16192,169424,216656,144880,16208,2130706432,214272,145088,16224,2130706432,214288,145360,16240
.long 173952,214304,145632,16128,173968,214320,145904,16144,173984,214336,146112,16160,174000,214352,146384,16176
.long 174016,2130706432,146656,16192,174032,2130706432,146928,16208,175104,218880,147136,16224,175120,218896,147408,16240
.long 175136,218912,143600,17280,175152,218928,143840,17296,175168,218944,144080,17312,175184,218960,144320,17328
.long 172800,220032,144624,17344,172816,220048,144864,17360,172832,220064,145104,17376,172848,220080,145344,17392
.long 172864,220096,145648,17280,172880,220112,145888,17296,2130706432,217728,146128,17312,2130706432,217744,146368,17328
.long 177408,217760,146672,17344,177424,217776,146912,17360,177440,217792,147152,17376,177456,217808,147392,17392
.long 94464,106048,118688,0,94480,106064,118704,0,94496,103680,118720,0,94512,103696,118736,0
.long 94528,103712,119808,0,94544,103728,119824,0,95616,103744,119840,0,95632,103760,119856,0
.long 95648,108288,119872,0,95664,108304,119888,0,95680,108320,117504,0,95696,108336,117520,0
.long 93312,108352,117536,0,93328,108368,117552,0,93344,109440,117568,0,93360,109456,117584,0
.long 93376,109472,122112,0,93392,109488,122128,0,97920,109504,122144,0,97936,109520,122160,0
.long 97952,107136,122176,0,97968,107152,122192,0,97984,107168,123264,0,98000,107184,123280,0
.long 99072,107200,123296,0,99088,107216,123312,0,99104,111744,123328,0,99120,111760,123344,0
.long 99136,111776,120960,0,99152,111792,120976,0,96768,111808,120992,0,96784,111824,121008,0
.long 96800,112896,121024,0,96816,112912,121040,0,96832,112928,2130706432,0,96848,112944,2130706432,0
.long 101376,112960,2130706432,0,101392,112976,2130706432,0,101408,110592,2130706432,0,101424,110608,2130706432,0
.long 101440,110624,2130706432,0,101456,110640,2130706432,0,102528,110656,2130706432,0,102544,110672,2130706432,0
.long 102560,115200,2130706432,0,102576,115216,2130706432,0,102592,115232,2130706432,0,102608,115248,2130706432,0
.long 100224,115264,2130706432,0,100240,115280,2130706432,0,100256,116352,2130706432,0,100272,116368,2130706432,0
.long 100288,116384,2130706432,0,100304,116400,2130706432,0,104832,116416,2130706432,0,104848,116432,2130706432,0
.long 104864,114048,2130706432,0,104880,114064,2130706432,0,104896,114080,2130706432,0,104912,114096,2130706432,0
.long 105984,114112,2130706432,0,106000,114128,2130706432,0,106016,118656,2130706432,0,106032,118672,2130706432,0

.p2align 6
.amdhsa_kernel parallel_sum__sliding_local_dilated__mixer_gmlp__prompt_kernel
  .amdhsa_next_free_vgpr 256
  .amdhsa_next_free_sgpr 102
  .amdhsa_accum_offset 256
  .amdhsa_group_segment_fixed_size 0
  .amdhsa_kernarg_size 88
  .amdhsa_user_sgpr_count 2
  .amdhsa_user_sgpr_kernarg_segment_ptr 1
  .amdhsa_system_sgpr_workgroup_id_x 1
.end_amdhsa_kernel
```
